```python
import torch

def _softmax(x, axis=-1):
    return torch.softmax(x, dim=axis)
def _gelu(x):
    return torch.nn.functional.gelu(x, approximate="tanh")
def _silu(x):
    return torch.nn.functional.silu(x)
def _sigmoid(x):
    return torch.sigmoid(x)
def _layernorm(x, axis=-1, eps=1e-5):
    m = x.mean(dim=axis, keepdim=True)
    v = x.var(dim=axis, keepdim=True, unbiased=False)
    return (x - m) / torch.sqrt(v + eps)
def _scatter_add(tgt, idx, src, axis=0):
    return tgt.clone().index_add_(axis, idx, src)
def _segment_sum(src, seg, n):
    out = torch.zeros((n,) + src.shape[1:], dtype=src.dtype)
    return out.index_add_(0, seg, src)
def _pad(x, pw):
    flat = tuple(v for pair in reversed(pw) for v in pair)
    return torch.nn.functional.pad(x, flat)

kernel_name = 'concat_heads__mha_block_cached__gqa_block_cached__near_ridge'

def setup_inputs():

    _w = (lambda a: (lambda t: t.to(torch.bfloat16) if t.is_floating_point() else t)(torch.as_tensor(a)))
    def _A_setup():
        B, Sq, D = 8, 224, 512
        H, Sk, Dh = 32, 512, 128
        return {
            "x": _w((lambda *s: torch.randn(*s, dtype=torch.bfloat16) * 0.8)(B, Sq, D)),
            "k_cache": _w((lambda *s: torch.randn(*s, dtype=torch.bfloat16) * 0.8)(B, H, Sk, Dh)),
            "v_cache": _w((lambda *s: torch.randn(*s, dtype=torch.bfloat16) * 0.05)(B, H, Sk, Dh)),
            "wq": _w((lambda *s: torch.randn(*s, dtype=torch.bfloat16) * 0.8)(D, H * Dh) * (D ** -0.5)),
            "wo": _w((lambda *s: torch.randn(*s, dtype=torch.bfloat16) * 0.05)(H * Dh, D) * ((H * Dh) ** -0.5)),
        }
    _A_in = _A_setup()

    def _B_setup():
        B, Sq, D = 8, 224, 512
        Hq, Hkv, Sk, Dh = 32, 32, 512, 128
        assert Hq % Hkv == 0, (Hq, Hkv)
        return {
            "x": _w((lambda *s: torch.randn(*s, dtype=torch.bfloat16) * 0.8)(B, Sq, D)),
            "k_cache": _w((lambda *s: torch.randn(*s, dtype=torch.bfloat16) * 0.8)(B, Hkv, Sk, Dh)),
            "v_cache": _w((lambda *s: torch.randn(*s, dtype=torch.bfloat16) * 0.05)(B, Hkv, Sk, Dh)),
            "wq": _w((lambda *s: torch.randn(*s, dtype=torch.bfloat16) * 0.8)(D, Hq * Dh) * (D ** -0.5)),
            "wo": _w((lambda *s: torch.randn(*s, dtype=torch.bfloat16) * 0.05)(Hq * Dh, D) * ((Hq * Dh) ** -0.5)),
        }
    _B_in = _B_setup()

    return {
        "A_x": _A_in["x"],
        "A_k_cache": _A_in["k_cache"],
        "A_v_cache": _A_in["v_cache"],
        "A_wq": _A_in["wq"],
        "A_wo": _A_in["wo"],
        "B_x": _B_in["x"],
        "B_k_cache": _B_in["k_cache"],
        "B_v_cache": _B_in["v_cache"],
        "B_wq": _B_in["wq"],
        "B_wo": _B_in["wo"],
    }

def reference(A_x, A_k_cache, A_v_cache, A_wq, A_wo, B_x, B_k_cache, B_v_cache, B_wq, B_wo):
    def _A_ref(x, k_cache, v_cache, wq, wo):
        B, Sq, D = x.shape
        H, Dh = 32, 128
        q = (lambda x, *d: x.permute(*d))((x @ wq).reshape(B, Sq, H, Dh), 0, 2, 1, 3)
        scores = torch.einsum("bhqd,bhkd->bhqk", q, k_cache) * (Dh ** -0.5)
        p = _softmax(scores, axis=-1)
        o = torch.einsum("bhqk,bhkd->bhqd", p, v_cache)
        return (lambda x, *d: x.permute(*d))(o, 0, 2, 1, 3).reshape(B, Sq, H * Dh) @ wo

    def _B_ref(x, k_cache, v_cache, wq, wo):
        B, Sq, D = x.shape
        Hq, Dh = 32, 128
        Hkv = k_cache.shape[1]
        rep = Hq // Hkv
        q = (lambda x, *d: x.permute(*d))((x @ wq).reshape(B, Sq, Hq, Dh), 0, 2, 1, 3)
        k = (lambda x, n, axis: torch.repeat_interleave(x, n, dim=axis))(k_cache, rep, axis=1)
        v = (lambda x, n, axis: torch.repeat_interleave(x, n, dim=axis))(v_cache, rep, axis=1)
        scores = torch.einsum("bhqd,bhkd->bhqk", q, k) * (Dh ** -0.5)
        p = _softmax(scores, axis=-1)
        o = torch.einsum("bhqk,bhkd->bhqd", p, v)
        return (lambda x, *d: x.permute(*d))(o, 0, 2, 1, 3).reshape(B, Sq, Hq * Dh) @ wo

    a = _A_ref(A_x, A_k_cache, A_v_cache, A_wq, A_wo)
    b = _B_ref(B_x, B_k_cache, B_v_cache, B_wq, B_wo)
    return torch.concatenate([a, b], axis=-1)
```

```asm
; @launch grid=(256,1,1) block=(512,1,1) lds=163840
.amdgcn_target "amdgcn-amd-amdhsa--gfx950"
.text
.globl concat_heads__mha_block_cached__gqa_block_cached__near_ridge_kernel
.p2align 8
.type concat_heads__mha_block_cached__gqa_block_cached__near_ridge_kernel,@function
concat_heads__mha_block_cached__gqa_block_cached__near_ridge_kernel:
    s_cmp_ge_u32 s2, 256
    s_cbranch_scc1 L_k1_end
    s_load_dwordx2 s[4:5], s[0:1], 0
    s_load_dwordx2 s[8:9], s[0:1], 24
    s_load_dwordx2 s[6:7], s[0:1], 40
    s_load_dwordx2 s[10:11], s[0:1], 64
    s_load_dwordx4 s[12:15], s[0:1], 8
    s_load_dwordx4 s[16:19], s[0:1], 48
    s_load_dwordx2 s[48:49], s[0:1], 32
    s_load_dwordx2 s[50:51], s[0:1], 72
    s_load_dwordx4 s[44:47], s[0:1], 88
    s_load_dwordx2 s[66:67], s[0:1], 80
    v_lshrrev_b32 v240, 6, v0
    v_and_b32 v241, 63, v0
    s_nop 0
    v_readfirstlane_b32 s3, v240
    s_cmp_ge_u32 s2, 16
    s_cbranch_scc1 L_nocw
    s_getpc_b64 s[20:21]
    s_and_b32 s20, s20, 0xffffff00
    s_mov_b32 s22, CODE_END - concat_heads__mha_block_cached__gqa_block_cached__near_ridge_kernel
    s_mov_b32 s23, 0x00020000
    v_lshlrev_b32 v239, 7, v0
    buffer_load_dword v238, v239, s[20:23], 0 offen
L_nocw:
    s_mov_b32 s31, s2
    s_and_b32 s77, s2, 0x1c
    s_bfe_u32 s78, s2, 0x20005
    s_or_b32 s77, s77, s78
    s_lshr_b32 s78, s2, 7
    s_lshl_b32 s78, s78, 5
    s_or_b32 s77, s77, s78
    s_and_b32 s78, s2, 3
    s_lshl_b32 s78, s78, 6
    s_or_b32 s2, s77, s78
    s_and_b32 s77, s2, 7
    s_lshr_b32 s78, s2, 3
    s_and_b32 s71, s77, 3
    s_and_b32 s72, s78, 3
    s_lshr_b32 s78, s78, 2
    s_lshr_b32 s77, s77, 2
    s_lshl_b32 s79, s71, 2
    s_add_u32 s79, s79, s72
    s_add_u32 s69, s78, s79
    s_and_b32 s69, s69, 0
    s_lshr_b32 s70, s79, 1
    s_and_b32 s70, s70, 7
    s_lshr_b32 s34, s3, 1
    s_and_b32 s34, s34, 1
    s_and_b32 s65, s3, 1
    s_lshl_b32 s64, s34, 13
    s_lshl_b32 s32, s3, 10
    s_lshr_b32 s23, s3, 2
    s_lshl_b32 s22, s23, 1
    s_add_u32 s22, s22, s65
    s_lshl_b32 s33, s22, 11
    s_add_u32 s33, s33, s64
    s_lshl_b32 s22, s22, 16
    s_lshl_b32 s21, s34, 8
    s_add_u32 s22, s22, s21
    s_lshl_b32 s21, s65, 1
    s_lshl_b32 s20, s3, 13
    v_and_b32 v242, 3, v241
    v_bfe_u32 v243, v241, 2, 2
    v_lshrrev_b32 v244, 4, v241
    v_xor_b32 v237, s21, v242
    v_bfe_u32 v236, v241, 2, 3
    v_lshlrev_b32 v230, 10, v236
    v_lshrrev_b32 v236, 5, v241
    v_lshl_add_u32 v230, v236, 6, v230
    v_lshl_add_u32 v230, v237, 4, v230
    v_add_u32 v230, s20, v230
    v_lshlrev_b32 v231, 13, v243
    v_lshl_add_u32 v231, v244, 6, v231
    v_lshl_add_u32 v231, v237, 4, v231
    v_add_u32 v231, s22, v231
    s_mul_i32 s22, s78, 229376
    s_lshl_b32 s23, s79, 9
    s_waitcnt lgkmcnt(0)
    s_cmp_eq_u32 s77, 0
    s_cselect_b32 s4, s4, s6
    s_cselect_b32 s5, s5, s7
    s_cselect_b32 s8, s8, s10
    s_cselect_b32 s9, s9, s11
    s_add_u32 s4, s4, s22
    s_addc_u32 s5, s5, 0
    s_mov_b32 s6, 229376
    s_mov_b32 s7, 0x00020000
    s_add_u32 s8, s8, s23
    s_addc_u32 s9, s9, 0
    s_sub_u32 s10, 4194304, s23
    s_mov_b32 s11, 0x00020000
    s_add_u32 m0, s32, 98304
    s_add_u32 s20, s70, 0
    s_and_b32 s20, s20, 7
    s_xor_b32 s20, s20, s69
    s_lshl_b32 s20, s20, 7
    buffer_load_dwordx4 v230, s[4:7], s20 offen lds
    s_add_u32 m0, s32, 106496
    s_add_u32 s20, s20, 65536
    buffer_load_dwordx4 v230, s[4:7], s20 offen lds
    s_add_u32 m0, s32, 114688
    s_add_u32 s20, s20, 65536
    buffer_load_dwordx4 v230, s[4:7], s20 offen lds
    s_add_u32 m0, s32, 122880
    s_add_u32 s20, s20, 65536
    buffer_load_dwordx4 v230, s[4:7], s20 offen lds
    s_add_u32 m0, s33, 16384
    s_add_u32 s21, s70, 0
    s_and_b32 s21, s21, 7
    s_xor_b32 s21, s21, s69
    s_lshl_b32 s21, s21, 19
    buffer_load_dwordx4 v231, s[8:11], s21 offen lds
    s_add_u32 m0, s33, 17408
    s_add_u32 s21, s21, 32768
    buffer_load_dwordx4 v231, s[8:11], s21 offen lds
    s_add_u32 m0, s33, 32768
    s_add_u32 s21, s70, 0
    s_and_b32 s21, s21, 7
    s_xor_b32 s21, s21, s69
    s_lshl_b32 s21, s21, 19
    s_add_u32 s21, s21, 262144
    buffer_load_dwordx4 v231, s[8:11], s21 offen lds
    s_add_u32 m0, s33, 33792
    s_add_u32 s21, s21, 32768
    buffer_load_dwordx4 v231, s[8:11], s21 offen lds
    s_cmp_eq_u32 s77, 0
    s_cselect_b32 s12, s12, s16
    s_cselect_b32 s13, s13, s17
    s_cselect_b32 s16, s14, s18
    s_cselect_b32 s17, s15, s19
    s_cselect_b32 s48, s48, s50
    s_cselect_b32 s49, s49, s51
    s_lshl_b32 s22, s78, 5
    s_lshl_b32 s23, s79, 1
    s_add_u32 s23, s23, s34
    s_add_u32 s22, s22, s23
    s_lshl_b32 s22, s22, 17
    s_and_b32 s22, s22, -1
    s_add_u32 s12, s12, s22
    s_addc_u32 s13, s13, 0
    s_mov_b32 s14, 131072
    s_mov_b32 s15, 0x00020000
    s_and_b32 s23, s3, 3
    s_cmp_ge_u32 s23, 9
    s_cselect_b32 s22, 0, s22
    s_add_u32 s16, s16, s22
    s_addc_u32 s17, s17, 0
    s_mov_b32 s18, 131072
    s_mov_b32 s19, 0x00020000
    s_mov_b32 s40, s46
    s_mov_b32 s41, s47
    s_mov_b32 s42, 67108864
    s_mov_b32 s43, 0x00020000
    s_mov_b32 s46, 256
    s_mov_b32 s47, 0x00020000
    s_mul_i32 s35, s65, 112
    s_lshr_b32 s22, s3, 2
    s_lshl_b32 s22, s22, 6
    s_add_u32 s35, s35, s22
    s_mov_b32 s30, 0x3e0293ee
    s_lshl_b32 s22, s71, 20
    s_add_u32 s48, s48, s22
    s_addc_u32 s49, s49, 0
    s_lshr_b32 s22, s2, 3
    s_lshl_b32 s22, s22, 2
    s_and_b32 s23, s3, 3
    s_add_u32 s22, s22, s23
    s_lshl_b32 s22, s22, 13
    s_add_u32 s50, s48, s22
    s_addc_u32 s51, s49, 0
    s_lshl_b32 s22, s34, 17
    s_lshl_b32 s23, s72, 8
    s_add_u32 s22, s22, s23
    s_add_u32 s48, s48, s22
    s_addc_u32 s49, s49, 0
    s_lshl_b32 s20, s77, 3
    s_add_u32 s20, s20, s78
    s_lshl_b32 s20, s20, 2
    s_add_u32 s20, s20, s71
    s_mul_i32 s22, s20, 229376
    s_and_b32 s23, s3, 3
    s_mul_i32 s23, s23, 14336
    s_add_u32 s22, s22, s23
    s_lshr_b32 s23, s3, 2
    s_lshl_b32 s23, s23, 13
    s_add_u32 s22, s22, s23
    s_add_u32 s23, s72, 0
    s_and_b32 s23, s23, 3
    s_lshl_b32 s56, s23, 18
    s_mul_i32 s23, s23, 57344
    s_add_u32 s52, s22, s23
    s_add_u32 s23, s72, 1
    s_and_b32 s23, s23, 3
    s_lshl_b32 s57, s23, 18
    s_mul_i32 s23, s23, 57344
    s_add_u32 s53, s22, s23
    s_add_u32 s23, s72, 2
    s_and_b32 s23, s23, 3
    s_lshl_b32 s58, s23, 18
    s_mul_i32 s23, s23, 57344
    s_add_u32 s54, s22, s23
    s_add_u32 s23, s72, 3
    s_and_b32 s23, s23, 3
    s_lshl_b32 s59, s23, 18
    s_mul_i32 s23, s23, 57344
    s_add_u32 s55, s22, s23
    s_andn2_b32 s71, s20, 3
    s_lshl_b32 s22, s71, 1
    s_add_u32 s22, s22, s3
    s_lshl_b32 s22, s22, 7
    s_add_u32 s60, s22, 33554432
    s_lshl_b32 s72, s79, 3
    s_getreg_b32 s61, hwreg(HW_REG_XCC_ID)
    s_and_b32 s61, s61, 15
    s_or_b32 s22, s79, s3
    s_cmp_lg_u32 s22, 0
    s_cbranch_scc1 L_nolead
    s_memrealtime s[22:23]
    s_waitcnt lgkmcnt(0)
    s_or_b32 s22, s22, 64
    s_andn2_b32 s22, s22, 63
    v_mov_b32 v236, s22
    v_mov_b32 v235, 0
    s_mov_b64 exec, 1
    buffer_store_dword v236, v235, s[44:47], s71 offen sc1
    s_mov_b64 exec, -1
L_nolead:
    s_add_u32 s72, s72, s60
    s_lshr_b32 s24, s2, 3
    s_lshl_b32 s24, s24, 1
    s_add_u32 s24, s24, s34
    s_mul_i32 s24, s24, 5
    s_add_u32 s24, s24, s2
    s_and_b32 s24, s24, 15
    s_lshl_b32 s24, s24, 13
    s_mov_b32 s25, s24
    s_lshr_b32 s92, s3, 2
    s_lshl_b32 s92, s92, 1
    s_add_u32 s92, s92, s65
    s_mul_i32 s92, s92, 128
    s_add_u32 s92, s92, s24
    s_mov_b32 s38, 81920
    s_mov_b32 s68, 163840
    s_mov_b32 s63, 0
    v_bfe_u32 v236, v241, 3, 1
    v_lshlrev_b32 v224, 10, v236
    v_and_b32 v235, 7, v241
    v_lshl_add_u32 v224, v235, 6, v224
    v_lshlrev_b32 v235, 1, v236
    v_xor_b32 v235, v235, v244
    v_lshl_add_u32 v224, v235, 4, v224
    s_lshl_b32 s22, s35, 7
    s_add_u32 s22, s22, 98304
    v_add_u32 v224, s22, v224
    v_lshlrev_b32 v235, 6, v243
    v_and_b32 v240, 1, v244
    v_lshl_add_u32 v235, v240, 5, v235
    v_lshl_add_u32 v235, v242, 3, v235
    v_lshl_add_u32 v226, v244, 11, v235
    s_add_u32 s22, s64, 16384
    v_add_u32 v226, s22, v226
    v_xor_b32 v227, 32, v226
    v_lshl_add_u32 v253, v244, 10, v235
    s_add_u32 s22, s64, 81920
    v_add_u32 v253, s22, v253
    v_xor_b32 v254, 32, v253
    v_lshlrev_b32 v252, 10, v243
    v_lshl_add_u32 v252, v242, 6, v252
    v_lshrrev_b32 v235, 1, v244
    v_lshl_add_u32 v235, v240, 1, v235
    v_xor_b32 v235, v235, v236
    v_lshl_add_u32 v252, v235, 4, v252
    v_add_u32 v252, s64, v252
    s_cmp_ge_u32 s3, 4
    s_cbranch_scc1 L_role_Y
    s_lshl_b32 s75, s3, 14
    s_xor_b32 s76, s75, 0x8000
    s_and_b32 s22, s79, 3
    s_lshl_b32 s22, s22, 2
    s_add_u32 s22, s22, s3
    s_mul_i32 s22, s22, 14
    v_add_u32 v232, s22, v241
    v_lshlrev_b32 v232, 10, v232
    v_cmp_gt_u32 vcc, 14, v241
    v_mov_b32 v235, 0x40000000
    s_nop 0
    v_cndmask_b32 v232, v235, v232, vcc
    s_waitcnt vmcnt(2)
    s_barrier
    ds_read_b128 v[192:195], v224 offset:0
    ds_read_b128 v[196:199], v224 offset:2048
    ds_read_b128 v[200:203], v224 offset:4096
    ds_read_b128 v[204:207], v224 offset:6144
    ds_read_b64_tr_b16 v[128:129], v226 offset:0
    ds_read_b64_tr_b16 v[130:131], v226 offset:1024
    ds_read_b64_tr_b16 v[132:133], v227 offset:0
    ds_read_b64_tr_b16 v[134:135], v227 offset:1024
    ds_read_b64_tr_b16 v[136:137], v226 offset:256
    ds_read_b64_tr_b16 v[138:139], v226 offset:1280
    ds_read_b64_tr_b16 v[140:141], v227 offset:256
    ds_read_b64_tr_b16 v[142:143], v227 offset:1280
    ds_read_b64_tr_b16 v[144:145], v226 offset:512
    ds_read_b64_tr_b16 v[146:147], v226 offset:1536
    ds_read_b64_tr_b16 v[148:149], v227 offset:512
    ds_read_b64_tr_b16 v[150:151], v227 offset:1536
    ds_read_b64_tr_b16 v[152:153], v226 offset:768
    ds_read_b64_tr_b16 v[154:155], v226 offset:1792
    ds_read_b64_tr_b16 v[156:157], v227 offset:768
    ds_read_b64_tr_b16 v[158:159], v227 offset:1792
    s_add_u32 m0, s32, 131072
    s_add_u32 s20, s70, 1
    s_and_b32 s20, s20, 7
    s_xor_b32 s20, s20, s69
    s_lshl_b32 s20, s20, 7
    buffer_load_dwordx4 v230, s[4:7], s20 offen lds
    s_add_u32 m0, s32, 139264
    s_add_u32 s20, s20, 65536
    buffer_load_dwordx4 v230, s[4:7], s20 offen lds
    s_add_u32 m0, s32, 147456
    s_add_u32 s20, s20, 65536
    buffer_load_dwordx4 v230, s[4:7], s20 offen lds
    s_add_u32 m0, s32, 155648
    s_add_u32 s20, s20, 65536
    buffer_load_dwordx4 v230, s[4:7], s20 offen lds
    s_add_u32 m0, s33, 49152
    s_add_u32 s21, s70, 1
    s_and_b32 s21, s21, 7
    s_xor_b32 s21, s21, s69
    s_lshl_b32 s21, s21, 19
    buffer_load_dwordx4 v231, s[8:11], s21 offen lds
    s_add_u32 m0, s33, 50176
    s_add_u32 s21, s21, 32768
    buffer_load_dwordx4 v231, s[8:11], s21 offen lds
    s_waitcnt vmcnt(6) lgkmcnt(0)
    s_barrier
    v_mfma_f32_16x16x32_bf16 v[0:3], v[128:131], v[192:195], 0
    ds_read_b128 v[208:211], v224 offset:512
    v_mfma_f32_16x16x32_bf16 v[4:7], v[128:131], v[196:199], 0
    ds_read_b128 v[212:215], v224 offset:2560
    s_add_u32 m0, s33, 65536
    s_add_u32 s21, s70, 1
    s_and_b32 s21, s21, 7
    s_xor_b32 s21, s21, s69
    s_lshl_b32 s21, s21, 19
    s_add_u32 s21, s21, 262144
    buffer_load_dwordx4 v231, s[8:11], s21 offen lds
    v_mfma_f32_16x16x32_bf16 v[8:11], v[128:131], v[200:203], 0
    ds_read_b128 v[216:219], v224 offset:4608
    v_mfma_f32_16x16x32_bf16 v[12:15], v[128:131], v[204:207], 0
    ds_read_b128 v[220:223], v224 offset:6656
    s_add_u32 m0, s33, 66560
    s_add_u32 s21, s21, 32768
    buffer_load_dwordx4 v231, s[8:11], s21 offen lds
    v_mfma_f32_16x16x32_bf16 v[28:31], v[132:135], v[204:207], 0
    ds_read_b64_tr_b16 v[160:161], v226 offset:16384
    v_mfma_f32_16x16x32_bf16 v[24:27], v[132:135], v[200:203], 0
    ds_read_b64_tr_b16 v[162:163], v226 offset:17408
    s_add_u32 m0, s33, 16384
    s_add_u32 s21, s70, 2
    s_and_b32 s21, s21, 7
    s_xor_b32 s21, s21, s69
    s_lshl_b32 s21, s21, 19
    buffer_load_dwordx4 v231, s[8:11], s21 offen lds
    v_mfma_f32_16x16x32_bf16 v[20:23], v[132:135], v[196:199], 0
    ds_read_b64_tr_b16 v[164:165], v227 offset:16384
    v_mfma_f32_16x16x32_bf16 v[16:19], v[132:135], v[192:195], 0
    ds_read_b64_tr_b16 v[166:167], v227 offset:17408
    s_add_u32 m0, s33, 17408
    s_add_u32 s21, s21, 32768
    buffer_load_dwordx4 v231, s[8:11], s21 offen lds
    v_mfma_f32_16x16x32_bf16 v[32:35], v[136:139], v[192:195], 0
    ds_read_b64_tr_b16 v[168:169], v226 offset:16640
    v_mfma_f32_16x16x32_bf16 v[36:39], v[136:139], v[196:199], 0
    ds_read_b64_tr_b16 v[170:171], v226 offset:17664
    v_mfma_f32_16x16x32_bf16 v[40:43], v[136:139], v[200:203], 0
    ds_read_b64_tr_b16 v[172:173], v227 offset:16640
    v_mfma_f32_16x16x32_bf16 v[44:47], v[136:139], v[204:207], 0
    ds_read_b64_tr_b16 v[174:175], v227 offset:17664
    v_mfma_f32_16x16x32_bf16 v[60:63], v[140:143], v[204:207], 0
    ds_read_b64_tr_b16 v[176:177], v226 offset:16896
    v_mfma_f32_16x16x32_bf16 v[56:59], v[140:143], v[200:203], 0
    ds_read_b64_tr_b16 v[178:179], v226 offset:17920
    v_mfma_f32_16x16x32_bf16 v[52:55], v[140:143], v[196:199], 0
    ds_read_b64_tr_b16 v[180:181], v227 offset:16896
    v_mfma_f32_16x16x32_bf16 v[48:51], v[140:143], v[192:195], 0
    ds_read_b64_tr_b16 v[182:183], v227 offset:17920
    v_mfma_f32_16x16x32_bf16 v[64:67], v[144:147], v[192:195], 0
    ds_read_b64_tr_b16 v[184:185], v226 offset:17152
    v_mfma_f32_16x16x32_bf16 v[68:71], v[144:147], v[196:199], 0
    ds_read_b64_tr_b16 v[186:187], v226 offset:18176
    v_mfma_f32_16x16x32_bf16 v[72:75], v[144:147], v[200:203], 0
    ds_read_b64_tr_b16 v[188:189], v227 offset:17152
    v_mfma_f32_16x16x32_bf16 v[76:79], v[144:147], v[204:207], 0
    ds_read_b64_tr_b16 v[190:191], v227 offset:18176
    v_mfma_f32_16x16x32_bf16 v[92:95], v[148:151], v[204:207], 0
    v_mfma_f32_16x16x32_bf16 v[88:91], v[148:151], v[200:203], 0
    v_mfma_f32_16x16x32_bf16 v[84:87], v[148:151], v[196:199], 0
    v_mfma_f32_16x16x32_bf16 v[80:83], v[148:151], v[192:195], 0
    v_mfma_f32_16x16x32_bf16 v[96:99], v[152:155], v[192:195], 0
    v_mfma_f32_16x16x32_bf16 v[100:103], v[152:155], v[196:199], 0
    v_mfma_f32_16x16x32_bf16 v[104:107], v[152:155], v[200:203], 0
    v_mfma_f32_16x16x32_bf16 v[108:111], v[152:155], v[204:207], 0
    s_waitcnt vmcnt(4) lgkmcnt(0)
    s_barrier
    v_mfma_f32_16x16x32_bf16 v[124:127], v[156:159], v[204:207], 0
    v_mfma_f32_16x16x32_bf16 v[120:123], v[156:159], v[200:203], 0
    v_mfma_f32_16x16x32_bf16 v[116:119], v[156:159], v[196:199], 0
    v_mfma_f32_16x16x32_bf16 v[112:115], v[156:159], v[192:195], 0
    v_mfma_f32_16x16x32_bf16 v[0:3], v[160:163], v[208:211], v[0:3]
    ds_read_b128 v[192:195], v224 offset:32768
    v_mfma_f32_16x16x32_bf16 v[4:7], v[160:163], v[212:215], v[4:7]
    ds_read_b128 v[196:199], v224 offset:34816
    s_add_u32 m0, s32, 98304
    s_add_u32 s20, s70, 2
    s_and_b32 s20, s20, 7
    s_xor_b32 s20, s20, s69
    s_lshl_b32 s20, s20, 7
    buffer_load_dwordx4 v230, s[4:7], s20 offen lds
    v_mfma_f32_16x16x32_bf16 v[8:11], v[160:163], v[216:219], v[8:11]
    ds_read_b128 v[200:203], v224 offset:36864
    v_mfma_f32_16x16x32_bf16 v[12:15], v[160:163], v[220:223], v[12:15]
    ds_read_b128 v[204:207], v224 offset:38912
    s_add_u32 m0, s32, 106496
    s_add_u32 s20, s20, 65536
    buffer_load_dwordx4 v230, s[4:7], s20 offen lds
    v_mfma_f32_16x16x32_bf16 v[28:31], v[164:167], v[220:223], v[28:31]
    ds_read_b64_tr_b16 v[128:129], v226 offset:32768
    v_mfma_f32_16x16x32_bf16 v[24:27], v[164:167], v[216:219], v[24:27]
    ds_read_b64_tr_b16 v[130:131], v226 offset:33792
    s_add_u32 m0, s32, 114688
    s_add_u32 s20, s20, 65536
    buffer_load_dwordx4 v230, s[4:7], s20 offen lds
    v_mfma_f32_16x16x32_bf16 v[20:23], v[164:167], v[212:215], v[20:23]
    ds_read_b64_tr_b16 v[132:133], v227 offset:32768
    v_mfma_f32_16x16x32_bf16 v[16:19], v[164:167], v[208:211], v[16:19]
    ds_read_b64_tr_b16 v[134:135], v227 offset:33792
    s_add_u32 m0, s32, 122880
    s_add_u32 s20, s20, 65536
    buffer_load_dwordx4 v230, s[4:7], s20 offen lds
    v_mfma_f32_16x16x32_bf16 v[32:35], v[168:171], v[208:211], v[32:35]
    ds_read_b64_tr_b16 v[136:137], v226 offset:33024
    v_mfma_f32_16x16x32_bf16 v[36:39], v[168:171], v[212:215], v[36:39]
    ds_read_b64_tr_b16 v[138:139], v226 offset:34048
    v_mfma_f32_16x16x32_bf16 v[40:43], v[168:171], v[216:219], v[40:43]
    ds_read_b64_tr_b16 v[140:141], v227 offset:33024
    v_mfma_f32_16x16x32_bf16 v[44:47], v[168:171], v[220:223], v[44:47]
    ds_read_b64_tr_b16 v[142:143], v227 offset:34048
    v_mfma_f32_16x16x32_bf16 v[60:63], v[172:175], v[220:223], v[60:63]
    ds_read_b64_tr_b16 v[144:145], v226 offset:33280
    v_mfma_f32_16x16x32_bf16 v[56:59], v[172:175], v[216:219], v[56:59]
    ds_read_b64_tr_b16 v[146:147], v226 offset:34304
    v_mfma_f32_16x16x32_bf16 v[52:55], v[172:175], v[212:215], v[52:55]
    ds_read_b64_tr_b16 v[148:149], v227 offset:33280
    v_mfma_f32_16x16x32_bf16 v[48:51], v[172:175], v[208:211], v[48:51]
    ds_read_b64_tr_b16 v[150:151], v227 offset:34304
    v_mfma_f32_16x16x32_bf16 v[64:67], v[176:179], v[208:211], v[64:67]
    ds_read_b64_tr_b16 v[152:153], v226 offset:33536
    v_mfma_f32_16x16x32_bf16 v[68:71], v[176:179], v[212:215], v[68:71]
    ds_read_b64_tr_b16 v[154:155], v226 offset:34560
    v_mfma_f32_16x16x32_bf16 v[72:75], v[176:179], v[216:219], v[72:75]
    ds_read_b64_tr_b16 v[156:157], v227 offset:33536
    v_mfma_f32_16x16x32_bf16 v[76:79], v[176:179], v[220:223], v[76:79]
    ds_read_b64_tr_b16 v[158:159], v227 offset:34560
    v_mfma_f32_16x16x32_bf16 v[92:95], v[180:183], v[220:223], v[92:95]
    v_mfma_f32_16x16x32_bf16 v[88:91], v[180:183], v[216:219], v[88:91]
    v_mfma_f32_16x16x32_bf16 v[84:87], v[180:183], v[212:215], v[84:87]
    v_mfma_f32_16x16x32_bf16 v[80:83], v[180:183], v[208:211], v[80:83]
    v_mfma_f32_16x16x32_bf16 v[96:99], v[184:187], v[208:211], v[96:99]
    v_mfma_f32_16x16x32_bf16 v[100:103], v[184:187], v[212:215], v[100:103]
    v_mfma_f32_16x16x32_bf16 v[104:107], v[184:187], v[216:219], v[104:107]
    v_mfma_f32_16x16x32_bf16 v[108:111], v[184:187], v[220:223], v[108:111]
    s_waitcnt vmcnt(6) lgkmcnt(0)
    s_barrier
    v_mfma_f32_16x16x32_bf16 v[124:127], v[188:191], v[220:223], v[124:127]
    v_mfma_f32_16x16x32_bf16 v[120:123], v[188:191], v[216:219], v[120:123]
    v_mfma_f32_16x16x32_bf16 v[116:119], v[188:191], v[212:215], v[116:119]
    v_mfma_f32_16x16x32_bf16 v[112:115], v[188:191], v[208:211], v[112:115]
    v_mfma_f32_16x16x32_bf16 v[0:3], v[128:131], v[192:195], v[0:3]
    ds_read_b128 v[208:211], v224 offset:33280
    v_mfma_f32_16x16x32_bf16 v[4:7], v[128:131], v[196:199], v[4:7]
    ds_read_b128 v[212:215], v224 offset:35328
    v_mov_b32 v236, 0
    buffer_load_dword v237, v236, s[44:47], s71 offen sc1
    v_mfma_f32_16x16x32_bf16 v[8:11], v[128:131], v[200:203], v[8:11]
    ds_read_b128 v[216:219], v224 offset:37376
    v_mfma_f32_16x16x32_bf16 v[12:15], v[128:131], v[204:207], v[12:15]
    ds_read_b128 v[220:223], v224 offset:39424
    s_add_u32 m0, s33, 32768
    s_add_u32 s21, s70, 2
    s_and_b32 s21, s21, 7
    s_xor_b32 s21, s21, s69
    s_lshl_b32 s21, s21, 19
    s_add_u32 s21, s21, 262144
    buffer_load_dwordx4 v231, s[8:11], s21 offen lds
    v_mfma_f32_16x16x32_bf16 v[28:31], v[132:135], v[204:207], v[28:31]
    ds_read_b64_tr_b16 v[160:161], v226 offset:49152
    v_mfma_f32_16x16x32_bf16 v[24:27], v[132:135], v[200:203], v[24:27]
    ds_read_b64_tr_b16 v[162:163], v226 offset:50176
    s_add_u32 m0, s33, 33792
    s_add_u32 s21, s21, 32768
    buffer_load_dwordx4 v231, s[8:11], s21 offen lds
    v_mfma_f32_16x16x32_bf16 v[20:23], v[132:135], v[196:199], v[20:23]
    ds_read_b64_tr_b16 v[164:165], v227 offset:49152
    v_mfma_f32_16x16x32_bf16 v[16:19], v[132:135], v[192:195], v[16:19]
    ds_read_b64_tr_b16 v[166:167], v227 offset:50176
    s_add_u32 m0, s33, 49152
    s_add_u32 s21, s70, 3
    s_and_b32 s21, s21, 7
    s_xor_b32 s21, s21, s69
    s_lshl_b32 s21, s21, 19
    buffer_load_dwordx4 v231, s[8:11], s21 offen lds
    v_mfma_f32_16x16x32_bf16 v[32:35], v[136:139], v[192:195], v[32:35]
    ds_read_b64_tr_b16 v[168:169], v226 offset:49408
    v_mfma_f32_16x16x32_bf16 v[36:39], v[136:139], v[196:199], v[36:39]
    ds_read_b64_tr_b16 v[170:171], v226 offset:50432
    s_add_u32 m0, s33, 50176
    s_add_u32 s21, s21, 32768
    buffer_load_dwordx4 v231, s[8:11], s21 offen lds
    v_mfma_f32_16x16x32_bf16 v[40:43], v[136:139], v[200:203], v[40:43]
    ds_read_b64_tr_b16 v[172:173], v227 offset:49408
    v_mfma_f32_16x16x32_bf16 v[44:47], v[136:139], v[204:207], v[44:47]
    ds_read_b64_tr_b16 v[174:175], v227 offset:50432
    v_mfma_f32_16x16x32_bf16 v[60:63], v[140:143], v[204:207], v[60:63]
    ds_read_b64_tr_b16 v[176:177], v226 offset:49664
    v_mfma_f32_16x16x32_bf16 v[56:59], v[140:143], v[200:203], v[56:59]
    ds_read_b64_tr_b16 v[178:179], v226 offset:50688
    v_mfma_f32_16x16x32_bf16 v[52:55], v[140:143], v[196:199], v[52:55]
    ds_read_b64_tr_b16 v[180:181], v227 offset:49664
    v_mfma_f32_16x16x32_bf16 v[48:51], v[140:143], v[192:195], v[48:51]
    ds_read_b64_tr_b16 v[182:183], v227 offset:50688
    v_mfma_f32_16x16x32_bf16 v[64:67], v[144:147], v[192:195], v[64:67]
    ds_read_b64_tr_b16 v[184:185], v226 offset:49920
    v_mfma_f32_16x16x32_bf16 v[68:71], v[144:147], v[196:199], v[68:71]
    ds_read_b64_tr_b16 v[186:187], v226 offset:50944
    v_mfma_f32_16x16x32_bf16 v[72:75], v[144:147], v[200:203], v[72:75]
    ds_read_b64_tr_b16 v[188:189], v227 offset:49920
    v_mfma_f32_16x16x32_bf16 v[76:79], v[144:147], v[204:207], v[76:79]
    ds_read_b64_tr_b16 v[190:191], v227 offset:50944
    v_mfma_f32_16x16x32_bf16 v[92:95], v[148:151], v[204:207], v[92:95]
    v_mfma_f32_16x16x32_bf16 v[88:91], v[148:151], v[200:203], v[88:91]
    v_mfma_f32_16x16x32_bf16 v[84:87], v[148:151], v[196:199], v[84:87]
    v_mfma_f32_16x16x32_bf16 v[80:83], v[148:151], v[192:195], v[80:83]
    v_mfma_f32_16x16x32_bf16 v[96:99], v[152:155], v[192:195], v[96:99]
    v_mfma_f32_16x16x32_bf16 v[100:103], v[152:155], v[196:199], v[100:103]
    v_mfma_f32_16x16x32_bf16 v[104:107], v[152:155], v[200:203], v[104:107]
    v_mfma_f32_16x16x32_bf16 v[108:111], v[152:155], v[204:207], v[108:111]
    s_waitcnt vmcnt(5) lgkmcnt(0)
    s_barrier
    v_mfma_f32_16x16x32_bf16 v[124:127], v[156:159], v[204:207], v[124:127]
    v_mfma_f32_16x16x32_bf16 v[120:123], v[156:159], v[200:203], v[120:123]
    v_mfma_f32_16x16x32_bf16 v[116:119], v[156:159], v[196:199], v[116:119]
    v_mfma_f32_16x16x32_bf16 v[112:115], v[156:159], v[192:195], v[112:115]
    v_mfma_f32_16x16x32_bf16 v[0:3], v[160:163], v[208:211], v[0:3]
    ds_read_b128 v[192:195], v224 offset:0
    v_mfma_f32_16x16x32_bf16 v[4:7], v[160:163], v[212:215], v[4:7]
    ds_read_b128 v[196:199], v224 offset:2048
    s_add_u32 m0, s32, 131072
    s_add_u32 s20, s70, 3
    s_and_b32 s20, s20, 7
    s_xor_b32 s20, s20, s69
    s_lshl_b32 s20, s20, 7
    buffer_load_dwordx4 v230, s[4:7], s20 offen lds
    v_mfma_f32_16x16x32_bf16 v[8:11], v[160:163], v[216:219], v[8:11]
    ds_read_b128 v[200:203], v224 offset:4096
    v_mfma_f32_16x16x32_bf16 v[12:15], v[160:163], v[220:223], v[12:15]
    ds_read_b128 v[204:207], v224 offset:6144
    s_add_u32 m0, s32, 139264
    s_add_u32 s20, s20, 65536
    buffer_load_dwordx4 v230, s[4:7], s20 offen lds
    v_mfma_f32_16x16x32_bf16 v[28:31], v[164:167], v[220:223], v[28:31]
    ds_read_b64_tr_b16 v[128:129], v226 offset:0
    v_mfma_f32_16x16x32_bf16 v[24:27], v[164:167], v[216:219], v[24:27]
    ds_read_b64_tr_b16 v[130:131], v226 offset:1024
    s_add_u32 m0, s32, 147456
    s_add_u32 s20, s20, 65536
    buffer_load_dwordx4 v230, s[4:7], s20 offen lds
    v_mfma_f32_16x16x32_bf16 v[20:23], v[164:167], v[212:215], v[20:23]
    ds_read_b64_tr_b16 v[132:133], v227 offset:0
    v_mfma_f32_16x16x32_bf16 v[16:19], v[164:167], v[208:211], v[16:19]
    ds_read_b64_tr_b16 v[134:135], v227 offset:1024
    s_add_u32 m0, s32, 155648
    s_add_u32 s20, s20, 65536
    buffer_load_dwordx4 v230, s[4:7], s20 offen lds
    v_mfma_f32_16x16x32_bf16 v[32:35], v[168:171], v[208:211], v[32:35]
    ds_read_b64_tr_b16 v[136:137], v226 offset:256
    v_mfma_f32_16x16x32_bf16 v[36:39], v[168:171], v[212:215], v[36:39]
    ds_read_b64_tr_b16 v[138:139], v226 offset:1280
    v_mfma_f32_16x16x32_bf16 v[40:43], v[168:171], v[216:219], v[40:43]
    ds_read_b64_tr_b16 v[140:141], v227 offset:256
    v_mfma_f32_16x16x32_bf16 v[44:47], v[168:171], v[220:223], v[44:47]
    ds_read_b64_tr_b16 v[142:143], v227 offset:1280
    v_mfma_f32_16x16x32_bf16 v[60:63], v[172:175], v[220:223], v[60:63]
    ds_read_b64_tr_b16 v[144:145], v226 offset:512
    v_mfma_f32_16x16x32_bf16 v[56:59], v[172:175], v[216:219], v[56:59]
    ds_read_b64_tr_b16 v[146:147], v226 offset:1536
    v_mfma_f32_16x16x32_bf16 v[52:55], v[172:175], v[212:215], v[52:55]
    ds_read_b64_tr_b16 v[148:149], v227 offset:512
    v_mfma_f32_16x16x32_bf16 v[48:51], v[172:175], v[208:211], v[48:51]
    ds_read_b64_tr_b16 v[150:151], v227 offset:1536
    v_mfma_f32_16x16x32_bf16 v[64:67], v[176:179], v[208:211], v[64:67]
    ds_read_b64_tr_b16 v[152:153], v226 offset:768
    v_mfma_f32_16x16x32_bf16 v[68:71], v[176:179], v[212:215], v[68:71]
    ds_read_b64_tr_b16 v[154:155], v226 offset:1792
    v_mfma_f32_16x16x32_bf16 v[72:75], v[176:179], v[216:219], v[72:75]
    ds_read_b64_tr_b16 v[156:157], v227 offset:768
    v_mfma_f32_16x16x32_bf16 v[76:79], v[176:179], v[220:223], v[76:79]
    ds_read_b64_tr_b16 v[158:159], v227 offset:1792
    v_mfma_f32_16x16x32_bf16 v[92:95], v[180:183], v[220:223], v[92:95]
    v_mfma_f32_16x16x32_bf16 v[88:91], v[180:183], v[216:219], v[88:91]
    v_mfma_f32_16x16x32_bf16 v[84:87], v[180:183], v[212:215], v[84:87]
    v_mfma_f32_16x16x32_bf16 v[80:83], v[180:183], v[208:211], v[80:83]
    v_mfma_f32_16x16x32_bf16 v[96:99], v[184:187], v[208:211], v[96:99]
    v_mfma_f32_16x16x32_bf16 v[100:103], v[184:187], v[212:215], v[100:103]
    v_mfma_f32_16x16x32_bf16 v[104:107], v[184:187], v[216:219], v[104:107]
    v_mfma_f32_16x16x32_bf16 v[108:111], v[184:187], v[220:223], v[108:111]
    s_waitcnt vmcnt(6) lgkmcnt(0)
    s_barrier
    v_mfma_f32_16x16x32_bf16 v[124:127], v[188:191], v[220:223], v[124:127]
    v_mfma_f32_16x16x32_bf16 v[120:123], v[188:191], v[216:219], v[120:123]
    v_mfma_f32_16x16x32_bf16 v[116:119], v[188:191], v[212:215], v[116:119]
    v_mfma_f32_16x16x32_bf16 v[112:115], v[188:191], v[208:211], v[112:115]
    v_mfma_f32_16x16x32_bf16 v[0:3], v[128:131], v[192:195], v[0:3]
    ds_read_b128 v[208:211], v224 offset:512
    v_mfma_f32_16x16x32_bf16 v[4:7], v[128:131], v[196:199], v[4:7]
    ds_read_b128 v[212:215], v224 offset:2560
    s_add_u32 m0, s33, 65536
    s_add_u32 s21, s70, 3
    s_and_b32 s21, s21, 7
    s_xor_b32 s21, s21, s69
    s_lshl_b32 s21, s21, 19
    s_add_u32 s21, s21, 262144
    buffer_load_dwordx4 v231, s[8:11], s21 offen lds
    v_mfma_f32_16x16x32_bf16 v[8:11], v[128:131], v[200:203], v[8:11]
    ds_read_b128 v[216:219], v224 offset:4608
    v_mfma_f32_16x16x32_bf16 v[12:15], v[128:131], v[204:207], v[12:15]
    ds_read_b128 v[220:223], v224 offset:6656
    s_add_u32 m0, s33, 66560
    s_add_u32 s21, s21, 32768
    buffer_load_dwordx4 v231, s[8:11], s21 offen lds
    v_mfma_f32_16x16x32_bf16 v[28:31], v[132:135], v[204:207], v[28:31]
    ds_read_b64_tr_b16 v[160:161], v226 offset:16384
    v_mfma_f32_16x16x32_bf16 v[24:27], v[132:135], v[200:203], v[24:27]
    ds_read_b64_tr_b16 v[162:163], v226 offset:17408
    s_add_u32 m0, s33, 16384
    s_add_u32 s21, s70, 4
    s_and_b32 s21, s21, 7
    s_xor_b32 s21, s21, s69
    s_lshl_b32 s21, s21, 19
    buffer_load_dwordx4 v231, s[8:11], s21 offen lds
    v_mfma_f32_16x16x32_bf16 v[20:23], v[132:135], v[196:199], v[20:23]
    ds_read_b64_tr_b16 v[164:165], v227 offset:16384
    v_mfma_f32_16x16x32_bf16 v[16:19], v[132:135], v[192:195], v[16:19]
    ds_read_b64_tr_b16 v[166:167], v227 offset:17408
    s_add_u32 m0, s33, 17408
    s_add_u32 s21, s21, 32768
    buffer_load_dwordx4 v231, s[8:11], s21 offen lds
    v_mfma_f32_16x16x32_bf16 v[32:35], v[136:139], v[192:195], v[32:35]
    ds_read_b64_tr_b16 v[168:169], v226 offset:16640
    v_mfma_f32_16x16x32_bf16 v[36:39], v[136:139], v[196:199], v[36:39]
    ds_read_b64_tr_b16 v[170:171], v226 offset:17664
    v_mfma_f32_16x16x32_bf16 v[40:43], v[136:139], v[200:203], v[40:43]
    ds_read_b64_tr_b16 v[172:173], v227 offset:16640
    v_mfma_f32_16x16x32_bf16 v[44:47], v[136:139], v[204:207], v[44:47]
    ds_read_b64_tr_b16 v[174:175], v227 offset:17664
    v_mfma_f32_16x16x32_bf16 v[60:63], v[140:143], v[204:207], v[60:63]
    ds_read_b64_tr_b16 v[176:177], v226 offset:16896
    v_mfma_f32_16x16x32_bf16 v[56:59], v[140:143], v[200:203], v[56:59]
    ds_read_b64_tr_b16 v[178:179], v226 offset:17920
    v_mfma_f32_16x16x32_bf16 v[52:55], v[140:143], v[196:199], v[52:55]
    ds_read_b64_tr_b16 v[180:181], v227 offset:16896
    v_mfma_f32_16x16x32_bf16 v[48:51], v[140:143], v[192:195], v[48:51]
    ds_read_b64_tr_b16 v[182:183], v227 offset:17920
    v_mfma_f32_16x16x32_bf16 v[64:67], v[144:147], v[192:195], v[64:67]
    ds_read_b64_tr_b16 v[184:185], v226 offset:17152
    v_mfma_f32_16x16x32_bf16 v[68:71], v[144:147], v[196:199], v[68:71]
    ds_read_b64_tr_b16 v[186:187], v226 offset:18176
    v_mfma_f32_16x16x32_bf16 v[72:75], v[144:147], v[200:203], v[72:75]
    ds_read_b64_tr_b16 v[188:189], v227 offset:17152
    v_mfma_f32_16x16x32_bf16 v[76:79], v[144:147], v[204:207], v[76:79]
    ds_read_b64_tr_b16 v[190:191], v227 offset:18176
    v_mfma_f32_16x16x32_bf16 v[92:95], v[148:151], v[204:207], v[92:95]
    v_mfma_f32_16x16x32_bf16 v[88:91], v[148:151], v[200:203], v[88:91]
    v_mfma_f32_16x16x32_bf16 v[84:87], v[148:151], v[196:199], v[84:87]
    v_mfma_f32_16x16x32_bf16 v[80:83], v[148:151], v[192:195], v[80:83]
    v_mfma_f32_16x16x32_bf16 v[96:99], v[152:155], v[192:195], v[96:99]
    v_mfma_f32_16x16x32_bf16 v[100:103], v[152:155], v[196:199], v[100:103]
    v_mfma_f32_16x16x32_bf16 v[104:107], v[152:155], v[200:203], v[104:107]
    v_mfma_f32_16x16x32_bf16 v[108:111], v[152:155], v[204:207], v[108:111]
    s_waitcnt vmcnt(4) lgkmcnt(0)
    s_barrier
    v_mfma_f32_16x16x32_bf16 v[124:127], v[156:159], v[204:207], v[124:127]
    v_mfma_f32_16x16x32_bf16 v[120:123], v[156:159], v[200:203], v[120:123]
    v_mfma_f32_16x16x32_bf16 v[116:119], v[156:159], v[196:199], v[116:119]
    v_mfma_f32_16x16x32_bf16 v[112:115], v[156:159], v[192:195], v[112:115]
    v_mfma_f32_16x16x32_bf16 v[0:3], v[160:163], v[208:211], v[0:3]
    ds_read_b128 v[192:195], v224 offset:32768
    v_mfma_f32_16x16x32_bf16 v[4:7], v[160:163], v[212:215], v[4:7]
    ds_read_b128 v[196:199], v224 offset:34816
    s_add_u32 m0, s32, 98304
    s_add_u32 s20, s70, 4
    s_and_b32 s20, s20, 7
    s_xor_b32 s20, s20, s69
    s_lshl_b32 s20, s20, 7
    buffer_load_dwordx4 v230, s[4:7], s20 offen lds
    v_mfma_f32_16x16x32_bf16 v[8:11], v[160:163], v[216:219], v[8:11]
    ds_read_b128 v[200:203], v224 offset:36864
    v_mfma_f32_16x16x32_bf16 v[12:15], v[160:163], v[220:223], v[12:15]
    ds_read_b128 v[204:207], v224 offset:38912
    s_add_u32 m0, s32, 106496
    s_add_u32 s20, s20, 65536
    buffer_load_dwordx4 v230, s[4:7], s20 offen lds
    v_mfma_f32_16x16x32_bf16 v[28:31], v[164:167], v[220:223], v[28:31]
    ds_read_b64_tr_b16 v[128:129], v226 offset:32768
    v_mfma_f32_16x16x32_bf16 v[24:27], v[164:167], v[216:219], v[24:27]
    ds_read_b64_tr_b16 v[130:131], v226 offset:33792
    s_add_u32 m0, s32, 114688
    s_add_u32 s20, s20, 65536
    buffer_load_dwordx4 v230, s[4:7], s20 offen lds
    v_mfma_f32_16x16x32_bf16 v[20:23], v[164:167], v[212:215], v[20:23]
    ds_read_b64_tr_b16 v[132:133], v227 offset:32768
    v_mfma_f32_16x16x32_bf16 v[16:19], v[164:167], v[208:211], v[16:19]
    ds_read_b64_tr_b16 v[134:135], v227 offset:33792
    s_add_u32 m0, s32, 122880
    s_add_u32 s20, s20, 65536
    buffer_load_dwordx4 v230, s[4:7], s20 offen lds
    v_mfma_f32_16x16x32_bf16 v[32:35], v[168:171], v[208:211], v[32:35]
    ds_read_b64_tr_b16 v[136:137], v226 offset:33024
    v_mfma_f32_16x16x32_bf16 v[36:39], v[168:171], v[212:215], v[36:39]
    ds_read_b64_tr_b16 v[138:139], v226 offset:34048
    v_mfma_f32_16x16x32_bf16 v[40:43], v[168:171], v[216:219], v[40:43]
    ds_read_b64_tr_b16 v[140:141], v227 offset:33024
    v_mfma_f32_16x16x32_bf16 v[44:47], v[168:171], v[220:223], v[44:47]
    ds_read_b64_tr_b16 v[142:143], v227 offset:34048
    v_mfma_f32_16x16x32_bf16 v[60:63], v[172:175], v[220:223], v[60:63]
    ds_read_b64_tr_b16 v[144:145], v226 offset:33280
    v_mfma_f32_16x16x32_bf16 v[56:59], v[172:175], v[216:219], v[56:59]
    ds_read_b64_tr_b16 v[146:147], v226 offset:34304
    v_mfma_f32_16x16x32_bf16 v[52:55], v[172:175], v[212:215], v[52:55]
    ds_read_b64_tr_b16 v[148:149], v227 offset:33280
    v_mfma_f32_16x16x32_bf16 v[48:51], v[172:175], v[208:211], v[48:51]
    ds_read_b64_tr_b16 v[150:151], v227 offset:34304
    v_mfma_f32_16x16x32_bf16 v[64:67], v[176:179], v[208:211], v[64:67]
    ds_read_b64_tr_b16 v[152:153], v226 offset:33536
    v_mfma_f32_16x16x32_bf16 v[68:71], v[176:179], v[212:215], v[68:71]
    ds_read_b64_tr_b16 v[154:155], v226 offset:34560
    v_mfma_f32_16x16x32_bf16 v[72:75], v[176:179], v[216:219], v[72:75]
    ds_read_b64_tr_b16 v[156:157], v227 offset:33536
    v_mfma_f32_16x16x32_bf16 v[76:79], v[176:179], v[220:223], v[76:79]
    ds_read_b64_tr_b16 v[158:159], v227 offset:34560
    v_mfma_f32_16x16x32_bf16 v[92:95], v[180:183], v[220:223], v[92:95]
    v_mfma_f32_16x16x32_bf16 v[88:91], v[180:183], v[216:219], v[88:91]
    v_mfma_f32_16x16x32_bf16 v[84:87], v[180:183], v[212:215], v[84:87]
    v_mfma_f32_16x16x32_bf16 v[80:83], v[180:183], v[208:211], v[80:83]
    v_mfma_f32_16x16x32_bf16 v[96:99], v[184:187], v[208:211], v[96:99]
    v_mfma_f32_16x16x32_bf16 v[100:103], v[184:187], v[212:215], v[100:103]
    v_mfma_f32_16x16x32_bf16 v[104:107], v[184:187], v[216:219], v[104:107]
    v_mfma_f32_16x16x32_bf16 v[108:111], v[184:187], v[220:223], v[108:111]
    s_waitcnt vmcnt(6) lgkmcnt(0)
    s_barrier
    v_mfma_f32_16x16x32_bf16 v[124:127], v[188:191], v[220:223], v[124:127]
    v_mfma_f32_16x16x32_bf16 v[120:123], v[188:191], v[216:219], v[120:123]
    v_mfma_f32_16x16x32_bf16 v[116:119], v[188:191], v[212:215], v[116:119]
    v_mfma_f32_16x16x32_bf16 v[112:115], v[188:191], v[208:211], v[112:115]
    v_mfma_f32_16x16x32_bf16 v[0:3], v[128:131], v[192:195], v[0:3]
    ds_read_b128 v[208:211], v224 offset:33280
    v_mfma_f32_16x16x32_bf16 v[4:7], v[128:131], v[196:199], v[4:7]
    ds_read_b128 v[212:215], v224 offset:35328
    s_add_u32 m0, s33, 32768
    s_add_u32 s21, s70, 4
    s_and_b32 s21, s21, 7
    s_xor_b32 s21, s21, s69
    s_lshl_b32 s21, s21, 19
    s_add_u32 s21, s21, 262144
    buffer_load_dwordx4 v231, s[8:11], s21 offen lds
    v_mfma_f32_16x16x32_bf16 v[8:11], v[128:131], v[200:203], v[8:11]
    ds_read_b128 v[216:219], v224 offset:37376
    v_mfma_f32_16x16x32_bf16 v[12:15], v[128:131], v[204:207], v[12:15]
    ds_read_b128 v[220:223], v224 offset:39424
    s_add_u32 m0, s33, 33792
    s_add_u32 s21, s21, 32768
    buffer_load_dwordx4 v231, s[8:11], s21 offen lds
    v_mfma_f32_16x16x32_bf16 v[28:31], v[132:135], v[204:207], v[28:31]
    ds_read_b64_tr_b16 v[160:161], v226 offset:49152
    v_mfma_f32_16x16x32_bf16 v[24:27], v[132:135], v[200:203], v[24:27]
    ds_read_b64_tr_b16 v[162:163], v226 offset:50176
    s_add_u32 m0, s33, 49152
    s_add_u32 s21, s70, 5
    s_and_b32 s21, s21, 7
    s_xor_b32 s21, s21, s69
    s_lshl_b32 s21, s21, 19
    buffer_load_dwordx4 v231, s[8:11], s21 offen lds
    v_mfma_f32_16x16x32_bf16 v[20:23], v[132:135], v[196:199], v[20:23]
    ds_read_b64_tr_b16 v[164:165], v227 offset:49152
    v_mfma_f32_16x16x32_bf16 v[16:19], v[132:135], v[192:195], v[16:19]
    ds_read_b64_tr_b16 v[166:167], v227 offset:50176
    s_add_u32 m0, s33, 50176
    s_add_u32 s21, s21, 32768
    buffer_load_dwordx4 v231, s[8:11], s21 offen lds
    v_mfma_f32_16x16x32_bf16 v[32:35], v[136:139], v[192:195], v[32:35]
    ds_read_b64_tr_b16 v[168:169], v226 offset:49408
    v_mfma_f32_16x16x32_bf16 v[36:39], v[136:139], v[196:199], v[36:39]
    ds_read_b64_tr_b16 v[170:171], v226 offset:50432
    v_readfirstlane_b32 s36, v237
    v_or_b32 v237, s61, v237
    s_mov_b64 exec, 1
    buffer_store_dwordx2 v[236:237], v236, s[40:43], s72 offen sc1
    s_mov_b64 exec, -1
    v_mfma_f32_16x16x32_bf16 v[40:43], v[136:139], v[200:203], v[40:43]
    ds_read_b64_tr_b16 v[172:173], v227 offset:49408
    v_mfma_f32_16x16x32_bf16 v[44:47], v[136:139], v[204:207], v[44:47]
    ds_read_b64_tr_b16 v[174:175], v227 offset:50432
    v_mfma_f32_16x16x32_bf16 v[60:63], v[140:143], v[204:207], v[60:63]
    ds_read_b64_tr_b16 v[176:177], v226 offset:49664
    v_mfma_f32_16x16x32_bf16 v[56:59], v[140:143], v[200:203], v[56:59]
    ds_read_b64_tr_b16 v[178:179], v226 offset:50688
    v_mfma_f32_16x16x32_bf16 v[52:55], v[140:143], v[196:199], v[52:55]
    ds_read_b64_tr_b16 v[180:181], v227 offset:49664
    v_mfma_f32_16x16x32_bf16 v[48:51], v[140:143], v[192:195], v[48:51]
    ds_read_b64_tr_b16 v[182:183], v227 offset:50688
    v_mfma_f32_16x16x32_bf16 v[64:67], v[144:147], v[192:195], v[64:67]
    ds_read_b64_tr_b16 v[184:185], v226 offset:49920
    v_mfma_f32_16x16x32_bf16 v[68:71], v[144:147], v[196:199], v[68:71]
    ds_read_b64_tr_b16 v[186:187], v226 offset:50944
    v_mfma_f32_16x16x32_bf16 v[72:75], v[144:147], v[200:203], v[72:75]
    ds_read_b64_tr_b16 v[188:189], v227 offset:49920
    v_mfma_f32_16x16x32_bf16 v[76:79], v[144:147], v[204:207], v[76:79]
    ds_read_b64_tr_b16 v[190:191], v227 offset:50944
    v_mfma_f32_16x16x32_bf16 v[92:95], v[148:151], v[204:207], v[92:95]
    v_mfma_f32_16x16x32_bf16 v[88:91], v[148:151], v[200:203], v[88:91]
    v_mfma_f32_16x16x32_bf16 v[84:87], v[148:151], v[196:199], v[84:87]
    v_mfma_f32_16x16x32_bf16 v[80:83], v[148:151], v[192:195], v[80:83]
    v_mfma_f32_16x16x32_bf16 v[96:99], v[152:155], v[192:195], v[96:99]
    v_mfma_f32_16x16x32_bf16 v[100:103], v[152:155], v[196:199], v[100:103]
    v_mfma_f32_16x16x32_bf16 v[104:107], v[152:155], v[200:203], v[104:107]
    v_mfma_f32_16x16x32_bf16 v[108:111], v[152:155], v[204:207], v[108:111]
    s_waitcnt vmcnt(5) lgkmcnt(0)
    s_barrier
    v_mfma_f32_16x16x32_bf16 v[124:127], v[156:159], v[204:207], v[124:127]
    v_mfma_f32_16x16x32_bf16 v[120:123], v[156:159], v[200:203], v[120:123]
    v_mfma_f32_16x16x32_bf16 v[116:119], v[156:159], v[196:199], v[116:119]
    v_mfma_f32_16x16x32_bf16 v[112:115], v[156:159], v[192:195], v[112:115]
    v_mfma_f32_16x16x32_bf16 v[0:3], v[160:163], v[208:211], v[0:3]
    ds_read_b128 v[192:195], v224 offset:0
    v_mfma_f32_16x16x32_bf16 v[4:7], v[160:163], v[212:215], v[4:7]
    ds_read_b128 v[196:199], v224 offset:2048
    s_add_u32 m0, s32, 131072
    s_add_u32 s20, s70, 5
    s_and_b32 s20, s20, 7
    s_xor_b32 s20, s20, s69
    s_lshl_b32 s20, s20, 7
    buffer_load_dwordx4 v230, s[4:7], s20 offen lds
    v_mfma_f32_16x16x32_bf16 v[8:11], v[160:163], v[216:219], v[8:11]
    ds_read_b128 v[200:203], v224 offset:4096
    v_mfma_f32_16x16x32_bf16 v[12:15], v[160:163], v[220:223], v[12:15]
    ds_read_b128 v[204:207], v224 offset:6144
    s_add_u32 m0, s32, 139264
    s_add_u32 s20, s20, 65536
    buffer_load_dwordx4 v230, s[4:7], s20 offen lds
    v_mfma_f32_16x16x32_bf16 v[28:31], v[164:167], v[220:223], v[28:31]
    ds_read_b64_tr_b16 v[128:129], v226 offset:0
    v_mfma_f32_16x16x32_bf16 v[24:27], v[164:167], v[216:219], v[24:27]
    ds_read_b64_tr_b16 v[130:131], v226 offset:1024
    s_add_u32 m0, s32, 147456
    s_add_u32 s20, s20, 65536
    buffer_load_dwordx4 v230, s[4:7], s20 offen lds
    v_mfma_f32_16x16x32_bf16 v[20:23], v[164:167], v[212:215], v[20:23]
    ds_read_b64_tr_b16 v[132:133], v227 offset:0
    v_mfma_f32_16x16x32_bf16 v[16:19], v[164:167], v[208:211], v[16:19]
    ds_read_b64_tr_b16 v[134:135], v227 offset:1024
    s_add_u32 m0, s32, 155648
    s_add_u32 s20, s20, 65536
    buffer_load_dwordx4 v230, s[4:7], s20 offen lds
    v_mfma_f32_16x16x32_bf16 v[32:35], v[168:171], v[208:211], v[32:35]
    ds_read_b64_tr_b16 v[136:137], v226 offset:256
    v_mfma_f32_16x16x32_bf16 v[36:39], v[168:171], v[212:215], v[36:39]
    ds_read_b64_tr_b16 v[138:139], v226 offset:1280
    v_mfma_f32_16x16x32_bf16 v[40:43], v[168:171], v[216:219], v[40:43]
    ds_read_b64_tr_b16 v[140:141], v227 offset:256
    v_mfma_f32_16x16x32_bf16 v[44:47], v[168:171], v[220:223], v[44:47]
    ds_read_b64_tr_b16 v[142:143], v227 offset:1280
    v_mfma_f32_16x16x32_bf16 v[60:63], v[172:175], v[220:223], v[60:63]
    ds_read_b64_tr_b16 v[144:145], v226 offset:512
    v_mfma_f32_16x16x32_bf16 v[56:59], v[172:175], v[216:219], v[56:59]
    ds_read_b64_tr_b16 v[146:147], v226 offset:1536
    v_mfma_f32_16x16x32_bf16 v[52:55], v[172:175], v[212:215], v[52:55]
    ds_read_b64_tr_b16 v[148:149], v227 offset:512
    v_mfma_f32_16x16x32_bf16 v[48:51], v[172:175], v[208:211], v[48:51]
    ds_read_b64_tr_b16 v[150:151], v227 offset:1536
    v_mfma_f32_16x16x32_bf16 v[64:67], v[176:179], v[208:211], v[64:67]
    ds_read_b64_tr_b16 v[152:153], v226 offset:768
    v_mfma_f32_16x16x32_bf16 v[68:71], v[176:179], v[212:215], v[68:71]
    ds_read_b64_tr_b16 v[154:155], v226 offset:1792
    v_mfma_f32_16x16x32_bf16 v[72:75], v[176:179], v[216:219], v[72:75]
    ds_read_b64_tr_b16 v[156:157], v227 offset:768
    v_mfma_f32_16x16x32_bf16 v[76:79], v[176:179], v[220:223], v[76:79]
    ds_read_b64_tr_b16 v[158:159], v227 offset:1792
    v_mfma_f32_16x16x32_bf16 v[92:95], v[180:183], v[220:223], v[92:95]
    v_mfma_f32_16x16x32_bf16 v[88:91], v[180:183], v[216:219], v[88:91]
    v_mfma_f32_16x16x32_bf16 v[84:87], v[180:183], v[212:215], v[84:87]
    v_mfma_f32_16x16x32_bf16 v[80:83], v[180:183], v[208:211], v[80:83]
    v_mfma_f32_16x16x32_bf16 v[96:99], v[184:187], v[208:211], v[96:99]
    v_mfma_f32_16x16x32_bf16 v[100:103], v[184:187], v[212:215], v[100:103]
    v_mfma_f32_16x16x32_bf16 v[104:107], v[184:187], v[216:219], v[104:107]
    v_mfma_f32_16x16x32_bf16 v[108:111], v[184:187], v[220:223], v[108:111]
    s_waitcnt vmcnt(7) lgkmcnt(0)
    s_barrier
    v_mfma_f32_16x16x32_bf16 v[124:127], v[188:191], v[220:223], v[124:127]
    v_mfma_f32_16x16x32_bf16 v[120:123], v[188:191], v[216:219], v[120:123]
    v_mfma_f32_16x16x32_bf16 v[116:119], v[188:191], v[212:215], v[116:119]
    v_mfma_f32_16x16x32_bf16 v[112:115], v[188:191], v[208:211], v[112:115]
    v_mfma_f32_16x16x32_bf16 v[0:3], v[128:131], v[192:195], v[0:3]
    ds_read_b128 v[208:211], v224 offset:512
    v_mfma_f32_16x16x32_bf16 v[4:7], v[128:131], v[196:199], v[4:7]
    ds_read_b128 v[212:215], v224 offset:2560
    s_add_u32 m0, s33, 65536
    s_add_u32 s21, s70, 5
    s_and_b32 s21, s21, 7
    s_xor_b32 s21, s21, s69
    s_lshl_b32 s21, s21, 19
    s_add_u32 s21, s21, 262144
    buffer_load_dwordx4 v231, s[8:11], s21 offen lds
    v_mfma_f32_16x16x32_bf16 v[8:11], v[128:131], v[200:203], v[8:11]
    ds_read_b128 v[216:219], v224 offset:4608
    v_mfma_f32_16x16x32_bf16 v[12:15], v[128:131], v[204:207], v[12:15]
    ds_read_b128 v[220:223], v224 offset:6656
    s_add_u32 m0, s33, 66560
    s_add_u32 s21, s21, 32768
    buffer_load_dwordx4 v231, s[8:11], s21 offen lds
    v_mfma_f32_16x16x32_bf16 v[28:31], v[132:135], v[204:207], v[28:31]
    ds_read_b64_tr_b16 v[160:161], v226 offset:16384
    v_mfma_f32_16x16x32_bf16 v[24:27], v[132:135], v[200:203], v[24:27]
    ds_read_b64_tr_b16 v[162:163], v226 offset:17408
    s_add_u32 m0, s33, 16384
    s_add_u32 s21, s70, 6
    s_and_b32 s21, s21, 7
    s_xor_b32 s21, s21, s69
    s_lshl_b32 s21, s21, 19
    buffer_load_dwordx4 v231, s[8:11], s21 offen lds
    v_mfma_f32_16x16x32_bf16 v[20:23], v[132:135], v[196:199], v[20:23]
    ds_read_b64_tr_b16 v[164:165], v227 offset:16384
    v_mfma_f32_16x16x32_bf16 v[16:19], v[132:135], v[192:195], v[16:19]
    ds_read_b64_tr_b16 v[166:167], v227 offset:17408
    s_add_u32 m0, s33, 17408
    s_add_u32 s21, s21, 32768
    buffer_load_dwordx4 v231, s[8:11], s21 offen lds
    v_mfma_f32_16x16x32_bf16 v[32:35], v[136:139], v[192:195], v[32:35]
    ds_read_b64_tr_b16 v[168:169], v226 offset:16640
    v_mfma_f32_16x16x32_bf16 v[36:39], v[136:139], v[196:199], v[36:39]
    ds_read_b64_tr_b16 v[170:171], v226 offset:17664
    v_mfma_f32_16x16x32_bf16 v[40:43], v[136:139], v[200:203], v[40:43]
    ds_read_b64_tr_b16 v[172:173], v227 offset:16640
    v_mfma_f32_16x16x32_bf16 v[44:47], v[136:139], v[204:207], v[44:47]
    ds_read_b64_tr_b16 v[174:175], v227 offset:17664
    v_mfma_f32_16x16x32_bf16 v[60:63], v[140:143], v[204:207], v[60:63]
    ds_read_b64_tr_b16 v[176:177], v226 offset:16896
    v_mfma_f32_16x16x32_bf16 v[56:59], v[140:143], v[200:203], v[56:59]
    ds_read_b64_tr_b16 v[178:179], v226 offset:17920
    v_mfma_f32_16x16x32_bf16 v[52:55], v[140:143], v[196:199], v[52:55]
    ds_read_b64_tr_b16 v[180:181], v227 offset:16896
    v_mfma_f32_16x16x32_bf16 v[48:51], v[140:143], v[192:195], v[48:51]
    ds_read_b64_tr_b16 v[182:183], v227 offset:17920
    v_mfma_f32_16x16x32_bf16 v[64:67], v[144:147], v[192:195], v[64:67]
    ds_read_b64_tr_b16 v[184:185], v226 offset:17152
    v_mfma_f32_16x16x32_bf16 v[68:71], v[144:147], v[196:199], v[68:71]
    ds_read_b64_tr_b16 v[186:187], v226 offset:18176
    v_mfma_f32_16x16x32_bf16 v[72:75], v[144:147], v[200:203], v[72:75]
    ds_read_b64_tr_b16 v[188:189], v227 offset:17152
    v_mfma_f32_16x16x32_bf16 v[76:79], v[144:147], v[204:207], v[76:79]
    ds_read_b64_tr_b16 v[190:191], v227 offset:18176
    v_mfma_f32_16x16x32_bf16 v[92:95], v[148:151], v[204:207], v[92:95]
    v_mfma_f32_16x16x32_bf16 v[88:91], v[148:151], v[200:203], v[88:91]
    v_mfma_f32_16x16x32_bf16 v[84:87], v[148:151], v[196:199], v[84:87]
    v_mfma_f32_16x16x32_bf16 v[80:83], v[148:151], v[192:195], v[80:83]
    v_mfma_f32_16x16x32_bf16 v[96:99], v[152:155], v[192:195], v[96:99]
    v_mfma_f32_16x16x32_bf16 v[100:103], v[152:155], v[196:199], v[100:103]
    v_mfma_f32_16x16x32_bf16 v[104:107], v[152:155], v[200:203], v[104:107]
    v_mfma_f32_16x16x32_bf16 v[108:111], v[152:155], v[204:207], v[108:111]
    s_waitcnt vmcnt(4) lgkmcnt(0)
    s_barrier
    v_mfma_f32_16x16x32_bf16 v[124:127], v[156:159], v[204:207], v[124:127]
    v_mfma_f32_16x16x32_bf16 v[120:123], v[156:159], v[200:203], v[120:123]
    v_mfma_f32_16x16x32_bf16 v[116:119], v[156:159], v[196:199], v[116:119]
    v_mfma_f32_16x16x32_bf16 v[112:115], v[156:159], v[192:195], v[112:115]
    v_mfma_f32_16x16x32_bf16 v[0:3], v[160:163], v[208:211], v[0:3]
    ds_read_b128 v[192:195], v224 offset:32768
    v_mfma_f32_16x16x32_bf16 v[4:7], v[160:163], v[212:215], v[4:7]
    ds_read_b128 v[196:199], v224 offset:34816
    s_add_u32 m0, s32, 98304
    s_add_u32 s20, s70, 6
    s_and_b32 s20, s20, 7
    s_xor_b32 s20, s20, s69
    s_lshl_b32 s20, s20, 7
    buffer_load_dwordx4 v230, s[4:7], s20 offen lds
    v_mfma_f32_16x16x32_bf16 v[8:11], v[160:163], v[216:219], v[8:11]
    ds_read_b128 v[200:203], v224 offset:36864
    v_mfma_f32_16x16x32_bf16 v[12:15], v[160:163], v[220:223], v[12:15]
    ds_read_b128 v[204:207], v224 offset:38912
    s_add_u32 m0, s32, 106496
    s_add_u32 s20, s20, 65536
    buffer_load_dwordx4 v230, s[4:7], s20 offen lds
    v_mfma_f32_16x16x32_bf16 v[28:31], v[164:167], v[220:223], v[28:31]
    ds_read_b64_tr_b16 v[128:129], v226 offset:32768
    v_mfma_f32_16x16x32_bf16 v[24:27], v[164:167], v[216:219], v[24:27]
    ds_read_b64_tr_b16 v[130:131], v226 offset:33792
    s_add_u32 m0, s32, 114688
    s_add_u32 s20, s20, 65536
    buffer_load_dwordx4 v230, s[4:7], s20 offen lds
    v_mfma_f32_16x16x32_bf16 v[20:23], v[164:167], v[212:215], v[20:23]
    ds_read_b64_tr_b16 v[132:133], v227 offset:32768
    v_mfma_f32_16x16x32_bf16 v[16:19], v[164:167], v[208:211], v[16:19]
    ds_read_b64_tr_b16 v[134:135], v227 offset:33792
    s_add_u32 m0, s32, 122880
    s_add_u32 s20, s20, 65536
    buffer_load_dwordx4 v230, s[4:7], s20 offen lds
    v_mfma_f32_16x16x32_bf16 v[32:35], v[168:171], v[208:211], v[32:35]
    ds_read_b64_tr_b16 v[136:137], v226 offset:33024
    v_mfma_f32_16x16x32_bf16 v[36:39], v[168:171], v[212:215], v[36:39]
    ds_read_b64_tr_b16 v[138:139], v226 offset:34048
    v_mfma_f32_16x16x32_bf16 v[40:43], v[168:171], v[216:219], v[40:43]
    ds_read_b64_tr_b16 v[140:141], v227 offset:33024
    v_mfma_f32_16x16x32_bf16 v[44:47], v[168:171], v[220:223], v[44:47]
    ds_read_b64_tr_b16 v[142:143], v227 offset:34048
    v_mfma_f32_16x16x32_bf16 v[60:63], v[172:175], v[220:223], v[60:63]
    ds_read_b64_tr_b16 v[144:145], v226 offset:33280
    v_mfma_f32_16x16x32_bf16 v[56:59], v[172:175], v[216:219], v[56:59]
    ds_read_b64_tr_b16 v[146:147], v226 offset:34304
    v_mfma_f32_16x16x32_bf16 v[52:55], v[172:175], v[212:215], v[52:55]
    ds_read_b64_tr_b16 v[148:149], v227 offset:33280
    v_mfma_f32_16x16x32_bf16 v[48:51], v[172:175], v[208:211], v[48:51]
    ds_read_b64_tr_b16 v[150:151], v227 offset:34304
    v_mfma_f32_16x16x32_bf16 v[64:67], v[176:179], v[208:211], v[64:67]
    ds_read_b64_tr_b16 v[152:153], v226 offset:33536
    v_mfma_f32_16x16x32_bf16 v[68:71], v[176:179], v[212:215], v[68:71]
    ds_read_b64_tr_b16 v[154:155], v226 offset:34560
    v_mfma_f32_16x16x32_bf16 v[72:75], v[176:179], v[216:219], v[72:75]
    ds_read_b64_tr_b16 v[156:157], v227 offset:33536
    v_mfma_f32_16x16x32_bf16 v[76:79], v[176:179], v[220:223], v[76:79]
    ds_read_b64_tr_b16 v[158:159], v227 offset:34560
    v_mfma_f32_16x16x32_bf16 v[92:95], v[180:183], v[220:223], v[92:95]
    v_mfma_f32_16x16x32_bf16 v[88:91], v[180:183], v[216:219], v[88:91]
    v_mfma_f32_16x16x32_bf16 v[84:87], v[180:183], v[212:215], v[84:87]
    v_mfma_f32_16x16x32_bf16 v[80:83], v[180:183], v[208:211], v[80:83]
    v_mfma_f32_16x16x32_bf16 v[96:99], v[184:187], v[208:211], v[96:99]
    v_mfma_f32_16x16x32_bf16 v[100:103], v[184:187], v[212:215], v[100:103]
    v_mfma_f32_16x16x32_bf16 v[104:107], v[184:187], v[216:219], v[104:107]
    v_mfma_f32_16x16x32_bf16 v[108:111], v[184:187], v[220:223], v[108:111]
    s_waitcnt vmcnt(6) lgkmcnt(0)
    s_barrier
    v_mfma_f32_16x16x32_bf16 v[124:127], v[188:191], v[220:223], v[124:127]
    v_mfma_f32_16x16x32_bf16 v[120:123], v[188:191], v[216:219], v[120:123]
    v_mfma_f32_16x16x32_bf16 v[116:119], v[188:191], v[212:215], v[116:119]
    v_mfma_f32_16x16x32_bf16 v[112:115], v[188:191], v[208:211], v[112:115]
    v_mfma_f32_16x16x32_bf16 v[0:3], v[128:131], v[192:195], v[0:3]
    ds_read_b128 v[208:211], v224 offset:33280
    v_mfma_f32_16x16x32_bf16 v[4:7], v[128:131], v[196:199], v[4:7]
    ds_read_b128 v[212:215], v224 offset:35328
    s_add_u32 m0, s33, 32768
    s_add_u32 s21, s70, 6
    s_and_b32 s21, s21, 7
    s_xor_b32 s21, s21, s69
    s_lshl_b32 s21, s21, 19
    s_add_u32 s21, s21, 262144
    buffer_load_dwordx4 v231, s[8:11], s21 offen lds
    v_mfma_f32_16x16x32_bf16 v[8:11], v[128:131], v[200:203], v[8:11]
    ds_read_b128 v[216:219], v224 offset:37376
    v_mfma_f32_16x16x32_bf16 v[12:15], v[128:131], v[204:207], v[12:15]
    ds_read_b128 v[220:223], v224 offset:39424
    s_add_u32 m0, s33, 33792
    s_add_u32 s21, s21, 32768
    buffer_load_dwordx4 v231, s[8:11], s21 offen lds
    v_mfma_f32_16x16x32_bf16 v[28:31], v[132:135], v[204:207], v[28:31]
    ds_read_b64_tr_b16 v[160:161], v226 offset:49152
    v_mfma_f32_16x16x32_bf16 v[24:27], v[132:135], v[200:203], v[24:27]
    ds_read_b64_tr_b16 v[162:163], v226 offset:50176
    s_add_u32 m0, s33, 49152
    s_add_u32 s21, s70, 7
    s_and_b32 s21, s21, 7
    s_xor_b32 s21, s21, s69
    s_lshl_b32 s21, s21, 19
    buffer_load_dwordx4 v231, s[8:11], s21 offen lds
    v_mfma_f32_16x16x32_bf16 v[20:23], v[132:135], v[196:199], v[20:23]
    ds_read_b64_tr_b16 v[164:165], v227 offset:49152
    v_mfma_f32_16x16x32_bf16 v[16:19], v[132:135], v[192:195], v[16:19]
    ds_read_b64_tr_b16 v[166:167], v227 offset:50176
    s_add_u32 m0, s33, 50176
    s_add_u32 s21, s21, 32768
    buffer_load_dwordx4 v231, s[8:11], s21 offen lds
    v_mfma_f32_16x16x32_bf16 v[32:35], v[136:139], v[192:195], v[32:35]
    ds_read_b64_tr_b16 v[168:169], v226 offset:49408
    v_mfma_f32_16x16x32_bf16 v[36:39], v[136:139], v[196:199], v[36:39]
    ds_read_b64_tr_b16 v[170:171], v226 offset:50432
    v_mfma_f32_16x16x32_bf16 v[40:43], v[136:139], v[200:203], v[40:43]
    ds_read_b64_tr_b16 v[172:173], v227 offset:49408
    v_mfma_f32_16x16x32_bf16 v[44:47], v[136:139], v[204:207], v[44:47]
    ds_read_b64_tr_b16 v[174:175], v227 offset:50432
    v_mfma_f32_16x16x32_bf16 v[60:63], v[140:143], v[204:207], v[60:63]
    ds_read_b64_tr_b16 v[176:177], v226 offset:49664
    v_mfma_f32_16x16x32_bf16 v[56:59], v[140:143], v[200:203], v[56:59]
    ds_read_b64_tr_b16 v[178:179], v226 offset:50688
    v_mfma_f32_16x16x32_bf16 v[52:55], v[140:143], v[196:199], v[52:55]
    ds_read_b64_tr_b16 v[180:181], v227 offset:49664
    v_mfma_f32_16x16x32_bf16 v[48:51], v[140:143], v[192:195], v[48:51]
    ds_read_b64_tr_b16 v[182:183], v227 offset:50688
    v_mfma_f32_16x16x32_bf16 v[64:67], v[144:147], v[192:195], v[64:67]
    ds_read_b64_tr_b16 v[184:185], v226 offset:49920
    v_mfma_f32_16x16x32_bf16 v[68:71], v[144:147], v[196:199], v[68:71]
    ds_read_b64_tr_b16 v[186:187], v226 offset:50944
    v_mfma_f32_16x16x32_bf16 v[72:75], v[144:147], v[200:203], v[72:75]
    ds_read_b64_tr_b16 v[188:189], v227 offset:49920
    v_mfma_f32_16x16x32_bf16 v[76:79], v[144:147], v[204:207], v[76:79]
    ds_read_b64_tr_b16 v[190:191], v227 offset:50944
    v_mfma_f32_16x16x32_bf16 v[92:95], v[148:151], v[204:207], v[92:95]
    v_mfma_f32_16x16x32_bf16 v[88:91], v[148:151], v[200:203], v[88:91]
    v_mfma_f32_16x16x32_bf16 v[84:87], v[148:151], v[196:199], v[84:87]
    v_mfma_f32_16x16x32_bf16 v[80:83], v[148:151], v[192:195], v[80:83]
    v_mfma_f32_16x16x32_bf16 v[96:99], v[152:155], v[192:195], v[96:99]
    v_mfma_f32_16x16x32_bf16 v[100:103], v[152:155], v[196:199], v[100:103]
    v_mfma_f32_16x16x32_bf16 v[104:107], v[152:155], v[200:203], v[104:107]
    v_mfma_f32_16x16x32_bf16 v[108:111], v[152:155], v[204:207], v[108:111]
    s_waitcnt vmcnt(4) lgkmcnt(0)
    s_barrier
    v_mfma_f32_16x16x32_bf16 v[124:127], v[156:159], v[204:207], v[124:127]
    v_mfma_f32_16x16x32_bf16 v[120:123], v[156:159], v[200:203], v[120:123]
    v_mfma_f32_16x16x32_bf16 v[116:119], v[156:159], v[196:199], v[116:119]
    v_mfma_f32_16x16x32_bf16 v[112:115], v[156:159], v[192:195], v[112:115]
    v_mfma_f32_16x16x32_bf16 v[0:3], v[160:163], v[208:211], v[0:3]
    ds_read_b128 v[192:195], v224 offset:0
    v_mfma_f32_16x16x32_bf16 v[4:7], v[160:163], v[212:215], v[4:7]
    ds_read_b128 v[196:199], v224 offset:2048
    v_mbcnt_lo_u32_b32 v239, -1, 0
    v_and_b32 v239, 15, v239
    v_lshlrev_b32 v239, 3, v239
    buffer_load_dword v238, v239, s[40:43], s60 offen offset:4 sc1
    v_mfma_f32_16x16x32_bf16 v[8:11], v[160:163], v[216:219], v[8:11]
    ds_read_b128 v[200:203], v224 offset:4096
    v_mfma_f32_16x16x32_bf16 v[12:15], v[160:163], v[220:223], v[12:15]
    ds_read_b128 v[204:207], v224 offset:6144
    s_add_u32 m0, s32, 131072
    s_add_u32 s20, s70, 7
    s_and_b32 s20, s20, 7
    s_xor_b32 s20, s20, s69
    s_lshl_b32 s20, s20, 7
    buffer_load_dwordx4 v230, s[4:7], s20 offen lds
    v_mfma_f32_16x16x32_bf16 v[28:31], v[164:167], v[220:223], v[28:31]
    ds_read_b64_tr_b16 v[128:129], v226 offset:0
    v_mfma_f32_16x16x32_bf16 v[24:27], v[164:167], v[216:219], v[24:27]
    ds_read_b64_tr_b16 v[130:131], v226 offset:1024
    s_add_u32 m0, s32, 139264
    s_add_u32 s20, s20, 65536
    buffer_load_dwordx4 v230, s[4:7], s20 offen lds
    v_mfma_f32_16x16x32_bf16 v[20:23], v[164:167], v[212:215], v[20:23]
    ds_read_b64_tr_b16 v[132:133], v227 offset:0
    v_mfma_f32_16x16x32_bf16 v[16:19], v[164:167], v[208:211], v[16:19]
    ds_read_b64_tr_b16 v[134:135], v227 offset:1024
    s_add_u32 m0, s32, 147456
    s_add_u32 s20, s20, 65536
    buffer_load_dwordx4 v230, s[4:7], s20 offen lds
    v_mfma_f32_16x16x32_bf16 v[32:35], v[168:171], v[208:211], v[32:35]
    ds_read_b64_tr_b16 v[136:137], v226 offset:256
    v_mfma_f32_16x16x32_bf16 v[36:39], v[168:171], v[212:215], v[36:39]
    ds_read_b64_tr_b16 v[138:139], v226 offset:1280
    s_add_u32 m0, s32, 155648
    s_add_u32 s20, s20, 65536
    buffer_load_dwordx4 v230, s[4:7], s20 offen lds
    v_mfma_f32_16x16x32_bf16 v[40:43], v[168:171], v[216:219], v[40:43]
    ds_read_b64_tr_b16 v[140:141], v227 offset:256
    v_mfma_f32_16x16x32_bf16 v[44:47], v[168:171], v[220:223], v[44:47]
    ds_read_b64_tr_b16 v[142:143], v227 offset:1280
    v_mfma_f32_16x16x32_bf16 v[60:63], v[172:175], v[220:223], v[60:63]
    ds_read_b64_tr_b16 v[144:145], v226 offset:512
    v_mfma_f32_16x16x32_bf16 v[56:59], v[172:175], v[216:219], v[56:59]
    ds_read_b64_tr_b16 v[146:147], v226 offset:1536
    v_mfma_f32_16x16x32_bf16 v[52:55], v[172:175], v[212:215], v[52:55]
    ds_read_b64_tr_b16 v[148:149], v227 offset:512
    v_mfma_f32_16x16x32_bf16 v[48:51], v[172:175], v[208:211], v[48:51]
    ds_read_b64_tr_b16 v[150:151], v227 offset:1536
    v_mfma_f32_16x16x32_bf16 v[64:67], v[176:179], v[208:211], v[64:67]
    ds_read_b64_tr_b16 v[152:153], v226 offset:768
    v_mfma_f32_16x16x32_bf16 v[68:71], v[176:179], v[212:215], v[68:71]
    ds_read_b64_tr_b16 v[154:155], v226 offset:1792
    v_mfma_f32_16x16x32_bf16 v[72:75], v[176:179], v[216:219], v[72:75]
    ds_read_b64_tr_b16 v[156:157], v227 offset:768
    v_mfma_f32_16x16x32_bf16 v[76:79], v[176:179], v[220:223], v[76:79]
    ds_read_b64_tr_b16 v[158:159], v227 offset:1792
    v_mfma_f32_16x16x32_bf16 v[92:95], v[180:183], v[220:223], v[92:95]
    v_mfma_f32_16x16x32_bf16 v[88:91], v[180:183], v[216:219], v[88:91]
    v_mfma_f32_16x16x32_bf16 v[84:87], v[180:183], v[212:215], v[84:87]
    v_mfma_f32_16x16x32_bf16 v[80:83], v[180:183], v[208:211], v[80:83]
    v_mfma_f32_16x16x32_bf16 v[96:99], v[184:187], v[208:211], v[96:99]
    v_mfma_f32_16x16x32_bf16 v[100:103], v[184:187], v[212:215], v[100:103]
    v_mfma_f32_16x16x32_bf16 v[104:107], v[184:187], v[216:219], v[104:107]
    v_mfma_f32_16x16x32_bf16 v[108:111], v[184:187], v[220:223], v[108:111]
    s_waitcnt vmcnt(7) lgkmcnt(0)
    s_barrier
    v_mfma_f32_16x16x32_bf16 v[124:127], v[188:191], v[220:223], v[124:127]
    v_mfma_f32_16x16x32_bf16 v[120:123], v[188:191], v[216:219], v[120:123]
    v_mfma_f32_16x16x32_bf16 v[116:119], v[188:191], v[212:215], v[116:119]
    v_mfma_f32_16x16x32_bf16 v[112:115], v[188:191], v[208:211], v[112:115]
    v_mfma_f32_16x16x32_bf16 v[0:3], v[128:131], v[192:195], v[0:3]
    ds_read_b128 v[208:211], v224 offset:512
    v_mfma_f32_16x16x32_bf16 v[4:7], v[128:131], v[196:199], v[4:7]
    ds_read_b128 v[212:215], v224 offset:2560
    s_add_u32 m0, s33, 65536
    s_add_u32 s21, s70, 7
    s_and_b32 s21, s21, 7
    s_xor_b32 s21, s21, s69
    s_lshl_b32 s21, s21, 19
    s_add_u32 s21, s21, 262144
    buffer_load_dwordx4 v231, s[8:11], s21 offen lds
    v_mfma_f32_16x16x32_bf16 v[8:11], v[128:131], v[200:203], v[8:11]
    ds_read_b128 v[216:219], v224 offset:4608
    v_mfma_f32_16x16x32_bf16 v[12:15], v[128:131], v[204:207], v[12:15]
    ds_read_b128 v[220:223], v224 offset:6656
    s_add_u32 m0, s33, 66560
    s_add_u32 s21, s21, 32768
    buffer_load_dwordx4 v231, s[8:11], s21 offen lds
    v_mfma_f32_16x16x32_bf16 v[28:31], v[132:135], v[204:207], v[28:31]
    ds_read_b64_tr_b16 v[160:161], v226 offset:16384
    v_mfma_f32_16x16x32_bf16 v[24:27], v[132:135], v[200:203], v[24:27]
    ds_read_b64_tr_b16 v[162:163], v226 offset:17408
    v_mfma_f32_16x16x32_bf16 v[20:23], v[132:135], v[196:199], v[20:23]
    ds_read_b64_tr_b16 v[164:165], v227 offset:16384
    v_mfma_f32_16x16x32_bf16 v[16:19], v[132:135], v[192:195], v[16:19]
    ds_read_b64_tr_b16 v[166:167], v227 offset:17408
    v_mfma_f32_16x16x32_bf16 v[32:35], v[136:139], v[192:195], v[32:35]
    ds_read_b64_tr_b16 v[168:169], v226 offset:16640
    v_mfma_f32_16x16x32_bf16 v[36:39], v[136:139], v[196:199], v[36:39]
    ds_read_b64_tr_b16 v[170:171], v226 offset:17664
    v_mfma_f32_16x16x32_bf16 v[40:43], v[136:139], v[200:203], v[40:43]
    ds_read_b64_tr_b16 v[172:173], v227 offset:16640
    v_mfma_f32_16x16x32_bf16 v[44:47], v[136:139], v[204:207], v[44:47]
    ds_read_b64_tr_b16 v[174:175], v227 offset:17664
    v_mfma_f32_16x16x32_bf16 v[60:63], v[140:143], v[204:207], v[60:63]
    ds_read_b64_tr_b16 v[176:177], v226 offset:16896
    v_mfma_f32_16x16x32_bf16 v[56:59], v[140:143], v[200:203], v[56:59]
    ds_read_b64_tr_b16 v[178:179], v226 offset:17920
    v_mfma_f32_16x16x32_bf16 v[52:55], v[140:143], v[196:199], v[52:55]
    ds_read_b64_tr_b16 v[180:181], v227 offset:16896
    v_mfma_f32_16x16x32_bf16 v[48:51], v[140:143], v[192:195], v[48:51]
    ds_read_b64_tr_b16 v[182:183], v227 offset:17920
    v_mfma_f32_16x16x32_bf16 v[64:67], v[144:147], v[192:195], v[64:67]
    ds_read_b64_tr_b16 v[184:185], v226 offset:17152
    v_mfma_f32_16x16x32_bf16 v[68:71], v[144:147], v[196:199], v[68:71]
    ds_read_b64_tr_b16 v[186:187], v226 offset:18176
    v_mfma_f32_16x16x32_bf16 v[72:75], v[144:147], v[200:203], v[72:75]
    ds_read_b64_tr_b16 v[188:189], v227 offset:17152
    v_mfma_f32_16x16x32_bf16 v[76:79], v[144:147], v[204:207], v[76:79]
    ds_read_b64_tr_b16 v[190:191], v227 offset:18176
    v_mfma_f32_16x16x32_bf16 v[92:95], v[148:151], v[204:207], v[92:95]
    v_mfma_f32_16x16x32_bf16 v[88:91], v[148:151], v[200:203], v[88:91]
    v_mfma_f32_16x16x32_bf16 v[84:87], v[148:151], v[196:199], v[84:87]
    v_mfma_f32_16x16x32_bf16 v[80:83], v[148:151], v[192:195], v[80:83]
    v_mfma_f32_16x16x32_bf16 v[96:99], v[152:155], v[192:195], v[96:99]
    v_mfma_f32_16x16x32_bf16 v[100:103], v[152:155], v[196:199], v[100:103]
    v_mfma_f32_16x16x32_bf16 v[104:107], v[152:155], v[200:203], v[104:107]
    v_mfma_f32_16x16x32_bf16 v[108:111], v[152:155], v[204:207], v[108:111]
    s_waitcnt vmcnt(2) lgkmcnt(0)
    s_barrier
    v_mfma_f32_16x16x32_bf16 v[124:127], v[156:159], v[204:207], v[124:127]
    v_mfma_f32_16x16x32_bf16 v[120:123], v[156:159], v[200:203], v[120:123]
    v_mfma_f32_16x16x32_bf16 v[116:119], v[156:159], v[196:199], v[116:119]
    v_mfma_f32_16x16x32_bf16 v[112:115], v[156:159], v[192:195], v[112:115]
    v_mfma_f32_16x16x32_bf16 v[0:3], v[160:163], v[208:211], v[0:3]
    ds_read_b128 v[192:195], v224 offset:32768
    v_mfma_f32_16x16x32_bf16 v[4:7], v[160:163], v[212:215], v[4:7]
    ds_read_b128 v[196:199], v224 offset:34816
    v_mfma_f32_16x16x32_bf16 v[8:11], v[160:163], v[216:219], v[8:11]
    ds_read_b128 v[200:203], v224 offset:36864
    v_mfma_f32_16x16x32_bf16 v[12:15], v[160:163], v[220:223], v[12:15]
    ds_read_b128 v[204:207], v224 offset:38912
    v_mfma_f32_16x16x32_bf16 v[28:31], v[164:167], v[220:223], v[28:31]
    ds_read_b64_tr_b16 v[128:129], v226 offset:32768
    v_mfma_f32_16x16x32_bf16 v[24:27], v[164:167], v[216:219], v[24:27]
    ds_read_b64_tr_b16 v[130:131], v226 offset:33792
    v_mfma_f32_16x16x32_bf16 v[20:23], v[164:167], v[212:215], v[20:23]
    ds_read_b64_tr_b16 v[132:133], v227 offset:32768
    v_mfma_f32_16x16x32_bf16 v[16:19], v[164:167], v[208:211], v[16:19]
    ds_read_b64_tr_b16 v[134:135], v227 offset:33792
    v_mfma_f32_16x16x32_bf16 v[32:35], v[168:171], v[208:211], v[32:35]
    ds_read_b64_tr_b16 v[136:137], v226 offset:33024
    v_mfma_f32_16x16x32_bf16 v[36:39], v[168:171], v[212:215], v[36:39]
    ds_read_b64_tr_b16 v[138:139], v226 offset:34048
    v_mfma_f32_16x16x32_bf16 v[40:43], v[168:171], v[216:219], v[40:43]
    ds_read_b64_tr_b16 v[140:141], v227 offset:33024
    v_mfma_f32_16x16x32_bf16 v[44:47], v[168:171], v[220:223], v[44:47]
    ds_read_b64_tr_b16 v[142:143], v227 offset:34048
    v_mfma_f32_16x16x32_bf16 v[60:63], v[172:175], v[220:223], v[60:63]
    ds_read_b64_tr_b16 v[144:145], v226 offset:33280
    v_mfma_f32_16x16x32_bf16 v[56:59], v[172:175], v[216:219], v[56:59]
    ds_read_b64_tr_b16 v[146:147], v226 offset:34304
    v_mfma_f32_16x16x32_bf16 v[52:55], v[172:175], v[212:215], v[52:55]
    ds_read_b64_tr_b16 v[148:149], v227 offset:33280
    v_mfma_f32_16x16x32_bf16 v[48:51], v[172:175], v[208:211], v[48:51]
    ds_read_b64_tr_b16 v[150:151], v227 offset:34304
    v_mfma_f32_16x16x32_bf16 v[64:67], v[176:179], v[208:211], v[64:67]
    ds_read_b64_tr_b16 v[152:153], v226 offset:33536
    v_mfma_f32_16x16x32_bf16 v[68:71], v[176:179], v[212:215], v[68:71]
    ds_read_b64_tr_b16 v[154:155], v226 offset:34560
    v_mfma_f32_16x16x32_bf16 v[72:75], v[176:179], v[216:219], v[72:75]
    ds_read_b64_tr_b16 v[156:157], v227 offset:33536
    v_mfma_f32_16x16x32_bf16 v[76:79], v[176:179], v[220:223], v[76:79]
    ds_read_b64_tr_b16 v[158:159], v227 offset:34560
    v_mfma_f32_16x16x32_bf16 v[92:95], v[180:183], v[220:223], v[92:95]
    v_mfma_f32_16x16x32_bf16 v[88:91], v[180:183], v[216:219], v[88:91]
    v_mfma_f32_16x16x32_bf16 v[84:87], v[180:183], v[212:215], v[84:87]
    v_mfma_f32_16x16x32_bf16 v[80:83], v[180:183], v[208:211], v[80:83]
    v_mfma_f32_16x16x32_bf16 v[96:99], v[184:187], v[208:211], v[96:99]
    v_mfma_f32_16x16x32_bf16 v[100:103], v[184:187], v[212:215], v[100:103]
    v_mfma_f32_16x16x32_bf16 v[104:107], v[184:187], v[216:219], v[104:107]
    v_mfma_f32_16x16x32_bf16 v[108:111], v[184:187], v[220:223], v[108:111]
    s_waitcnt vmcnt(0) lgkmcnt(0)
    s_barrier
    v_mfma_f32_16x16x32_bf16 v[124:127], v[188:191], v[220:223], v[124:127]
    v_mfma_f32_16x16x32_bf16 v[120:123], v[188:191], v[216:219], v[120:123]
    v_mfma_f32_16x16x32_bf16 v[116:119], v[188:191], v[212:215], v[116:119]
    v_mfma_f32_16x16x32_bf16 v[112:115], v[188:191], v[208:211], v[112:115]
    v_mfma_f32_16x16x32_bf16 v[0:3], v[128:131], v[192:195], v[0:3]
    ds_read_b128 v[208:211], v224 offset:33280
    v_mfma_f32_16x16x32_bf16 v[4:7], v[128:131], v[196:199], v[4:7]
    ds_read_b128 v[212:215], v224 offset:35328
    v_mfma_f32_16x16x32_bf16 v[8:11], v[128:131], v[200:203], v[8:11]
    ds_read_b128 v[216:219], v224 offset:37376
    v_mfma_f32_16x16x32_bf16 v[12:15], v[128:131], v[204:207], v[12:15]
    ds_read_b128 v[220:223], v224 offset:39424
    v_mfma_f32_16x16x32_bf16 v[28:31], v[132:135], v[204:207], v[28:31]
    ds_read_b64_tr_b16 v[160:161], v226 offset:49152
    v_mfma_f32_16x16x32_bf16 v[24:27], v[132:135], v[200:203], v[24:27]
    ds_read_b64_tr_b16 v[162:163], v226 offset:50176
    v_mfma_f32_16x16x32_bf16 v[20:23], v[132:135], v[196:199], v[20:23]
    ds_read_b64_tr_b16 v[164:165], v227 offset:49152
    v_mfma_f32_16x16x32_bf16 v[16:19], v[132:135], v[192:195], v[16:19]
    ds_read_b64_tr_b16 v[166:167], v227 offset:50176
    v_mfma_f32_16x16x32_bf16 v[32:35], v[136:139], v[192:195], v[32:35]
    ds_read_b64_tr_b16 v[168:169], v226 offset:49408
    v_mfma_f32_16x16x32_bf16 v[36:39], v[136:139], v[196:199], v[36:39]
    ds_read_b64_tr_b16 v[170:171], v226 offset:50432
    v_mfma_f32_16x16x32_bf16 v[40:43], v[136:139], v[200:203], v[40:43]
    ds_read_b64_tr_b16 v[172:173], v227 offset:49408
    v_mfma_f32_16x16x32_bf16 v[44:47], v[136:139], v[204:207], v[44:47]
    ds_read_b64_tr_b16 v[174:175], v227 offset:50432
    v_mfma_f32_16x16x32_bf16 v[60:63], v[140:143], v[204:207], v[60:63]
    ds_read_b64_tr_b16 v[176:177], v226 offset:49664
    v_mfma_f32_16x16x32_bf16 v[56:59], v[140:143], v[200:203], v[56:59]
    ds_read_b64_tr_b16 v[178:179], v226 offset:50688
    v_mfma_f32_16x16x32_bf16 v[52:55], v[140:143], v[196:199], v[52:55]
    ds_read_b64_tr_b16 v[180:181], v227 offset:49664
    v_mfma_f32_16x16x32_bf16 v[48:51], v[140:143], v[192:195], v[48:51]
    ds_read_b64_tr_b16 v[182:183], v227 offset:50688
    v_mfma_f32_16x16x32_bf16 v[64:67], v[144:147], v[192:195], v[64:67]
    ds_read_b64_tr_b16 v[184:185], v226 offset:49920
    v_mfma_f32_16x16x32_bf16 v[68:71], v[144:147], v[196:199], v[68:71]
    ds_read_b64_tr_b16 v[186:187], v226 offset:50944
    v_mfma_f32_16x16x32_bf16 v[72:75], v[144:147], v[200:203], v[72:75]
    ds_read_b64_tr_b16 v[188:189], v227 offset:49920
    v_mfma_f32_16x16x32_bf16 v[76:79], v[144:147], v[204:207], v[76:79]
    ds_read_b64_tr_b16 v[190:191], v227 offset:50944
    v_mfma_f32_16x16x32_bf16 v[92:95], v[148:151], v[204:207], v[92:95]
    v_mfma_f32_16x16x32_bf16 v[88:91], v[148:151], v[200:203], v[88:91]
    v_mfma_f32_16x16x32_bf16 v[84:87], v[148:151], v[196:199], v[84:87]
    v_mfma_f32_16x16x32_bf16 v[80:83], v[148:151], v[192:195], v[80:83]
    v_mfma_f32_16x16x32_bf16 v[96:99], v[152:155], v[192:195], v[96:99]
    v_mfma_f32_16x16x32_bf16 v[100:103], v[152:155], v[196:199], v[100:103]
    v_mfma_f32_16x16x32_bf16 v[104:107], v[152:155], v[200:203], v[104:107]
    v_mfma_f32_16x16x32_bf16 v[108:111], v[152:155], v[204:207], v[108:111]
    s_waitcnt lgkmcnt(0)
    s_barrier
    v_mfma_f32_16x16x32_bf16 v[124:127], v[156:159], v[204:207], v[124:127]
    v_mfma_f32_16x16x32_bf16 v[120:123], v[156:159], v[200:203], v[120:123]
    v_mfma_f32_16x16x32_bf16 v[116:119], v[156:159], v[196:199], v[116:119]
    v_mfma_f32_16x16x32_bf16 v[112:115], v[156:159], v[192:195], v[112:115]
    s_mov_b32 s79, 0
    s_cmp_lg_u32 s36, 0
    s_cbranch_scc1 L_hchk_X
L_getn_X:
    buffer_load_dword v237, v236, s[44:47], s71 offen sc1
    s_add_u32 s79, s79, 1
    s_waitcnt vmcnt(0)
    v_readfirstlane_b32 s36, v237
    s_cmp_ge_u32 s79, 0x40000
    s_cbranch_scc1 L_gotn_X
    s_cmp_eq_u32 s36, 0
    s_cbranch_scc1 L_getn_X
L_gotn_X:
    v_or_b32 v237, s61, v237
    s_mov_b64 exec, 1
    buffer_store_dwordx2 v[236:237], v236, s[40:43], s72 offen sc1
    s_mov_b64 exec, -1
L_hld_X:
    buffer_load_dword v238, v239, s[40:43], s60 offen offset:4 sc1
    s_add_u32 s79, s79, 1
    s_waitcnt vmcnt(0)
L_hchk_X:
    v_xor_b32 v238, v237, v238
    v_cmp_lt_u32 vcc, 15, v238
    s_cmp_ge_u32 s79, 0x40000
    s_cbranch_scc1 L_hok_X
    s_cbranch_vccnz L_hld_X
L_hok_X:
    v_cmp_ne_u32 vcc, 0, v238
    s_nop 0
    s_cmp_eq_u64 vcc, 0
    s_cselect_b32 s61, 1, 0
    s_cselect_b32 s78, 0, 16777216
    s_mov_b32 s27, 15
    s_mov_b32 s29, 0
    s_mov_b32 s37, 16384
    s_add_u32 s29, s29, 1
    s_cmp_lt_u32 s29, 5
    s_cselect_b32 s28, s37, 4294901760
    s_cselect_b32 s29, s29, 0
    v_mov_b32 v248, 0
    v_mov_b32 v249, 0
    v_mov_b32 v250, 0
    v_mov_b32 v251, 0
    v_mfma_f32_16x16x32_bf16 v[0:3], v[160:163], v[208:211], v[0:3]
    ds_read_b128 v[232:235], v252 offset:0
    v_mfma_f32_16x16x32_bf16 v[4:7], v[160:163], v[212:215], v[4:7]
    ds_read_b128 v[236:239], v252 offset:4096
    v_mfma_f32_16x16x32_bf16 v[8:11], v[160:163], v[216:219], v[8:11]
    ds_read_b128 v[240:243], v252 offset:256
    v_mfma_f32_16x16x32_bf16 v[12:15], v[160:163], v[220:223], v[12:15]
    ds_read_b128 v[244:247], v252 offset:4352
    v_mfma_f32_16x16x32_bf16 v[16:19], v[164:167], v[208:211], v[16:19]
    v_mfma_f32_16x16x32_bf16 v[20:23], v[164:167], v[212:215], v[20:23]
    v_mfma_f32_16x16x32_bf16 v[24:27], v[164:167], v[216:219], v[24:27]
    v_mfma_f32_16x16x32_bf16 v[28:31], v[164:167], v[220:223], v[28:31]
    v_mul_f32 v0, s30, v0
    v_mul_f32 v1, s30, v1
    v_mul_f32 v2, s30, v2
    v_mul_f32 v3, s30, v3
    v_mfma_f32_16x16x32_bf16 v[32:35], v[168:171], v[208:211], v[32:35]
    v_cvt_pk_bf16_f32 v128, v0, v1
    v_cvt_pk_bf16_f32 v129, v2, v3
    v_mul_f32 v16, s30, v16
    v_mul_f32 v17, s30, v17
    v_mfma_f32_16x16x32_bf16 v[36:39], v[168:171], v[212:215], v[36:39]
    v_mul_f32 v18, s30, v18
    v_mul_f32 v19, s30, v19
    v_cvt_pk_bf16_f32 v130, v16, v17
    v_cvt_pk_bf16_f32 v131, v18, v19
    v_mfma_f32_16x16x32_bf16 v[40:43], v[168:171], v[216:219], v[40:43]
    v_mul_f32 v4, s30, v4
    v_mul_f32 v5, s30, v5
    v_mul_f32 v6, s30, v6
    v_mul_f32 v7, s30, v7
    v_mfma_f32_16x16x32_bf16 v[44:47], v[168:171], v[220:223], v[44:47]
    v_cvt_pk_bf16_f32 v132, v4, v5
    v_cvt_pk_bf16_f32 v133, v6, v7
    v_mul_f32 v20, s30, v20
    v_mul_f32 v21, s30, v21
    v_mfma_f32_16x16x32_bf16 v[48:51], v[172:175], v[208:211], v[48:51]
    v_mul_f32 v22, s30, v22
    v_mul_f32 v23, s30, v23
    v_cvt_pk_bf16_f32 v134, v20, v21
    v_cvt_pk_bf16_f32 v135, v22, v23
    v_mfma_f32_16x16x32_bf16 v[52:55], v[172:175], v[212:215], v[52:55]
    v_mul_f32 v8, s30, v8
    v_mul_f32 v9, s30, v9
    v_mul_f32 v10, s30, v10
    v_mul_f32 v11, s30, v11
    v_mfma_f32_16x16x32_bf16 v[56:59], v[172:175], v[216:219], v[56:59]
    v_cvt_pk_bf16_f32 v136, v8, v9
    v_cvt_pk_bf16_f32 v137, v10, v11
    v_mul_f32 v24, s30, v24
    v_mul_f32 v25, s30, v25
    v_mfma_f32_16x16x32_bf16 v[60:63], v[172:175], v[220:223], v[60:63]
    v_mul_f32 v26, s30, v26
    v_mul_f32 v27, s30, v27
    v_cvt_pk_bf16_f32 v138, v24, v25
    v_cvt_pk_bf16_f32 v139, v26, v27
    v_mfma_f32_16x16x32_bf16 v[64:67], v[176:179], v[208:211], v[64:67]
    v_mul_f32 v12, s30, v12
    v_mul_f32 v13, s30, v13
    v_mul_f32 v14, s30, v14
    v_mul_f32 v15, s30, v15
    v_mfma_f32_16x16x32_bf16 v[68:71], v[176:179], v[212:215], v[68:71]
    v_cvt_pk_bf16_f32 v140, v12, v13
    v_cvt_pk_bf16_f32 v141, v14, v15
    v_mul_f32 v28, s30, v28
    v_mul_f32 v29, s30, v29
    v_mfma_f32_16x16x32_bf16 v[72:75], v[176:179], v[216:219], v[72:75]
    v_mul_f32 v30, s30, v30
    v_mul_f32 v31, s30, v31
    v_cvt_pk_bf16_f32 v142, v28, v29
    v_cvt_pk_bf16_f32 v143, v30, v31
    v_mfma_f32_16x16x32_bf16 v[76:79], v[176:179], v[220:223], v[76:79]
    v_permlane16_swap_b32 v128, v130
    v_permlane16_swap_b32 v129, v131
    v_permlane16_swap_b32 v132, v134
    v_permlane16_swap_b32 v133, v135
    v_mfma_f32_16x16x32_bf16 v[80:83], v[180:183], v[208:211], v[80:83]
    v_permlane16_swap_b32 v136, v138
    v_permlane16_swap_b32 v137, v139
    v_permlane16_swap_b32 v140, v142
    v_permlane16_swap_b32 v141, v143
    v_mfma_f32_16x16x32_bf16 v[84:87], v[180:183], v[212:215], v[84:87]
    v_mul_f32 v32, s30, v32
    v_mul_f32 v33, s30, v33
    v_mul_f32 v34, s30, v34
    v_mul_f32 v35, s30, v35
    v_mfma_f32_16x16x32_bf16 v[88:91], v[180:183], v[216:219], v[88:91]
    v_cvt_pk_bf16_f32 v144, v32, v33
    v_cvt_pk_bf16_f32 v145, v34, v35
    v_mul_f32 v48, s30, v48
    v_mul_f32 v49, s30, v49
    v_mfma_f32_16x16x32_bf16 v[92:95], v[180:183], v[220:223], v[92:95]
    v_mul_f32 v50, s30, v50
    v_mul_f32 v51, s30, v51
    v_cvt_pk_bf16_f32 v146, v48, v49
    v_cvt_pk_bf16_f32 v147, v50, v51
    v_mfma_f32_16x16x32_bf16 v[96:99], v[184:187], v[208:211], v[96:99]
    v_mul_f32 v36, s30, v36
    v_mul_f32 v37, s30, v37
    v_mul_f32 v38, s30, v38
    v_mul_f32 v39, s30, v39
    v_mfma_f32_16x16x32_bf16 v[100:103], v[184:187], v[212:215], v[100:103]
    v_cvt_pk_bf16_f32 v148, v36, v37
    v_cvt_pk_bf16_f32 v149, v38, v39
    v_mul_f32 v52, s30, v52
    v_mul_f32 v53, s30, v53
    v_mfma_f32_16x16x32_bf16 v[104:107], v[184:187], v[216:219], v[104:107]
    v_mul_f32 v54, s30, v54
    v_mul_f32 v55, s30, v55
    v_cvt_pk_bf16_f32 v150, v52, v53
    v_cvt_pk_bf16_f32 v151, v54, v55
    v_mfma_f32_16x16x32_bf16 v[108:111], v[184:187], v[220:223], v[108:111]
    v_mul_f32 v40, s30, v40
    v_mul_f32 v41, s30, v41
    v_mul_f32 v42, s30, v42
    v_mul_f32 v43, s30, v43
    v_mfma_f32_16x16x32_bf16 v[112:115], v[188:191], v[208:211], v[112:115]
    v_cvt_pk_bf16_f32 v152, v40, v41
    v_cvt_pk_bf16_f32 v153, v42, v43
    v_mul_f32 v56, s30, v56
    v_mul_f32 v57, s30, v57
    v_mfma_f32_16x16x32_bf16 v[116:119], v[188:191], v[212:215], v[116:119]
    v_mul_f32 v58, s30, v58
    v_mul_f32 v59, s30, v59
    v_cvt_pk_bf16_f32 v154, v56, v57
    v_cvt_pk_bf16_f32 v155, v58, v59
    v_mfma_f32_16x16x32_bf16 v[120:123], v[188:191], v[216:219], v[120:123]
    v_mul_f32 v44, s30, v44
    v_mul_f32 v45, s30, v45
    v_mul_f32 v46, s30, v46
    v_mul_f32 v47, s30, v47
    v_mfma_f32_16x16x32_bf16 v[124:127], v[188:191], v[220:223], v[124:127]
    v_cvt_pk_bf16_f32 v156, v44, v45
    v_cvt_pk_bf16_f32 v157, v46, v47
    v_mul_f32 v60, s30, v60
    v_mul_f32 v61, s30, v61
    s_waitcnt lgkmcnt(3)
    v_mfma_f32_16x16x32_bf16 v[192:195], v[232:235], v[128:131], 0
    ds_read_b128 v[224:227], v252 offset:512
    v_mul_f32 v62, s30, v62
    v_mul_f32 v63, s30, v63
    v_cvt_pk_bf16_f32 v158, v60, v61
    v_cvt_pk_bf16_f32 v159, v62, v63
    v_mfma_f32_16x16x32_bf16 v[200:203], v[232:235], v[132:135], 0
    v_permlane16_swap_b32 v144, v146
    v_permlane16_swap_b32 v145, v147
    v_permlane16_swap_b32 v148, v150
    v_permlane16_swap_b32 v149, v151
    v_mfma_f32_16x16x32_bf16 v[208:211], v[232:235], v[136:139], 0
    v_permlane16_swap_b32 v152, v154
    v_permlane16_swap_b32 v153, v155
    v_permlane16_swap_b32 v156, v158
    v_permlane16_swap_b32 v157, v159
    v_mfma_f32_16x16x32_bf16 v[216:219], v[232:235], v[140:143], 0
    v_mul_f32 v64, s30, v64
    v_mul_f32 v65, s30, v65
    v_mul_f32 v66, s30, v66
    v_mul_f32 v67, s30, v67
    s_waitcnt lgkmcnt(3)
    v_mfma_f32_16x16x32_bf16 v[196:199], v[236:239], v[128:131], 0
    ds_read_b128 v[228:231], v252 offset:4608
    v_cvt_pk_bf16_f32 v160, v64, v65
    v_cvt_pk_bf16_f32 v161, v66, v67
    v_mul_f32 v80, s30, v80
    v_mul_f32 v81, s30, v81
    v_mfma_f32_16x16x32_bf16 v[204:207], v[236:239], v[132:135], 0
    v_mul_f32 v82, s30, v82
    v_mul_f32 v83, s30, v83
    v_cvt_pk_bf16_f32 v162, v80, v81
    v_cvt_pk_bf16_f32 v163, v82, v83
    v_mfma_f32_16x16x32_bf16 v[212:215], v[236:239], v[136:139], 0
    v_mul_f32 v68, s30, v68
    v_mul_f32 v69, s30, v69
    v_mul_f32 v70, s30, v70
    v_mul_f32 v71, s30, v71
    v_mfma_f32_16x16x32_bf16 v[220:223], v[236:239], v[140:143], 0
    v_cvt_pk_bf16_f32 v164, v68, v69
    v_cvt_pk_bf16_f32 v165, v70, v71
    v_mul_f32 v84, s30, v84
    v_mul_f32 v85, s30, v85
    s_waitcnt lgkmcnt(3)
    v_mfma_f32_16x16x32_bf16 v[192:195], v[240:243], v[144:147], v[192:195]
    ds_read_b128 v[232:235], v252 offset:768
    v_mul_f32 v86, s30, v86
    v_mul_f32 v87, s30, v87
    v_cvt_pk_bf16_f32 v166, v84, v85
    v_cvt_pk_bf16_f32 v167, v86, v87
    v_mfma_f32_16x16x32_bf16 v[200:203], v[240:243], v[148:151], v[200:203]
    v_mul_f32 v72, s30, v72
    v_mul_f32 v73, s30, v73
    v_mul_f32 v74, s30, v74
    v_mul_f32 v75, s30, v75
    v_mfma_f32_16x16x32_bf16 v[208:211], v[240:243], v[152:155], v[208:211]
    v_cvt_pk_bf16_f32 v168, v72, v73
    v_cvt_pk_bf16_f32 v169, v74, v75
    v_mul_f32 v88, s30, v88
    v_mul_f32 v89, s30, v89
    v_mfma_f32_16x16x32_bf16 v[216:219], v[240:243], v[156:159], v[216:219]
    v_mul_f32 v90, s30, v90
    v_mul_f32 v91, s30, v91
    v_cvt_pk_bf16_f32 v170, v88, v89
    v_cvt_pk_bf16_f32 v171, v90, v91
    s_waitcnt lgkmcnt(3)
    v_mfma_f32_16x16x32_bf16 v[196:199], v[244:247], v[144:147], v[196:199]
    ds_read_b128 v[236:239], v252 offset:4864
    v_add_u32 v252, s28, v252
    v_mul_f32 v76, s30, v76
    v_mul_f32 v77, s30, v77
    v_mul_f32 v78, s30, v78
    v_mul_f32 v79, s30, v79
    v_mfma_f32_16x16x32_bf16 v[204:207], v[244:247], v[148:151], v[204:207]
    v_cvt_pk_bf16_f32 v172, v76, v77
    v_cvt_pk_bf16_f32 v173, v78, v79
    v_mul_f32 v92, s30, v92
    v_mul_f32 v93, s30, v93
    v_mfma_f32_16x16x32_bf16 v[212:215], v[244:247], v[152:155], v[212:215]
    v_mul_f32 v94, s30, v94
    v_mul_f32 v95, s30, v95
    v_cvt_pk_bf16_f32 v174, v92, v93
    v_cvt_pk_bf16_f32 v175, v94, v95
    v_mfma_f32_16x16x32_bf16 v[220:223], v[244:247], v[156:159], v[220:223]
    v_permlane16_swap_b32 v160, v162
    v_permlane16_swap_b32 v161, v163
    v_permlane16_swap_b32 v164, v166
    v_permlane16_swap_b32 v165, v167
    v_permlane16_swap_b32 v168, v170
    v_permlane16_swap_b32 v169, v171
    v_permlane16_swap_b32 v172, v174
    v_permlane16_swap_b32 v173, v175
    s_waitcnt lgkmcnt(3)
    s_setprio 2
    s_waitcnt lgkmcnt(0)
    s_barrier
    v_mfma_f32_16x16x32_bf16 v[192:195], v[224:227], v[160:163], v[192:195]
    v_mul_f32 v96, s30, v96
    v_mul_f32 v97, s30, v97
    v_mul_f32 v98, s30, v98
    v_mul_f32 v99, s30, v99
    v_mfma_f32_16x16x32_bf16 v[200:203], v[224:227], v[164:167], v[200:203]
    ds_read_b64_tr_b16 v[240:241], v253 offset:0
    ds_read_b64_tr_b16 v[242:243], v253 offset:4096
    v_cvt_pk_bf16_f32 v176, v96, v97
    v_cvt_pk_bf16_f32 v177, v98, v99
    v_mul_f32 v112, s30, v112
    v_mul_f32 v113, s30, v113
    v_mfma_f32_16x16x32_bf16 v[208:211], v[224:227], v[168:171], v[208:211]
    v_mul_f32 v114, s30, v114
    v_mul_f32 v115, s30, v115
    v_cvt_pk_bf16_f32 v178, v112, v113
    v_cvt_pk_bf16_f32 v179, v114, v115
    v_mfma_f32_16x16x32_bf16 v[216:219], v[224:227], v[172:175], v[216:219]
    v_mul_f32 v100, s30, v100
    v_mul_f32 v101, s30, v101
    v_mul_f32 v102, s30, v102
    v_mul_f32 v103, s30, v103
    v_mfma_f32_16x16x32_bf16 v[196:199], v[228:231], v[160:163], v[196:199]
    v_cvt_pk_bf16_f32 v180, v100, v101
    v_cvt_pk_bf16_f32 v181, v102, v103
    v_mul_f32 v116, s30, v116
    v_mul_f32 v117, s30, v117
    v_mfma_f32_16x16x32_bf16 v[204:207], v[228:231], v[164:167], v[204:207]
    ds_read_b64_tr_b16 v[244:245], v254 offset:0
    ds_read_b64_tr_b16 v[246:247], v254 offset:4096
    v_mul_f32 v118, s30, v118
    v_mul_f32 v119, s30, v119
    v_cvt_pk_bf16_f32 v182, v116, v117
    v_cvt_pk_bf16_f32 v183, v118, v119
    v_mfma_f32_16x16x32_bf16 v[212:215], v[228:231], v[168:171], v[212:215]
    v_mul_f32 v104, s30, v104
    v_mul_f32 v105, s30, v105
    v_mul_f32 v106, s30, v106
    v_mul_f32 v107, s30, v107
    v_mfma_f32_16x16x32_bf16 v[220:223], v[228:231], v[172:175], v[220:223]
    v_cvt_pk_bf16_f32 v184, v104, v105
    v_cvt_pk_bf16_f32 v185, v106, v107
    v_mul_f32 v120, s30, v120
    v_mul_f32 v121, s30, v121
    v_mul_f32 v122, s30, v122
    v_mul_f32 v123, s30, v123
    v_cvt_pk_bf16_f32 v186, v120, v121
    v_cvt_pk_bf16_f32 v187, v122, v123
    v_mul_f32 v108, s30, v108
    v_mul_f32 v109, s30, v109
    v_mul_f32 v110, s30, v110
    v_mul_f32 v111, s30, v111
    v_cvt_pk_bf16_f32 v188, v108, v109
    v_cvt_pk_bf16_f32 v189, v110, v111
    v_mul_f32 v124, s30, v124
    v_mul_f32 v125, s30, v125
    v_mul_f32 v126, s30, v126
    v_mul_f32 v127, s30, v127
    v_cvt_pk_bf16_f32 v190, v124, v125
    v_cvt_pk_bf16_f32 v191, v126, v127
    v_permlane16_swap_b32 v176, v178
    v_permlane16_swap_b32 v177, v179
    v_permlane16_swap_b32 v180, v182
    v_permlane16_swap_b32 v181, v183
    v_permlane16_swap_b32 v184, v186
    v_permlane16_swap_b32 v185, v187
    v_permlane16_swap_b32 v188, v190
    v_permlane16_swap_b32 v189, v191
    v_mfma_f32_16x16x32_bf16 v[192:195], v[232:235], v[176:179], v[192:195]
    v_mfma_f32_16x16x32_bf16 v[200:203], v[232:235], v[180:183], v[200:203]
    ds_read_b64_tr_b16 v[224:225], v253 offset:256
    ds_read_b64_tr_b16 v[226:227], v253 offset:4352
    v_mfma_f32_16x16x32_bf16 v[208:211], v[232:235], v[184:187], v[208:211]
    v_mfma_f32_16x16x32_bf16 v[216:219], v[232:235], v[188:191], v[216:219]
    v_mfma_f32_16x16x32_bf16 v[196:199], v[236:239], v[176:179], v[196:199]
    v_mfma_f32_16x16x32_bf16 v[204:207], v[236:239], v[180:183], v[204:207]
    ds_read_b64_tr_b16 v[228:229], v254 offset:256
    ds_read_b64_tr_b16 v[230:231], v254 offset:4352
    v_mfma_f32_16x16x32_bf16 v[212:215], v[236:239], v[184:187], v[212:215]
    v_mfma_f32_16x16x32_bf16 v[220:223], v[236:239], v[188:191], v[220:223]
    s_setprio 0
    v_exp_f32 v192, v192
    v_exp_f32 v193, v193
    v_exp_f32 v194, v194
    v_exp_f32 v195, v195
    v_add_f32 v248, v248, v192
    v_add_f32 v248, v248, v193
    v_add_f32 v248, v248, v194
    v_add_f32 v248, v248, v195
    v_cvt_pk_bf16_f32 v192, v192, v193
    v_cvt_pk_bf16_f32 v193, v194, v195
    v_exp_f32 v200, v200
    v_exp_f32 v201, v201
    v_exp_f32 v202, v202
    v_exp_f32 v203, v203
    v_add_f32 v249, v249, v200
    v_add_f32 v249, v249, v201
    v_add_f32 v249, v249, v202
    v_add_f32 v249, v249, v203
    v_cvt_pk_bf16_f32 v200, v200, v201
    v_cvt_pk_bf16_f32 v201, v202, v203
    v_exp_f32 v208, v208
    v_exp_f32 v209, v209
    v_exp_f32 v210, v210
    v_exp_f32 v211, v211
    v_add_f32 v250, v250, v208
    v_add_f32 v250, v250, v209
    v_add_f32 v250, v250, v210
    v_add_f32 v250, v250, v211
    v_cvt_pk_bf16_f32 v208, v208, v209
    v_cvt_pk_bf16_f32 v209, v210, v211
    v_exp_f32 v216, v216
    v_exp_f32 v217, v217
    v_exp_f32 v218, v218
    v_exp_f32 v219, v219
    v_add_f32 v251, v251, v216
    v_add_f32 v251, v251, v217
    v_add_f32 v251, v251, v218
    v_add_f32 v251, v251, v219
    v_cvt_pk_bf16_f32 v216, v216, v217
    v_cvt_pk_bf16_f32 v217, v218, v219
    v_exp_f32 v196, v196
    v_exp_f32 v197, v197
    v_exp_f32 v198, v198
    v_exp_f32 v199, v199
    v_add_f32 v248, v248, v196
    v_add_f32 v248, v248, v197
    v_add_f32 v248, v248, v198
    v_add_f32 v248, v248, v199
    v_cvt_pk_bf16_f32 v194, v196, v197
    v_cvt_pk_bf16_f32 v195, v198, v199
    v_exp_f32 v204, v204
    v_exp_f32 v205, v205
    v_exp_f32 v206, v206
    v_exp_f32 v207, v207
    v_add_f32 v249, v249, v204
    v_add_f32 v249, v249, v205
    v_add_f32 v249, v249, v206
    v_add_f32 v249, v249, v207
    v_cvt_pk_bf16_f32 v202, v204, v205
    v_cvt_pk_bf16_f32 v203, v206, v207
    v_exp_f32 v212, v212
    v_exp_f32 v213, v213
    v_exp_f32 v214, v214
    v_exp_f32 v215, v215
    v_add_f32 v250, v250, v212
    v_add_f32 v250, v250, v213
    v_add_f32 v250, v250, v214
    v_add_f32 v250, v250, v215
    v_cvt_pk_bf16_f32 v210, v212, v213
    v_cvt_pk_bf16_f32 v211, v214, v215
    v_exp_f32 v220, v220
    v_exp_f32 v221, v221
    v_exp_f32 v222, v222
    v_exp_f32 v223, v223
    v_add_f32 v251, v251, v220
    v_add_f32 v251, v251, v221
    v_add_f32 v251, v251, v222
    v_add_f32 v251, v251, v223
    v_cvt_pk_bf16_f32 v218, v220, v221
    v_cvt_pk_bf16_f32 v219, v222, v223
    s_waitcnt lgkmcnt(6)
    v_mfma_f32_16x16x32_bf16 v[0:3], v[240:243], v[192:195], 0
    ds_read_b64_tr_b16 v[232:233], v253 offset:512
    ds_read_b64_tr_b16 v[234:235], v253 offset:4608
    v_mfma_f32_16x16x32_bf16 v[4:7], v[240:243], v[200:203], 0
    v_mfma_f32_16x16x32_bf16 v[8:11], v[240:243], v[208:211], 0
    v_mfma_f32_16x16x32_bf16 v[12:15], v[240:243], v[216:219], 0
    s_waitcnt lgkmcnt(6)
    v_mfma_f32_16x16x32_bf16 v[28:31], v[244:247], v[216:219], 0
    ds_read_b64_tr_b16 v[236:237], v254 offset:512
    ds_read_b64_tr_b16 v[238:239], v254 offset:4608
    v_mfma_f32_16x16x32_bf16 v[24:27], v[244:247], v[208:211], 0
    v_mfma_f32_16x16x32_bf16 v[20:23], v[244:247], v[200:203], 0
    v_mfma_f32_16x16x32_bf16 v[16:19], v[244:247], v[192:195], 0
    s_waitcnt lgkmcnt(6)
    v_mfma_f32_16x16x32_bf16 v[32:35], v[224:227], v[192:195], 0
    ds_read_b64_tr_b16 v[240:241], v253 offset:768
    ds_read_b64_tr_b16 v[242:243], v253 offset:4864
    v_mfma_f32_16x16x32_bf16 v[36:39], v[224:227], v[200:203], 0
    v_mfma_f32_16x16x32_bf16 v[40:43], v[224:227], v[208:211], 0
    v_mfma_f32_16x16x32_bf16 v[44:47], v[224:227], v[216:219], 0
    s_waitcnt lgkmcnt(6)
    v_mfma_f32_16x16x32_bf16 v[60:63], v[228:231], v[216:219], 0
    ds_read_b64_tr_b16 v[244:245], v254 offset:768
    ds_read_b64_tr_b16 v[246:247], v254 offset:4864
    v_add_u32 v253, s28, v253
    v_add_u32 v254, s28, v254
    v_mfma_f32_16x16x32_bf16 v[56:59], v[228:231], v[208:211], 0
    v_mfma_f32_16x16x32_bf16 v[52:55], v[228:231], v[200:203], 0
    v_mfma_f32_16x16x32_bf16 v[48:51], v[228:231], v[192:195], 0
    s_waitcnt lgkmcnt(6)
    v_mfma_f32_16x16x32_bf16 v[64:67], v[232:235], v[192:195], 0
    ds_read_b128 v[196:199], v252 offset:0
    v_mfma_f32_16x16x32_bf16 v[68:71], v[232:235], v[200:203], 0
    v_mfma_f32_16x16x32_bf16 v[72:75], v[232:235], v[208:211], 0
    v_mfma_f32_16x16x32_bf16 v[76:79], v[232:235], v[216:219], 0
    s_waitcnt lgkmcnt(5)
    v_mfma_f32_16x16x32_bf16 v[92:95], v[236:239], v[216:219], 0
    ds_read_b128 v[204:207], v252 offset:256
    v_mfma_f32_16x16x32_bf16 v[88:91], v[236:239], v[208:211], 0
    v_mfma_f32_16x16x32_bf16 v[84:87], v[236:239], v[200:203], 0
    v_mfma_f32_16x16x32_bf16 v[80:83], v[236:239], v[192:195], 0
    s_waitcnt lgkmcnt(4)
    v_mfma_f32_16x16x32_bf16 v[96:99], v[240:243], v[192:195], 0
    ds_read_b128 v[212:215], v252 offset:512
    v_mfma_f32_16x16x32_bf16 v[100:103], v[240:243], v[200:203], 0
    v_mfma_f32_16x16x32_bf16 v[104:107], v[240:243], v[208:211], 0
    v_mfma_f32_16x16x32_bf16 v[108:111], v[240:243], v[216:219], 0
    s_waitcnt lgkmcnt(3)
    v_mfma_f32_16x16x32_bf16 v[124:127], v[244:247], v[216:219], 0
    ds_read_b128 v[220:223], v252 offset:768
    v_mfma_f32_16x16x32_bf16 v[120:123], v[244:247], v[208:211], 0
    v_mfma_f32_16x16x32_bf16 v[116:119], v[244:247], v[200:203], 0
    v_mfma_f32_16x16x32_bf16 v[112:115], v[244:247], v[192:195], 0
    .p2align 6
L_attn_X:
    s_add_u32 s29, s29, 1
    s_cmp_lt_u32 s29, 5
    s_cselect_b32 s28, s37, 4294901760
    s_cselect_b32 s29, s29, 0
    s_waitcnt lgkmcnt(3)
    v_mfma_f32_16x16x32_bf16 v[192:195], v[196:199], v[128:131], 0
    ds_read_b128 v[224:227], v252 offset:4096
    s_waitcnt lgkmcnt(3)
    v_mfma_f32_16x16x32_bf16 v[192:195], v[204:207], v[144:147], v[192:195]
    ds_read_b128 v[228:231], v252 offset:4352
    s_waitcnt lgkmcnt(3)
    v_mfma_f32_16x16x32_bf16 v[192:195], v[212:215], v[160:163], v[192:195]
    ds_read_b128 v[232:235], v252 offset:4608
    s_waitcnt lgkmcnt(3)
    v_mfma_f32_16x16x32_bf16 v[192:195], v[220:223], v[176:179], v[192:195]
    ds_read_b128 v[236:239], v252 offset:4864
    v_add_u32 v252, s28, v252
    v_mfma_f32_16x16x32_bf16 v[200:203], v[220:223], v[180:183], 0
    v_mfma_f32_16x16x32_bf16 v[200:203], v[212:215], v[164:167], v[200:203]
    v_mfma_f32_16x16x32_bf16 v[200:203], v[204:207], v[148:151], v[200:203]
    s_nop 2
    v_exp_f32 v192, v192
    v_mfma_f32_16x16x32_bf16 v[200:203], v[196:199], v[132:135], v[200:203]
    v_exp_f32 v193, v193
    v_mfma_f32_16x16x32_bf16 v[208:211], v[196:199], v[136:139], 0
    v_exp_f32 v194, v194
    v_mfma_f32_16x16x32_bf16 v[208:211], v[204:207], v[152:155], v[208:211]
    v_exp_f32 v195, v195
    v_mfma_f32_16x16x32_bf16 v[208:211], v[212:215], v[168:171], v[208:211]
    v_add_f32 v248, v248, v192
    v_add_f32 v248, v248, v193
    v_mfma_f32_16x16x32_bf16 v[208:211], v[220:223], v[184:187], v[208:211]
    v_add_f32 v248, v248, v194
    v_add_f32 v248, v248, v195
    v_mfma_f32_16x16x32_bf16 v[216:219], v[220:223], v[188:191], 0
    v_cvt_pk_bf16_f32 v192, v192, v193
    v_cvt_pk_bf16_f32 v193, v194, v195
    v_mfma_f32_16x16x32_bf16 v[216:219], v[212:215], v[172:175], v[216:219]
    v_exp_f32 v200, v200
    v_mfma_f32_16x16x32_bf16 v[216:219], v[204:207], v[156:159], v[216:219]
    v_exp_f32 v201, v201
    v_mfma_f32_16x16x32_bf16 v[216:219], v[196:199], v[140:143], v[216:219]
    v_exp_f32 v202, v202
    s_setprio 2
    s_waitcnt lgkmcnt(0)
    s_barrier
    v_mfma_f32_16x16x32_bf16 v[196:199], v[224:227], v[128:131], 0
    ds_read_b64_tr_b16 v[240:241], v253 offset:0
    ds_read_b64_tr_b16 v[242:243], v253 offset:4096
    v_exp_f32 v203, v203
    v_mfma_f32_16x16x32_bf16 v[196:199], v[228:231], v[144:147], v[196:199]
    ds_read_b64_tr_b16 v[244:245], v254 offset:0
    ds_read_b64_tr_b16 v[246:247], v254 offset:4096
    v_add_f32 v249, v249, v200
    v_add_f32 v249, v249, v201
    v_mfma_f32_16x16x32_bf16 v[196:199], v[232:235], v[160:163], v[196:199]
    v_add_f32 v249, v249, v202
    v_add_f32 v249, v249, v203
    v_mfma_f32_16x16x32_bf16 v[196:199], v[236:239], v[176:179], v[196:199]
    v_cvt_pk_bf16_f32 v200, v200, v201
    v_cvt_pk_bf16_f32 v201, v202, v203
    v_mfma_f32_16x16x32_bf16 v[204:207], v[236:239], v[180:183], 0
    v_exp_f32 v208, v208
    v_mfma_f32_16x16x32_bf16 v[204:207], v[232:235], v[164:167], v[204:207]
    v_exp_f32 v209, v209
    v_mfma_f32_16x16x32_bf16 v[204:207], v[228:231], v[148:151], v[204:207]
    v_exp_f32 v210, v210
    v_mfma_f32_16x16x32_bf16 v[204:207], v[224:227], v[132:135], v[204:207]
    v_exp_f32 v211, v211
    v_mfma_f32_16x16x32_bf16 v[212:215], v[224:227], v[136:139], 0
    v_add_f32 v250, v250, v208
    v_add_f32 v250, v250, v209
    v_mfma_f32_16x16x32_bf16 v[212:215], v[228:231], v[152:155], v[212:215]
    v_add_f32 v250, v250, v210
    v_add_f32 v250, v250, v211
    v_mfma_f32_16x16x32_bf16 v[212:215], v[232:235], v[168:171], v[212:215]
    v_cvt_pk_bf16_f32 v208, v208, v209
    v_cvt_pk_bf16_f32 v209, v210, v211
    v_mfma_f32_16x16x32_bf16 v[212:215], v[236:239], v[184:187], v[212:215]
    v_exp_f32 v216, v216
    v_mfma_f32_16x16x32_bf16 v[220:223], v[236:239], v[188:191], 0
    v_exp_f32 v217, v217
    v_mfma_f32_16x16x32_bf16 v[220:223], v[232:235], v[172:175], v[220:223]
    v_exp_f32 v218, v218
    v_mfma_f32_16x16x32_bf16 v[220:223], v[228:231], v[156:159], v[220:223]
    v_exp_f32 v219, v219
    v_mfma_f32_16x16x32_bf16 v[220:223], v[224:227], v[140:143], v[220:223]
    v_add_f32 v251, v251, v216
    v_add_f32 v251, v251, v217
    s_setprio 0
    ds_read_b64_tr_b16 v[224:225], v253 offset:256
    ds_read_b64_tr_b16 v[226:227], v253 offset:4352
    ds_read_b64_tr_b16 v[228:229], v254 offset:256
    ds_read_b64_tr_b16 v[230:231], v254 offset:4352
    v_add_f32 v251, v251, v218
    v_add_f32 v251, v251, v219
    v_cvt_pk_bf16_f32 v216, v216, v217
    v_cvt_pk_bf16_f32 v217, v218, v219
    v_exp_f32 v196, v196
    v_exp_f32 v197, v197
    v_exp_f32 v198, v198
    v_exp_f32 v199, v199
    v_add_f32 v248, v248, v196
    v_add_f32 v248, v248, v197
    v_add_f32 v248, v248, v198
    v_add_f32 v248, v248, v199
    v_cvt_pk_bf16_f32 v194, v196, v197
    v_cvt_pk_bf16_f32 v195, v198, v199
    v_exp_f32 v204, v204
    v_exp_f32 v205, v205
    v_exp_f32 v206, v206
    v_exp_f32 v207, v207
    v_add_f32 v249, v249, v204
    v_add_f32 v249, v249, v205
    v_add_f32 v249, v249, v206
    v_add_f32 v249, v249, v207
    v_cvt_pk_bf16_f32 v202, v204, v205
    v_cvt_pk_bf16_f32 v203, v206, v207
    v_exp_f32 v212, v212
    v_exp_f32 v213, v213
    v_exp_f32 v214, v214
    v_exp_f32 v215, v215
    v_add_f32 v250, v250, v212
    v_add_f32 v250, v250, v213
    v_add_f32 v250, v250, v214
    v_add_f32 v250, v250, v215
    v_cvt_pk_bf16_f32 v210, v212, v213
    v_cvt_pk_bf16_f32 v211, v214, v215
    v_exp_f32 v220, v220
    v_exp_f32 v221, v221
    v_exp_f32 v222, v222
    v_exp_f32 v223, v223
    v_add_f32 v251, v251, v220
    v_add_f32 v251, v251, v221
    v_add_f32 v251, v251, v222
    v_add_f32 v251, v251, v223
    v_cvt_pk_bf16_f32 v218, v220, v221
    v_cvt_pk_bf16_f32 v219, v222, v223
    s_waitcnt lgkmcnt(6)
    v_mfma_f32_16x16x32_bf16 v[0:3], v[240:243], v[192:195], v[0:3]
    ds_read_b64_tr_b16 v[232:233], v253 offset:512
    ds_read_b64_tr_b16 v[234:235], v253 offset:4608
    v_mfma_f32_16x16x32_bf16 v[4:7], v[240:243], v[200:203], v[4:7]
    v_mfma_f32_16x16x32_bf16 v[8:11], v[240:243], v[208:211], v[8:11]
    v_mfma_f32_16x16x32_bf16 v[12:15], v[240:243], v[216:219], v[12:15]
    s_waitcnt lgkmcnt(6)
    v_mfma_f32_16x16x32_bf16 v[28:31], v[244:247], v[216:219], v[28:31]
    ds_read_b64_tr_b16 v[236:237], v254 offset:512
    ds_read_b64_tr_b16 v[238:239], v254 offset:4608
    v_mfma_f32_16x16x32_bf16 v[24:27], v[244:247], v[208:211], v[24:27]
    v_mfma_f32_16x16x32_bf16 v[20:23], v[244:247], v[200:203], v[20:23]
    v_mfma_f32_16x16x32_bf16 v[16:19], v[244:247], v[192:195], v[16:19]
    s_waitcnt lgkmcnt(6)
    v_mfma_f32_16x16x32_bf16 v[32:35], v[224:227], v[192:195], v[32:35]
    ds_read_b64_tr_b16 v[240:241], v253 offset:768
    ds_read_b64_tr_b16 v[242:243], v253 offset:4864
    v_mfma_f32_16x16x32_bf16 v[36:39], v[224:227], v[200:203], v[36:39]
    v_mfma_f32_16x16x32_bf16 v[40:43], v[224:227], v[208:211], v[40:43]
    v_mfma_f32_16x16x32_bf16 v[44:47], v[224:227], v[216:219], v[44:47]
    s_waitcnt lgkmcnt(6)
    v_mfma_f32_16x16x32_bf16 v[60:63], v[228:231], v[216:219], v[60:63]
    ds_read_b64_tr_b16 v[244:245], v254 offset:768
    ds_read_b64_tr_b16 v[246:247], v254 offset:4864
    v_add_u32 v253, s28, v253
    v_add_u32 v254, s28, v254
    v_mfma_f32_16x16x32_bf16 v[56:59], v[228:231], v[208:211], v[56:59]
    v_mfma_f32_16x16x32_bf16 v[52:55], v[228:231], v[200:203], v[52:55]
    v_mfma_f32_16x16x32_bf16 v[48:51], v[228:231], v[192:195], v[48:51]
    s_waitcnt lgkmcnt(6)
    v_mfma_f32_16x16x32_bf16 v[64:67], v[232:235], v[192:195], v[64:67]
    ds_read_b128 v[196:199], v252 offset:0
    v_mfma_f32_16x16x32_bf16 v[68:71], v[232:235], v[200:203], v[68:71]
    v_mfma_f32_16x16x32_bf16 v[72:75], v[232:235], v[208:211], v[72:75]
    v_mfma_f32_16x16x32_bf16 v[76:79], v[232:235], v[216:219], v[76:79]
    s_waitcnt lgkmcnt(5)
    v_mfma_f32_16x16x32_bf16 v[92:95], v[236:239], v[216:219], v[92:95]
    ds_read_b128 v[204:207], v252 offset:256
    v_mfma_f32_16x16x32_bf16 v[88:91], v[236:239], v[208:211], v[88:91]
    v_mfma_f32_16x16x32_bf16 v[84:87], v[236:239], v[200:203], v[84:87]
    v_mfma_f32_16x16x32_bf16 v[80:83], v[236:239], v[192:195], v[80:83]
    s_waitcnt lgkmcnt(4)
    v_mfma_f32_16x16x32_bf16 v[96:99], v[240:243], v[192:195], v[96:99]
    ds_read_b128 v[212:215], v252 offset:512
    v_mfma_f32_16x16x32_bf16 v[100:103], v[240:243], v[200:203], v[100:103]
    v_mfma_f32_16x16x32_bf16 v[104:107], v[240:243], v[208:211], v[104:107]
    v_mfma_f32_16x16x32_bf16 v[108:111], v[240:243], v[216:219], v[108:111]
    s_sub_u32 s27, s27, 1
    s_cmp_lg_u32 s27, 0
    s_waitcnt lgkmcnt(3)
    v_mfma_f32_16x16x32_bf16 v[124:127], v[244:247], v[216:219], v[124:127]
    ds_read_b128 v[220:223], v252 offset:768
    v_mfma_f32_16x16x32_bf16 v[120:123], v[244:247], v[208:211], v[120:123]
    v_mfma_f32_16x16x32_bf16 v[116:119], v[244:247], v[200:203], v[116:119]
    v_mfma_f32_16x16x32_bf16 v[112:115], v[244:247], v[192:195], v[112:115]
    s_cbranch_scc1 L_attn_X
    v_subrev_u32 v253, 98304, v253
    v_subrev_u32 v254, 98304, v254
    v_subrev_u32 v252, 16384, v252
    s_mov_b32 s27, 0
L_post_X:
    s_waitcnt lgkmcnt(0)
    v_mov_b32 v192, v248
    v_mov_b32 v193, v249
    v_mov_b32 v194, v250
    v_mov_b32 v195, v251
    v_permlane16_swap_b32 v192, v248
    v_permlane16_swap_b32 v193, v249
    v_permlane16_swap_b32 v194, v250
    v_permlane16_swap_b32 v195, v251
    v_add_f32 v248, v248, v192
    v_add_f32 v249, v249, v193
    v_add_f32 v250, v250, v194
    v_add_f32 v251, v251, v195
    v_mov_b32 v192, v248
    v_mov_b32 v193, v249
    v_mov_b32 v194, v250
    v_mov_b32 v195, v251
    v_permlane32_swap_b32 v192, v248
    v_permlane32_swap_b32 v193, v249
    v_permlane32_swap_b32 v194, v250
    v_permlane32_swap_b32 v195, v251
    v_add_f32 v248, v248, v192
    v_add_f32 v249, v249, v193
    v_add_f32 v250, v250, v194
    v_add_f32 v251, v251, v195
    s_mov_b32 s20, 0x30800000
    s_mov_b32 s21, 0x4e800000
    v_mov_b32 v200, s21
    s_mov_b64 s[22:23], 0
    v_med3_f32 v201, v248, s20, v200
    v_cmp_neq_f32 vcc, v201, v248
    v_rcp_f32 v192, v248
    s_or_b64 s[22:23], s[22:23], vcc
    v_med3_f32 v201, v249, s20, v200
    v_cmp_neq_f32 vcc, v201, v249
    v_rcp_f32 v194, v249
    s_or_b64 s[22:23], s[22:23], vcc
    v_med3_f32 v201, v250, s20, v200
    v_cmp_neq_f32 vcc, v201, v250
    v_rcp_f32 v196, v250
    s_or_b64 s[22:23], s[22:23], vcc
    v_med3_f32 v201, v251, s20, v200
    v_cmp_neq_f32 vcc, v201, v251
    v_rcp_f32 v198, v251
    s_or_b64 s[22:23], s[22:23], vcc
    s_cselect_b32 s62, 1, 0
    s_cmp_eq_u32 s27, 0
    s_cselect_b32 s62, s62, 0
    s_lshl_b32 s20, s3, 2
    s_add_u32 s20, s20, 163776
    v_mov_b32 v200, s20
    v_mov_b32 v201, s62
    ds_write_b32 v200, v201
    v_mbcnt_lo_u32_b32 v249, -1, 0
    v_mbcnt_hi_u32_b32 v249, -1, v249
    v_lshlrev_b32 v248, 4, v249
    v_mov_b32 v250, 0
    v_and_b32 v200, 7, v249
    v_lshlrev_b32 v200, 2, v200
    v_add_u32 v200, 163776, v200
    s_waitcnt lgkmcnt(0)
    s_barrier
    ds_read_b32 v201, v200
    ds_read_b64_tr_b16 v[228:229], v253 offset:16384
    ds_read_b64_tr_b16 v[230:231], v253 offset:20480
    ds_read_b64_tr_b16 v[232:233], v254 offset:16384
    ds_read_b64_tr_b16 v[234:235], v254 offset:20480
    ds_read_b64_tr_b16 v[236:237], v253 offset:16640
    ds_read_b64_tr_b16 v[238:239], v253 offset:20736
    ds_read_b64_tr_b16 v[240:241], v254 offset:16640
    ds_read_b64_tr_b16 v[242:243], v254 offset:20736
    s_waitcnt lgkmcnt(8)
    v_cmp_ne_u32 vcc, 0, v201
    s_cbranch_vccnz L_slow_X
    s_or_b32 s20, s62, s63
    s_cbranch_scc0 L_pack_X
    s_waitcnt vmcnt(0)
    s_branch L_nopack_X
L_pack_X:
    v_mul_f32 v0, v0, v192
    v_mul_f32 v1, v1, v192
    v_mul_f32 v2, v2, v192
    v_mul_f32 v3, v3, v192
    v_cvt_pk_bf16_f32 v128, v0, v1
    v_cvt_pk_bf16_f32 v129, v2, v3
    v_mul_f32 v16, v16, v192
    v_mul_f32 v17, v17, v192
    v_mul_f32 v18, v18, v192
    v_mul_f32 v19, v19, v192
    v_cvt_pk_bf16_f32 v130, v16, v17
    v_cvt_pk_bf16_f32 v131, v18, v19
    v_mul_f32 v4, v4, v194
    v_mul_f32 v5, v5, v194
    v_mul_f32 v6, v6, v194
    v_mul_f32 v7, v7, v194
    v_cvt_pk_bf16_f32 v132, v4, v5
    v_cvt_pk_bf16_f32 v133, v6, v7
    v_mul_f32 v20, v20, v194
    v_mul_f32 v21, v21, v194
    v_mul_f32 v22, v22, v194
    v_mul_f32 v23, v23, v194
    v_cvt_pk_bf16_f32 v134, v20, v21
    v_cvt_pk_bf16_f32 v135, v22, v23
    v_mul_f32 v8, v8, v196
    v_mul_f32 v9, v9, v196
    v_mul_f32 v10, v10, v196
    v_mul_f32 v11, v11, v196
    v_cvt_pk_bf16_f32 v136, v8, v9
    v_cvt_pk_bf16_f32 v137, v10, v11
    v_mul_f32 v24, v24, v196
    v_mul_f32 v25, v25, v196
    v_mul_f32 v26, v26, v196
    v_mul_f32 v27, v27, v196
    v_cvt_pk_bf16_f32 v138, v24, v25
    v_cvt_pk_bf16_f32 v139, v26, v27
    v_mul_f32 v12, v12, v198
    v_mul_f32 v13, v13, v198
    v_mul_f32 v14, v14, v198
    v_mul_f32 v15, v15, v198
    v_cvt_pk_bf16_f32 v140, v12, v13
    v_cvt_pk_bf16_f32 v141, v14, v15
    v_mul_f32 v28, v28, v198
    v_mul_f32 v29, v29, v198
    v_mul_f32 v30, v30, v198
    v_mul_f32 v31, v31, v198
    v_cvt_pk_bf16_f32 v142, v28, v29
    v_cvt_pk_bf16_f32 v143, v30, v31
    s_add_u32 s20, s52, 0
    s_cmp_eq_u32 s61, 0
    s_cbranch_scc1 L_st0_X_s
    buffer_store_dwordx4 v[128:131], v248, s[40:43], s20 offen offset:0
    buffer_store_dwordx4 v[132:135], v248, s[40:43], s20 offen offset:1024
    buffer_store_dwordx4 v[136:139], v248, s[40:43], s20 offen offset:2048
    buffer_store_dwordx4 v[140:143], v248, s[40:43], s20 offen offset:3072
    s_branch L_st0_X_e
L_st0_X_s:
    buffer_store_dwordx4 v[128:131], v248, s[40:43], s20 offen offset:0 sc1
    buffer_store_dwordx4 v[132:135], v248, s[40:43], s20 offen offset:1024 sc1
    buffer_store_dwordx4 v[136:139], v248, s[40:43], s20 offen offset:2048 sc1
    buffer_store_dwordx4 v[140:143], v248, s[40:43], s20 offen offset:3072 sc1
L_st0_X_e:
    v_mul_f32 v32, v32, v192
    v_mul_f32 v33, v33, v192
    v_mul_f32 v34, v34, v192
    v_mul_f32 v35, v35, v192
    v_cvt_pk_bf16_f32 v144, v32, v33
    v_cvt_pk_bf16_f32 v145, v34, v35
    v_mul_f32 v48, v48, v192
    v_mul_f32 v49, v49, v192
    v_mul_f32 v50, v50, v192
    v_mul_f32 v51, v51, v192
    v_cvt_pk_bf16_f32 v146, v48, v49
    v_cvt_pk_bf16_f32 v147, v50, v51
    v_mul_f32 v36, v36, v194
    v_mul_f32 v37, v37, v194
    v_mul_f32 v38, v38, v194
    v_mul_f32 v39, v39, v194
    v_cvt_pk_bf16_f32 v148, v36, v37
    v_cvt_pk_bf16_f32 v149, v38, v39
    v_mul_f32 v52, v52, v194
    v_mul_f32 v53, v53, v194
    v_mul_f32 v54, v54, v194
    v_mul_f32 v55, v55, v194
    v_cvt_pk_bf16_f32 v150, v52, v53
    v_cvt_pk_bf16_f32 v151, v54, v55
    v_mul_f32 v40, v40, v196
    v_mul_f32 v41, v41, v196
    v_mul_f32 v42, v42, v196
    v_mul_f32 v43, v43, v196
    v_cvt_pk_bf16_f32 v152, v40, v41
    v_cvt_pk_bf16_f32 v153, v42, v43
    v_mul_f32 v56, v56, v196
    v_mul_f32 v57, v57, v196
    v_mul_f32 v58, v58, v196
    v_mul_f32 v59, v59, v196
    v_cvt_pk_bf16_f32 v154, v56, v57
    v_cvt_pk_bf16_f32 v155, v58, v59
    v_mul_f32 v44, v44, v198
    v_mul_f32 v45, v45, v198
    v_mul_f32 v46, v46, v198
    v_mul_f32 v47, v47, v198
    v_cvt_pk_bf16_f32 v156, v44, v45
    v_cvt_pk_bf16_f32 v157, v46, v47
    v_mul_f32 v60, v60, v198
    v_mul_f32 v61, v61, v198
    v_mul_f32 v62, v62, v198
    v_mul_f32 v63, v63, v198
    v_cvt_pk_bf16_f32 v158, v60, v61
    v_cvt_pk_bf16_f32 v159, v62, v63
    s_add_u32 s20, s52, 4096
    s_cmp_eq_u32 s61, 0
    s_cbranch_scc1 L_st1_X_s
    buffer_store_dwordx4 v[144:147], v248, s[40:43], s20 offen offset:0
    buffer_store_dwordx4 v[148:151], v248, s[40:43], s20 offen offset:1024
    buffer_store_dwordx4 v[152:155], v248, s[40:43], s20 offen offset:2048
    buffer_store_dwordx4 v[156:159], v248, s[40:43], s20 offen offset:3072
    s_branch L_st1_X_e
L_st1_X_s:
    buffer_store_dwordx4 v[144:147], v248, s[40:43], s20 offen offset:0 sc1
    buffer_store_dwordx4 v[148:151], v248, s[40:43], s20 offen offset:1024 sc1
    buffer_store_dwordx4 v[152:155], v248, s[40:43], s20 offen offset:2048 sc1
    buffer_store_dwordx4 v[156:159], v248, s[40:43], s20 offen offset:3072 sc1
L_st1_X_e:
    v_mul_f32 v64, v64, v192
    v_mul_f32 v65, v65, v192
    v_mul_f32 v66, v66, v192
    v_mul_f32 v67, v67, v192
    v_cvt_pk_bf16_f32 v160, v64, v65
    v_cvt_pk_bf16_f32 v161, v66, v67
    v_mul_f32 v80, v80, v192
    v_mul_f32 v81, v81, v192
    v_mul_f32 v82, v82, v192
    v_mul_f32 v83, v83, v192
    v_cvt_pk_bf16_f32 v162, v80, v81
    v_cvt_pk_bf16_f32 v163, v82, v83
    v_mul_f32 v68, v68, v194
    v_mul_f32 v69, v69, v194
    v_mul_f32 v70, v70, v194
    v_mul_f32 v71, v71, v194
    v_cvt_pk_bf16_f32 v164, v68, v69
    v_cvt_pk_bf16_f32 v165, v70, v71
    v_mul_f32 v84, v84, v194
    v_mul_f32 v85, v85, v194
    v_mul_f32 v86, v86, v194
    v_mul_f32 v87, v87, v194
    v_cvt_pk_bf16_f32 v166, v84, v85
    v_cvt_pk_bf16_f32 v167, v86, v87
    v_mul_f32 v72, v72, v196
    v_mul_f32 v73, v73, v196
    v_mul_f32 v74, v74, v196
    v_mul_f32 v75, v75, v196
    v_cvt_pk_bf16_f32 v168, v72, v73
    v_cvt_pk_bf16_f32 v169, v74, v75
    v_mul_f32 v88, v88, v196
    v_mul_f32 v89, v89, v196
    v_mul_f32 v90, v90, v196
    v_mul_f32 v91, v91, v196
    v_cvt_pk_bf16_f32 v170, v88, v89
    v_cvt_pk_bf16_f32 v171, v90, v91
    v_mul_f32 v76, v76, v198
    v_mul_f32 v77, v77, v198
    v_mul_f32 v78, v78, v198
    v_mul_f32 v79, v79, v198
    v_cvt_pk_bf16_f32 v172, v76, v77
    v_cvt_pk_bf16_f32 v173, v78, v79
    v_mul_f32 v92, v92, v198
    v_mul_f32 v93, v93, v198
    v_mul_f32 v94, v94, v198
    v_mul_f32 v95, v95, v198
    v_cvt_pk_bf16_f32 v174, v92, v93
    v_cvt_pk_bf16_f32 v175, v94, v95
    v_mul_f32 v96, v96, v192
    v_mul_f32 v97, v97, v192
    v_mul_f32 v98, v98, v192
    v_mul_f32 v99, v99, v192
    v_cvt_pk_bf16_f32 v176, v96, v97
    v_cvt_pk_bf16_f32 v177, v98, v99
    v_mul_f32 v112, v112, v192
    v_mul_f32 v113, v113, v192
    v_mul_f32 v114, v114, v192
    v_mul_f32 v115, v115, v192
    v_cvt_pk_bf16_f32 v178, v112, v113
    v_cvt_pk_bf16_f32 v179, v114, v115
    v_mul_f32 v100, v100, v194
    v_mul_f32 v101, v101, v194
    v_mul_f32 v102, v102, v194
    v_mul_f32 v103, v103, v194
    v_cvt_pk_bf16_f32 v180, v100, v101
    v_cvt_pk_bf16_f32 v181, v102, v103
    v_mul_f32 v116, v116, v194
    v_mul_f32 v117, v117, v194
    v_mul_f32 v118, v118, v194
    v_mul_f32 v119, v119, v194
    v_cvt_pk_bf16_f32 v182, v116, v117
    v_cvt_pk_bf16_f32 v183, v118, v119
    v_mul_f32 v104, v104, v196
    v_mul_f32 v105, v105, v196
    v_mul_f32 v106, v106, v196
    v_mul_f32 v107, v107, v196
    v_cvt_pk_bf16_f32 v184, v104, v105
    v_cvt_pk_bf16_f32 v185, v106, v107
    v_mul_f32 v120, v120, v196
    v_mul_f32 v121, v121, v196
    v_mul_f32 v122, v122, v196
    v_mul_f32 v123, v123, v196
    v_cvt_pk_bf16_f32 v186, v120, v121
    v_cvt_pk_bf16_f32 v187, v122, v123
    v_mul_f32 v108, v108, v198
    v_mul_f32 v109, v109, v198
    v_mul_f32 v110, v110, v198
    v_mul_f32 v111, v111, v198
    v_cvt_pk_bf16_f32 v188, v108, v109
    v_cvt_pk_bf16_f32 v189, v110, v111
    v_mul_f32 v124, v124, v198
    v_mul_f32 v125, v125, v198
    v_mul_f32 v126, v126, v198
    v_mul_f32 v127, v127, v198
    v_cvt_pk_bf16_f32 v190, v124, v125
    v_cvt_pk_bf16_f32 v191, v126, v127
L_nopack_X:
    v_and_b32 v225, 3, v249
    v_lshlrev_b32 v225, 3, v225
    s_and_b32 s20, s2, 3
    s_lshl_b32 s20, s20, 5
    v_add_u32 v225, s20, v225
    s_waitcnt lgkmcnt(6)
    v_mfma_f32_16x16x32_bf16 v[0:3], v[228:231], v[128:131], 0
    ds_read_b64_tr_b16 v[244:245], v253 offset:16896
    ds_read_b64_tr_b16 v[246:247], v253 offset:20992
    v_mfma_f32_16x16x32_bf16 v[4:7], v[228:231], v[132:135], 0
    v_mfma_f32_16x16x32_bf16 v[8:11], v[228:231], v[136:139], 0
    v_mfma_f32_16x16x32_bf16 v[12:15], v[228:231], v[140:143], 0
    s_waitcnt lgkmcnt(6)
    v_mfma_f32_16x16x32_bf16 v[28:31], v[232:235], v[140:143], 0
    ds_read_b64_tr_b16 v[228:229], v254 offset:16896
    ds_read_b64_tr_b16 v[230:231], v254 offset:20992
    v_mfma_f32_16x16x32_bf16 v[24:27], v[232:235], v[136:139], 0
    v_mfma_f32_16x16x32_bf16 v[20:23], v[232:235], v[132:135], 0
    v_mfma_f32_16x16x32_bf16 v[16:19], v[232:235], v[128:131], 0
    s_waitcnt vmcnt(0)
    v_mov_b32 v255, 1
    s_mov_b64 exec, 1
    s_cmp_eq_u32 s61, 0
    s_cbranch_scc1 L_fl0_X_s
    buffer_store_dword v255, v250, s[40:43], s72 offen
    s_branch L_fl0_X_e
L_fl0_X_s:
    buffer_store_dword v255, v250, s[40:43], s72 offen sc1
L_fl0_X_e:
    s_mov_b64 exec, -1
    s_waitcnt lgkmcnt(6)
    v_mfma_f32_16x16x32_bf16 v[32:35], v[236:239], v[128:131], 0
    ds_read_b64_tr_b16 v[232:233], v253 offset:17152
    ds_read_b64_tr_b16 v[234:235], v253 offset:21248
    v_mfma_f32_16x16x32_bf16 v[36:39], v[236:239], v[132:135], 0
    v_mfma_f32_16x16x32_bf16 v[40:43], v[236:239], v[136:139], 0
    v_mfma_f32_16x16x32_bf16 v[44:47], v[236:239], v[140:143], 0
    s_waitcnt lgkmcnt(6)
    v_mfma_f32_16x16x32_bf16 v[60:63], v[240:243], v[140:143], 0
    ds_read_b64_tr_b16 v[236:237], v254 offset:17152
    ds_read_b64_tr_b16 v[238:239], v254 offset:21248
    v_mfma_f32_16x16x32_bf16 v[56:59], v[240:243], v[136:139], 0
    v_mfma_f32_16x16x32_bf16 v[52:55], v[240:243], v[132:135], 0
    v_mfma_f32_16x16x32_bf16 v[48:51], v[240:243], v[128:131], 0
    s_waitcnt lgkmcnt(6)
    v_mfma_f32_16x16x32_bf16 v[64:67], v[244:247], v[128:131], 0
    ds_read_b64_tr_b16 v[240:241], v253 offset:32768
    ds_read_b64_tr_b16 v[242:243], v253 offset:36864
    v_mfma_f32_16x16x32_bf16 v[68:71], v[244:247], v[132:135], 0
    v_mfma_f32_16x16x32_bf16 v[72:75], v[244:247], v[136:139], 0
    v_mfma_f32_16x16x32_bf16 v[76:79], v[244:247], v[140:143], 0
    s_waitcnt lgkmcnt(6)
    v_mfma_f32_16x16x32_bf16 v[92:95], v[228:231], v[140:143], 0
    ds_read_b64_tr_b16 v[244:245], v254 offset:32768
    ds_read_b64_tr_b16 v[246:247], v254 offset:36864
    v_mfma_f32_16x16x32_bf16 v[88:91], v[228:231], v[136:139], 0
    v_mfma_f32_16x16x32_bf16 v[84:87], v[228:231], v[132:135], 0
    v_mfma_f32_16x16x32_bf16 v[80:83], v[228:231], v[128:131], 0
    s_waitcnt lgkmcnt(6)
    v_mfma_f32_16x16x32_bf16 v[96:99], v[232:235], v[128:131], 0
    ds_read_b64_tr_b16 v[228:229], v253 offset:33024
    ds_read_b64_tr_b16 v[230:231], v253 offset:37120
    v_mfma_f32_16x16x32_bf16 v[100:103], v[232:235], v[132:135], 0
    v_mfma_f32_16x16x32_bf16 v[104:107], v[232:235], v[136:139], 0
    v_mfma_f32_16x16x32_bf16 v[108:111], v[232:235], v[140:143], 0
    s_waitcnt lgkmcnt(6)
    v_mfma_f32_16x16x32_bf16 v[124:127], v[236:239], v[140:143], 0
    ds_read_b64_tr_b16 v[232:233], v254 offset:33024
    ds_read_b64_tr_b16 v[234:235], v254 offset:37120
    v_mfma_f32_16x16x32_bf16 v[120:123], v[236:239], v[136:139], 0
    v_mfma_f32_16x16x32_bf16 v[116:119], v[236:239], v[132:135], 0
    v_mfma_f32_16x16x32_bf16 v[112:115], v[236:239], v[128:131], 0
    s_waitcnt lgkmcnt(6)
    v_mfma_f32_16x16x32_bf16 v[0:3], v[240:243], v[144:147], v[0:3]
    ds_read_b64_tr_b16 v[236:237], v253 offset:33280
    ds_read_b64_tr_b16 v[238:239], v253 offset:37376
    v_mfma_f32_16x16x32_bf16 v[4:7], v[240:243], v[148:151], v[4:7]
    v_mfma_f32_16x16x32_bf16 v[8:11], v[240:243], v[152:155], v[8:11]
    v_mfma_f32_16x16x32_bf16 v[12:15], v[240:243], v[156:159], v[12:15]
    s_waitcnt lgkmcnt(6)
    v_mfma_f32_16x16x32_bf16 v[28:31], v[244:247], v[156:159], v[28:31]
    ds_read_b64_tr_b16 v[240:241], v254 offset:33280
    ds_read_b64_tr_b16 v[242:243], v254 offset:37376
    v_mfma_f32_16x16x32_bf16 v[24:27], v[244:247], v[152:155], v[24:27]
    v_mfma_f32_16x16x32_bf16 v[20:23], v[244:247], v[148:151], v[20:23]
    v_mfma_f32_16x16x32_bf16 v[16:19], v[244:247], v[144:147], v[16:19]
    buffer_load_dword v224, v225, s[40:43], s60 offen sc1
    s_waitcnt lgkmcnt(6)
    v_mfma_f32_16x16x32_bf16 v[32:35], v[228:231], v[144:147], v[32:35]
    ds_read_b64_tr_b16 v[244:245], v253 offset:33536
    ds_read_b64_tr_b16 v[246:247], v253 offset:37632
    v_mfma_f32_16x16x32_bf16 v[36:39], v[228:231], v[148:151], v[36:39]
    v_mfma_f32_16x16x32_bf16 v[40:43], v[228:231], v[152:155], v[40:43]
    v_mfma_f32_16x16x32_bf16 v[44:47], v[228:231], v[156:159], v[44:47]
    s_waitcnt lgkmcnt(6)
    v_mfma_f32_16x16x32_bf16 v[60:63], v[232:235], v[156:159], v[60:63]
    ds_read_b64_tr_b16 v[228:229], v254 offset:33536
    ds_read_b64_tr_b16 v[230:231], v254 offset:37632
    v_mfma_f32_16x16x32_bf16 v[56:59], v[232:235], v[152:155], v[56:59]
    v_mfma_f32_16x16x32_bf16 v[52:55], v[232:235], v[148:151], v[52:55]
    v_mfma_f32_16x16x32_bf16 v[48:51], v[232:235], v[144:147], v[48:51]
    s_waitcnt lgkmcnt(6)
    v_mfma_f32_16x16x32_bf16 v[64:67], v[236:239], v[144:147], v[64:67]
    v_add_u32 v253, 98304, v253
    v_add_u32 v254, 98304, v254
    ds_read_b64_tr_b16 v[232:233], v253 offset:0
    ds_read_b64_tr_b16 v[234:235], v253 offset:4096
    v_mfma_f32_16x16x32_bf16 v[68:71], v[236:239], v[148:151], v[68:71]
    v_mfma_f32_16x16x32_bf16 v[72:75], v[236:239], v[152:155], v[72:75]
    v_mfma_f32_16x16x32_bf16 v[76:79], v[236:239], v[156:159], v[76:79]
    s_waitcnt lgkmcnt(6)
    v_mfma_f32_16x16x32_bf16 v[92:95], v[240:243], v[156:159], v[92:95]
    ds_read_b64_tr_b16 v[236:237], v254 offset:0
    ds_read_b64_tr_b16 v[238:239], v254 offset:4096
    v_mfma_f32_16x16x32_bf16 v[88:91], v[240:243], v[152:155], v[88:91]
    v_mfma_f32_16x16x32_bf16 v[84:87], v[240:243], v[148:151], v[84:87]
    v_mfma_f32_16x16x32_bf16 v[80:83], v[240:243], v[144:147], v[80:83]
    s_waitcnt lgkmcnt(6)
    v_mfma_f32_16x16x32_bf16 v[96:99], v[244:247], v[144:147], v[96:99]
    ds_read_b64_tr_b16 v[240:241], v253 offset:256
    ds_read_b64_tr_b16 v[242:243], v253 offset:4352
    v_mfma_f32_16x16x32_bf16 v[100:103], v[244:247], v[148:151], v[100:103]
    v_mfma_f32_16x16x32_bf16 v[104:107], v[244:247], v[152:155], v[104:107]
    v_mfma_f32_16x16x32_bf16 v[108:111], v[244:247], v[156:159], v[108:111]
    s_waitcnt lgkmcnt(6)
    v_mfma_f32_16x16x32_bf16 v[124:127], v[228:231], v[156:159], v[124:127]
    ds_read_b64_tr_b16 v[244:245], v254 offset:256
    ds_read_b64_tr_b16 v[246:247], v254 offset:4352
    v_mfma_f32_16x16x32_bf16 v[120:123], v[228:231], v[152:155], v[120:123]
    v_mfma_f32_16x16x32_bf16 v[116:119], v[228:231], v[148:151], v[116:119]
    v_mfma_f32_16x16x32_bf16 v[112:115], v[228:231], v[144:147], v[112:115]
    s_waitcnt vmcnt(0)
    v_cmp_gt_u32 vcc, 1, v224
    s_cbranch_vccz L_polled0_X
L_poll0_X:
    buffer_load_dword v224, v225, s[40:43], s60 offen sc1
    s_add_u32 s79, s79, 1
    s_cmp_ge_u32 s79, 0x40000
    s_waitcnt vmcnt(0)
    s_cbranch_scc1 L_polled0_X
    v_cmp_gt_u32 vcc, 1, v224
    s_cbranch_vccnz L_poll0_X
L_polled0_X:
    s_waitcnt lgkmcnt(6)
    v_mfma_f32_16x16x32_bf16 v[0:3], v[232:235], v[160:163], v[0:3]
    ds_read_b64_tr_b16 v[228:229], v253 offset:512
    ds_read_b64_tr_b16 v[230:231], v253 offset:4608
    v_mfma_f32_16x16x32_bf16 v[4:7], v[232:235], v[164:167], v[4:7]
    s_add_u32 s20, s53, 0
    buffer_load_dwordx4 v[192:195], v248, s[40:43], s20 offen offset:0 sc1
    v_mfma_f32_16x16x32_bf16 v[8:11], v[232:235], v[168:171], v[8:11]
    s_add_u32 s20, s53, 0
    buffer_load_dwordx4 v[196:199], v248, s[40:43], s20 offen offset:1024 sc1
    v_mfma_f32_16x16x32_bf16 v[12:15], v[232:235], v[172:175], v[12:15]
    s_add_u32 s20, s53, 0
    buffer_load_dwordx4 v[200:203], v248, s[40:43], s20 offen offset:2048 sc1
    s_waitcnt lgkmcnt(6)
    v_mfma_f32_16x16x32_bf16 v[28:31], v[236:239], v[172:175], v[28:31]
    ds_read_b64_tr_b16 v[232:233], v254 offset:512
    ds_read_b64_tr_b16 v[234:235], v254 offset:4608
    v_mfma_f32_16x16x32_bf16 v[24:27], v[236:239], v[168:171], v[24:27]
    s_add_u32 s20, s53, 0
    buffer_load_dwordx4 v[204:207], v248, s[40:43], s20 offen offset:3072 sc1
    v_mfma_f32_16x16x32_bf16 v[20:23], v[236:239], v[164:167], v[20:23]
    s_add_u32 s20, s54, 0
    buffer_load_dwordx4 v[208:211], v248, s[40:43], s20 offen offset:0 sc1
    v_mfma_f32_16x16x32_bf16 v[16:19], v[236:239], v[160:163], v[16:19]
    s_add_u32 s20, s54, 0
    buffer_load_dwordx4 v[212:215], v248, s[40:43], s20 offen offset:1024 sc1
    s_waitcnt lgkmcnt(6)
    v_mfma_f32_16x16x32_bf16 v[32:35], v[240:243], v[160:163], v[32:35]
    ds_read_b64_tr_b16 v[236:237], v253 offset:768
    ds_read_b64_tr_b16 v[238:239], v253 offset:4864
    v_mfma_f32_16x16x32_bf16 v[36:39], v[240:243], v[164:167], v[36:39]
    s_add_u32 s20, s54, 0
    buffer_load_dwordx4 v[216:219], v248, s[40:43], s20 offen offset:2048 sc1
    v_mfma_f32_16x16x32_bf16 v[40:43], v[240:243], v[168:171], v[40:43]
    s_add_u32 s20, s54, 0
    buffer_load_dwordx4 v[220:223], v248, s[40:43], s20 offen offset:3072 sc1
    v_mfma_f32_16x16x32_bf16 v[44:47], v[240:243], v[172:175], v[44:47]
    s_waitcnt lgkmcnt(6)
    v_mfma_f32_16x16x32_bf16 v[60:63], v[244:247], v[172:175], v[60:63]
    ds_read_b64_tr_b16 v[240:241], v254 offset:768
    ds_read_b64_tr_b16 v[242:243], v254 offset:4864
    v_mfma_f32_16x16x32_bf16 v[56:59], v[244:247], v[168:171], v[56:59]
    v_mfma_f32_16x16x32_bf16 v[52:55], v[244:247], v[164:167], v[52:55]
    v_mfma_f32_16x16x32_bf16 v[48:51], v[244:247], v[160:163], v[48:51]
    s_waitcnt lgkmcnt(6)
    v_mfma_f32_16x16x32_bf16 v[64:67], v[228:231], v[160:163], v[64:67]
    v_add_u32 v253, 4294918144, v253
    v_add_u32 v254, 4294918144, v254
    ds_read_b64_tr_b16 v[244:245], v253 offset:0
    ds_read_b64_tr_b16 v[246:247], v253 offset:4096
    v_mfma_f32_16x16x32_bf16 v[68:71], v[228:231], v[164:167], v[68:71]
    v_mfma_f32_16x16x32_bf16 v[72:75], v[228:231], v[168:171], v[72:75]
    v_mfma_f32_16x16x32_bf16 v[76:79], v[228:231], v[172:175], v[76:79]
    s_waitcnt lgkmcnt(6)
    v_mfma_f32_16x16x32_bf16 v[92:95], v[232:235], v[172:175], v[92:95]
    ds_read_b64_tr_b16 v[228:229], v254 offset:0
    ds_read_b64_tr_b16 v[230:231], v254 offset:4096
    v_mfma_f32_16x16x32_bf16 v[88:91], v[232:235], v[168:171], v[88:91]
    v_mfma_f32_16x16x32_bf16 v[84:87], v[232:235], v[164:167], v[84:87]
    v_mfma_f32_16x16x32_bf16 v[80:83], v[232:235], v[160:163], v[80:83]
    s_waitcnt lgkmcnt(6)
    v_mfma_f32_16x16x32_bf16 v[96:99], v[236:239], v[160:163], v[96:99]
    ds_read_b64_tr_b16 v[232:233], v253 offset:256
    ds_read_b64_tr_b16 v[234:235], v253 offset:4352
    v_mfma_f32_16x16x32_bf16 v[100:103], v[236:239], v[164:167], v[100:103]
    v_mfma_f32_16x16x32_bf16 v[104:107], v[236:239], v[168:171], v[104:107]
    v_mfma_f32_16x16x32_bf16 v[108:111], v[236:239], v[172:175], v[108:111]
    s_waitcnt lgkmcnt(6)
    v_mfma_f32_16x16x32_bf16 v[124:127], v[240:243], v[172:175], v[124:127]
    ds_read_b64_tr_b16 v[236:237], v254 offset:256
    ds_read_b64_tr_b16 v[238:239], v254 offset:4352
    v_mfma_f32_16x16x32_bf16 v[120:123], v[240:243], v[168:171], v[120:123]
    v_mfma_f32_16x16x32_bf16 v[116:119], v[240:243], v[164:167], v[116:119]
    v_mfma_f32_16x16x32_bf16 v[112:115], v[240:243], v[160:163], v[112:115]
    s_waitcnt lgkmcnt(6)
    v_mfma_f32_16x16x32_bf16 v[0:3], v[244:247], v[176:179], v[0:3]
    ds_read_b64_tr_b16 v[240:241], v253 offset:512
    ds_read_b64_tr_b16 v[242:243], v253 offset:4608
    v_mfma_f32_16x16x32_bf16 v[4:7], v[244:247], v[180:183], v[4:7]
    s_add_u32 s20, s55, 0
    buffer_load_dwordx4 v[128:131], v248, s[40:43], s20 offen offset:0 sc1
    v_mfma_f32_16x16x32_bf16 v[8:11], v[244:247], v[184:187], v[8:11]
    s_add_u32 s20, s55, 0
    buffer_load_dwordx4 v[132:135], v248, s[40:43], s20 offen offset:1024 sc1
    v_mfma_f32_16x16x32_bf16 v[12:15], v[244:247], v[188:191], v[12:15]
    s_add_u32 s20, s55, 0
    buffer_load_dwordx4 v[136:139], v248, s[40:43], s20 offen offset:2048 sc1
    s_waitcnt lgkmcnt(6)
    v_mfma_f32_16x16x32_bf16 v[28:31], v[228:231], v[188:191], v[28:31]
    ds_read_b64_tr_b16 v[244:245], v254 offset:512
    ds_read_b64_tr_b16 v[246:247], v254 offset:4608
    v_mfma_f32_16x16x32_bf16 v[24:27], v[228:231], v[184:187], v[24:27]
    s_add_u32 s20, s55, 0
    buffer_load_dwordx4 v[140:143], v248, s[40:43], s20 offen offset:3072 sc1
    v_mfma_f32_16x16x32_bf16 v[20:23], v[228:231], v[180:183], v[20:23]
    s_add_u32 s20, s53, 4096
    buffer_load_dwordx4 v[144:147], v248, s[40:43], s20 offen offset:0 sc1
    v_mfma_f32_16x16x32_bf16 v[16:19], v[228:231], v[176:179], v[16:19]
    s_add_u32 s20, s53, 4096
    buffer_load_dwordx4 v[148:151], v248, s[40:43], s20 offen offset:1024 sc1
    s_waitcnt lgkmcnt(6)
    v_mfma_f32_16x16x32_bf16 v[32:35], v[232:235], v[176:179], v[32:35]
    ds_read_b64_tr_b16 v[228:229], v253 offset:768
    ds_read_b64_tr_b16 v[230:231], v253 offset:4864
    v_mfma_f32_16x16x32_bf16 v[36:39], v[232:235], v[180:183], v[36:39]
    s_add_u32 s20, s53, 4096
    buffer_load_dwordx4 v[152:155], v248, s[40:43], s20 offen offset:2048 sc1
    v_mfma_f32_16x16x32_bf16 v[40:43], v[232:235], v[184:187], v[40:43]
    s_add_u32 s20, s53, 4096
    buffer_load_dwordx4 v[156:159], v248, s[40:43], s20 offen offset:3072 sc1
    v_mfma_f32_16x16x32_bf16 v[44:47], v[232:235], v[188:191], v[44:47]
    s_waitcnt lgkmcnt(6)
    v_mfma_f32_16x16x32_bf16 v[60:63], v[236:239], v[188:191], v[60:63]
    ds_read_b64_tr_b16 v[232:233], v254 offset:768
    ds_read_b64_tr_b16 v[234:235], v254 offset:4864
    v_mfma_f32_16x16x32_bf16 v[56:59], v[236:239], v[184:187], v[56:59]
    v_mfma_f32_16x16x32_bf16 v[52:55], v[236:239], v[180:183], v[52:55]
    v_mfma_f32_16x16x32_bf16 v[48:51], v[236:239], v[176:179], v[48:51]
    s_barrier
    s_waitcnt lgkmcnt(6)
    v_mfma_f32_16x16x32_bf16 v[64:67], v[240:243], v[176:179], v[64:67]
    v_add_u32 v253, 49152, v253
    v_add_u32 v254, 49152, v254
    ds_read_b64_tr_b16 v[236:237], v253 offset:16384
    ds_read_b64_tr_b16 v[238:239], v253 offset:20480
    v_mfma_f32_16x16x32_bf16 v[68:71], v[240:243], v[180:183], v[68:71]
    v_mfma_f32_16x16x32_bf16 v[72:75], v[240:243], v[184:187], v[72:75]
    v_mfma_f32_16x16x32_bf16 v[76:79], v[240:243], v[188:191], v[76:79]
    s_waitcnt lgkmcnt(6)
    v_mfma_f32_16x16x32_bf16 v[92:95], v[244:247], v[188:191], v[92:95]
    ds_read_b64_tr_b16 v[240:241], v254 offset:16384
    ds_read_b64_tr_b16 v[242:243], v254 offset:20480
    v_mfma_f32_16x16x32_bf16 v[88:91], v[244:247], v[184:187], v[88:91]
    v_mfma_f32_16x16x32_bf16 v[84:87], v[244:247], v[180:183], v[84:87]
    v_mfma_f32_16x16x32_bf16 v[80:83], v[244:247], v[176:179], v[80:83]
    s_waitcnt vmcnt(4)
    v_mov_b32 v255, 2
    s_mov_b64 exec, 1
    s_cmp_eq_u32 s61, 0
    s_cbranch_scc1 L_fl1_X_s
    buffer_store_dword v255, v250, s[40:43], s72 offen
    s_branch L_fl1_X_e
L_fl1_X_s:
    buffer_store_dword v255, v250, s[40:43], s72 offen sc1
L_fl1_X_e:
    s_mov_b64 exec, -1
    s_waitcnt lgkmcnt(6)
    v_mfma_f32_16x16x32_bf16 v[96:99], v[228:231], v[176:179], v[96:99]
    ds_read_b64_tr_b16 v[244:245], v253 offset:16640
    ds_read_b64_tr_b16 v[246:247], v253 offset:20736
    v_mfma_f32_16x16x32_bf16 v[100:103], v[228:231], v[180:183], v[100:103]
    v_mfma_f32_16x16x32_bf16 v[104:107], v[228:231], v[184:187], v[104:107]
    v_mfma_f32_16x16x32_bf16 v[108:111], v[228:231], v[188:191], v[108:111]
    s_waitcnt lgkmcnt(6)
    v_mfma_f32_16x16x32_bf16 v[124:127], v[232:235], v[188:191], v[124:127]
    ds_read_b64_tr_b16 v[228:229], v254 offset:16640
    ds_read_b64_tr_b16 v[230:231], v254 offset:20736
    v_mfma_f32_16x16x32_bf16 v[120:123], v[232:235], v[184:187], v[120:123]
    v_mfma_f32_16x16x32_bf16 v[116:119], v[232:235], v[180:183], v[116:119]
    v_mfma_f32_16x16x32_bf16 v[112:115], v[232:235], v[176:179], v[112:115]
    s_waitcnt lgkmcnt(6)
    v_mfma_f32_16x16x32_bf16 v[0:3], v[236:239], v[192:195], v[0:3]
    ds_read_b64_tr_b16 v[232:233], v253 offset:16896
    ds_read_b64_tr_b16 v[234:235], v253 offset:20992
    v_mfma_f32_16x16x32_bf16 v[4:7], v[236:239], v[196:199], v[4:7]
    v_mfma_f32_16x16x32_bf16 v[8:11], v[236:239], v[200:203], v[8:11]
    v_mfma_f32_16x16x32_bf16 v[12:15], v[236:239], v[204:207], v[12:15]
    s_waitcnt lgkmcnt(6)
    v_mfma_f32_16x16x32_bf16 v[28:31], v[240:243], v[204:207], v[28:31]
    ds_read_b64_tr_b16 v[236:237], v254 offset:16896
    ds_read_b64_tr_b16 v[238:239], v254 offset:20992
    v_mfma_f32_16x16x32_bf16 v[24:27], v[240:243], v[200:203], v[24:27]
    v_mfma_f32_16x16x32_bf16 v[20:23], v[240:243], v[196:199], v[20:23]
    v_mfma_f32_16x16x32_bf16 v[16:19], v[240:243], v[192:195], v[16:19]
    buffer_load_dword v224, v225, s[40:43], s60 offen sc1
    s_waitcnt lgkmcnt(6)
    v_mfma_f32_16x16x32_bf16 v[32:35], v[244:247], v[192:195], v[32:35]
    ds_read_b64_tr_b16 v[240:241], v253 offset:17152
    ds_read_b64_tr_b16 v[242:243], v253 offset:21248
    v_mfma_f32_16x16x32_bf16 v[36:39], v[244:247], v[196:199], v[36:39]
    v_mfma_f32_16x16x32_bf16 v[40:43], v[244:247], v[200:203], v[40:43]
    v_mfma_f32_16x16x32_bf16 v[44:47], v[244:247], v[204:207], v[44:47]
    s_waitcnt lgkmcnt(6)
    v_mfma_f32_16x16x32_bf16 v[60:63], v[228:231], v[204:207], v[60:63]
    ds_read_b64_tr_b16 v[244:245], v254 offset:17152
    ds_read_b64_tr_b16 v[246:247], v254 offset:21248
    v_mfma_f32_16x16x32_bf16 v[56:59], v[228:231], v[200:203], v[56:59]
    v_mfma_f32_16x16x32_bf16 v[52:55], v[228:231], v[196:199], v[52:55]
    v_mfma_f32_16x16x32_bf16 v[48:51], v[228:231], v[192:195], v[48:51]
    s_waitcnt lgkmcnt(6)
    v_mfma_f32_16x16x32_bf16 v[64:67], v[232:235], v[192:195], v[64:67]
    v_add_u32 v253, 4294918144, v253
    v_add_u32 v254, 4294918144, v254
    ds_read_b64_tr_b16 v[228:229], v253 offset:16384
    ds_read_b64_tr_b16 v[230:231], v253 offset:20480
    v_mfma_f32_16x16x32_bf16 v[68:71], v[232:235], v[196:199], v[68:71]
    v_mfma_f32_16x16x32_bf16 v[72:75], v[232:235], v[200:203], v[72:75]
    v_mfma_f32_16x16x32_bf16 v[76:79], v[232:235], v[204:207], v[76:79]
    s_waitcnt lgkmcnt(6)
    v_mfma_f32_16x16x32_bf16 v[92:95], v[236:239], v[204:207], v[92:95]
    ds_read_b64_tr_b16 v[232:233], v254 offset:16384
    ds_read_b64_tr_b16 v[234:235], v254 offset:20480
    v_mfma_f32_16x16x32_bf16 v[88:91], v[236:239], v[200:203], v[88:91]
    v_mfma_f32_16x16x32_bf16 v[84:87], v[236:239], v[196:199], v[84:87]
    v_mfma_f32_16x16x32_bf16 v[80:83], v[236:239], v[192:195], v[80:83]
    s_waitcnt lgkmcnt(6)
    v_mfma_f32_16x16x32_bf16 v[96:99], v[240:243], v[192:195], v[96:99]
    ds_read_b64_tr_b16 v[236:237], v253 offset:16640
    ds_read_b64_tr_b16 v[238:239], v253 offset:20736
    v_mfma_f32_16x16x32_bf16 v[100:103], v[240:243], v[196:199], v[100:103]
    v_mfma_f32_16x16x32_bf16 v[104:107], v[240:243], v[200:203], v[104:107]
    v_mfma_f32_16x16x32_bf16 v[108:111], v[240:243], v[204:207], v[108:111]
    s_waitcnt lgkmcnt(6)
    v_mfma_f32_16x16x32_bf16 v[124:127], v[244:247], v[204:207], v[124:127]
    ds_read_b64_tr_b16 v[240:241], v254 offset:16640
    ds_read_b64_tr_b16 v[242:243], v254 offset:20736
    v_mfma_f32_16x16x32_bf16 v[120:123], v[244:247], v[200:203], v[120:123]
    v_mfma_f32_16x16x32_bf16 v[116:119], v[244:247], v[196:199], v[116:119]
    v_mfma_f32_16x16x32_bf16 v[112:115], v[244:247], v[192:195], v[112:115]
    s_waitcnt vmcnt(0)
    v_cmp_gt_u32 vcc, 2, v224
    s_cbranch_vccz L_polled1_X
L_poll1_X:
    buffer_load_dword v224, v225, s[40:43], s60 offen sc1
    s_add_u32 s79, s79, 1
    s_cmp_ge_u32 s79, 0x40000
    s_waitcnt vmcnt(0)
    s_cbranch_scc1 L_polled1_X
    v_cmp_gt_u32 vcc, 2, v224
    s_cbranch_vccnz L_poll1_X
L_polled1_X:
    s_add_u32 s20, s52, 0
    s_add_u32 s20, s20, s78
    s_cmp_eq_u32 s61, 0
    s_cbranch_scc1 L_st2_X_s
    buffer_store_dwordx4 v[160:163], v248, s[40:43], s20 offen offset:0
    buffer_store_dwordx4 v[164:167], v248, s[40:43], s20 offen offset:1024
    buffer_store_dwordx4 v[168:171], v248, s[40:43], s20 offen offset:2048
    buffer_store_dwordx4 v[172:175], v248, s[40:43], s20 offen offset:3072
    s_branch L_st2_X_e
L_st2_X_s:
    buffer_store_dwordx4 v[160:163], v248, s[40:43], s20 offen offset:0 sc1
    buffer_store_dwordx4 v[164:167], v248, s[40:43], s20 offen offset:1024 sc1
    buffer_store_dwordx4 v[168:171], v248, s[40:43], s20 offen offset:2048 sc1
    buffer_store_dwordx4 v[172:175], v248, s[40:43], s20 offen offset:3072 sc1
L_st2_X_e:
    s_waitcnt lgkmcnt(6)
    v_mfma_f32_16x16x32_bf16 v[0:3], v[228:231], v[208:211], v[0:3]
    ds_read_b64_tr_b16 v[244:245], v253 offset:16896
    ds_read_b64_tr_b16 v[246:247], v253 offset:20992
    v_mfma_f32_16x16x32_bf16 v[4:7], v[228:231], v[212:215], v[4:7]
    s_add_u32 s20, s54, 4096
    buffer_load_dwordx4 v[192:195], v248, s[40:43], s20 offen offset:0 sc1
    v_mfma_f32_16x16x32_bf16 v[8:11], v[228:231], v[216:219], v[8:11]
    s_add_u32 s20, s54, 4096
    buffer_load_dwordx4 v[196:199], v248, s[40:43], s20 offen offset:1024 sc1
    v_mfma_f32_16x16x32_bf16 v[12:15], v[228:231], v[220:223], v[12:15]
    s_add_u32 s20, s54, 4096
    buffer_load_dwordx4 v[200:203], v248, s[40:43], s20 offen offset:2048 sc1
    s_waitcnt lgkmcnt(6)
    v_mfma_f32_16x16x32_bf16 v[28:31], v[232:235], v[220:223], v[28:31]
    ds_read_b64_tr_b16 v[228:229], v254 offset:16896
    ds_read_b64_tr_b16 v[230:231], v254 offset:20992
    v_mfma_f32_16x16x32_bf16 v[24:27], v[232:235], v[216:219], v[24:27]
    s_add_u32 s20, s54, 4096
    buffer_load_dwordx4 v[204:207], v248, s[40:43], s20 offen offset:3072 sc1
    v_mfma_f32_16x16x32_bf16 v[20:23], v[232:235], v[212:215], v[20:23]
    v_mfma_f32_16x16x32_bf16 v[16:19], v[232:235], v[208:211], v[16:19]
    s_waitcnt lgkmcnt(6)
    v_mfma_f32_16x16x32_bf16 v[32:35], v[236:239], v[208:211], v[32:35]
    ds_read_b64_tr_b16 v[232:233], v253 offset:17152
    ds_read_b64_tr_b16 v[234:235], v253 offset:21248
    v_mfma_f32_16x16x32_bf16 v[36:39], v[236:239], v[212:215], v[36:39]
    v_mfma_f32_16x16x32_bf16 v[40:43], v[236:239], v[216:219], v[40:43]
    v_mfma_f32_16x16x32_bf16 v[44:47], v[236:239], v[220:223], v[44:47]
    s_waitcnt lgkmcnt(6)
    v_mfma_f32_16x16x32_bf16 v[60:63], v[240:243], v[220:223], v[60:63]
    ds_read_b64_tr_b16 v[236:237], v254 offset:17152
    ds_read_b64_tr_b16 v[238:239], v254 offset:21248
    v_mfma_f32_16x16x32_bf16 v[56:59], v[240:243], v[216:219], v[56:59]
    v_mfma_f32_16x16x32_bf16 v[52:55], v[240:243], v[212:215], v[52:55]
    v_mfma_f32_16x16x32_bf16 v[48:51], v[240:243], v[208:211], v[48:51]
    s_waitcnt lgkmcnt(6)
    v_mfma_f32_16x16x32_bf16 v[64:67], v[244:247], v[208:211], v[64:67]
    v_add_u32 v253, 49152, v253
    v_add_u32 v254, 49152, v254
    ds_read_b64_tr_b16 v[240:241], v253 offset:32768
    ds_read_b64_tr_b16 v[242:243], v253 offset:36864
    v_mfma_f32_16x16x32_bf16 v[68:71], v[244:247], v[212:215], v[68:71]
    v_mfma_f32_16x16x32_bf16 v[72:75], v[244:247], v[216:219], v[72:75]
    v_mfma_f32_16x16x32_bf16 v[76:79], v[244:247], v[220:223], v[76:79]
    s_waitcnt lgkmcnt(6)
    v_mfma_f32_16x16x32_bf16 v[92:95], v[228:231], v[220:223], v[92:95]
    ds_read_b64_tr_b16 v[244:245], v254 offset:32768
    ds_read_b64_tr_b16 v[246:247], v254 offset:36864
    v_mfma_f32_16x16x32_bf16 v[88:91], v[228:231], v[216:219], v[88:91]
    v_mfma_f32_16x16x32_bf16 v[84:87], v[228:231], v[212:215], v[84:87]
    v_mfma_f32_16x16x32_bf16 v[80:83], v[228:231], v[208:211], v[80:83]
    s_waitcnt lgkmcnt(6)
    v_mfma_f32_16x16x32_bf16 v[96:99], v[232:235], v[208:211], v[96:99]
    ds_read_b64_tr_b16 v[228:229], v253 offset:33024
    ds_read_b64_tr_b16 v[230:231], v253 offset:37120
    v_mfma_f32_16x16x32_bf16 v[100:103], v[232:235], v[212:215], v[100:103]
    v_mfma_f32_16x16x32_bf16 v[104:107], v[232:235], v[216:219], v[104:107]
    v_mfma_f32_16x16x32_bf16 v[108:111], v[232:235], v[220:223], v[108:111]
    s_waitcnt lgkmcnt(6)
    v_mfma_f32_16x16x32_bf16 v[124:127], v[236:239], v[220:223], v[124:127]
    ds_read_b64_tr_b16 v[232:233], v254 offset:33024
    ds_read_b64_tr_b16 v[234:235], v254 offset:37120
    v_mfma_f32_16x16x32_bf16 v[120:123], v[236:239], v[216:219], v[120:123]
    v_mfma_f32_16x16x32_bf16 v[116:119], v[236:239], v[212:215], v[116:119]
    v_mfma_f32_16x16x32_bf16 v[112:115], v[236:239], v[208:211], v[112:115]
    s_waitcnt lgkmcnt(6)
    v_mfma_f32_16x16x32_bf16 v[0:3], v[240:243], v[128:131], v[0:3]
    ds_read_b64_tr_b16 v[236:237], v253 offset:33280
    ds_read_b64_tr_b16 v[238:239], v253 offset:37376
    v_mfma_f32_16x16x32_bf16 v[4:7], v[240:243], v[132:135], v[4:7]
    s_add_u32 s20, s55, 4096
    buffer_load_dwordx4 v[160:163], v248, s[40:43], s20 offen offset:0 sc1
    v_mfma_f32_16x16x32_bf16 v[8:11], v[240:243], v[136:139], v[8:11]
    s_add_u32 s20, s55, 4096
    buffer_load_dwordx4 v[164:167], v248, s[40:43], s20 offen offset:1024 sc1
    v_mfma_f32_16x16x32_bf16 v[12:15], v[240:243], v[140:143], v[12:15]
    s_add_u32 s20, s55, 4096
    buffer_load_dwordx4 v[168:171], v248, s[40:43], s20 offen offset:2048 sc1
    s_waitcnt lgkmcnt(6)
    v_mfma_f32_16x16x32_bf16 v[28:31], v[244:247], v[140:143], v[28:31]
    ds_read_b64_tr_b16 v[240:241], v254 offset:33280
    ds_read_b64_tr_b16 v[242:243], v254 offset:37376
    v_mfma_f32_16x16x32_bf16 v[24:27], v[244:247], v[136:139], v[24:27]
    s_add_u32 s20, s55, 4096
    buffer_load_dwordx4 v[172:175], v248, s[40:43], s20 offen offset:3072 sc1
    v_mfma_f32_16x16x32_bf16 v[20:23], v[244:247], v[132:135], v[20:23]
    v_mfma_f32_16x16x32_bf16 v[16:19], v[244:247], v[128:131], v[16:19]
    s_waitcnt lgkmcnt(6)
    v_mfma_f32_16x16x32_bf16 v[32:35], v[228:231], v[128:131], v[32:35]
    ds_read_b64_tr_b16 v[244:245], v253 offset:33536
    ds_read_b64_tr_b16 v[246:247], v253 offset:37632
    v_mfma_f32_16x16x32_bf16 v[36:39], v[228:231], v[132:135], v[36:39]
    v_mfma_f32_16x16x32_bf16 v[40:43], v[228:231], v[136:139], v[40:43]
    v_mfma_f32_16x16x32_bf16 v[44:47], v[228:231], v[140:143], v[44:47]
    s_waitcnt lgkmcnt(6)
    v_mfma_f32_16x16x32_bf16 v[60:63], v[232:235], v[140:143], v[60:63]
    ds_read_b64_tr_b16 v[228:229], v254 offset:33536
    ds_read_b64_tr_b16 v[230:231], v254 offset:37632
    v_mfma_f32_16x16x32_bf16 v[56:59], v[232:235], v[136:139], v[56:59]
    v_mfma_f32_16x16x32_bf16 v[52:55], v[232:235], v[132:135], v[52:55]
    v_mfma_f32_16x16x32_bf16 v[48:51], v[232:235], v[128:131], v[48:51]
    s_barrier
    s_waitcnt lgkmcnt(6)
    v_mfma_f32_16x16x32_bf16 v[64:67], v[236:239], v[128:131], v[64:67]
    v_add_u32 v253, 4294868992, v253
    v_add_u32 v254, 4294868992, v254
    ds_read_b64_tr_b16 v[232:233], v253 offset:0
    ds_read_b64_tr_b16 v[234:235], v253 offset:4096
    v_mfma_f32_16x16x32_bf16 v[68:71], v[236:239], v[132:135], v[68:71]
    v_mfma_f32_16x16x32_bf16 v[72:75], v[236:239], v[136:139], v[72:75]
    v_mfma_f32_16x16x32_bf16 v[76:79], v[236:239], v[140:143], v[76:79]
    s_waitcnt lgkmcnt(6)
    v_mfma_f32_16x16x32_bf16 v[92:95], v[240:243], v[140:143], v[92:95]
    ds_read_b64_tr_b16 v[236:237], v254 offset:0
    ds_read_b64_tr_b16 v[238:239], v254 offset:4096
    v_mfma_f32_16x16x32_bf16 v[88:91], v[240:243], v[136:139], v[88:91]
    v_mfma_f32_16x16x32_bf16 v[84:87], v[240:243], v[132:135], v[84:87]
    v_mfma_f32_16x16x32_bf16 v[80:83], v[240:243], v[128:131], v[80:83]
    s_waitcnt lgkmcnt(6)
    v_mfma_f32_16x16x32_bf16 v[96:99], v[244:247], v[128:131], v[96:99]
    ds_read_b64_tr_b16 v[240:241], v253 offset:256
    ds_read_b64_tr_b16 v[242:243], v253 offset:4352
    v_mfma_f32_16x16x32_bf16 v[100:103], v[244:247], v[132:135], v[100:103]
    v_mfma_f32_16x16x32_bf16 v[104:107], v[244:247], v[136:139], v[104:107]
    v_mfma_f32_16x16x32_bf16 v[108:111], v[244:247], v[140:143], v[108:111]
    s_waitcnt lgkmcnt(6)
    v_mfma_f32_16x16x32_bf16 v[124:127], v[228:231], v[140:143], v[124:127]
    ds_read_b64_tr_b16 v[244:245], v254 offset:256
    ds_read_b64_tr_b16 v[246:247], v254 offset:4352
    v_mfma_f32_16x16x32_bf16 v[120:123], v[228:231], v[136:139], v[120:123]
    v_mfma_f32_16x16x32_bf16 v[116:119], v[228:231], v[132:135], v[116:119]
    v_mfma_f32_16x16x32_bf16 v[112:115], v[228:231], v[128:131], v[112:115]
    s_waitcnt vmcnt(0)
    v_mov_b32 v255, 3
    s_mov_b64 exec, 1
    s_cmp_eq_u32 s61, 0
    s_cbranch_scc1 L_fl2_X_s
    buffer_store_dword v255, v250, s[40:43], s72 offen
    s_branch L_fl2_X_e
L_fl2_X_s:
    buffer_store_dword v255, v250, s[40:43], s72 offen sc1
L_fl2_X_e:
    s_mov_b64 exec, -1
    s_waitcnt lgkmcnt(6)
    v_mfma_f32_16x16x32_bf16 v[0:3], v[232:235], v[144:147], v[0:3]
    ds_read_b64_tr_b16 v[228:229], v253 offset:512
    ds_read_b64_tr_b16 v[230:231], v253 offset:4608
    v_mfma_f32_16x16x32_bf16 v[4:7], v[232:235], v[148:151], v[4:7]
    v_mfma_f32_16x16x32_bf16 v[8:11], v[232:235], v[152:155], v[8:11]
    v_mfma_f32_16x16x32_bf16 v[12:15], v[232:235], v[156:159], v[12:15]
    s_waitcnt lgkmcnt(6)
    v_mfma_f32_16x16x32_bf16 v[28:31], v[236:239], v[156:159], v[28:31]
    ds_read_b64_tr_b16 v[232:233], v254 offset:512
    ds_read_b64_tr_b16 v[234:235], v254 offset:4608
    v_mfma_f32_16x16x32_bf16 v[24:27], v[236:239], v[152:155], v[24:27]
    v_mfma_f32_16x16x32_bf16 v[20:23], v[236:239], v[148:151], v[20:23]
    v_mfma_f32_16x16x32_bf16 v[16:19], v[236:239], v[144:147], v[16:19]
    buffer_load_dword v224, v225, s[40:43], s60 offen sc1
    s_waitcnt lgkmcnt(6)
    v_mfma_f32_16x16x32_bf16 v[32:35], v[240:243], v[144:147], v[32:35]
    ds_read_b64_tr_b16 v[236:237], v253 offset:768
    ds_read_b64_tr_b16 v[238:239], v253 offset:4864
    v_mfma_f32_16x16x32_bf16 v[36:39], v[240:243], v[148:151], v[36:39]
    v_mfma_f32_16x16x32_bf16 v[40:43], v[240:243], v[152:155], v[40:43]
    v_mfma_f32_16x16x32_bf16 v[44:47], v[240:243], v[156:159], v[44:47]
    s_waitcnt lgkmcnt(6)
    v_mfma_f32_16x16x32_bf16 v[60:63], v[244:247], v[156:159], v[60:63]
    ds_read_b64_tr_b16 v[240:241], v254 offset:768
    ds_read_b64_tr_b16 v[242:243], v254 offset:4864
    v_mfma_f32_16x16x32_bf16 v[56:59], v[244:247], v[152:155], v[56:59]
    v_mfma_f32_16x16x32_bf16 v[52:55], v[244:247], v[148:151], v[52:55]
    v_mfma_f32_16x16x32_bf16 v[48:51], v[244:247], v[144:147], v[48:51]
    s_waitcnt lgkmcnt(6)
    v_mfma_f32_16x16x32_bf16 v[64:67], v[228:231], v[144:147], v[64:67]
    v_add_u32 v253, 49152, v253
    v_add_u32 v254, 49152, v254
    ds_read_b64_tr_b16 v[244:245], v253 offset:32768
    ds_read_b64_tr_b16 v[246:247], v253 offset:36864
    v_mfma_f32_16x16x32_bf16 v[68:71], v[228:231], v[148:151], v[68:71]
    v_mfma_f32_16x16x32_bf16 v[72:75], v[228:231], v[152:155], v[72:75]
    v_mfma_f32_16x16x32_bf16 v[76:79], v[228:231], v[156:159], v[76:79]
    s_waitcnt lgkmcnt(6)
    v_mfma_f32_16x16x32_bf16 v[92:95], v[232:235], v[156:159], v[92:95]
    ds_read_b64_tr_b16 v[228:229], v254 offset:32768
    ds_read_b64_tr_b16 v[230:231], v254 offset:36864
    v_mfma_f32_16x16x32_bf16 v[88:91], v[232:235], v[152:155], v[88:91]
    v_mfma_f32_16x16x32_bf16 v[84:87], v[232:235], v[148:151], v[84:87]
    v_mfma_f32_16x16x32_bf16 v[80:83], v[232:235], v[144:147], v[80:83]
    s_waitcnt lgkmcnt(6)
    v_mfma_f32_16x16x32_bf16 v[96:99], v[236:239], v[144:147], v[96:99]
    ds_read_b64_tr_b16 v[232:233], v253 offset:33024
    ds_read_b64_tr_b16 v[234:235], v253 offset:37120
    v_mfma_f32_16x16x32_bf16 v[100:103], v[236:239], v[148:151], v[100:103]
    v_mfma_f32_16x16x32_bf16 v[104:107], v[236:239], v[152:155], v[104:107]
    v_mfma_f32_16x16x32_bf16 v[108:111], v[236:239], v[156:159], v[108:111]
    s_waitcnt lgkmcnt(6)
    v_mfma_f32_16x16x32_bf16 v[124:127], v[240:243], v[156:159], v[124:127]
    ds_read_b64_tr_b16 v[236:237], v254 offset:33024
    ds_read_b64_tr_b16 v[238:239], v254 offset:37120
    v_mfma_f32_16x16x32_bf16 v[120:123], v[240:243], v[152:155], v[120:123]
    v_mfma_f32_16x16x32_bf16 v[116:119], v[240:243], v[148:151], v[116:119]
    v_mfma_f32_16x16x32_bf16 v[112:115], v[240:243], v[144:147], v[112:115]
    s_waitcnt vmcnt(0)
    v_cmp_gt_u32 vcc, 3, v224
    s_cbranch_vccz L_polled2_X
L_poll2_X:
    buffer_load_dword v224, v225, s[40:43], s60 offen sc1
    s_add_u32 s79, s79, 1
    s_cmp_ge_u32 s79, 0x40000
    s_waitcnt vmcnt(0)
    s_cbranch_scc1 L_polled2_X
    v_cmp_gt_u32 vcc, 3, v224
    s_cbranch_vccnz L_poll2_X
L_polled2_X:
    s_add_u32 s20, s52, 4096
    s_add_u32 s20, s20, s78
    s_cmp_eq_u32 s61, 0
    s_cbranch_scc1 L_st3_X_s
    buffer_store_dwordx4 v[176:179], v248, s[40:43], s20 offen offset:0
    buffer_store_dwordx4 v[180:183], v248, s[40:43], s20 offen offset:1024
    buffer_store_dwordx4 v[184:187], v248, s[40:43], s20 offen offset:2048
    buffer_store_dwordx4 v[188:191], v248, s[40:43], s20 offen offset:3072
    s_branch L_st3_X_e
L_st3_X_s:
    buffer_store_dwordx4 v[176:179], v248, s[40:43], s20 offen offset:0 sc1
    buffer_store_dwordx4 v[180:183], v248, s[40:43], s20 offen offset:1024 sc1
    buffer_store_dwordx4 v[184:187], v248, s[40:43], s20 offen offset:2048 sc1
    buffer_store_dwordx4 v[188:191], v248, s[40:43], s20 offen offset:3072 sc1
L_st3_X_e:
    s_waitcnt lgkmcnt(6)
    v_mfma_f32_16x16x32_bf16 v[0:3], v[244:247], v[192:195], v[0:3]
    ds_read_b64_tr_b16 v[240:241], v253 offset:33280
    ds_read_b64_tr_b16 v[242:243], v253 offset:37376
    v_mfma_f32_16x16x32_bf16 v[4:7], v[244:247], v[196:199], v[4:7]
    s_add_u32 s20, s53, 0
    s_add_u32 s20, s20, s78
    buffer_load_dwordx4 v[208:211], v248, s[40:43], s20 offen offset:0 sc1
    v_mfma_f32_16x16x32_bf16 v[8:11], v[244:247], v[200:203], v[8:11]
    s_add_u32 s20, s53, 0
    s_add_u32 s20, s20, s78
    buffer_load_dwordx4 v[212:215], v248, s[40:43], s20 offen offset:1024 sc1
    v_mfma_f32_16x16x32_bf16 v[12:15], v[244:247], v[204:207], v[12:15]
    s_add_u32 s20, s53, 0
    s_add_u32 s20, s20, s78
    buffer_load_dwordx4 v[216:219], v248, s[40:43], s20 offen offset:2048 sc1
    s_waitcnt lgkmcnt(6)
    v_mfma_f32_16x16x32_bf16 v[28:31], v[228:231], v[204:207], v[28:31]
    ds_read_b64_tr_b16 v[244:245], v254 offset:33280
    ds_read_b64_tr_b16 v[246:247], v254 offset:37376
    v_mfma_f32_16x16x32_bf16 v[24:27], v[228:231], v[200:203], v[24:27]
    s_add_u32 s20, s53, 0
    s_add_u32 s20, s20, s78
    buffer_load_dwordx4 v[220:223], v248, s[40:43], s20 offen offset:3072 sc1
    v_mfma_f32_16x16x32_bf16 v[20:23], v[228:231], v[196:199], v[20:23]
    s_add_u32 s20, s54, 0
    s_add_u32 s20, s20, s78
    buffer_load_dwordx4 v[128:131], v248, s[40:43], s20 offen offset:0 sc1
    v_mfma_f32_16x16x32_bf16 v[16:19], v[228:231], v[192:195], v[16:19]
    s_add_u32 s20, s54, 0
    s_add_u32 s20, s20, s78
    buffer_load_dwordx4 v[132:135], v248, s[40:43], s20 offen offset:1024 sc1
    s_waitcnt lgkmcnt(6)
    v_mfma_f32_16x16x32_bf16 v[32:35], v[232:235], v[192:195], v[32:35]
    ds_read_b64_tr_b16 v[228:229], v253 offset:33536
    ds_read_b64_tr_b16 v[230:231], v253 offset:37632
    v_mfma_f32_16x16x32_bf16 v[36:39], v[232:235], v[196:199], v[36:39]
    s_add_u32 s20, s54, 0
    s_add_u32 s20, s20, s78
    buffer_load_dwordx4 v[136:139], v248, s[40:43], s20 offen offset:2048 sc1
    v_mfma_f32_16x16x32_bf16 v[40:43], v[232:235], v[200:203], v[40:43]
    s_add_u32 s20, s54, 0
    s_add_u32 s20, s20, s78
    buffer_load_dwordx4 v[140:143], v248, s[40:43], s20 offen offset:3072 sc1
    v_mfma_f32_16x16x32_bf16 v[44:47], v[232:235], v[204:207], v[44:47]
    s_waitcnt lgkmcnt(6)
    v_mfma_f32_16x16x32_bf16 v[60:63], v[236:239], v[204:207], v[60:63]
    ds_read_b64_tr_b16 v[232:233], v254 offset:33536
    ds_read_b64_tr_b16 v[234:235], v254 offset:37632
    v_mfma_f32_16x16x32_bf16 v[56:59], v[236:239], v[200:203], v[56:59]
    v_mfma_f32_16x16x32_bf16 v[52:55], v[236:239], v[196:199], v[52:55]
    v_mfma_f32_16x16x32_bf16 v[48:51], v[236:239], v[192:195], v[48:51]
    s_waitcnt lgkmcnt(6)
    v_mfma_f32_16x16x32_bf16 v[64:67], v[240:243], v[192:195], v[64:67]
    v_add_u32 v253, 98304, v253
    v_add_u32 v254, 98304, v254
    ds_read_b64_tr_b16 v[236:237], v253 offset:0
    ds_read_b64_tr_b16 v[238:239], v253 offset:4096
    v_mfma_f32_16x16x32_bf16 v[68:71], v[240:243], v[196:199], v[68:71]
    v_mfma_f32_16x16x32_bf16 v[72:75], v[240:243], v[200:203], v[72:75]
    v_mfma_f32_16x16x32_bf16 v[76:79], v[240:243], v[204:207], v[76:79]
    s_waitcnt lgkmcnt(6)
    v_mfma_f32_16x16x32_bf16 v[92:95], v[244:247], v[204:207], v[92:95]
    ds_read_b64_tr_b16 v[240:241], v254 offset:0
    ds_read_b64_tr_b16 v[242:243], v254 offset:4096
    v_mfma_f32_16x16x32_bf16 v[88:91], v[244:247], v[200:203], v[88:91]
    v_mfma_f32_16x16x32_bf16 v[84:87], v[244:247], v[196:199], v[84:87]
    v_mfma_f32_16x16x32_bf16 v[80:83], v[244:247], v[192:195], v[80:83]
    s_waitcnt vmcnt(8)
    v_mov_b32 v255, 4
    s_mov_b64 exec, 1
    s_cmp_eq_u32 s61, 0
    s_cbranch_scc1 L_fl3_X_s
    buffer_store_dword v255, v250, s[40:43], s72 offen
    s_branch L_fl3_X_e
L_fl3_X_s:
    buffer_store_dword v255, v250, s[40:43], s72 offen sc1
L_fl3_X_e:
    s_mov_b64 exec, -1
    s_waitcnt lgkmcnt(6)
    v_mfma_f32_16x16x32_bf16 v[96:99], v[228:231], v[192:195], v[96:99]
    ds_read_b64_tr_b16 v[244:245], v253 offset:256
    ds_read_b64_tr_b16 v[246:247], v253 offset:4352
    v_mfma_f32_16x16x32_bf16 v[100:103], v[228:231], v[196:199], v[100:103]
    v_mfma_f32_16x16x32_bf16 v[104:107], v[228:231], v[200:203], v[104:107]
    v_mfma_f32_16x16x32_bf16 v[108:111], v[228:231], v[204:207], v[108:111]
    s_waitcnt lgkmcnt(6)
    v_mfma_f32_16x16x32_bf16 v[124:127], v[232:235], v[204:207], v[124:127]
    ds_read_b64_tr_b16 v[228:229], v254 offset:256
    ds_read_b64_tr_b16 v[230:231], v254 offset:4352
    v_mfma_f32_16x16x32_bf16 v[120:123], v[232:235], v[200:203], v[120:123]
    v_mfma_f32_16x16x32_bf16 v[116:119], v[232:235], v[196:199], v[116:119]
    v_mfma_f32_16x16x32_bf16 v[112:115], v[232:235], v[192:195], v[112:115]
    s_waitcnt lgkmcnt(6)
    v_mfma_f32_16x16x32_bf16 v[0:3], v[236:239], v[160:163], v[0:3]
    ds_read_b64_tr_b16 v[232:233], v253 offset:512
    ds_read_b64_tr_b16 v[234:235], v253 offset:4608
    v_mfma_f32_16x16x32_bf16 v[4:7], v[236:239], v[164:167], v[4:7]
    s_add_u32 s20, s55, 0
    s_add_u32 s20, s20, s78
    buffer_load_dwordx4 v[144:147], v248, s[40:43], s20 offen offset:0 sc1
    v_mfma_f32_16x16x32_bf16 v[8:11], v[236:239], v[168:171], v[8:11]
    s_add_u32 s20, s55, 0
    s_add_u32 s20, s20, s78
    buffer_load_dwordx4 v[148:151], v248, s[40:43], s20 offen offset:1024 sc1
    v_mfma_f32_16x16x32_bf16 v[12:15], v[236:239], v[172:175], v[12:15]
    s_add_u32 s20, s55, 0
    s_add_u32 s20, s20, s78
    buffer_load_dwordx4 v[152:155], v248, s[40:43], s20 offen offset:2048 sc1
    s_waitcnt lgkmcnt(6)
    v_mfma_f32_16x16x32_bf16 v[28:31], v[240:243], v[172:175], v[28:31]
    ds_read_b64_tr_b16 v[236:237], v254 offset:512
    ds_read_b64_tr_b16 v[238:239], v254 offset:4608
    v_mfma_f32_16x16x32_bf16 v[24:27], v[240:243], v[168:171], v[24:27]
    s_add_u32 s20, s55, 0
    s_add_u32 s20, s20, s78
    buffer_load_dwordx4 v[156:159], v248, s[40:43], s20 offen offset:3072 sc1
    v_mfma_f32_16x16x32_bf16 v[20:23], v[240:243], v[164:167], v[20:23]
    v_mfma_f32_16x16x32_bf16 v[16:19], v[240:243], v[160:163], v[16:19]
    s_waitcnt lgkmcnt(6)
    v_mfma_f32_16x16x32_bf16 v[32:35], v[244:247], v[160:163], v[32:35]
    ds_read_b64_tr_b16 v[240:241], v253 offset:768
    ds_read_b64_tr_b16 v[242:243], v253 offset:4864
    v_mfma_f32_16x16x32_bf16 v[36:39], v[244:247], v[164:167], v[36:39]
    v_mfma_f32_16x16x32_bf16 v[40:43], v[244:247], v[168:171], v[40:43]
    v_mfma_f32_16x16x32_bf16 v[44:47], v[244:247], v[172:175], v[44:47]
    s_waitcnt lgkmcnt(6)
    v_mfma_f32_16x16x32_bf16 v[60:63], v[228:231], v[172:175], v[60:63]
    ds_read_b64_tr_b16 v[244:245], v254 offset:768
    ds_read_b64_tr_b16 v[246:247], v254 offset:4864
    v_mfma_f32_16x16x32_bf16 v[56:59], v[228:231], v[168:171], v[56:59]
    v_mfma_f32_16x16x32_bf16 v[52:55], v[228:231], v[164:167], v[52:55]
    v_mfma_f32_16x16x32_bf16 v[48:51], v[228:231], v[160:163], v[48:51]
    s_barrier
    s_waitcnt lgkmcnt(6)
    v_mfma_f32_16x16x32_bf16 v[64:67], v[232:235], v[160:163], v[64:67]
    v_add_u32 v253, 4294819840, v253
    v_add_u32 v254, 4294819840, v254
    ds_read_b64_tr_b16 v[228:229], v253 offset:16384
    ds_read_b64_tr_b16 v[230:231], v253 offset:20480
    v_mfma_f32_16x16x32_bf16 v[68:71], v[232:235], v[164:167], v[68:71]
    v_mfma_f32_16x16x32_bf16 v[72:75], v[232:235], v[168:171], v[72:75]
    v_mfma_f32_16x16x32_bf16 v[76:79], v[232:235], v[172:175], v[76:79]
    s_waitcnt lgkmcnt(6)
    v_mfma_f32_16x16x32_bf16 v[92:95], v[236:239], v[172:175], v[92:95]
    ds_read_b64_tr_b16 v[232:233], v254 offset:16384
    ds_read_b64_tr_b16 v[234:235], v254 offset:20480
    v_mfma_f32_16x16x32_bf16 v[88:91], v[236:239], v[168:171], v[88:91]
    v_mfma_f32_16x16x32_bf16 v[84:87], v[236:239], v[164:167], v[84:87]
    v_mfma_f32_16x16x32_bf16 v[80:83], v[236:239], v[160:163], v[80:83]
    s_waitcnt lgkmcnt(6)
    v_mfma_f32_16x16x32_bf16 v[96:99], v[240:243], v[160:163], v[96:99]
    ds_read_b64_tr_b16 v[236:237], v253 offset:16640
    ds_read_b64_tr_b16 v[238:239], v253 offset:20736
    v_mfma_f32_16x16x32_bf16 v[100:103], v[240:243], v[164:167], v[100:103]
    v_mfma_f32_16x16x32_bf16 v[104:107], v[240:243], v[168:171], v[104:107]
    v_mfma_f32_16x16x32_bf16 v[108:111], v[240:243], v[172:175], v[108:111]
    s_waitcnt lgkmcnt(6)
    v_mfma_f32_16x16x32_bf16 v[124:127], v[244:247], v[172:175], v[124:127]
    ds_read_b64_tr_b16 v[240:241], v254 offset:16640
    ds_read_b64_tr_b16 v[242:243], v254 offset:20736
    v_mfma_f32_16x16x32_bf16 v[120:123], v[244:247], v[168:171], v[120:123]
    v_mfma_f32_16x16x32_bf16 v[116:119], v[244:247], v[164:167], v[116:119]
    v_mfma_f32_16x16x32_bf16 v[112:115], v[244:247], v[160:163], v[112:115]
    s_waitcnt vmcnt(9)
    s_waitcnt lgkmcnt(6)
    v_mfma_f32_16x16x32_bf16 v[0:3], v[228:231], v[208:211], v[0:3]
    ds_read_b64_tr_b16 v[244:245], v253 offset:16896
    ds_read_b64_tr_b16 v[246:247], v253 offset:20992
    v_mfma_f32_16x16x32_bf16 v[4:7], v[228:231], v[212:215], v[4:7]
    v_mfma_f32_16x16x32_bf16 v[8:11], v[228:231], v[216:219], v[8:11]
    v_mfma_f32_16x16x32_bf16 v[12:15], v[228:231], v[220:223], v[12:15]
    s_waitcnt lgkmcnt(6)
    v_mfma_f32_16x16x32_bf16 v[28:31], v[232:235], v[220:223], v[28:31]
    ds_read_b64_tr_b16 v[228:229], v254 offset:16896
    ds_read_b64_tr_b16 v[230:231], v254 offset:20992
    v_mfma_f32_16x16x32_bf16 v[24:27], v[232:235], v[216:219], v[24:27]
    v_mfma_f32_16x16x32_bf16 v[20:23], v[232:235], v[212:215], v[20:23]
    v_mfma_f32_16x16x32_bf16 v[16:19], v[232:235], v[208:211], v[16:19]
    buffer_load_dword v224, v225, s[40:43], s60 offen sc1
    s_waitcnt lgkmcnt(6)
    v_mfma_f32_16x16x32_bf16 v[32:35], v[236:239], v[208:211], v[32:35]
    ds_read_b64_tr_b16 v[232:233], v253 offset:17152
    ds_read_b64_tr_b16 v[234:235], v253 offset:21248
    v_mfma_f32_16x16x32_bf16 v[36:39], v[236:239], v[212:215], v[36:39]
    v_mfma_f32_16x16x32_bf16 v[40:43], v[236:239], v[216:219], v[40:43]
    v_mfma_f32_16x16x32_bf16 v[44:47], v[236:239], v[220:223], v[44:47]
    s_waitcnt lgkmcnt(6)
    v_mfma_f32_16x16x32_bf16 v[60:63], v[240:243], v[220:223], v[60:63]
    ds_read_b64_tr_b16 v[236:237], v254 offset:17152
    ds_read_b64_tr_b16 v[238:239], v254 offset:21248
    v_mfma_f32_16x16x32_bf16 v[56:59], v[240:243], v[216:219], v[56:59]
    v_mfma_f32_16x16x32_bf16 v[52:55], v[240:243], v[212:215], v[52:55]
    v_mfma_f32_16x16x32_bf16 v[48:51], v[240:243], v[208:211], v[48:51]
    s_waitcnt lgkmcnt(6)
    v_mfma_f32_16x16x32_bf16 v[64:67], v[244:247], v[208:211], v[64:67]
    ds_read_b64_tr_b16 v[240:241], v253 offset:32768
    ds_read_b64_tr_b16 v[242:243], v253 offset:36864
    v_mfma_f32_16x16x32_bf16 v[68:71], v[244:247], v[212:215], v[68:71]
    v_mfma_f32_16x16x32_bf16 v[72:75], v[244:247], v[216:219], v[72:75]
    v_mfma_f32_16x16x32_bf16 v[76:79], v[244:247], v[220:223], v[76:79]
    s_waitcnt lgkmcnt(6)
    v_mfma_f32_16x16x32_bf16 v[92:95], v[228:231], v[220:223], v[92:95]
    ds_read_b64_tr_b16 v[244:245], v254 offset:32768
    ds_read_b64_tr_b16 v[246:247], v254 offset:36864
    v_mfma_f32_16x16x32_bf16 v[88:91], v[228:231], v[216:219], v[88:91]
    v_mfma_f32_16x16x32_bf16 v[84:87], v[228:231], v[212:215], v[84:87]
    v_mfma_f32_16x16x32_bf16 v[80:83], v[228:231], v[208:211], v[80:83]
    s_waitcnt lgkmcnt(6)
    v_mfma_f32_16x16x32_bf16 v[96:99], v[232:235], v[208:211], v[96:99]
    ds_read_b64_tr_b16 v[228:229], v253 offset:33024
    ds_read_b64_tr_b16 v[230:231], v253 offset:37120
    v_mfma_f32_16x16x32_bf16 v[100:103], v[232:235], v[212:215], v[100:103]
    v_mfma_f32_16x16x32_bf16 v[104:107], v[232:235], v[216:219], v[104:107]
    v_mfma_f32_16x16x32_bf16 v[108:111], v[232:235], v[220:223], v[108:111]
    s_waitcnt lgkmcnt(6)
    v_mfma_f32_16x16x32_bf16 v[124:127], v[236:239], v[220:223], v[124:127]
    ds_read_b64_tr_b16 v[232:233], v254 offset:33024
    ds_read_b64_tr_b16 v[234:235], v254 offset:37120
    v_mfma_f32_16x16x32_bf16 v[120:123], v[236:239], v[216:219], v[120:123]
    v_mfma_f32_16x16x32_bf16 v[116:119], v[236:239], v[212:215], v[116:119]
    v_mfma_f32_16x16x32_bf16 v[112:115], v[236:239], v[208:211], v[112:115]
    s_waitcnt vmcnt(0)
    v_cmp_gt_u32 vcc, 4, v224
    s_cbranch_vccz L_polled3_X
L_poll3_X:
    buffer_load_dword v224, v225, s[40:43], s60 offen sc1
    s_add_u32 s79, s79, 1
    s_cmp_ge_u32 s79, 0x40000
    s_waitcnt vmcnt(0)
    s_cbranch_scc1 L_polled3_X
    v_cmp_gt_u32 vcc, 4, v224
    s_cbranch_vccnz L_poll3_X
L_polled3_X:
    s_waitcnt lgkmcnt(6)
    v_mfma_f32_16x16x32_bf16 v[0:3], v[240:243], v[128:131], v[0:3]
    ds_read_b64_tr_b16 v[236:237], v253 offset:33280
    ds_read_b64_tr_b16 v[238:239], v253 offset:37376
    v_mfma_f32_16x16x32_bf16 v[4:7], v[240:243], v[132:135], v[4:7]
    s_add_u32 s20, s53, 4096
    s_add_u32 s20, s20, s78
    buffer_load_dwordx4 v[176:179], v248, s[40:43], s20 offen offset:0 sc1
    v_mfma_f32_16x16x32_bf16 v[8:11], v[240:243], v[136:139], v[8:11]
    s_add_u32 s20, s53, 4096
    s_add_u32 s20, s20, s78
    buffer_load_dwordx4 v[180:183], v248, s[40:43], s20 offen offset:1024 sc1
    v_mfma_f32_16x16x32_bf16 v[12:15], v[240:243], v[140:143], v[12:15]
    s_add_u32 s20, s53, 4096
    s_add_u32 s20, s20, s78
    buffer_load_dwordx4 v[184:187], v248, s[40:43], s20 offen offset:2048 sc1
    s_waitcnt lgkmcnt(6)
    v_mfma_f32_16x16x32_bf16 v[28:31], v[244:247], v[140:143], v[28:31]
    ds_read_b64_tr_b16 v[240:241], v254 offset:33280
    ds_read_b64_tr_b16 v[242:243], v254 offset:37376
    v_mfma_f32_16x16x32_bf16 v[24:27], v[244:247], v[136:139], v[24:27]
    s_add_u32 s20, s53, 4096
    s_add_u32 s20, s20, s78
    buffer_load_dwordx4 v[188:191], v248, s[40:43], s20 offen offset:3072 sc1
    v_mfma_f32_16x16x32_bf16 v[20:23], v[244:247], v[132:135], v[20:23]
    s_add_u32 s20, s54, 4096
    s_add_u32 s20, s20, s78
    buffer_load_dwordx4 v[192:195], v248, s[40:43], s20 offen offset:0 sc1
    v_mfma_f32_16x16x32_bf16 v[16:19], v[244:247], v[128:131], v[16:19]
    s_add_u32 s20, s54, 4096
    s_add_u32 s20, s20, s78
    buffer_load_dwordx4 v[196:199], v248, s[40:43], s20 offen offset:1024 sc1
    s_waitcnt lgkmcnt(6)
    v_mfma_f32_16x16x32_bf16 v[32:35], v[228:231], v[128:131], v[32:35]
    ds_read_b64_tr_b16 v[244:245], v253 offset:33536
    ds_read_b64_tr_b16 v[246:247], v253 offset:37632
    v_mfma_f32_16x16x32_bf16 v[36:39], v[228:231], v[132:135], v[36:39]
    s_add_u32 s20, s54, 4096
    s_add_u32 s20, s20, s78
    buffer_load_dwordx4 v[200:203], v248, s[40:43], s20 offen offset:2048 sc1
    v_mfma_f32_16x16x32_bf16 v[40:43], v[228:231], v[136:139], v[40:43]
    s_add_u32 s20, s54, 4096
    s_add_u32 s20, s20, s78
    buffer_load_dwordx4 v[204:207], v248, s[40:43], s20 offen offset:3072 sc1
    v_mfma_f32_16x16x32_bf16 v[44:47], v[228:231], v[140:143], v[44:47]
    s_waitcnt lgkmcnt(6)
    v_mfma_f32_16x16x32_bf16 v[60:63], v[232:235], v[140:143], v[60:63]
    ds_read_b64_tr_b16 v[228:229], v254 offset:33536
    ds_read_b64_tr_b16 v[230:231], v254 offset:37632
    v_mfma_f32_16x16x32_bf16 v[56:59], v[232:235], v[136:139], v[56:59]
    v_mfma_f32_16x16x32_bf16 v[52:55], v[232:235], v[132:135], v[52:55]
    v_mfma_f32_16x16x32_bf16 v[48:51], v[232:235], v[128:131], v[48:51]
    s_waitcnt lgkmcnt(6)
    v_mfma_f32_16x16x32_bf16 v[64:67], v[236:239], v[128:131], v[64:67]
    v_add_u32 v253, 49152, v253
    v_add_u32 v254, 49152, v254
    ds_read_b64_tr_b16 v[232:233], v253 offset:0
    ds_read_b64_tr_b16 v[234:235], v253 offset:4096
    v_mfma_f32_16x16x32_bf16 v[68:71], v[236:239], v[132:135], v[68:71]
    v_mfma_f32_16x16x32_bf16 v[72:75], v[236:239], v[136:139], v[72:75]
    v_mfma_f32_16x16x32_bf16 v[76:79], v[236:239], v[140:143], v[76:79]
    s_waitcnt lgkmcnt(6)
    v_mfma_f32_16x16x32_bf16 v[92:95], v[240:243], v[140:143], v[92:95]
    ds_read_b64_tr_b16 v[236:237], v254 offset:0
    ds_read_b64_tr_b16 v[238:239], v254 offset:4096
    v_mfma_f32_16x16x32_bf16 v[88:91], v[240:243], v[136:139], v[88:91]
    v_mfma_f32_16x16x32_bf16 v[84:87], v[240:243], v[132:135], v[84:87]
    v_mfma_f32_16x16x32_bf16 v[80:83], v[240:243], v[128:131], v[80:83]
    s_waitcnt lgkmcnt(6)
    v_mfma_f32_16x16x32_bf16 v[96:99], v[244:247], v[128:131], v[96:99]
    ds_read_b64_tr_b16 v[240:241], v253 offset:256
    ds_read_b64_tr_b16 v[242:243], v253 offset:4352
    v_mfma_f32_16x16x32_bf16 v[100:103], v[244:247], v[132:135], v[100:103]
    v_mfma_f32_16x16x32_bf16 v[104:107], v[244:247], v[136:139], v[104:107]
    v_mfma_f32_16x16x32_bf16 v[108:111], v[244:247], v[140:143], v[108:111]
    s_waitcnt lgkmcnt(6)
    v_mfma_f32_16x16x32_bf16 v[124:127], v[228:231], v[140:143], v[124:127]
    ds_read_b64_tr_b16 v[244:245], v254 offset:256
    ds_read_b64_tr_b16 v[246:247], v254 offset:4352
    v_mfma_f32_16x16x32_bf16 v[120:123], v[228:231], v[136:139], v[120:123]
    v_mfma_f32_16x16x32_bf16 v[116:119], v[228:231], v[132:135], v[116:119]
    v_mfma_f32_16x16x32_bf16 v[112:115], v[228:231], v[128:131], v[112:115]
    s_waitcnt lgkmcnt(6)
    v_mfma_f32_16x16x32_bf16 v[0:3], v[232:235], v[144:147], v[0:3]
    ds_read_b64_tr_b16 v[228:229], v253 offset:512
    ds_read_b64_tr_b16 v[230:231], v253 offset:4608
    v_mfma_f32_16x16x32_bf16 v[4:7], v[232:235], v[148:151], v[4:7]
    s_add_u32 s20, s55, 4096
    s_add_u32 s20, s20, s78
    buffer_load_dwordx4 v[160:163], v248, s[40:43], s20 offen offset:0 sc1
    v_mfma_f32_16x16x32_bf16 v[8:11], v[232:235], v[152:155], v[8:11]
    s_add_u32 s20, s55, 4096
    s_add_u32 s20, s20, s78
    buffer_load_dwordx4 v[164:167], v248, s[40:43], s20 offen offset:1024 sc1
    v_mfma_f32_16x16x32_bf16 v[12:15], v[232:235], v[156:159], v[12:15]
    s_add_u32 s20, s55, 4096
    s_add_u32 s20, s20, s78
    buffer_load_dwordx4 v[168:171], v248, s[40:43], s20 offen offset:2048 sc1
    s_waitcnt lgkmcnt(6)
    v_mfma_f32_16x16x32_bf16 v[28:31], v[236:239], v[156:159], v[28:31]
    ds_read_b64_tr_b16 v[232:233], v254 offset:512
    ds_read_b64_tr_b16 v[234:235], v254 offset:4608
    v_mfma_f32_16x16x32_bf16 v[24:27], v[236:239], v[152:155], v[24:27]
    s_add_u32 s20, s55, 4096
    s_add_u32 s20, s20, s78
    buffer_load_dwordx4 v[172:175], v248, s[40:43], s20 offen offset:3072 sc1
    v_mfma_f32_16x16x32_bf16 v[20:23], v[236:239], v[148:151], v[20:23]
    v_mfma_f32_16x16x32_bf16 v[16:19], v[236:239], v[144:147], v[16:19]
    s_waitcnt lgkmcnt(6)
    v_mfma_f32_16x16x32_bf16 v[32:35], v[240:243], v[144:147], v[32:35]
    ds_read_b64_tr_b16 v[236:237], v253 offset:768
    ds_read_b64_tr_b16 v[238:239], v253 offset:4864
    v_mfma_f32_16x16x32_bf16 v[36:39], v[240:243], v[148:151], v[36:39]
    v_mfma_f32_16x16x32_bf16 v[40:43], v[240:243], v[152:155], v[40:43]
    v_mfma_f32_16x16x32_bf16 v[44:47], v[240:243], v[156:159], v[44:47]
    s_waitcnt lgkmcnt(6)
    v_mfma_f32_16x16x32_bf16 v[60:63], v[244:247], v[156:159], v[60:63]
    ds_read_b64_tr_b16 v[240:241], v254 offset:768
    ds_read_b64_tr_b16 v[242:243], v254 offset:4864
    v_mfma_f32_16x16x32_bf16 v[56:59], v[244:247], v[152:155], v[56:59]
    v_mfma_f32_16x16x32_bf16 v[52:55], v[244:247], v[148:151], v[52:55]
    v_mfma_f32_16x16x32_bf16 v[48:51], v[244:247], v[144:147], v[48:51]
    s_waitcnt lgkmcnt(6)
    v_mfma_f32_16x16x32_bf16 v[64:67], v[228:231], v[144:147], v[64:67]
    v_add_u32 v253, 49152, v253
    v_add_u32 v254, 49152, v254
    ds_read_b64_tr_b16 v[244:245], v253 offset:0
    ds_read_b64_tr_b16 v[246:247], v253 offset:4096
    v_mfma_f32_16x16x32_bf16 v[68:71], v[228:231], v[148:151], v[68:71]
    v_mfma_f32_16x16x32_bf16 v[72:75], v[228:231], v[152:155], v[72:75]
    v_mfma_f32_16x16x32_bf16 v[76:79], v[228:231], v[156:159], v[76:79]
    s_waitcnt lgkmcnt(6)
    v_mfma_f32_16x16x32_bf16 v[92:95], v[232:235], v[156:159], v[92:95]
    ds_read_b64_tr_b16 v[228:229], v254 offset:0
    ds_read_b64_tr_b16 v[230:231], v254 offset:4096
    v_mfma_f32_16x16x32_bf16 v[88:91], v[232:235], v[152:155], v[88:91]
    v_mfma_f32_16x16x32_bf16 v[84:87], v[232:235], v[148:151], v[84:87]
    v_mfma_f32_16x16x32_bf16 v[80:83], v[232:235], v[144:147], v[80:83]
    s_waitcnt lgkmcnt(6)
    v_mfma_f32_16x16x32_bf16 v[96:99], v[236:239], v[144:147], v[96:99]
    ds_read_b64_tr_b16 v[232:233], v253 offset:256
    ds_read_b64_tr_b16 v[234:235], v253 offset:4352
    v_mfma_f32_16x16x32_bf16 v[100:103], v[236:239], v[148:151], v[100:103]
    v_mfma_f32_16x16x32_bf16 v[104:107], v[236:239], v[152:155], v[104:107]
    v_mfma_f32_16x16x32_bf16 v[108:111], v[236:239], v[156:159], v[108:111]
    s_waitcnt lgkmcnt(6)
    v_mfma_f32_16x16x32_bf16 v[124:127], v[240:243], v[156:159], v[124:127]
    ds_read_b64_tr_b16 v[236:237], v254 offset:256
    ds_read_b64_tr_b16 v[238:239], v254 offset:4352
    v_mfma_f32_16x16x32_bf16 v[120:123], v[240:243], v[152:155], v[120:123]
    v_mfma_f32_16x16x32_bf16 v[116:119], v[240:243], v[148:151], v[116:119]
    v_mfma_f32_16x16x32_bf16 v[112:115], v[240:243], v[144:147], v[112:115]
    s_waitcnt vmcnt(8)
    s_waitcnt lgkmcnt(6)
    v_mfma_f32_16x16x32_bf16 v[0:3], v[244:247], v[176:179], v[0:3]
    ds_read_b64_tr_b16 v[240:241], v253 offset:512
    ds_read_b64_tr_b16 v[242:243], v253 offset:4608
    v_mfma_f32_16x16x32_bf16 v[4:7], v[244:247], v[180:183], v[4:7]
    v_mfma_f32_16x16x32_bf16 v[8:11], v[244:247], v[184:187], v[8:11]
    v_mfma_f32_16x16x32_bf16 v[12:15], v[244:247], v[188:191], v[12:15]
    s_waitcnt lgkmcnt(6)
    v_mfma_f32_16x16x32_bf16 v[28:31], v[228:231], v[188:191], v[28:31]
    ds_read_b64_tr_b16 v[244:245], v254 offset:512
    ds_read_b64_tr_b16 v[246:247], v254 offset:4608
    v_mfma_f32_16x16x32_bf16 v[24:27], v[228:231], v[184:187], v[24:27]
    v_mfma_f32_16x16x32_bf16 v[20:23], v[228:231], v[180:183], v[20:23]
    v_mfma_f32_16x16x32_bf16 v[16:19], v[228:231], v[176:179], v[16:19]
    s_waitcnt lgkmcnt(6)
    v_mfma_f32_16x16x32_bf16 v[32:35], v[232:235], v[176:179], v[32:35]
    ds_read_b64_tr_b16 v[228:229], v253 offset:768
    ds_read_b64_tr_b16 v[230:231], v253 offset:4864
    v_mfma_f32_16x16x32_bf16 v[36:39], v[232:235], v[180:183], v[36:39]
    v_mfma_f32_16x16x32_bf16 v[40:43], v[232:235], v[184:187], v[40:43]
    v_mfma_f32_16x16x32_bf16 v[44:47], v[232:235], v[188:191], v[44:47]
    s_waitcnt lgkmcnt(6)
    v_mfma_f32_16x16x32_bf16 v[60:63], v[236:239], v[188:191], v[60:63]
    ds_read_b64_tr_b16 v[232:233], v254 offset:768
    ds_read_b64_tr_b16 v[234:235], v254 offset:4864
    v_mfma_f32_16x16x32_bf16 v[56:59], v[236:239], v[184:187], v[56:59]
    v_mfma_f32_16x16x32_bf16 v[52:55], v[236:239], v[180:183], v[52:55]
    v_mfma_f32_16x16x32_bf16 v[48:51], v[236:239], v[176:179], v[48:51]
    s_barrier
    s_waitcnt lgkmcnt(6)
    v_mfma_f32_16x16x32_bf16 v[64:67], v[240:243], v[176:179], v[64:67]
    v_add_u32 v253, 4294918144, v253
    v_add_u32 v254, 4294918144, v254
    ds_read_b64_tr_b16 v[236:237], v253 offset:16896
    ds_read_b64_tr_b16 v[238:239], v253 offset:20992
    v_mfma_f32_16x16x32_bf16 v[68:71], v[240:243], v[180:183], v[68:71]
    v_mfma_f32_16x16x32_bf16 v[72:75], v[240:243], v[184:187], v[72:75]
    v_mfma_f32_16x16x32_bf16 v[76:79], v[240:243], v[188:191], v[76:79]
    s_waitcnt lgkmcnt(6)
    v_mfma_f32_16x16x32_bf16 v[92:95], v[244:247], v[188:191], v[92:95]
    ds_read_b64_tr_b16 v[240:241], v253 offset:33280
    ds_read_b64_tr_b16 v[242:243], v253 offset:37376
    v_mfma_f32_16x16x32_bf16 v[88:91], v[244:247], v[184:187], v[88:91]
    v_mfma_f32_16x16x32_bf16 v[84:87], v[244:247], v[180:183], v[84:87]
    v_mfma_f32_16x16x32_bf16 v[80:83], v[244:247], v[176:179], v[80:83]
    s_waitcnt lgkmcnt(6)
    v_mfma_f32_16x16x32_bf16 v[96:99], v[228:231], v[176:179], v[96:99]
    ds_read_b64_tr_b16 v[244:245], v254 offset:16896
    ds_read_b64_tr_b16 v[246:247], v254 offset:20992
    v_mfma_f32_16x16x32_bf16 v[100:103], v[228:231], v[180:183], v[100:103]
    v_mfma_f32_16x16x32_bf16 v[104:107], v[228:231], v[184:187], v[104:107]
    v_mfma_f32_16x16x32_bf16 v[108:111], v[228:231], v[188:191], v[108:111]
    s_waitcnt lgkmcnt(6)
    v_mfma_f32_16x16x32_bf16 v[124:127], v[232:235], v[188:191], v[124:127]
    ds_read_b64_tr_b16 v[228:229], v254 offset:33280
    ds_read_b64_tr_b16 v[230:231], v254 offset:37376
    v_mfma_f32_16x16x32_bf16 v[120:123], v[232:235], v[184:187], v[120:123]
    v_mfma_f32_16x16x32_bf16 v[116:119], v[232:235], v[180:183], v[116:119]
    v_mfma_f32_16x16x32_bf16 v[112:115], v[232:235], v[176:179], v[112:115]
    s_waitcnt vmcnt(4)
    s_waitcnt vmcnt(0)
    v_add_u32 v251, s75, v248
    v_add_u32 v252, s76, v248
    s_mov_b32 s12, s66
    s_mov_b32 s13, s67
    s_and_b32 s20, s2, 3
    s_add_u32 s21, s20, s3
    s_and_b32 s21, s21, 3
    s_mul_i32 s22, s20, 229376
    s_sub_u32 s56, s52, s22
    s_lshl_b32 s22, s21, 11
    s_add_u32 s56, s56, s22
    s_cmp_eq_u32 s61, 0
    s_cselect_b32 s57, 41943040, 0
    s_add_u32 s56, s56, s57
    s_add_u32 s57, s57, s52
    s_bfe_u32 s22, s2, 0x10002
    s_lshr_b32 s23, s2, 3
    s_lshl_b32 s59, s22, 10
    s_and_b32 s22, s23, 3
    s_lshl_b32 s22, s22, 8
    s_add_u32 s59, s59, s22
    s_lshl_b32 s22, s34, 7
    s_add_u32 s59, s59, s22
    s_lshr_b32 s23, s23, 2
    s_mul_i32 s23, s23, 224
    s_add_u32 s23, s23, s35
    s_lshl_b32 s22, s21, 4
    s_add_u32 s23, s23, s22
    s_lshl_b32 s23, s23, 11
    s_add_u32 s59, s59, s23
    s_mov_b32 s63, s21
    s_mov_b32 s14, 3670016
    s_waitcnt lgkmcnt(6)
    v_mfma_f32_16x16x32_bf16 v[64:67], v[236:239], v[192:195], v[64:67]
    ds_read_b64_tr_b16 v[232:233], v253 offset:17152
    ds_read_b64_tr_b16 v[234:235], v253 offset:21248
    v_mfma_f32_16x16x32_bf16 v[68:71], v[236:239], v[196:199], v[68:71]
    v_mfma_f32_16x16x32_bf16 v[72:75], v[236:239], v[200:203], v[72:75]
    v_mfma_f32_16x16x32_bf16 v[76:79], v[236:239], v[204:207], v[76:79]
    s_waitcnt lgkmcnt(6)
    v_mfma_f32_16x16x32_bf16 v[76:79], v[240:243], v[172:175], v[76:79]
    ds_read_b64_tr_b16 v[236:237], v253 offset:33536
    ds_read_b64_tr_b16 v[238:239], v253 offset:37632
    v_mfma_f32_16x16x32_bf16 v[72:75], v[240:243], v[168:171], v[72:75]
    v_mfma_f32_16x16x32_bf16 v[68:71], v[240:243], v[164:167], v[68:71]
    v_mfma_f32_16x16x32_bf16 v[64:67], v[240:243], v[160:163], v[64:67]
    s_waitcnt lgkmcnt(6)
    v_mfma_f32_16x16x32_bf16 v[80:83], v[244:247], v[192:195], v[80:83]
    ds_read_b64_tr_b16 v[240:241], v254 offset:17152
    ds_read_b64_tr_b16 v[242:243], v254 offset:21248
    v_mfma_f32_16x16x32_bf16 v[84:87], v[244:247], v[196:199], v[84:87]
    v_mfma_f32_16x16x32_bf16 v[88:91], v[244:247], v[200:203], v[88:91]
    v_mfma_f32_16x16x32_bf16 v[92:95], v[244:247], v[204:207], v[92:95]
    s_waitcnt lgkmcnt(6)
    v_mfma_f32_16x16x32_bf16 v[92:95], v[228:231], v[172:175], v[92:95]
    ds_read_b64_tr_b16 v[244:245], v254 offset:33536
    ds_read_b64_tr_b16 v[246:247], v254 offset:37632
    v_mfma_f32_16x16x32_bf16 v[88:91], v[228:231], v[168:171], v[88:91]
    ds_write_b128 v251, v[64:67] offset:0
    v_mfma_f32_16x16x32_bf16 v[84:87], v[228:231], v[164:167], v[84:87]
    v_mfma_f32_16x16x32_bf16 v[80:83], v[228:231], v[160:163], v[80:83]
    ds_write_b128 v251, v[68:71] offset:1024
    v_mov_b32 v255, 5
    s_mov_b64 exec, 1
    s_cmp_eq_u32 s61, 0
    s_cbranch_scc1 L_fl4_X_s
    buffer_store_dword v255, v250, s[40:43], s72 offen
    s_branch L_fl4_X_e
L_fl4_X_s:
    buffer_store_dword v255, v250, s[40:43], s72 offen sc1
L_fl4_X_e:
    s_mov_b64 exec, -1
    s_waitcnt lgkmcnt(8)
    v_mfma_f32_16x16x32_bf16 v[96:99], v[232:235], v[192:195], v[96:99]
    ds_read_b64_tr_b16 v[228:229], v253 offset:16384
    ds_read_b64_tr_b16 v[230:231], v253 offset:20480
    v_mfma_f32_16x16x32_bf16 v[100:103], v[232:235], v[196:199], v[100:103]
    ds_write_b128 v251, v[72:75] offset:2048
    v_mfma_f32_16x16x32_bf16 v[104:107], v[232:235], v[200:203], v[104:107]
    v_mfma_f32_16x16x32_bf16 v[108:111], v[232:235], v[204:207], v[108:111]
    ds_write_b128 v251, v[76:79] offset:3072
    s_waitcnt lgkmcnt(10)
    v_mfma_f32_16x16x32_bf16 v[108:111], v[236:239], v[172:175], v[108:111]
    ds_read_b64_tr_b16 v[232:233], v253 offset:32768
    ds_read_b64_tr_b16 v[234:235], v253 offset:36864
    v_mfma_f32_16x16x32_bf16 v[104:107], v[236:239], v[168:171], v[104:107]
    ds_write_b128 v251, v[80:83] offset:4096
    v_mfma_f32_16x16x32_bf16 v[100:103], v[236:239], v[164:167], v[100:103]
    v_mfma_f32_16x16x32_bf16 v[96:99], v[236:239], v[160:163], v[96:99]
    ds_write_b128 v251, v[84:87] offset:5120
    s_waitcnt lgkmcnt(12)
    v_mfma_f32_16x16x32_bf16 v[112:115], v[240:243], v[192:195], v[112:115]
    ds_read_b64_tr_b16 v[236:237], v254 offset:16384
    ds_read_b64_tr_b16 v[238:239], v254 offset:20480
    v_mfma_f32_16x16x32_bf16 v[116:119], v[240:243], v[196:199], v[116:119]
    ds_write_b128 v251, v[88:91] offset:6144
    v_mfma_f32_16x16x32_bf16 v[120:123], v[240:243], v[200:203], v[120:123]
    v_mfma_f32_16x16x32_bf16 v[124:127], v[240:243], v[204:207], v[124:127]
    ds_write_b128 v251, v[92:95] offset:7168
    s_waitcnt lgkmcnt(14)
    v_mfma_f32_16x16x32_bf16 v[124:127], v[244:247], v[172:175], v[124:127]
    ds_read_b64_tr_b16 v[240:241], v254 offset:32768
    ds_read_b64_tr_b16 v[242:243], v254 offset:36864
    v_mfma_f32_16x16x32_bf16 v[120:123], v[244:247], v[168:171], v[120:123]
    ds_write_b128 v251, v[96:99] offset:8192
    v_mfma_f32_16x16x32_bf16 v[116:119], v[244:247], v[164:167], v[116:119]
    v_mfma_f32_16x16x32_bf16 v[112:115], v[244:247], v[160:163], v[112:115]
    ds_write_b128 v251, v[100:103] offset:9216
    s_waitcnt lgkmcnt(14)
    v_mfma_f32_16x16x32_bf16 v[0:3], v[228:231], v[192:195], v[0:3]
    ds_read_b64_tr_b16 v[244:245], v253 offset:16640
    ds_read_b64_tr_b16 v[246:247], v253 offset:20736
    v_mfma_f32_16x16x32_bf16 v[4:7], v[228:231], v[196:199], v[4:7]
    ds_write_b128 v251, v[104:107] offset:10240
    v_mfma_f32_16x16x32_bf16 v[8:11], v[228:231], v[200:203], v[8:11]
    v_mfma_f32_16x16x32_bf16 v[12:15], v[228:231], v[204:207], v[12:15]
    ds_write_b128 v251, v[108:111] offset:11264
    s_waitcnt lgkmcnt(14)
    v_mfma_f32_16x16x32_bf16 v[12:15], v[232:235], v[172:175], v[12:15]
    ds_read_b64_tr_b16 v[228:229], v253 offset:33024
    ds_read_b64_tr_b16 v[230:231], v253 offset:37120
    v_mfma_f32_16x16x32_bf16 v[8:11], v[232:235], v[168:171], v[8:11]
    ds_write_b128 v251, v[112:115] offset:12288
    v_mfma_f32_16x16x32_bf16 v[4:7], v[232:235], v[164:167], v[4:7]
    v_mfma_f32_16x16x32_bf16 v[0:3], v[232:235], v[160:163], v[0:3]
    ds_write_b128 v251, v[116:119] offset:13312
    buffer_load_dword v224, v225, s[40:43], s60 offen sc1
    s_waitcnt lgkmcnt(14)
    v_mfma_f32_16x16x32_bf16 v[16:19], v[236:239], v[192:195], v[16:19]
    ds_read_b64_tr_b16 v[232:233], v254 offset:16640
    ds_read_b64_tr_b16 v[234:235], v254 offset:20736
    v_mfma_f32_16x16x32_bf16 v[20:23], v[236:239], v[196:199], v[20:23]
    ds_write_b128 v251, v[120:123] offset:14336
    v_mfma_f32_16x16x32_bf16 v[24:27], v[236:239], v[200:203], v[24:27]
    v_mfma_f32_16x16x32_bf16 v[28:31], v[236:239], v[204:207], v[28:31]
    ds_write_b128 v251, v[124:127] offset:15360
    s_waitcnt lgkmcnt(14)
    v_mfma_f32_16x16x32_bf16 v[28:31], v[240:243], v[172:175], v[28:31]
    ds_read_b64_tr_b16 v[236:237], v254 offset:33024
    ds_read_b64_tr_b16 v[238:239], v254 offset:37120
    v_mfma_f32_16x16x32_bf16 v[24:27], v[240:243], v[168:171], v[24:27]
    v_mfma_f32_16x16x32_bf16 v[20:23], v[240:243], v[164:167], v[20:23]
    v_mfma_f32_16x16x32_bf16 v[16:19], v[240:243], v[160:163], v[16:19]
    s_waitcnt lgkmcnt(2)
    s_barrier
    v_mfma_f32_16x16x32_bf16 v[32:35], v[244:247], v[192:195], v[32:35]
    v_mfma_f32_16x16x32_bf16 v[36:39], v[244:247], v[196:199], v[36:39]
    ds_read_b128 v[64:67], v252 offset:0
    ds_read_b128 v[80:83], v252 offset:4096
    v_mfma_f32_16x16x32_bf16 v[40:43], v[244:247], v[200:203], v[40:43]
    ds_read_b128 v[68:71], v252 offset:1024
    ds_read_b128 v[84:87], v252 offset:5120
    v_mfma_f32_16x16x32_bf16 v[44:47], v[244:247], v[204:207], v[44:47]
    ds_read_b128 v[72:75], v252 offset:2048
    ds_read_b128 v[88:91], v252 offset:6144
    v_mfma_f32_16x16x32_bf16 v[44:47], v[228:231], v[172:175], v[44:47]
    v_mfma_f32_16x16x32_bf16 v[40:43], v[228:231], v[168:171], v[40:43]
    ds_read_b128 v[76:79], v252 offset:3072
    ds_read_b128 v[92:95], v252 offset:7168
    v_mfma_f32_16x16x32_bf16 v[36:39], v[228:231], v[164:167], v[36:39]
    ds_read_b128 v[96:99], v252 offset:8192
    ds_read_b128 v[112:115], v252 offset:12288
    v_mfma_f32_16x16x32_bf16 v[32:35], v[228:231], v[160:163], v[32:35]
    ds_read_b128 v[100:103], v252 offset:9216
    ds_read_b128 v[116:119], v252 offset:13312
    v_mfma_f32_16x16x32_bf16 v[48:51], v[232:235], v[192:195], v[48:51]
    v_mfma_f32_16x16x32_bf16 v[52:55], v[232:235], v[196:199], v[52:55]
    v_mfma_f32_16x16x32_bf16 v[56:59], v[232:235], v[200:203], v[56:59]
    v_mfma_f32_16x16x32_bf16 v[60:63], v[232:235], v[204:207], v[60:63]
    s_waitcnt lgkmcnt(12)
    v_mfma_f32_16x16x32_bf16 v[60:63], v[236:239], v[172:175], v[60:63]
    v_mfma_f32_16x16x32_bf16 v[56:59], v[236:239], v[168:171], v[56:59]
    ds_read_b128 v[104:107], v252 offset:10240
    ds_read_b128 v[120:123], v252 offset:14336
    v_mfma_f32_16x16x32_bf16 v[52:55], v[236:239], v[164:167], v[52:55]
    v_mfma_f32_16x16x32_bf16 v[48:51], v[236:239], v[160:163], v[48:51]
    s_waitcnt vmcnt(0)
    v_cmp_gt_u32 vcc, 5, v224
    s_cbranch_vccz L_polled4_X
L_poll4_X:
    buffer_load_dword v224, v225, s[40:43], s60 offen sc1
    s_add_u32 s79, s79, 1
    s_cmp_ge_u32 s79, 0x40000
    s_waitcnt vmcnt(0)
    s_cbranch_scc1 L_polled4_X
    v_cmp_gt_u32 vcc, 5, v224
    s_cbranch_vccnz L_poll4_X
L_polled4_X:
    s_waitcnt lgkmcnt(12)
    v_add_f32 v0, v0, v64
    v_add_f32 v1, v1, v65
    v_add_f32 v2, v2, v66
    v_add_f32 v3, v3, v67
    v_add_f32 v16, v16, v80
    v_add_f32 v17, v17, v81
    v_add_f32 v18, v18, v82
    v_add_f32 v19, v19, v83
    v_cvt_pk_bf16_f32 v64, v0, v1
    v_cvt_pk_bf16_f32 v65, v2, v3
    v_cvt_pk_bf16_f32 v66, v16, v17
    v_cvt_pk_bf16_f32 v67, v18, v19
    s_add_u32 s20, s57, 0
    v_permlane16_swap_b32 v64, v66
    v_permlane16_swap_b32 v65, v67
    s_cmp_eq_u32 s61, 0
    s_cbranch_scc1 L_ps0_X_s
    buffer_store_dwordx4 v[64:67], v248, s[40:43], s20 offen offset:0
    s_branch L_ps0_X_e
L_ps0_X_s:
    buffer_store_dwordx4 v[64:67], v248, s[40:43], s20 offen offset:0 sc1
L_ps0_X_e:
    ds_read_b128 v[108:111], v252 offset:11264
    ds_read_b128 v[124:127], v252 offset:15360
    s_waitcnt lgkmcnt(12)
    v_add_f32 v4, v4, v68
    v_add_f32 v5, v5, v69
    v_add_f32 v6, v6, v70
    v_add_f32 v7, v7, v71
    v_add_f32 v20, v20, v84
    v_add_f32 v21, v21, v85
    v_add_f32 v22, v22, v86
    v_add_f32 v23, v23, v87
    v_cvt_pk_bf16_f32 v68, v4, v5
    v_cvt_pk_bf16_f32 v69, v6, v7
    v_cvt_pk_bf16_f32 v70, v20, v21
    v_cvt_pk_bf16_f32 v71, v22, v23
    s_add_u32 s20, s57, 2048
    v_permlane16_swap_b32 v68, v70
    v_permlane16_swap_b32 v69, v71
    s_cmp_eq_u32 s61, 0
    s_cbranch_scc1 L_ps1_X_s
    buffer_store_dwordx4 v[68:71], v248, s[40:43], s20 offen offset:0
    s_branch L_ps1_X_e
L_ps1_X_s:
    buffer_store_dwordx4 v[68:71], v248, s[40:43], s20 offen offset:0 sc1
L_ps1_X_e:
    s_waitcnt lgkmcnt(10)
    v_add_f32 v8, v8, v72
    v_add_f32 v9, v9, v73
    v_add_f32 v10, v10, v74
    v_add_f32 v11, v11, v75
    v_add_f32 v24, v24, v88
    v_add_f32 v25, v25, v89
    v_add_f32 v26, v26, v90
    v_add_f32 v27, v27, v91
    v_cvt_pk_bf16_f32 v72, v8, v9
    v_cvt_pk_bf16_f32 v73, v10, v11
    v_cvt_pk_bf16_f32 v74, v24, v25
    v_cvt_pk_bf16_f32 v75, v26, v27
    s_add_u32 s20, s57, 4096
    v_permlane16_swap_b32 v72, v74
    v_permlane16_swap_b32 v73, v75
    s_cmp_eq_u32 s61, 0
    s_cbranch_scc1 L_ps2_X_s
    buffer_store_dwordx4 v[72:75], v248, s[40:43], s20 offen offset:0
    s_branch L_ps2_X_e
L_ps2_X_s:
    buffer_store_dwordx4 v[72:75], v248, s[40:43], s20 offen offset:0 sc1
L_ps2_X_e:
    s_waitcnt lgkmcnt(8)
    v_add_f32 v12, v12, v76
    v_add_f32 v13, v13, v77
    v_add_f32 v14, v14, v78
    v_add_f32 v15, v15, v79
    v_add_f32 v28, v28, v92
    v_add_f32 v29, v29, v93
    v_add_f32 v30, v30, v94
    v_add_f32 v31, v31, v95
    v_cvt_pk_bf16_f32 v76, v12, v13
    v_cvt_pk_bf16_f32 v77, v14, v15
    v_cvt_pk_bf16_f32 v78, v28, v29
    v_cvt_pk_bf16_f32 v79, v30, v31
    s_add_u32 s20, s57, 6144
    v_permlane16_swap_b32 v76, v78
    v_permlane16_swap_b32 v77, v79
    s_cmp_eq_u32 s61, 0
    s_cbranch_scc1 L_ps3_X_s
    buffer_store_dwordx4 v[76:79], v248, s[40:43], s20 offen offset:0
    s_branch L_ps3_X_e
L_ps3_X_s:
    buffer_store_dwordx4 v[76:79], v248, s[40:43], s20 offen offset:0 sc1
L_ps3_X_e:
    s_waitcnt lgkmcnt(6)
    v_add_f32 v32, v32, v96
    v_add_f32 v33, v33, v97
    v_add_f32 v34, v34, v98
    v_add_f32 v35, v35, v99
    v_add_f32 v48, v48, v112
    v_add_f32 v49, v49, v113
    v_add_f32 v50, v50, v114
    v_add_f32 v51, v51, v115
    v_cvt_pk_bf16_f32 v96, v32, v33
    v_cvt_pk_bf16_f32 v97, v34, v35
    v_cvt_pk_bf16_f32 v98, v48, v49
    v_cvt_pk_bf16_f32 v99, v50, v51
    s_add_u32 s20, s57, 0
    v_permlane16_swap_b32 v96, v98
    v_permlane16_swap_b32 v97, v99
    s_cmp_eq_u32 s61, 0
    s_cbranch_scc1 L_ps4_X_s
    buffer_store_dwordx4 v[96:99], v248, s[40:43], s20 offen offset:1024
    s_branch L_ps4_X_e
L_ps4_X_s:
    buffer_store_dwordx4 v[96:99], v248, s[40:43], s20 offen offset:1024 sc1
L_ps4_X_e:
    s_waitcnt lgkmcnt(4)
    v_add_f32 v36, v36, v100
    v_add_f32 v37, v37, v101
    v_add_f32 v38, v38, v102
    v_add_f32 v39, v39, v103
    v_add_f32 v52, v52, v116
    v_add_f32 v53, v53, v117
    v_add_f32 v54, v54, v118
    v_add_f32 v55, v55, v119
    v_cvt_pk_bf16_f32 v100, v36, v37
    v_cvt_pk_bf16_f32 v101, v38, v39
    v_cvt_pk_bf16_f32 v102, v52, v53
    v_cvt_pk_bf16_f32 v103, v54, v55
    s_add_u32 s20, s57, 2048
    v_permlane16_swap_b32 v100, v102
    v_permlane16_swap_b32 v101, v103
    s_cmp_eq_u32 s61, 0
    s_cbranch_scc1 L_ps5_X_s
    buffer_store_dwordx4 v[100:103], v248, s[40:43], s20 offen offset:1024
    s_branch L_ps5_X_e
L_ps5_X_s:
    buffer_store_dwordx4 v[100:103], v248, s[40:43], s20 offen offset:1024 sc1
L_ps5_X_e:
    s_waitcnt lgkmcnt(2)
    v_add_f32 v40, v40, v104
    v_add_f32 v41, v41, v105
    v_add_f32 v42, v42, v106
    v_add_f32 v43, v43, v107
    v_add_f32 v56, v56, v120
    v_add_f32 v57, v57, v121
    v_add_f32 v58, v58, v122
    v_add_f32 v59, v59, v123
    v_cvt_pk_bf16_f32 v104, v40, v41
    v_cvt_pk_bf16_f32 v105, v42, v43
    v_cvt_pk_bf16_f32 v106, v56, v57
    v_cvt_pk_bf16_f32 v107, v58, v59
    s_add_u32 s20, s57, 4096
    v_permlane16_swap_b32 v104, v106
    v_permlane16_swap_b32 v105, v107
    s_cmp_eq_u32 s61, 0
    s_cbranch_scc1 L_ps6_X_s
    buffer_store_dwordx4 v[104:107], v248, s[40:43], s20 offen offset:1024
    s_branch L_ps6_X_e
L_ps6_X_s:
    buffer_store_dwordx4 v[104:107], v248, s[40:43], s20 offen offset:1024 sc1
L_ps6_X_e:
    s_waitcnt lgkmcnt(0)
    v_add_f32 v44, v44, v108
    v_add_f32 v45, v45, v109
    v_add_f32 v46, v46, v110
    v_add_f32 v47, v47, v111
    v_add_f32 v60, v60, v124
    v_add_f32 v61, v61, v125
    v_add_f32 v62, v62, v126
    v_add_f32 v63, v63, v127
    v_cvt_pk_bf16_f32 v108, v44, v45
    v_cvt_pk_bf16_f32 v109, v46, v47
    v_cvt_pk_bf16_f32 v110, v60, v61
    v_cvt_pk_bf16_f32 v111, v62, v63
    s_add_u32 s20, s57, 6144
    v_permlane16_swap_b32 v108, v110
    v_permlane16_swap_b32 v109, v111
    s_cmp_eq_u32 s61, 0
    s_cbranch_scc1 L_ps7_X_s
    buffer_store_dwordx4 v[108:111], v248, s[40:43], s20 offen offset:1024
    s_branch L_ps7_X_e
L_ps7_X_s:
    buffer_store_dwordx4 v[108:111], v248, s[40:43], s20 offen offset:1024 sc1
L_ps7_X_e:
    v_and_b32 v225, 3, v249
    v_lshlrev_b32 v225, 5, v225
    s_and_b32 s20, s2, 0x18
    v_add_u32 v225, s20, v225
    v_and_b32 v251, 15, v249
    v_lshlrev_b32 v251, 11, v251
    v_bfe_u32 v252, v249, 4, 1
    v_lshl_add_u32 v251, v252, 5, v251
    v_lshrrev_b32 v252, 5, v249
    v_lshl_add_u32 v251, v252, 4, v251
    s_mov_b32 s23, 0xffff0000
    s_waitcnt vmcnt(0)
    v_mov_b32 v255, 6
    s_mov_b64 exec, 1
    s_cmp_eq_u32 s61, 0
    s_cbranch_scc1 L_fl5_X_s
    buffer_store_dword v255, v250, s[40:43], s72 offen
    s_branch L_fl5_X_e
L_fl5_X_s:
    buffer_store_dword v255, v250, s[40:43], s72 offen sc1
L_fl5_X_e:
    s_mov_b64 exec, -1
L_poll5_X:
    buffer_load_dword v224, v225, s[40:43], s60 offen sc1
    s_add_u32 s79, s79, 1
    s_cmp_ge_u32 s79, 0x40000
    s_waitcnt vmcnt(0)
    s_cbranch_scc1 L_polled5_X
    v_cmp_gt_u32 vcc, 6, v224
    s_cbranch_vccnz L_poll5_X
L_polled5_X:
    buffer_load_dwordx4 v[0:3], v248, s[40:43], s56 offen offset:0 sc1
    buffer_load_dwordx4 v[4:7], v248, s[40:43], s56 offen offset:1024 sc1
    s_add_u32 s56, s56, 229376
    buffer_load_dwordx4 v[8:11], v248, s[40:43], s56 offen offset:0 sc1
    buffer_load_dwordx4 v[12:15], v248, s[40:43], s56 offen offset:1024 sc1
    s_add_u32 s56, s56, 229376
    buffer_load_dwordx4 v[16:19], v248, s[40:43], s56 offen offset:0 sc1
    buffer_load_dwordx4 v[20:23], v248, s[40:43], s56 offen offset:1024 sc1
    s_add_u32 s56, s56, 229376
    buffer_load_dwordx4 v[24:27], v248, s[40:43], s56 offen offset:0 sc1
    buffer_load_dwordx4 v[28:31], v248, s[40:43], s56 offen offset:1024 sc1
    s_waitcnt vmcnt(6)
    v_lshlrev_b32 v32, 16, v0
    v_and_b32 v33, s23, v0
    v_lshlrev_b32 v34, 16, v1
    v_and_b32 v35, s23, v1
    v_lshlrev_b32 v36, 16, v2
    v_and_b32 v37, s23, v2
    v_lshlrev_b32 v38, 16, v3
    v_and_b32 v39, s23, v3
    v_lshlrev_b32 v40, 16, v4
    v_and_b32 v41, s23, v4
    v_lshlrev_b32 v42, 16, v5
    v_and_b32 v43, s23, v5
    v_lshlrev_b32 v44, 16, v6
    v_and_b32 v45, s23, v6
    v_lshlrev_b32 v46, 16, v7
    v_and_b32 v47, s23, v7
    s_waitcnt vmcnt(4)
    v_lshlrev_b32 v48, 16, v8
    v_and_b32 v49, s23, v8
    v_pk_add_f32 v[32:33], v[32:33], v[48:49]
    v_lshlrev_b32 v48, 16, v9
    v_and_b32 v49, s23, v9
    v_pk_add_f32 v[34:35], v[34:35], v[48:49]
    v_lshlrev_b32 v48, 16, v10
    v_and_b32 v49, s23, v10
    v_pk_add_f32 v[36:37], v[36:37], v[48:49]
    v_lshlrev_b32 v48, 16, v11
    v_and_b32 v49, s23, v11
    v_pk_add_f32 v[38:39], v[38:39], v[48:49]
    v_lshlrev_b32 v48, 16, v12
    v_and_b32 v49, s23, v12
    v_pk_add_f32 v[40:41], v[40:41], v[48:49]
    v_lshlrev_b32 v48, 16, v13
    v_and_b32 v49, s23, v13
    v_pk_add_f32 v[42:43], v[42:43], v[48:49]
    v_lshlrev_b32 v48, 16, v14
    v_and_b32 v49, s23, v14
    v_pk_add_f32 v[44:45], v[44:45], v[48:49]
    v_lshlrev_b32 v48, 16, v15
    v_and_b32 v49, s23, v15
    v_pk_add_f32 v[46:47], v[46:47], v[48:49]
    s_waitcnt vmcnt(2)
    v_lshlrev_b32 v48, 16, v16
    v_and_b32 v49, s23, v16
    v_pk_add_f32 v[32:33], v[32:33], v[48:49]
    v_lshlrev_b32 v48, 16, v17
    v_and_b32 v49, s23, v17
    v_pk_add_f32 v[34:35], v[34:35], v[48:49]
    v_lshlrev_b32 v48, 16, v18
    v_and_b32 v49, s23, v18
    v_pk_add_f32 v[36:37], v[36:37], v[48:49]
    v_lshlrev_b32 v48, 16, v19
    v_and_b32 v49, s23, v19
    v_pk_add_f32 v[38:39], v[38:39], v[48:49]
    v_lshlrev_b32 v48, 16, v20
    v_and_b32 v49, s23, v20
    v_pk_add_f32 v[40:41], v[40:41], v[48:49]
    v_lshlrev_b32 v48, 16, v21
    v_and_b32 v49, s23, v21
    v_pk_add_f32 v[42:43], v[42:43], v[48:49]
    v_lshlrev_b32 v48, 16, v22
    v_and_b32 v49, s23, v22
    v_pk_add_f32 v[44:45], v[44:45], v[48:49]
    v_lshlrev_b32 v48, 16, v23
    v_and_b32 v49, s23, v23
    v_pk_add_f32 v[46:47], v[46:47], v[48:49]
    s_waitcnt vmcnt(0)
    v_lshlrev_b32 v48, 16, v24
    v_and_b32 v49, s23, v24
    v_pk_add_f32 v[32:33], v[32:33], v[48:49]
    v_lshlrev_b32 v48, 16, v25
    v_and_b32 v49, s23, v25
    v_pk_add_f32 v[34:35], v[34:35], v[48:49]
    v_lshlrev_b32 v48, 16, v26
    v_and_b32 v49, s23, v26
    v_pk_add_f32 v[36:37], v[36:37], v[48:49]
    v_lshlrev_b32 v48, 16, v27
    v_and_b32 v49, s23, v27
    v_pk_add_f32 v[38:39], v[38:39], v[48:49]
    v_lshlrev_b32 v48, 16, v28
    v_and_b32 v49, s23, v28
    v_pk_add_f32 v[40:41], v[40:41], v[48:49]
    v_lshlrev_b32 v48, 16, v29
    v_and_b32 v49, s23, v29
    v_pk_add_f32 v[42:43], v[42:43], v[48:49]
    v_lshlrev_b32 v48, 16, v30
    v_and_b32 v49, s23, v30
    v_pk_add_f32 v[44:45], v[44:45], v[48:49]
    v_lshlrev_b32 v48, 16, v31
    v_and_b32 v49, s23, v31
    v_pk_add_f32 v[46:47], v[46:47], v[48:49]
    v_cvt_pk_bf16_f32 v52, v32, v33
    v_cvt_pk_bf16_f32 v53, v34, v35
    v_cvt_pk_bf16_f32 v54, v36, v37
    v_cvt_pk_bf16_f32 v55, v38, v39
    v_cvt_pk_bf16_f32 v56, v40, v41
    v_cvt_pk_bf16_f32 v57, v42, v43
    v_cvt_pk_bf16_f32 v58, v44, v45
    v_cvt_pk_bf16_f32 v59, v46, v47
    buffer_store_dwordx4 v[52:55], v251, s[12:15], s59 offen offset:0
    buffer_store_dwordx4 v[56:59], v251, s[12:15], s59 offen offset:64
L_done_X:
    s_endpgm
L_role_Y:
    v_lshlrev_b32 v235, 6, v244
    v_lshl_add_u32 v245, v237, 4, v235
    v_lshl_add_u32 v251, v243, 8, v245
    s_lshl_b32 s22, s34, 7
    v_xor_b32 v245, s22, v245
    v_lshl_add_u32 v245, v243, 10, v245
    s_lshl_b32 s22, s65, 12
    v_add_u32 v245, s22, v245
    v_lshl_add_u32 v255, v243, 8, v235
    v_xor_b32 v235, s65, v242
    v_lshl_add_u32 v255, v235, 4, v255
    s_lshl_b32 s22, s65, 11
    v_add_u32 v255, s22, v255
    s_add_u32 s26, s64, s22
    s_lshl_b32 s22, s65, 10
    v_add_u32 v251, s22, v251
    s_add_u32 s39, s64, s22
    s_add_u32 s39, s39, 81920
    s_mov_b32 s96, s50
    s_mov_b32 s97, s51
    s_mov_b32 s98, 8192
    s_mov_b32 s99, 0x00020000
    s_mov_b32 s73, s26
    s_mov_b32 s74, s39
    v_lshlrev_b32 v246, 7, v241
    s_lshl_b32 s22, s78, 2
    s_and_b32 s23, s3, 3
    s_add_u32 s22, s22, s23
    s_lshl_b32 s22, s22, 14
    v_lshlrev_b32 v232, 13, v243
    v_lshl_add_u32 v232, v242, 7, v232
    v_add_u32 v232, s22, v232
    v_cmp_gt_u32 vcc, 8, v241
    v_mov_b32 v235, 0x40000000
    s_nop 0
    v_cndmask_b32 v232, v235, v232, vcc
    s_mov_b32 s77, s24
    s_and_b32 s22, s3, 3
    s_mul_i32 s75, s22, 12288
    s_add_u32 s75, s75, 114688
    s_xor_b32 s22, s22, 2
    s_mul_i32 s76, s22, 12288
    s_add_u32 s76, s76, 114688
    s_setprio 1
    s_waitcnt vmcnt(2)
    s_barrier
    ds_read_b128 v[176:179], v224 offset:0
    ds_read_b128 v[180:183], v224 offset:2048
    ds_read_b128 v[184:187], v224 offset:4096
    ds_read_b64_tr_b16 v[112:113], v226 offset:0
    ds_read_b64_tr_b16 v[114:115], v226 offset:1024
    ds_read_b64_tr_b16 v[116:117], v227 offset:0
    ds_read_b64_tr_b16 v[118:119], v227 offset:1024
    ds_read_b64_tr_b16 v[120:121], v226 offset:256
    ds_read_b64_tr_b16 v[122:123], v226 offset:1280
    ds_read_b64_tr_b16 v[124:125], v227 offset:256
    ds_read_b64_tr_b16 v[126:127], v227 offset:1280
    ds_read_b64_tr_b16 v[128:129], v226 offset:512
    ds_read_b64_tr_b16 v[130:131], v226 offset:1536
    ds_read_b64_tr_b16 v[132:133], v227 offset:512
    ds_read_b64_tr_b16 v[134:135], v227 offset:1536
    ds_read_b64_tr_b16 v[136:137], v226 offset:768
    ds_read_b64_tr_b16 v[138:139], v226 offset:1792
    ds_read_b64_tr_b16 v[140:141], v227 offset:768
    ds_read_b64_tr_b16 v[142:143], v227 offset:1792
    s_add_u32 m0, s32, 131072
    s_add_u32 s20, s70, 1
    s_and_b32 s20, s20, 7
    s_xor_b32 s20, s20, s69
    s_lshl_b32 s20, s20, 7
    buffer_load_dwordx4 v230, s[4:7], s20 offen lds
    s_add_u32 m0, s32, 139264
    s_add_u32 s20, s20, 65536
    buffer_load_dwordx4 v230, s[4:7], s20 offen lds
    s_add_u32 m0, s32, 147456
    s_add_u32 s20, s20, 65536
    buffer_load_dwordx4 v230, s[4:7], s20 offen lds
    s_add_u32 m0, s33, 49152
    s_add_u32 s21, s70, 1
    s_and_b32 s21, s21, 7
    s_xor_b32 s21, s21, s69
    s_lshl_b32 s21, s21, 19
    buffer_load_dwordx4 v231, s[8:11], s21 offen lds
    s_add_u32 m0, s33, 50176
    s_add_u32 s21, s21, 32768
    buffer_load_dwordx4 v231, s[8:11], s21 offen lds
    s_waitcnt vmcnt(5) lgkmcnt(0)
    s_barrier
    v_mfma_f32_16x16x32_bf16 v[0:3], v[112:115], v[176:179], 0
    ds_read_b128 v[188:191], v224 offset:512
    ds_read_b128 v[192:195], v224 offset:2560
    v_mfma_f32_16x16x32_bf16 v[4:7], v[112:115], v[180:183], 0
    ds_read_b128 v[196:199], v224 offset:4608
    ds_read_b64_tr_b16 v[144:145], v226 offset:16384
    s_add_u32 m0, s33, 65536
    s_add_u32 s21, s70, 1
    s_and_b32 s21, s21, 7
    s_xor_b32 s21, s21, s69
    s_lshl_b32 s21, s21, 19
    s_add_u32 s21, s21, 262144
    buffer_load_dwordx4 v231, s[8:11], s21 offen lds
    v_mfma_f32_16x16x32_bf16 v[8:11], v[112:115], v[184:187], 0
    ds_read_b64_tr_b16 v[146:147], v226 offset:17408
    ds_read_b64_tr_b16 v[148:149], v227 offset:16384
    v_mfma_f32_16x16x32_bf16 v[20:23], v[116:119], v[184:187], 0
    ds_read_b64_tr_b16 v[150:151], v227 offset:17408
    ds_read_b64_tr_b16 v[152:153], v226 offset:16640
    s_add_u32 m0, s33, 66560
    s_add_u32 s21, s21, 32768
    buffer_load_dwordx4 v231, s[8:11], s21 offen lds
    v_mfma_f32_16x16x32_bf16 v[16:19], v[116:119], v[180:183], 0
    ds_read_b64_tr_b16 v[154:155], v226 offset:17664
    ds_read_b64_tr_b16 v[156:157], v227 offset:16640
    v_mfma_f32_16x16x32_bf16 v[12:15], v[116:119], v[176:179], 0
    ds_read_b64_tr_b16 v[158:159], v227 offset:17664
    ds_read_b64_tr_b16 v[160:161], v226 offset:16896
    s_add_u32 m0, s33, 16384
    s_add_u32 s21, s70, 2
    s_and_b32 s21, s21, 7
    s_xor_b32 s21, s21, s69
    s_lshl_b32 s21, s21, 19
    buffer_load_dwordx4 v231, s[8:11], s21 offen lds
    v_mfma_f32_16x16x32_bf16 v[24:27], v[120:123], v[176:179], 0
    ds_read_b64_tr_b16 v[162:163], v226 offset:17920
    ds_read_b64_tr_b16 v[164:165], v227 offset:16896
    v_mfma_f32_16x16x32_bf16 v[28:31], v[120:123], v[180:183], 0
    ds_read_b64_tr_b16 v[166:167], v227 offset:17920
    ds_read_b64_tr_b16 v[168:169], v226 offset:17152
    s_add_u32 m0, s33, 17408
    s_add_u32 s21, s21, 32768
    buffer_load_dwordx4 v231, s[8:11], s21 offen lds
    v_mfma_f32_16x16x32_bf16 v[32:35], v[120:123], v[184:187], 0
    ds_read_b64_tr_b16 v[170:171], v226 offset:18176
    ds_read_b64_tr_b16 v[172:173], v227 offset:17152
    v_mfma_f32_16x16x32_bf16 v[44:47], v[124:127], v[184:187], 0
    ds_read_b64_tr_b16 v[174:175], v227 offset:18176
    v_mfma_f32_16x16x32_bf16 v[40:43], v[124:127], v[180:183], 0
    v_mfma_f32_16x16x32_bf16 v[36:39], v[124:127], v[176:179], 0
    v_mfma_f32_16x16x32_bf16 v[48:51], v[128:131], v[176:179], 0
    v_mfma_f32_16x16x32_bf16 v[52:55], v[128:131], v[180:183], 0
    v_mfma_f32_16x16x32_bf16 v[56:59], v[128:131], v[184:187], 0
    v_mfma_f32_16x16x32_bf16 v[68:71], v[132:135], v[184:187], 0
    v_mfma_f32_16x16x32_bf16 v[64:67], v[132:135], v[180:183], 0
    v_mfma_f32_16x16x32_bf16 v[60:63], v[132:135], v[176:179], 0
    v_mfma_f32_16x16x32_bf16 v[72:75], v[136:139], v[176:179], 0
    v_mfma_f32_16x16x32_bf16 v[76:79], v[136:139], v[180:183], 0
    s_waitcnt vmcnt(4) lgkmcnt(0)
    s_barrier
    v_mfma_f32_16x16x32_bf16 v[80:83], v[136:139], v[184:187], 0
    v_mfma_f32_16x16x32_bf16 v[92:95], v[140:143], v[184:187], 0
    v_mfma_f32_16x16x32_bf16 v[88:91], v[140:143], v[180:183], 0
    v_mfma_f32_16x16x32_bf16 v[84:87], v[140:143], v[176:179], 0
    v_mfma_f32_16x16x32_bf16 v[0:3], v[144:147], v[188:191], v[0:3]
    ds_read_b128 v[176:179], v224 offset:32768
    ds_read_b128 v[180:183], v224 offset:34816
    v_mfma_f32_16x16x32_bf16 v[4:7], v[144:147], v[192:195], v[4:7]
    ds_read_b128 v[184:187], v224 offset:36864
    ds_read_b64_tr_b16 v[112:113], v226 offset:32768
    s_add_u32 m0, s32, 98304
    s_add_u32 s20, s70, 2
    s_and_b32 s20, s20, 7
    s_xor_b32 s20, s20, s69
    s_lshl_b32 s20, s20, 7
    buffer_load_dwordx4 v230, s[4:7], s20 offen lds
    v_mfma_f32_16x16x32_bf16 v[8:11], v[144:147], v[196:199], v[8:11]
    ds_read_b64_tr_b16 v[114:115], v226 offset:33792
    ds_read_b64_tr_b16 v[116:117], v227 offset:32768
    v_mfma_f32_16x16x32_bf16 v[20:23], v[148:151], v[196:199], v[20:23]
    ds_read_b64_tr_b16 v[118:119], v227 offset:33792
    ds_read_b64_tr_b16 v[120:121], v226 offset:33024
    s_add_u32 m0, s32, 106496
    s_add_u32 s20, s20, 65536
    buffer_load_dwordx4 v230, s[4:7], s20 offen lds
    v_mfma_f32_16x16x32_bf16 v[16:19], v[148:151], v[192:195], v[16:19]
    ds_read_b64_tr_b16 v[122:123], v226 offset:34048
    ds_read_b64_tr_b16 v[124:125], v227 offset:33024
    v_mfma_f32_16x16x32_bf16 v[12:15], v[148:151], v[188:191], v[12:15]
    ds_read_b64_tr_b16 v[126:127], v227 offset:34048
    ds_read_b64_tr_b16 v[128:129], v226 offset:33280
    s_add_u32 m0, s32, 114688
    s_add_u32 s20, s20, 65536
    buffer_load_dwordx4 v230, s[4:7], s20 offen lds
    v_mfma_f32_16x16x32_bf16 v[24:27], v[152:155], v[188:191], v[24:27]
    ds_read_b64_tr_b16 v[130:131], v226 offset:34304
    ds_read_b64_tr_b16 v[132:133], v227 offset:33280
    v_mfma_f32_16x16x32_bf16 v[28:31], v[152:155], v[192:195], v[28:31]
    ds_read_b64_tr_b16 v[134:135], v227 offset:34304
    ds_read_b64_tr_b16 v[136:137], v226 offset:33536
    v_mfma_f32_16x16x32_bf16 v[32:35], v[152:155], v[196:199], v[32:35]
    ds_read_b64_tr_b16 v[138:139], v226 offset:34560
    ds_read_b64_tr_b16 v[140:141], v227 offset:33536
    v_mfma_f32_16x16x32_bf16 v[44:47], v[156:159], v[196:199], v[44:47]
    ds_read_b64_tr_b16 v[142:143], v227 offset:34560
    v_mfma_f32_16x16x32_bf16 v[40:43], v[156:159], v[192:195], v[40:43]
    v_mfma_f32_16x16x32_bf16 v[36:39], v[156:159], v[188:191], v[36:39]
    v_mfma_f32_16x16x32_bf16 v[48:51], v[160:163], v[188:191], v[48:51]
    v_mfma_f32_16x16x32_bf16 v[52:55], v[160:163], v[192:195], v[52:55]
    v_mfma_f32_16x16x32_bf16 v[56:59], v[160:163], v[196:199], v[56:59]
    v_mfma_f32_16x16x32_bf16 v[68:71], v[164:167], v[196:199], v[68:71]
    v_mfma_f32_16x16x32_bf16 v[64:67], v[164:167], v[192:195], v[64:67]
    v_mfma_f32_16x16x32_bf16 v[60:63], v[164:167], v[188:191], v[60:63]
    v_mfma_f32_16x16x32_bf16 v[72:75], v[168:171], v[188:191], v[72:75]
    v_mfma_f32_16x16x32_bf16 v[76:79], v[168:171], v[192:195], v[76:79]
    s_waitcnt vmcnt(5) lgkmcnt(0)
    s_barrier
    v_mfma_f32_16x16x32_bf16 v[80:83], v[168:171], v[196:199], v[80:83]
    v_mfma_f32_16x16x32_bf16 v[92:95], v[172:175], v[196:199], v[92:95]
    v_mfma_f32_16x16x32_bf16 v[88:91], v[172:175], v[192:195], v[88:91]
    v_mfma_f32_16x16x32_bf16 v[84:87], v[172:175], v[188:191], v[84:87]
    v_mfma_f32_16x16x32_bf16 v[0:3], v[112:115], v[176:179], v[0:3]
    ds_read_b128 v[188:191], v224 offset:33280
    ds_read_b128 v[192:195], v224 offset:35328
    v_mfma_f32_16x16x32_bf16 v[4:7], v[112:115], v[180:183], v[4:7]
    ds_read_b128 v[196:199], v224 offset:37376
    ds_read_b64_tr_b16 v[144:145], v226 offset:49152
    v_mov_b32 v236, 0
    buffer_load_dword v237, v236, s[44:47], s71 offen sc1
    v_mfma_f32_16x16x32_bf16 v[8:11], v[112:115], v[184:187], v[8:11]
    ds_read_b64_tr_b16 v[146:147], v226 offset:50176
    ds_read_b64_tr_b16 v[148:149], v227 offset:49152
    v_mfma_f32_16x16x32_bf16 v[20:23], v[116:119], v[184:187], v[20:23]
    ds_read_b64_tr_b16 v[150:151], v227 offset:50176
    ds_read_b64_tr_b16 v[152:153], v226 offset:49408
    s_add_u32 m0, s33, 32768
    s_add_u32 s21, s70, 2
    s_and_b32 s21, s21, 7
    s_xor_b32 s21, s21, s69
    s_lshl_b32 s21, s21, 19
    s_add_u32 s21, s21, 262144
    buffer_load_dwordx4 v231, s[8:11], s21 offen lds
    v_mfma_f32_16x16x32_bf16 v[16:19], v[116:119], v[180:183], v[16:19]
    ds_read_b64_tr_b16 v[154:155], v226 offset:50432
    ds_read_b64_tr_b16 v[156:157], v227 offset:49408
    v_mfma_f32_16x16x32_bf16 v[12:15], v[116:119], v[176:179], v[12:15]
    ds_read_b64_tr_b16 v[158:159], v227 offset:50432
    ds_read_b64_tr_b16 v[160:161], v226 offset:49664
    s_add_u32 m0, s33, 33792
    s_add_u32 s21, s21, 32768
    buffer_load_dwordx4 v231, s[8:11], s21 offen lds
    v_mfma_f32_16x16x32_bf16 v[24:27], v[120:123], v[176:179], v[24:27]
    ds_read_b64_tr_b16 v[162:163], v226 offset:50688
    ds_read_b64_tr_b16 v[164:165], v227 offset:49664
    v_mfma_f32_16x16x32_bf16 v[28:31], v[120:123], v[180:183], v[28:31]
    ds_read_b64_tr_b16 v[166:167], v227 offset:50688
    ds_read_b64_tr_b16 v[168:169], v226 offset:49920
    s_add_u32 m0, s33, 49152
    s_add_u32 s21, s70, 3
    s_and_b32 s21, s21, 7
    s_xor_b32 s21, s21, s69
    s_lshl_b32 s21, s21, 19
    buffer_load_dwordx4 v231, s[8:11], s21 offen lds
    v_mfma_f32_16x16x32_bf16 v[32:35], v[120:123], v[184:187], v[32:35]
    ds_read_b64_tr_b16 v[170:171], v226 offset:50944
    ds_read_b64_tr_b16 v[172:173], v227 offset:49920
    v_mfma_f32_16x16x32_bf16 v[44:47], v[124:127], v[184:187], v[44:47]
    ds_read_b64_tr_b16 v[174:175], v227 offset:50944
    s_add_u32 m0, s33, 50176
    s_add_u32 s21, s21, 32768
    buffer_load_dwordx4 v231, s[8:11], s21 offen lds
    v_mfma_f32_16x16x32_bf16 v[40:43], v[124:127], v[180:183], v[40:43]
    v_mfma_f32_16x16x32_bf16 v[36:39], v[124:127], v[176:179], v[36:39]
    s_mov_b32 m0, s26
    s_nop 0
    buffer_load_dwordx4 v255, s[12:15], s24 offen nt lds
    v_mfma_f32_16x16x32_bf16 v[48:51], v[128:131], v[176:179], v[48:51]
    v_mfma_f32_16x16x32_bf16 v[52:55], v[128:131], v[180:183], v[52:55]
    s_mov_b32 m0, s26
    s_nop 0
    buffer_load_dwordx4 v255, s[12:15], s24 offen offset:1024 nt lds
    v_mfma_f32_16x16x32_bf16 v[56:59], v[128:131], v[184:187], v[56:59]
    v_mfma_f32_16x16x32_bf16 v[68:71], v[132:135], v[184:187], v[68:71]
    v_mfma_f32_16x16x32_bf16 v[64:67], v[132:135], v[180:183], v[64:67]
    v_mfma_f32_16x16x32_bf16 v[60:63], v[132:135], v[176:179], v[60:63]
    v_mfma_f32_16x16x32_bf16 v[72:75], v[136:139], v[176:179], v[72:75]
    v_mfma_f32_16x16x32_bf16 v[76:79], v[136:139], v[180:183], v[76:79]
    s_waitcnt vmcnt(7) lgkmcnt(0)
    s_barrier
    v_mfma_f32_16x16x32_bf16 v[80:83], v[136:139], v[184:187], v[80:83]
    v_mfma_f32_16x16x32_bf16 v[92:95], v[140:143], v[184:187], v[92:95]
    v_mfma_f32_16x16x32_bf16 v[88:91], v[140:143], v[180:183], v[88:91]
    v_mfma_f32_16x16x32_bf16 v[84:87], v[140:143], v[176:179], v[84:87]
    v_mfma_f32_16x16x32_bf16 v[0:3], v[144:147], v[188:191], v[0:3]
    ds_read_b128 v[176:179], v224 offset:0
    ds_read_b128 v[180:183], v224 offset:2048
    v_mfma_f32_16x16x32_bf16 v[4:7], v[144:147], v[192:195], v[4:7]
    ds_read_b128 v[184:187], v224 offset:4096
    ds_read_b64_tr_b16 v[112:113], v226 offset:0
    s_add_u32 m0, s32, 131072
    s_add_u32 s20, s70, 3
    s_and_b32 s20, s20, 7
    s_xor_b32 s20, s20, s69
    s_lshl_b32 s20, s20, 7
    buffer_load_dwordx4 v230, s[4:7], s20 offen lds
    v_mfma_f32_16x16x32_bf16 v[8:11], v[144:147], v[196:199], v[8:11]
    ds_read_b64_tr_b16 v[114:115], v226 offset:1024
    ds_read_b64_tr_b16 v[116:117], v227 offset:0
    v_mfma_f32_16x16x32_bf16 v[20:23], v[148:151], v[196:199], v[20:23]
    ds_read_b64_tr_b16 v[118:119], v227 offset:1024
    ds_read_b64_tr_b16 v[120:121], v226 offset:256
    s_add_u32 m0, s32, 139264
    s_add_u32 s20, s20, 65536
    buffer_load_dwordx4 v230, s[4:7], s20 offen lds
    v_mfma_f32_16x16x32_bf16 v[16:19], v[148:151], v[192:195], v[16:19]
    ds_read_b64_tr_b16 v[122:123], v226 offset:1280
    ds_read_b64_tr_b16 v[124:125], v227 offset:256
    v_mfma_f32_16x16x32_bf16 v[12:15], v[148:151], v[188:191], v[12:15]
    ds_read_b64_tr_b16 v[126:127], v227 offset:1280
    ds_read_b64_tr_b16 v[128:129], v226 offset:512
    s_add_u32 m0, s32, 147456
    s_add_u32 s20, s20, 65536
    buffer_load_dwordx4 v230, s[4:7], s20 offen lds
    v_mfma_f32_16x16x32_bf16 v[24:27], v[152:155], v[188:191], v[24:27]
    ds_read_b64_tr_b16 v[130:131], v226 offset:1536
    ds_read_b64_tr_b16 v[132:133], v227 offset:512
    v_mfma_f32_16x16x32_bf16 v[28:31], v[152:155], v[192:195], v[28:31]
    ds_read_b64_tr_b16 v[134:135], v227 offset:1536
    ds_read_b64_tr_b16 v[136:137], v226 offset:768
    s_add_u32 m0, s26, 4096
    s_add_u32 s24, s24, 4096
    buffer_load_dwordx4 v255, s[12:15], s24 offen nt lds
    v_mfma_f32_16x16x32_bf16 v[32:35], v[152:155], v[196:199], v[32:35]
    ds_read_b64_tr_b16 v[138:139], v226 offset:1792
    ds_read_b64_tr_b16 v[140:141], v227 offset:768
    v_mfma_f32_16x16x32_bf16 v[44:47], v[156:159], v[196:199], v[44:47]
    ds_read_b64_tr_b16 v[142:143], v227 offset:1792
    s_add_u32 m0, s26, 4096
    s_nop 0
    buffer_load_dwordx4 v255, s[12:15], s24 offen offset:1024 nt lds
    s_add_u32 s24, s24, 4096
    s_and_b32 s24, s24, 0x1ffff
    s_add_u32 s26, s26, 16384
    s_cmp_ge_u32 s26, s38
    s_cselect_b32 s26, s73, s26
    v_mfma_f32_16x16x32_bf16 v[40:43], v[156:159], v[192:195], v[40:43]
    v_mfma_f32_16x16x32_bf16 v[36:39], v[156:159], v[188:191], v[36:39]
    v_mfma_f32_16x16x32_bf16 v[48:51], v[160:163], v[188:191], v[48:51]
    v_mfma_f32_16x16x32_bf16 v[52:55], v[160:163], v[192:195], v[52:55]
    v_mfma_f32_16x16x32_bf16 v[56:59], v[160:163], v[196:199], v[56:59]
    v_mfma_f32_16x16x32_bf16 v[68:71], v[164:167], v[196:199], v[68:71]
    v_mfma_f32_16x16x32_bf16 v[64:67], v[164:167], v[192:195], v[64:67]
    v_mfma_f32_16x16x32_bf16 v[60:63], v[164:167], v[188:191], v[60:63]
    v_mfma_f32_16x16x32_bf16 v[72:75], v[168:171], v[188:191], v[72:75]
    v_mfma_f32_16x16x32_bf16 v[76:79], v[168:171], v[192:195], v[76:79]
    s_waitcnt vmcnt(9) lgkmcnt(0)
    s_barrier
    v_mfma_f32_16x16x32_bf16 v[80:83], v[168:171], v[196:199], v[80:83]
    v_mfma_f32_16x16x32_bf16 v[92:95], v[172:175], v[196:199], v[92:95]
    v_mfma_f32_16x16x32_bf16 v[88:91], v[172:175], v[192:195], v[88:91]
    v_mfma_f32_16x16x32_bf16 v[84:87], v[172:175], v[188:191], v[84:87]
    v_mfma_f32_16x16x32_bf16 v[0:3], v[112:115], v[176:179], v[0:3]
    ds_read_b128 v[188:191], v224 offset:512
    ds_read_b128 v[192:195], v224 offset:2560
    v_mfma_f32_16x16x32_bf16 v[4:7], v[112:115], v[180:183], v[4:7]
    ds_read_b128 v[196:199], v224 offset:4608
    ds_read_b64_tr_b16 v[144:145], v226 offset:16384
    s_add_u32 m0, s33, 65536
    s_add_u32 s21, s70, 3
    s_and_b32 s21, s21, 7
    s_xor_b32 s21, s21, s69
    s_lshl_b32 s21, s21, 19
    s_add_u32 s21, s21, 262144
    buffer_load_dwordx4 v231, s[8:11], s21 offen lds
    v_mfma_f32_16x16x32_bf16 v[8:11], v[112:115], v[184:187], v[8:11]
    ds_read_b64_tr_b16 v[146:147], v226 offset:17408
    ds_read_b64_tr_b16 v[148:149], v227 offset:16384
    v_mfma_f32_16x16x32_bf16 v[20:23], v[116:119], v[184:187], v[20:23]
    ds_read_b64_tr_b16 v[150:151], v227 offset:17408
    ds_read_b64_tr_b16 v[152:153], v226 offset:16640
    s_add_u32 m0, s33, 66560
    s_add_u32 s21, s21, 32768
    buffer_load_dwordx4 v231, s[8:11], s21 offen lds
    v_mfma_f32_16x16x32_bf16 v[16:19], v[116:119], v[180:183], v[16:19]
    ds_read_b64_tr_b16 v[154:155], v226 offset:17664
    ds_read_b64_tr_b16 v[156:157], v227 offset:16640
    v_mfma_f32_16x16x32_bf16 v[12:15], v[116:119], v[176:179], v[12:15]
    ds_read_b64_tr_b16 v[158:159], v227 offset:17664
    ds_read_b64_tr_b16 v[160:161], v226 offset:16896
    s_add_u32 m0, s33, 16384
    s_add_u32 s21, s70, 4
    s_and_b32 s21, s21, 7
    s_xor_b32 s21, s21, s69
    s_lshl_b32 s21, s21, 19
    buffer_load_dwordx4 v231, s[8:11], s21 offen lds
    v_mfma_f32_16x16x32_bf16 v[24:27], v[120:123], v[176:179], v[24:27]
    ds_read_b64_tr_b16 v[162:163], v226 offset:17920
    ds_read_b64_tr_b16 v[164:165], v227 offset:16896
    v_mfma_f32_16x16x32_bf16 v[28:31], v[120:123], v[180:183], v[28:31]
    ds_read_b64_tr_b16 v[166:167], v227 offset:17920
    ds_read_b64_tr_b16 v[168:169], v226 offset:17152
    s_add_u32 m0, s33, 17408
    s_add_u32 s21, s21, 32768
    buffer_load_dwordx4 v231, s[8:11], s21 offen lds
    v_mfma_f32_16x16x32_bf16 v[32:35], v[120:123], v[184:187], v[32:35]
    ds_read_b64_tr_b16 v[170:171], v226 offset:18176
    ds_read_b64_tr_b16 v[172:173], v227 offset:17152
    v_mfma_f32_16x16x32_bf16 v[44:47], v[124:127], v[184:187], v[44:47]
    ds_read_b64_tr_b16 v[174:175], v227 offset:18176
    s_mov_b32 m0, s39
    s_nop 0
    buffer_load_dwordx4 v251, s[16:19], s25 offen nt lds
    v_mfma_f32_16x16x32_bf16 v[40:43], v[124:127], v[180:183], v[40:43]
    v_mfma_f32_16x16x32_bf16 v[36:39], v[124:127], v[176:179], v[36:39]
    s_mov_b32 m0, s39
    s_nop 0
    buffer_load_dwordx4 v251, s[16:19], s25 offen offset:2048 nt lds
    v_mfma_f32_16x16x32_bf16 v[48:51], v[128:131], v[176:179], v[48:51]
    v_mfma_f32_16x16x32_bf16 v[52:55], v[128:131], v[180:183], v[52:55]
    v_mfma_f32_16x16x32_bf16 v[56:59], v[128:131], v[184:187], v[56:59]
    v_mfma_f32_16x16x32_bf16 v[68:71], v[132:135], v[184:187], v[68:71]
    v_mfma_f32_16x16x32_bf16 v[64:67], v[132:135], v[180:183], v[64:67]
    v_mfma_f32_16x16x32_bf16 v[60:63], v[132:135], v[176:179], v[60:63]
    v_mfma_f32_16x16x32_bf16 v[72:75], v[136:139], v[176:179], v[72:75]
    v_mfma_f32_16x16x32_bf16 v[76:79], v[136:139], v[180:183], v[76:79]
    s_waitcnt vmcnt(8) lgkmcnt(0)
    s_barrier
    v_mfma_f32_16x16x32_bf16 v[80:83], v[136:139], v[184:187], v[80:83]
    v_mfma_f32_16x16x32_bf16 v[92:95], v[140:143], v[184:187], v[92:95]
    v_mfma_f32_16x16x32_bf16 v[88:91], v[140:143], v[180:183], v[88:91]
    v_mfma_f32_16x16x32_bf16 v[84:87], v[140:143], v[176:179], v[84:87]
    v_mfma_f32_16x16x32_bf16 v[0:3], v[144:147], v[188:191], v[0:3]
    ds_read_b128 v[176:179], v224 offset:32768
    ds_read_b128 v[180:183], v224 offset:34816
    v_mfma_f32_16x16x32_bf16 v[4:7], v[144:147], v[192:195], v[4:7]
    ds_read_b128 v[184:187], v224 offset:36864
    ds_read_b64_tr_b16 v[112:113], v226 offset:32768
    s_add_u32 m0, s32, 98304
    s_add_u32 s20, s70, 4
    s_and_b32 s20, s20, 7
    s_xor_b32 s20, s20, s69
    s_lshl_b32 s20, s20, 7
    buffer_load_dwordx4 v230, s[4:7], s20 offen lds
    v_mfma_f32_16x16x32_bf16 v[8:11], v[144:147], v[196:199], v[8:11]
    ds_read_b64_tr_b16 v[114:115], v226 offset:33792
    ds_read_b64_tr_b16 v[116:117], v227 offset:32768
    v_mfma_f32_16x16x32_bf16 v[20:23], v[148:151], v[196:199], v[20:23]
    ds_read_b64_tr_b16 v[118:119], v227 offset:33792
    ds_read_b64_tr_b16 v[120:121], v226 offset:33024
    s_add_u32 m0, s32, 106496
    s_add_u32 s20, s20, 65536
    buffer_load_dwordx4 v230, s[4:7], s20 offen lds
    v_mfma_f32_16x16x32_bf16 v[16:19], v[148:151], v[192:195], v[16:19]
    ds_read_b64_tr_b16 v[122:123], v226 offset:34048
    ds_read_b64_tr_b16 v[124:125], v227 offset:33024
    v_mfma_f32_16x16x32_bf16 v[12:15], v[148:151], v[188:191], v[12:15]
    ds_read_b64_tr_b16 v[126:127], v227 offset:34048
    ds_read_b64_tr_b16 v[128:129], v226 offset:33280
    s_add_u32 m0, s32, 114688
    s_add_u32 s20, s20, 65536
    buffer_load_dwordx4 v230, s[4:7], s20 offen lds
    v_mfma_f32_16x16x32_bf16 v[24:27], v[152:155], v[188:191], v[24:27]
    ds_read_b64_tr_b16 v[130:131], v226 offset:34304
    ds_read_b64_tr_b16 v[132:133], v227 offset:33280
    v_mfma_f32_16x16x32_bf16 v[28:31], v[152:155], v[192:195], v[28:31]
    ds_read_b64_tr_b16 v[134:135], v227 offset:34304
    ds_read_b64_tr_b16 v[136:137], v226 offset:33536
    s_add_u32 m0, s39, 4096
    s_add_u32 s25, s25, 4096
    buffer_load_dwordx4 v251, s[16:19], s25 offen nt lds
    v_mfma_f32_16x16x32_bf16 v[32:35], v[152:155], v[196:199], v[32:35]
    ds_read_b64_tr_b16 v[138:139], v226 offset:34560
    ds_read_b64_tr_b16 v[140:141], v227 offset:33536
    v_mfma_f32_16x16x32_bf16 v[44:47], v[156:159], v[196:199], v[44:47]
    ds_read_b64_tr_b16 v[142:143], v227 offset:34560
    s_add_u32 m0, s39, 4096
    s_nop 0
    buffer_load_dwordx4 v251, s[16:19], s25 offen offset:2048 nt lds
    s_add_u32 s25, s25, 4096
    s_and_b32 s25, s25, 0x1ffff
    s_add_u32 s39, s39, 16384
    s_cmp_ge_u32 s39, s68
    s_cselect_b32 s39, s74, s39
    v_mfma_f32_16x16x32_bf16 v[40:43], v[156:159], v[192:195], v[40:43]
    v_mfma_f32_16x16x32_bf16 v[36:39], v[156:159], v[188:191], v[36:39]
    v_mfma_f32_16x16x32_bf16 v[48:51], v[160:163], v[188:191], v[48:51]
    v_mfma_f32_16x16x32_bf16 v[52:55], v[160:163], v[192:195], v[52:55]
    v_mfma_f32_16x16x32_bf16 v[56:59], v[160:163], v[196:199], v[56:59]
    v_mfma_f32_16x16x32_bf16 v[68:71], v[164:167], v[196:199], v[68:71]
    v_mfma_f32_16x16x32_bf16 v[64:67], v[164:167], v[192:195], v[64:67]
    v_mfma_f32_16x16x32_bf16 v[60:63], v[164:167], v[188:191], v[60:63]
    v_mfma_f32_16x16x32_bf16 v[72:75], v[168:171], v[188:191], v[72:75]
    v_mfma_f32_16x16x32_bf16 v[76:79], v[168:171], v[192:195], v[76:79]
    s_waitcnt vmcnt(9) lgkmcnt(0)
    s_barrier
    v_mfma_f32_16x16x32_bf16 v[80:83], v[168:171], v[196:199], v[80:83]
    v_mfma_f32_16x16x32_bf16 v[92:95], v[172:175], v[196:199], v[92:95]
    v_mfma_f32_16x16x32_bf16 v[88:91], v[172:175], v[192:195], v[88:91]
    v_mfma_f32_16x16x32_bf16 v[84:87], v[172:175], v[188:191], v[84:87]
    v_mfma_f32_16x16x32_bf16 v[0:3], v[112:115], v[176:179], v[0:3]
    ds_read_b128 v[188:191], v224 offset:33280
    ds_read_b128 v[192:195], v224 offset:35328
    v_mfma_f32_16x16x32_bf16 v[4:7], v[112:115], v[180:183], v[4:7]
    ds_read_b128 v[196:199], v224 offset:37376
    ds_read_b64_tr_b16 v[144:145], v226 offset:49152
    s_add_u32 m0, s33, 32768
    s_add_u32 s21, s70, 4
    s_and_b32 s21, s21, 7
    s_xor_b32 s21, s21, s69
    s_lshl_b32 s21, s21, 19
    s_add_u32 s21, s21, 262144
    buffer_load_dwordx4 v231, s[8:11], s21 offen lds
    v_mfma_f32_16x16x32_bf16 v[8:11], v[112:115], v[184:187], v[8:11]
    ds_read_b64_tr_b16 v[146:147], v226 offset:50176
    ds_read_b64_tr_b16 v[148:149], v227 offset:49152
    v_mfma_f32_16x16x32_bf16 v[20:23], v[116:119], v[184:187], v[20:23]
    ds_read_b64_tr_b16 v[150:151], v227 offset:50176
    ds_read_b64_tr_b16 v[152:153], v226 offset:49408
    s_add_u32 m0, s33, 33792
    s_add_u32 s21, s21, 32768
    buffer_load_dwordx4 v231, s[8:11], s21 offen lds
    v_mfma_f32_16x16x32_bf16 v[16:19], v[116:119], v[180:183], v[16:19]
    ds_read_b64_tr_b16 v[154:155], v226 offset:50432
    ds_read_b64_tr_b16 v[156:157], v227 offset:49408
    v_mfma_f32_16x16x32_bf16 v[12:15], v[116:119], v[176:179], v[12:15]
    ds_read_b64_tr_b16 v[158:159], v227 offset:50432
    ds_read_b64_tr_b16 v[160:161], v226 offset:49664
    s_add_u32 m0, s33, 49152
    s_add_u32 s21, s70, 5
    s_and_b32 s21, s21, 7
    s_xor_b32 s21, s21, s69
    s_lshl_b32 s21, s21, 19
    buffer_load_dwordx4 v231, s[8:11], s21 offen lds
    v_mfma_f32_16x16x32_bf16 v[24:27], v[120:123], v[176:179], v[24:27]
    ds_read_b64_tr_b16 v[162:163], v226 offset:50688
    ds_read_b64_tr_b16 v[164:165], v227 offset:49664
    v_mfma_f32_16x16x32_bf16 v[28:31], v[120:123], v[180:183], v[28:31]
    ds_read_b64_tr_b16 v[166:167], v227 offset:50688
    ds_read_b64_tr_b16 v[168:169], v226 offset:49920
    s_add_u32 m0, s33, 50176
    s_add_u32 s21, s21, 32768
    buffer_load_dwordx4 v231, s[8:11], s21 offen lds
    v_mfma_f32_16x16x32_bf16 v[32:35], v[120:123], v[184:187], v[32:35]
    ds_read_b64_tr_b16 v[170:171], v226 offset:50944
    ds_read_b64_tr_b16 v[172:173], v227 offset:49920
    v_mfma_f32_16x16x32_bf16 v[44:47], v[124:127], v[184:187], v[44:47]
    ds_read_b64_tr_b16 v[174:175], v227 offset:50944
    v_readfirstlane_b32 s36, v237
    v_or_b32 v237, s61, v237
    s_mov_b64 exec, 1
    buffer_store_dwordx2 v[236:237], v236, s[40:43], s72 offen sc1
    s_mov_b64 exec, -1
    v_mfma_f32_16x16x32_bf16 v[40:43], v[124:127], v[180:183], v[40:43]
    v_mfma_f32_16x16x32_bf16 v[36:39], v[124:127], v[176:179], v[36:39]
    s_add_u32 s23, s77, 81920
    s_and_b32 s23, s23, 0x1ffff
    buffer_load_dwordx4 v[200:203], v255, s[12:15], s23 offen offset:0 nt
    v_mfma_f32_16x16x32_bf16 v[48:51], v[128:131], v[176:179], v[48:51]
    v_mfma_f32_16x16x32_bf16 v[52:55], v[128:131], v[180:183], v[52:55]
    v_mfma_f32_16x16x32_bf16 v[56:59], v[128:131], v[184:187], v[56:59]
    v_mfma_f32_16x16x32_bf16 v[68:71], v[132:135], v[184:187], v[68:71]
    v_mfma_f32_16x16x32_bf16 v[64:67], v[132:135], v[180:183], v[64:67]
    v_mfma_f32_16x16x32_bf16 v[60:63], v[132:135], v[176:179], v[60:63]
    v_mfma_f32_16x16x32_bf16 v[72:75], v[136:139], v[176:179], v[72:75]
    v_mfma_f32_16x16x32_bf16 v[76:79], v[136:139], v[180:183], v[76:79]
    s_waitcnt vmcnt(8) lgkmcnt(0)
    s_barrier
    v_mfma_f32_16x16x32_bf16 v[80:83], v[136:139], v[184:187], v[80:83]
    v_mfma_f32_16x16x32_bf16 v[92:95], v[140:143], v[184:187], v[92:95]
    v_mfma_f32_16x16x32_bf16 v[88:91], v[140:143], v[180:183], v[88:91]
    v_mfma_f32_16x16x32_bf16 v[84:87], v[140:143], v[176:179], v[84:87]
    v_mfma_f32_16x16x32_bf16 v[0:3], v[144:147], v[188:191], v[0:3]
    ds_read_b128 v[176:179], v224 offset:0
    ds_read_b128 v[180:183], v224 offset:2048
    v_mfma_f32_16x16x32_bf16 v[4:7], v[144:147], v[192:195], v[4:7]
    ds_read_b128 v[184:187], v224 offset:4096
    ds_read_b64_tr_b16 v[112:113], v226 offset:0
    s_add_u32 m0, s32, 131072
    s_add_u32 s20, s70, 5
    s_and_b32 s20, s20, 7
    s_xor_b32 s20, s20, s69
    s_lshl_b32 s20, s20, 7
    buffer_load_dwordx4 v230, s[4:7], s20 offen lds
    v_mfma_f32_16x16x32_bf16 v[8:11], v[144:147], v[196:199], v[8:11]
    ds_read_b64_tr_b16 v[114:115], v226 offset:1024
    ds_read_b64_tr_b16 v[116:117], v227 offset:0
    v_mfma_f32_16x16x32_bf16 v[20:23], v[148:151], v[196:199], v[20:23]
    ds_read_b64_tr_b16 v[118:119], v227 offset:1024
    ds_read_b64_tr_b16 v[120:121], v226 offset:256
    s_add_u32 m0, s32, 139264
    s_add_u32 s20, s20, 65536
    buffer_load_dwordx4 v230, s[4:7], s20 offen lds
    v_mfma_f32_16x16x32_bf16 v[16:19], v[148:151], v[192:195], v[16:19]
    ds_read_b64_tr_b16 v[122:123], v226 offset:1280
    ds_read_b64_tr_b16 v[124:125], v227 offset:256
    v_mfma_f32_16x16x32_bf16 v[12:15], v[148:151], v[188:191], v[12:15]
    ds_read_b64_tr_b16 v[126:127], v227 offset:1280
    ds_read_b64_tr_b16 v[128:129], v226 offset:512
    s_add_u32 m0, s32, 147456
    s_add_u32 s20, s20, 65536
    buffer_load_dwordx4 v230, s[4:7], s20 offen lds
    v_mfma_f32_16x16x32_bf16 v[24:27], v[152:155], v[188:191], v[24:27]
    ds_read_b64_tr_b16 v[130:131], v226 offset:1536
    ds_read_b64_tr_b16 v[132:133], v227 offset:512
    v_mfma_f32_16x16x32_bf16 v[28:31], v[152:155], v[192:195], v[28:31]
    ds_read_b64_tr_b16 v[134:135], v227 offset:1536
    ds_read_b64_tr_b16 v[136:137], v226 offset:768
    s_add_u32 s23, s77, 81920
    s_and_b32 s23, s23, 0x1ffff
    buffer_load_dwordx4 v[204:207], v255, s[12:15], s23 offen offset:1024 nt
    v_mfma_f32_16x16x32_bf16 v[32:35], v[152:155], v[196:199], v[32:35]
    ds_read_b64_tr_b16 v[138:139], v226 offset:1792
    ds_read_b64_tr_b16 v[140:141], v227 offset:768
    v_mfma_f32_16x16x32_bf16 v[44:47], v[156:159], v[196:199], v[44:47]
    ds_read_b64_tr_b16 v[142:143], v227 offset:1792
    v_mfma_f32_16x16x32_bf16 v[40:43], v[156:159], v[192:195], v[40:43]
    v_mfma_f32_16x16x32_bf16 v[36:39], v[156:159], v[188:191], v[36:39]
    v_mfma_f32_16x16x32_bf16 v[48:51], v[160:163], v[188:191], v[48:51]
    v_mfma_f32_16x16x32_bf16 v[52:55], v[160:163], v[192:195], v[52:55]
    v_mfma_f32_16x16x32_bf16 v[56:59], v[160:163], v[196:199], v[56:59]
    v_mfma_f32_16x16x32_bf16 v[68:71], v[164:167], v[196:199], v[68:71]
    v_mfma_f32_16x16x32_bf16 v[64:67], v[164:167], v[192:195], v[64:67]
    v_mfma_f32_16x16x32_bf16 v[60:63], v[164:167], v[188:191], v[60:63]
    v_mfma_f32_16x16x32_bf16 v[72:75], v[168:171], v[188:191], v[72:75]
    v_mfma_f32_16x16x32_bf16 v[76:79], v[168:171], v[192:195], v[76:79]
    s_waitcnt vmcnt(8) lgkmcnt(0)
    s_barrier
    v_mfma_f32_16x16x32_bf16 v[80:83], v[168:171], v[196:199], v[80:83]
    v_mfma_f32_16x16x32_bf16 v[92:95], v[172:175], v[196:199], v[92:95]
    v_mfma_f32_16x16x32_bf16 v[88:91], v[172:175], v[192:195], v[88:91]
    v_mfma_f32_16x16x32_bf16 v[84:87], v[172:175], v[188:191], v[84:87]
    v_mfma_f32_16x16x32_bf16 v[0:3], v[112:115], v[176:179], v[0:3]
    ds_read_b128 v[188:191], v224 offset:512
    ds_read_b128 v[192:195], v224 offset:2560
    v_mfma_f32_16x16x32_bf16 v[4:7], v[112:115], v[180:183], v[4:7]
    ds_read_b128 v[196:199], v224 offset:4608
    ds_read_b64_tr_b16 v[144:145], v226 offset:16384
    s_add_u32 m0, s33, 65536
    s_add_u32 s21, s70, 5
    s_and_b32 s21, s21, 7
    s_xor_b32 s21, s21, s69
    s_lshl_b32 s21, s21, 19
    s_add_u32 s21, s21, 262144
    buffer_load_dwordx4 v231, s[8:11], s21 offen lds
    v_mfma_f32_16x16x32_bf16 v[8:11], v[112:115], v[184:187], v[8:11]
    ds_read_b64_tr_b16 v[146:147], v226 offset:17408
    ds_read_b64_tr_b16 v[148:149], v227 offset:16384
    v_mfma_f32_16x16x32_bf16 v[20:23], v[116:119], v[184:187], v[20:23]
    ds_read_b64_tr_b16 v[150:151], v227 offset:17408
    ds_read_b64_tr_b16 v[152:153], v226 offset:16640
    s_add_u32 m0, s33, 66560
    s_add_u32 s21, s21, 32768
    buffer_load_dwordx4 v231, s[8:11], s21 offen lds
    v_mfma_f32_16x16x32_bf16 v[16:19], v[116:119], v[180:183], v[16:19]
    ds_read_b64_tr_b16 v[154:155], v226 offset:17664
    ds_read_b64_tr_b16 v[156:157], v227 offset:16640
    v_mfma_f32_16x16x32_bf16 v[12:15], v[116:119], v[176:179], v[12:15]
    ds_read_b64_tr_b16 v[158:159], v227 offset:17664
    ds_read_b64_tr_b16 v[160:161], v226 offset:16896
    s_add_u32 m0, s33, 16384
    s_add_u32 s21, s70, 6
    s_and_b32 s21, s21, 7
    s_xor_b32 s21, s21, s69
    s_lshl_b32 s21, s21, 19
    buffer_load_dwordx4 v231, s[8:11], s21 offen lds
    v_mfma_f32_16x16x32_bf16 v[24:27], v[120:123], v[176:179], v[24:27]
    ds_read_b64_tr_b16 v[162:163], v226 offset:17920
    ds_read_b64_tr_b16 v[164:165], v227 offset:16896
    v_mfma_f32_16x16x32_bf16 v[28:31], v[120:123], v[180:183], v[28:31]
    ds_read_b64_tr_b16 v[166:167], v227 offset:17920
    ds_read_b64_tr_b16 v[168:169], v226 offset:17152
    s_add_u32 m0, s33, 17408
    s_add_u32 s21, s21, 32768
    buffer_load_dwordx4 v231, s[8:11], s21 offen lds
    v_mfma_f32_16x16x32_bf16 v[32:35], v[120:123], v[184:187], v[32:35]
    ds_read_b64_tr_b16 v[170:171], v226 offset:18176
    ds_read_b64_tr_b16 v[172:173], v227 offset:17152
    v_mfma_f32_16x16x32_bf16 v[44:47], v[124:127], v[184:187], v[44:47]
    ds_read_b64_tr_b16 v[174:175], v227 offset:18176
    s_add_u32 s23, s77, 86016
    s_and_b32 s23, s23, 0x1ffff
    buffer_load_dwordx4 v[208:211], v255, s[12:15], s23 offen offset:0 nt
    v_mfma_f32_16x16x32_bf16 v[40:43], v[124:127], v[180:183], v[40:43]
    v_mfma_f32_16x16x32_bf16 v[36:39], v[124:127], v[176:179], v[36:39]
    s_mov_b32 s23, 0
    s_mov_b64 exec, 0xffff
    buffer_load_dword v247, v246, s[96:99], s23 offen
    s_mov_b64 exec, -1
    v_mfma_f32_16x16x32_bf16 v[48:51], v[128:131], v[176:179], v[48:51]
    v_mfma_f32_16x16x32_bf16 v[52:55], v[128:131], v[180:183], v[52:55]
    v_mfma_f32_16x16x32_bf16 v[56:59], v[128:131], v[184:187], v[56:59]
    v_mfma_f32_16x16x32_bf16 v[68:71], v[132:135], v[184:187], v[68:71]
    v_mfma_f32_16x16x32_bf16 v[64:67], v[132:135], v[180:183], v[64:67]
    v_mfma_f32_16x16x32_bf16 v[60:63], v[132:135], v[176:179], v[60:63]
    v_mfma_f32_16x16x32_bf16 v[72:75], v[136:139], v[176:179], v[72:75]
    v_mfma_f32_16x16x32_bf16 v[76:79], v[136:139], v[180:183], v[76:79]
    s_waitcnt vmcnt(7) lgkmcnt(0)
    s_barrier
    v_mfma_f32_16x16x32_bf16 v[80:83], v[136:139], v[184:187], v[80:83]
    v_mfma_f32_16x16x32_bf16 v[92:95], v[140:143], v[184:187], v[92:95]
    v_mfma_f32_16x16x32_bf16 v[88:91], v[140:143], v[180:183], v[88:91]
    v_mfma_f32_16x16x32_bf16 v[84:87], v[140:143], v[176:179], v[84:87]
    v_mfma_f32_16x16x32_bf16 v[0:3], v[144:147], v[188:191], v[0:3]
    ds_read_b128 v[176:179], v224 offset:32768
    ds_read_b128 v[180:183], v224 offset:34816
    v_mfma_f32_16x16x32_bf16 v[4:7], v[144:147], v[192:195], v[4:7]
    ds_read_b128 v[184:187], v224 offset:36864
    ds_read_b64_tr_b16 v[112:113], v226 offset:32768
    s_add_u32 m0, s32, 98304
    s_add_u32 s20, s70, 6
    s_and_b32 s20, s20, 7
    s_xor_b32 s20, s20, s69
    s_lshl_b32 s20, s20, 7
    buffer_load_dwordx4 v230, s[4:7], s20 offen lds
    v_mfma_f32_16x16x32_bf16 v[8:11], v[144:147], v[196:199], v[8:11]
    ds_read_b64_tr_b16 v[114:115], v226 offset:33792
    ds_read_b64_tr_b16 v[116:117], v227 offset:32768
    v_mfma_f32_16x16x32_bf16 v[20:23], v[148:151], v[196:199], v[20:23]
    ds_read_b64_tr_b16 v[118:119], v227 offset:33792
    ds_read_b64_tr_b16 v[120:121], v226 offset:33024
    s_add_u32 m0, s32, 106496
    s_add_u32 s20, s20, 65536
    buffer_load_dwordx4 v230, s[4:7], s20 offen lds
    v_mfma_f32_16x16x32_bf16 v[16:19], v[148:151], v[192:195], v[16:19]
    ds_read_b64_tr_b16 v[122:123], v226 offset:34048
    ds_read_b64_tr_b16 v[124:125], v227 offset:33024
    v_mfma_f32_16x16x32_bf16 v[12:15], v[148:151], v[188:191], v[12:15]
    ds_read_b64_tr_b16 v[126:127], v227 offset:34048
    ds_read_b64_tr_b16 v[128:129], v226 offset:33280
    s_add_u32 m0, s32, 114688
    s_add_u32 s20, s20, 65536
    buffer_load_dwordx4 v230, s[4:7], s20 offen lds
    v_mfma_f32_16x16x32_bf16 v[24:27], v[152:155], v[188:191], v[24:27]
    ds_read_b64_tr_b16 v[130:131], v226 offset:34304
    ds_read_b64_tr_b16 v[132:133], v227 offset:33280
    v_mfma_f32_16x16x32_bf16 v[28:31], v[152:155], v[192:195], v[28:31]
    ds_read_b64_tr_b16 v[134:135], v227 offset:34304
    ds_read_b64_tr_b16 v[136:137], v226 offset:33536
    s_add_u32 s23, s77, 86016
    s_and_b32 s23, s23, 0x1ffff
    buffer_load_dwordx4 v[212:215], v255, s[12:15], s23 offen offset:1024 nt
    v_mfma_f32_16x16x32_bf16 v[32:35], v[152:155], v[196:199], v[32:35]
    ds_read_b64_tr_b16 v[138:139], v226 offset:34560
    ds_read_b64_tr_b16 v[140:141], v227 offset:33536
    v_mfma_f32_16x16x32_bf16 v[44:47], v[156:159], v[196:199], v[44:47]
    ds_read_b64_tr_b16 v[142:143], v227 offset:34560
    s_mov_b32 s23, 2048
    s_mov_b64 exec, 0xffff
    buffer_load_dword v247, v246, s[96:99], s23 offen
    s_mov_b64 exec, -1
    v_mfma_f32_16x16x32_bf16 v[40:43], v[156:159], v[192:195], v[40:43]
    v_mfma_f32_16x16x32_bf16 v[36:39], v[156:159], v[188:191], v[36:39]
    v_mfma_f32_16x16x32_bf16 v[48:51], v[160:163], v[188:191], v[48:51]
    v_mfma_f32_16x16x32_bf16 v[52:55], v[160:163], v[192:195], v[52:55]
    v_mfma_f32_16x16x32_bf16 v[56:59], v[160:163], v[196:199], v[56:59]
    v_mfma_f32_16x16x32_bf16 v[68:71], v[164:167], v[196:199], v[68:71]
    v_mfma_f32_16x16x32_bf16 v[64:67], v[164:167], v[192:195], v[64:67]
    v_mfma_f32_16x16x32_bf16 v[60:63], v[164:167], v[188:191], v[60:63]
    v_mfma_f32_16x16x32_bf16 v[72:75], v[168:171], v[188:191], v[72:75]
    v_mfma_f32_16x16x32_bf16 v[76:79], v[168:171], v[192:195], v[76:79]
    s_waitcnt vmcnt(9) lgkmcnt(0)
    s_barrier
    v_mfma_f32_16x16x32_bf16 v[80:83], v[168:171], v[196:199], v[80:83]
    v_mfma_f32_16x16x32_bf16 v[92:95], v[172:175], v[196:199], v[92:95]
    v_mfma_f32_16x16x32_bf16 v[88:91], v[172:175], v[192:195], v[88:91]
    v_mfma_f32_16x16x32_bf16 v[84:87], v[172:175], v[188:191], v[84:87]
    v_mfma_f32_16x16x32_bf16 v[0:3], v[112:115], v[176:179], v[0:3]
    ds_read_b128 v[188:191], v224 offset:33280
    ds_read_b128 v[192:195], v224 offset:35328
    v_mfma_f32_16x16x32_bf16 v[4:7], v[112:115], v[180:183], v[4:7]
    ds_read_b128 v[196:199], v224 offset:37376
    ds_read_b64_tr_b16 v[144:145], v226 offset:49152
    s_add_u32 m0, s33, 32768
    s_add_u32 s21, s70, 6
    s_and_b32 s21, s21, 7
    s_xor_b32 s21, s21, s69
    s_lshl_b32 s21, s21, 19
    s_add_u32 s21, s21, 262144
    buffer_load_dwordx4 v231, s[8:11], s21 offen lds
    v_mfma_f32_16x16x32_bf16 v[8:11], v[112:115], v[184:187], v[8:11]
    ds_read_b64_tr_b16 v[146:147], v226 offset:50176
    ds_read_b64_tr_b16 v[148:149], v227 offset:49152
    v_mfma_f32_16x16x32_bf16 v[20:23], v[116:119], v[184:187], v[20:23]
    ds_read_b64_tr_b16 v[150:151], v227 offset:50176
    ds_read_b64_tr_b16 v[152:153], v226 offset:49408
    s_add_u32 m0, s33, 33792
    s_add_u32 s21, s21, 32768
    buffer_load_dwordx4 v231, s[8:11], s21 offen lds
    v_mfma_f32_16x16x32_bf16 v[16:19], v[116:119], v[180:183], v[16:19]
    ds_read_b64_tr_b16 v[154:155], v226 offset:50432
    ds_read_b64_tr_b16 v[156:157], v227 offset:49408
    v_mfma_f32_16x16x32_bf16 v[12:15], v[116:119], v[176:179], v[12:15]
    ds_read_b64_tr_b16 v[158:159], v227 offset:50432
    ds_read_b64_tr_b16 v[160:161], v226 offset:49664
    s_add_u32 m0, s33, 49152
    s_add_u32 s21, s70, 7
    s_and_b32 s21, s21, 7
    s_xor_b32 s21, s21, s69
    s_lshl_b32 s21, s21, 19
    buffer_load_dwordx4 v231, s[8:11], s21 offen lds
    v_mfma_f32_16x16x32_bf16 v[24:27], v[120:123], v[176:179], v[24:27]
    ds_read_b64_tr_b16 v[162:163], v226 offset:50688
    ds_read_b64_tr_b16 v[164:165], v227 offset:49664
    v_mfma_f32_16x16x32_bf16 v[28:31], v[120:123], v[180:183], v[28:31]
    ds_read_b64_tr_b16 v[166:167], v227 offset:50688
    ds_read_b64_tr_b16 v[168:169], v226 offset:49920
    s_add_u32 m0, s33, 50176
    s_add_u32 s21, s21, 32768
    buffer_load_dwordx4 v231, s[8:11], s21 offen lds
    v_mfma_f32_16x16x32_bf16 v[32:35], v[120:123], v[184:187], v[32:35]
    ds_read_b64_tr_b16 v[170:171], v226 offset:50944
    ds_read_b64_tr_b16 v[172:173], v227 offset:49920
    v_mfma_f32_16x16x32_bf16 v[44:47], v[124:127], v[184:187], v[44:47]
    ds_read_b64_tr_b16 v[174:175], v227 offset:50944
    s_mov_b32 s23, 4096
    s_mov_b64 exec, 0xffff
    buffer_load_dword v247, v246, s[96:99], s23 offen
    s_mov_b64 exec, -1
    v_mfma_f32_16x16x32_bf16 v[40:43], v[124:127], v[180:183], v[40:43]
    v_mfma_f32_16x16x32_bf16 v[36:39], v[124:127], v[176:179], v[36:39]
    v_mfma_f32_16x16x32_bf16 v[48:51], v[128:131], v[176:179], v[48:51]
    v_mfma_f32_16x16x32_bf16 v[52:55], v[128:131], v[180:183], v[52:55]
    v_mfma_f32_16x16x32_bf16 v[56:59], v[128:131], v[184:187], v[56:59]
    v_mfma_f32_16x16x32_bf16 v[68:71], v[132:135], v[184:187], v[68:71]
    v_mfma_f32_16x16x32_bf16 v[64:67], v[132:135], v[180:183], v[64:67]
    v_mfma_f32_16x16x32_bf16 v[60:63], v[132:135], v[176:179], v[60:63]
    v_mfma_f32_16x16x32_bf16 v[72:75], v[136:139], v[176:179], v[72:75]
    v_mfma_f32_16x16x32_bf16 v[76:79], v[136:139], v[180:183], v[76:79]
    s_waitcnt vmcnt(7) lgkmcnt(0)
    s_barrier
    v_mfma_f32_16x16x32_bf16 v[80:83], v[136:139], v[184:187], v[80:83]
    v_mfma_f32_16x16x32_bf16 v[92:95], v[140:143], v[184:187], v[92:95]
    v_mfma_f32_16x16x32_bf16 v[88:91], v[140:143], v[180:183], v[88:91]
    v_mfma_f32_16x16x32_bf16 v[84:87], v[140:143], v[176:179], v[84:87]
    v_mfma_f32_16x16x32_bf16 v[0:3], v[144:147], v[188:191], v[0:3]
    ds_read_b128 v[176:179], v224 offset:0
    ds_read_b128 v[180:183], v224 offset:2048
    v_mfma_f32_16x16x32_bf16 v[4:7], v[144:147], v[192:195], v[4:7]
    ds_read_b128 v[184:187], v224 offset:4096
    ds_read_b64_tr_b16 v[112:113], v226 offset:0
    v_mbcnt_lo_u32_b32 v239, -1, 0
    v_and_b32 v239, 15, v239
    v_lshlrev_b32 v239, 3, v239
    buffer_load_dword v238, v239, s[40:43], s60 offen offset:4 sc1
    v_mfma_f32_16x16x32_bf16 v[8:11], v[144:147], v[196:199], v[8:11]
    ds_read_b64_tr_b16 v[114:115], v226 offset:1024
    ds_read_b64_tr_b16 v[116:117], v227 offset:0
    v_mfma_f32_16x16x32_bf16 v[20:23], v[148:151], v[196:199], v[20:23]
    ds_read_b64_tr_b16 v[118:119], v227 offset:1024
    ds_read_b64_tr_b16 v[120:121], v226 offset:256
    s_add_u32 m0, s32, 131072
    s_add_u32 s20, s70, 7
    s_and_b32 s20, s20, 7
    s_xor_b32 s20, s20, s69
    s_lshl_b32 s20, s20, 7
    buffer_load_dwordx4 v230, s[4:7], s20 offen lds
    v_mfma_f32_16x16x32_bf16 v[16:19], v[148:151], v[192:195], v[16:19]
    ds_read_b64_tr_b16 v[122:123], v226 offset:1280
    ds_read_b64_tr_b16 v[124:125], v227 offset:256
    v_mfma_f32_16x16x32_bf16 v[12:15], v[148:151], v[188:191], v[12:15]
    ds_read_b64_tr_b16 v[126:127], v227 offset:1280
    ds_read_b64_tr_b16 v[128:129], v226 offset:512
    s_add_u32 m0, s32, 139264
    s_add_u32 s20, s20, 65536
    buffer_load_dwordx4 v230, s[4:7], s20 offen lds
    v_mfma_f32_16x16x32_bf16 v[24:27], v[152:155], v[188:191], v[24:27]
    ds_read_b64_tr_b16 v[130:131], v226 offset:1536
    ds_read_b64_tr_b16 v[132:133], v227 offset:512
    v_mfma_f32_16x16x32_bf16 v[28:31], v[152:155], v[192:195], v[28:31]
    ds_read_b64_tr_b16 v[134:135], v227 offset:1536
    ds_read_b64_tr_b16 v[136:137], v226 offset:768
    s_add_u32 m0, s32, 147456
    s_add_u32 s20, s20, 65536
    buffer_load_dwordx4 v230, s[4:7], s20 offen lds
    v_mfma_f32_16x16x32_bf16 v[32:35], v[152:155], v[196:199], v[32:35]
    ds_read_b64_tr_b16 v[138:139], v226 offset:1792
    ds_read_b64_tr_b16 v[140:141], v227 offset:768
    v_mfma_f32_16x16x32_bf16 v[44:47], v[156:159], v[196:199], v[44:47]
    ds_read_b64_tr_b16 v[142:143], v227 offset:1792
    s_mov_b32 s23, 6144
    s_mov_b64 exec, 0xffff
    buffer_load_dword v247, v246, s[96:99], s23 offen
    s_mov_b64 exec, -1
    v_mfma_f32_16x16x32_bf16 v[40:43], v[156:159], v[192:195], v[40:43]
    v_mfma_f32_16x16x32_bf16 v[36:39], v[156:159], v[188:191], v[36:39]
    v_mfma_f32_16x16x32_bf16 v[48:51], v[160:163], v[188:191], v[48:51]
    v_mfma_f32_16x16x32_bf16 v[52:55], v[160:163], v[192:195], v[52:55]
    v_mfma_f32_16x16x32_bf16 v[56:59], v[160:163], v[196:199], v[56:59]
    v_mfma_f32_16x16x32_bf16 v[68:71], v[164:167], v[196:199], v[68:71]
    v_mfma_f32_16x16x32_bf16 v[64:67], v[164:167], v[192:195], v[64:67]
    v_mfma_f32_16x16x32_bf16 v[60:63], v[164:167], v[188:191], v[60:63]
    v_mfma_f32_16x16x32_bf16 v[72:75], v[168:171], v[188:191], v[72:75]
    v_mfma_f32_16x16x32_bf16 v[76:79], v[168:171], v[192:195], v[76:79]
    s_waitcnt vmcnt(8) lgkmcnt(0)
    s_barrier
    v_mfma_f32_16x16x32_bf16 v[80:83], v[168:171], v[196:199], v[80:83]
    v_mfma_f32_16x16x32_bf16 v[92:95], v[172:175], v[196:199], v[92:95]
    v_mfma_f32_16x16x32_bf16 v[88:91], v[172:175], v[192:195], v[88:91]
    v_mfma_f32_16x16x32_bf16 v[84:87], v[172:175], v[188:191], v[84:87]
    v_mfma_f32_16x16x32_bf16 v[0:3], v[112:115], v[176:179], v[0:3]
    ds_read_b128 v[188:191], v224 offset:512
    ds_read_b128 v[192:195], v224 offset:2560
    v_mfma_f32_16x16x32_bf16 v[4:7], v[112:115], v[180:183], v[4:7]
    ds_read_b128 v[196:199], v224 offset:4608
    ds_read_b64_tr_b16 v[144:145], v226 offset:16384
    s_add_u32 m0, s33, 65536
    s_add_u32 s21, s70, 7
    s_and_b32 s21, s21, 7
    s_xor_b32 s21, s21, s69
    s_lshl_b32 s21, s21, 19
    s_add_u32 s21, s21, 262144
    buffer_load_dwordx4 v231, s[8:11], s21 offen lds
    v_mfma_f32_16x16x32_bf16 v[8:11], v[112:115], v[184:187], v[8:11]
    ds_read_b64_tr_b16 v[146:147], v226 offset:17408
    ds_read_b64_tr_b16 v[148:149], v227 offset:16384
    v_mfma_f32_16x16x32_bf16 v[20:23], v[116:119], v[184:187], v[20:23]
    ds_read_b64_tr_b16 v[150:151], v227 offset:17408
    ds_read_b64_tr_b16 v[152:153], v226 offset:16640
    s_add_u32 m0, s33, 66560
    s_add_u32 s21, s21, 32768
    buffer_load_dwordx4 v231, s[8:11], s21 offen lds
    v_mfma_f32_16x16x32_bf16 v[16:19], v[116:119], v[180:183], v[16:19]
    ds_read_b64_tr_b16 v[154:155], v226 offset:17664
    ds_read_b64_tr_b16 v[156:157], v227 offset:16640
    v_mfma_f32_16x16x32_bf16 v[12:15], v[116:119], v[176:179], v[12:15]
    ds_read_b64_tr_b16 v[158:159], v227 offset:17664
    ds_read_b64_tr_b16 v[160:161], v226 offset:16896
    s_mov_b32 m0, s26
    s_nop 0
    buffer_load_dwordx4 v255, s[12:15], s24 offen nt lds
    v_mfma_f32_16x16x32_bf16 v[24:27], v[120:123], v[176:179], v[24:27]
    ds_read_b64_tr_b16 v[162:163], v226 offset:17920
    ds_read_b64_tr_b16 v[164:165], v227 offset:16896
    v_mfma_f32_16x16x32_bf16 v[28:31], v[120:123], v[180:183], v[28:31]
    ds_read_b64_tr_b16 v[166:167], v227 offset:17920
    ds_read_b64_tr_b16 v[168:169], v226 offset:17152
    s_mov_b32 m0, s26
    s_nop 0
    buffer_load_dwordx4 v255, s[12:15], s24 offen offset:1024 nt lds
    v_mfma_f32_16x16x32_bf16 v[32:35], v[120:123], v[184:187], v[32:35]
    ds_read_b64_tr_b16 v[170:171], v226 offset:18176
    ds_read_b64_tr_b16 v[172:173], v227 offset:17152
    v_mfma_f32_16x16x32_bf16 v[44:47], v[124:127], v[184:187], v[44:47]
    ds_read_b64_tr_b16 v[174:175], v227 offset:18176
    s_add_u32 m0, s26, 4096
    s_add_u32 s24, s24, 4096
    buffer_load_dwordx4 v255, s[12:15], s24 offen nt lds
    v_mfma_f32_16x16x32_bf16 v[40:43], v[124:127], v[180:183], v[40:43]
    v_mfma_f32_16x16x32_bf16 v[36:39], v[124:127], v[176:179], v[36:39]
    s_add_u32 m0, s26, 4096
    s_nop 0
    buffer_load_dwordx4 v255, s[12:15], s24 offen offset:1024 nt lds
    s_add_u32 s24, s24, 4096
    s_and_b32 s24, s24, 0x1ffff
    s_add_u32 s26, s26, 16384
    s_cmp_ge_u32 s26, s38
    s_cselect_b32 s26, s73, s26
    v_mfma_f32_16x16x32_bf16 v[48:51], v[128:131], v[176:179], v[48:51]
    v_mfma_f32_16x16x32_bf16 v[52:55], v[128:131], v[180:183], v[52:55]
    v_mfma_f32_16x16x32_bf16 v[56:59], v[128:131], v[184:187], v[56:59]
    v_mfma_f32_16x16x32_bf16 v[68:71], v[132:135], v[184:187], v[68:71]
    v_mfma_f32_16x16x32_bf16 v[64:67], v[132:135], v[180:183], v[64:67]
    v_mfma_f32_16x16x32_bf16 v[60:63], v[132:135], v[176:179], v[60:63]
    v_mfma_f32_16x16x32_bf16 v[72:75], v[136:139], v[176:179], v[72:75]
    v_mfma_f32_16x16x32_bf16 v[76:79], v[136:139], v[180:183], v[76:79]
    s_waitcnt vmcnt(7) lgkmcnt(0)
    s_barrier
    v_mfma_f32_16x16x32_bf16 v[80:83], v[136:139], v[184:187], v[80:83]
    v_mfma_f32_16x16x32_bf16 v[92:95], v[140:143], v[184:187], v[92:95]
    v_mfma_f32_16x16x32_bf16 v[88:91], v[140:143], v[180:183], v[88:91]
    v_mfma_f32_16x16x32_bf16 v[84:87], v[140:143], v[176:179], v[84:87]
    v_mfma_f32_16x16x32_bf16 v[0:3], v[144:147], v[188:191], v[0:3]
    ds_read_b128 v[176:179], v224 offset:32768
    ds_read_b128 v[180:183], v224 offset:34816
    v_mfma_f32_16x16x32_bf16 v[4:7], v[144:147], v[192:195], v[4:7]
    ds_read_b128 v[184:187], v224 offset:36864
    ds_read_b64_tr_b16 v[112:113], v226 offset:32768
    s_mov_b32 m0, s39
    s_nop 0
    buffer_load_dwordx4 v251, s[16:19], s25 offen nt lds
    v_mfma_f32_16x16x32_bf16 v[8:11], v[144:147], v[196:199], v[8:11]
    ds_read_b64_tr_b16 v[114:115], v226 offset:33792
    ds_read_b64_tr_b16 v[116:117], v227 offset:32768
    v_mfma_f32_16x16x32_bf16 v[20:23], v[148:151], v[196:199], v[20:23]
    ds_read_b64_tr_b16 v[118:119], v227 offset:33792
    ds_read_b64_tr_b16 v[120:121], v226 offset:33024
    s_mov_b32 m0, s39
    s_nop 0
    buffer_load_dwordx4 v251, s[16:19], s25 offen offset:2048 nt lds
    v_mfma_f32_16x16x32_bf16 v[16:19], v[148:151], v[192:195], v[16:19]
    ds_read_b64_tr_b16 v[122:123], v226 offset:34048
    ds_read_b64_tr_b16 v[124:125], v227 offset:33024
    v_mfma_f32_16x16x32_bf16 v[12:15], v[148:151], v[188:191], v[12:15]
    ds_read_b64_tr_b16 v[126:127], v227 offset:34048
    ds_read_b64_tr_b16 v[128:129], v226 offset:33280
    s_add_u32 m0, s39, 4096
    s_add_u32 s25, s25, 4096
    buffer_load_dwordx4 v251, s[16:19], s25 offen nt lds
    v_mfma_f32_16x16x32_bf16 v[24:27], v[152:155], v[188:191], v[24:27]
    ds_read_b64_tr_b16 v[130:131], v226 offset:34304
    ds_read_b64_tr_b16 v[132:133], v227 offset:33280
    v_mfma_f32_16x16x32_bf16 v[28:31], v[152:155], v[192:195], v[28:31]
    ds_read_b64_tr_b16 v[134:135], v227 offset:34304
    ds_read_b64_tr_b16 v[136:137], v226 offset:33536
    s_add_u32 m0, s39, 4096
    s_nop 0
    buffer_load_dwordx4 v251, s[16:19], s25 offen offset:2048 nt lds
    s_add_u32 s25, s25, 4096
    s_and_b32 s25, s25, 0x1ffff
    s_add_u32 s39, s39, 16384
    s_cmp_ge_u32 s39, s68
    s_cselect_b32 s39, s74, s39
    v_mfma_f32_16x16x32_bf16 v[32:35], v[152:155], v[196:199], v[32:35]
    ds_read_b64_tr_b16 v[138:139], v226 offset:34560
    ds_read_b64_tr_b16 v[140:141], v227 offset:33536
    v_mfma_f32_16x16x32_bf16 v[44:47], v[156:159], v[196:199], v[44:47]
    ds_read_b64_tr_b16 v[142:143], v227 offset:34560
    v_mfma_f32_16x16x32_bf16 v[40:43], v[156:159], v[192:195], v[40:43]
    v_mfma_f32_16x16x32_bf16 v[36:39], v[156:159], v[188:191], v[36:39]
    v_mfma_f32_16x16x32_bf16 v[48:51], v[160:163], v[188:191], v[48:51]
    v_mfma_f32_16x16x32_bf16 v[52:55], v[160:163], v[192:195], v[52:55]
    v_mfma_f32_16x16x32_bf16 v[56:59], v[160:163], v[196:199], v[56:59]
    v_mfma_f32_16x16x32_bf16 v[68:71], v[164:167], v[196:199], v[68:71]
    v_mfma_f32_16x16x32_bf16 v[64:67], v[164:167], v[192:195], v[64:67]
    v_mfma_f32_16x16x32_bf16 v[60:63], v[164:167], v[188:191], v[60:63]
    v_mfma_f32_16x16x32_bf16 v[72:75], v[168:171], v[188:191], v[72:75]
    v_mfma_f32_16x16x32_bf16 v[76:79], v[168:171], v[192:195], v[76:79]
    s_waitcnt vmcnt(8) lgkmcnt(0)
    s_barrier
    v_mfma_f32_16x16x32_bf16 v[80:83], v[168:171], v[196:199], v[80:83]
    v_mfma_f32_16x16x32_bf16 v[92:95], v[172:175], v[196:199], v[92:95]
    v_mfma_f32_16x16x32_bf16 v[88:91], v[172:175], v[192:195], v[88:91]
    v_mfma_f32_16x16x32_bf16 v[84:87], v[172:175], v[188:191], v[84:87]
    v_mfma_f32_16x16x32_bf16 v[0:3], v[112:115], v[176:179], v[0:3]
    ds_read_b128 v[188:191], v224 offset:33280
    ds_read_b128 v[192:195], v224 offset:35328
    v_mfma_f32_16x16x32_bf16 v[4:7], v[112:115], v[180:183], v[4:7]
    ds_read_b128 v[196:199], v224 offset:37376
    ds_read_b64_tr_b16 v[144:145], v226 offset:49152
    s_mov_b32 m0, s26
    s_nop 0
    buffer_load_dwordx4 v255, s[12:15], s24 offen nt lds
    v_mfma_f32_16x16x32_bf16 v[8:11], v[112:115], v[184:187], v[8:11]
    ds_read_b64_tr_b16 v[146:147], v226 offset:50176
    ds_read_b64_tr_b16 v[148:149], v227 offset:49152
    v_mfma_f32_16x16x32_bf16 v[20:23], v[116:119], v[184:187], v[20:23]
    ds_read_b64_tr_b16 v[150:151], v227 offset:50176
    ds_read_b64_tr_b16 v[152:153], v226 offset:49408
    s_mov_b32 m0, s26
    s_nop 0
    buffer_load_dwordx4 v255, s[12:15], s24 offen offset:1024 nt lds
    v_mfma_f32_16x16x32_bf16 v[16:19], v[116:119], v[180:183], v[16:19]
    ds_read_b64_tr_b16 v[154:155], v226 offset:50432
    ds_read_b64_tr_b16 v[156:157], v227 offset:49408
    v_mfma_f32_16x16x32_bf16 v[12:15], v[116:119], v[176:179], v[12:15]
    ds_read_b64_tr_b16 v[158:159], v227 offset:50432
    ds_read_b64_tr_b16 v[160:161], v226 offset:49664
    s_add_u32 m0, s26, 4096
    s_add_u32 s24, s24, 4096
    buffer_load_dwordx4 v255, s[12:15], s24 offen nt lds
    v_mfma_f32_16x16x32_bf16 v[24:27], v[120:123], v[176:179], v[24:27]
    ds_read_b64_tr_b16 v[162:163], v226 offset:50688
    ds_read_b64_tr_b16 v[164:165], v227 offset:49664
    v_mfma_f32_16x16x32_bf16 v[28:31], v[120:123], v[180:183], v[28:31]
    ds_read_b64_tr_b16 v[166:167], v227 offset:50688
    ds_read_b64_tr_b16 v[168:169], v226 offset:49920
    s_add_u32 m0, s26, 4096
    s_nop 0
    buffer_load_dwordx4 v255, s[12:15], s24 offen offset:1024 nt lds
    s_add_u32 s24, s24, 4096
    s_and_b32 s24, s24, 0x1ffff
    s_add_u32 s26, s26, 16384
    s_cmp_ge_u32 s26, s38
    s_cselect_b32 s26, s73, s26
    v_mfma_f32_16x16x32_bf16 v[32:35], v[120:123], v[184:187], v[32:35]
    ds_read_b64_tr_b16 v[170:171], v226 offset:50944
    ds_read_b64_tr_b16 v[172:173], v227 offset:49920
    v_mfma_f32_16x16x32_bf16 v[44:47], v[124:127], v[184:187], v[44:47]
    ds_read_b64_tr_b16 v[174:175], v227 offset:50944
    v_mfma_f32_16x16x32_bf16 v[40:43], v[124:127], v[180:183], v[40:43]
    v_mfma_f32_16x16x32_bf16 v[36:39], v[124:127], v[176:179], v[36:39]
    v_mfma_f32_16x16x32_bf16 v[48:51], v[128:131], v[176:179], v[48:51]
    v_mfma_f32_16x16x32_bf16 v[52:55], v[128:131], v[180:183], v[52:55]
    v_mfma_f32_16x16x32_bf16 v[56:59], v[128:131], v[184:187], v[56:59]
    v_mfma_f32_16x16x32_bf16 v[68:71], v[132:135], v[184:187], v[68:71]
    v_mfma_f32_16x16x32_bf16 v[64:67], v[132:135], v[180:183], v[64:67]
    v_mfma_f32_16x16x32_bf16 v[60:63], v[132:135], v[176:179], v[60:63]
    v_mfma_f32_16x16x32_bf16 v[72:75], v[136:139], v[176:179], v[72:75]
    v_mfma_f32_16x16x32_bf16 v[76:79], v[136:139], v[180:183], v[76:79]
    s_waitcnt lgkmcnt(0)
    s_barrier
    v_mfma_f32_16x16x32_bf16 v[80:83], v[136:139], v[184:187], v[80:83]
    v_mfma_f32_16x16x32_bf16 v[92:95], v[140:143], v[184:187], v[92:95]
    v_mfma_f32_16x16x32_bf16 v[88:91], v[140:143], v[180:183], v[88:91]
    v_mfma_f32_16x16x32_bf16 v[84:87], v[140:143], v[176:179], v[84:87]
    s_mov_b32 s79, 0
    s_cmp_lg_u32 s36, 0
    s_cbranch_scc1 L_hchk_Y
L_getn_Y:
    buffer_load_dword v237, v236, s[44:47], s71 offen sc1
    s_add_u32 s79, s79, 1
    s_waitcnt vmcnt(0)
    v_readfirstlane_b32 s36, v237
    s_cmp_ge_u32 s79, 0x40000
    s_cbranch_scc1 L_gotn_Y
    s_cmp_eq_u32 s36, 0
    s_cbranch_scc1 L_getn_Y
L_gotn_Y:
    v_or_b32 v237, s61, v237
    s_mov_b64 exec, 1
    buffer_store_dwordx2 v[236:237], v236, s[40:43], s72 offen sc1
    s_mov_b64 exec, -1
L_hld_Y:
    buffer_load_dword v238, v239, s[40:43], s60 offen offset:4 sc1
    s_add_u32 s79, s79, 1
    s_waitcnt vmcnt(0)
L_hchk_Y:
    v_xor_b32 v238, v237, v238
    v_cmp_lt_u32 vcc, 15, v238
    s_cmp_ge_u32 s79, 0x40000
    s_cbranch_scc1 L_hok_Y
    s_cbranch_vccnz L_hld_Y
L_hok_Y:
    v_cmp_ne_u32 vcc, 0, v238
    s_nop 0
    s_cmp_eq_u64 vcc, 0
    s_cselect_b32 s61, 1, 0
    s_cselect_b32 s78, 0, 16777216
    s_mov_b32 s4, s48
    s_mov_b32 s5, s49
    s_mov_b32 s6, 916736
    s_mov_b32 s27, 15
    s_mov_b32 s29, 0
    s_mov_b32 s37, 16384
    s_add_u32 s29, s29, 1
    s_cmp_lt_u32 s29, 5
    s_cselect_b32 s28, s37, 4294901760
    s_cselect_b32 s29, s29, 0
    v_mov_b32 v248, 0
    v_mov_b32 v249, 0
    v_mov_b32 v250, 0
    v_mfma_f32_16x16x32_bf16 v[0:3], v[144:147], v[188:191], v[0:3]
    ds_read_b128 v[176:179], v252 offset:0
    v_mfma_f32_16x16x32_bf16 v[4:7], v[144:147], v[192:195], v[4:7]
    ds_read_b128 v[180:183], v252 offset:4096
    v_mfma_f32_16x16x32_bf16 v[8:11], v[144:147], v[196:199], v[8:11]
    ds_read_b128 v[184:187], v252 offset:256
    v_mfma_f32_16x16x32_bf16 v[12:15], v[148:151], v[188:191], v[12:15]
    v_mfma_f32_16x16x32_bf16 v[16:19], v[148:151], v[192:195], v[16:19]
    s_mov_b32 m0, s39
    s_nop 0
    buffer_load_dwordx4 v251, s[16:19], s25 offen nt lds
    v_mfma_f32_16x16x32_bf16 v[20:23], v[148:151], v[196:199], v[20:23]
    v_mfma_f32_16x16x32_bf16 v[24:27], v[152:155], v[188:191], v[24:27]
    v_mul_f32 v0, s30, v0
    v_mul_f32 v1, s30, v1
    v_mul_f32 v2, s30, v2
    v_mul_f32 v3, s30, v3
    v_mfma_f32_16x16x32_bf16 v[28:31], v[152:155], v[192:195], v[28:31]
    v_cvt_pk_bf16_f32 v96, v0, v1
    v_cvt_pk_bf16_f32 v97, v2, v3
    v_mul_f32 v12, s30, v12
    v_mul_f32 v13, s30, v13
    v_mfma_f32_16x16x32_bf16 v[32:35], v[152:155], v[196:199], v[32:35]
    v_mul_f32 v14, s30, v14
    v_mul_f32 v15, s30, v15
    v_cvt_pk_bf16_f32 v98, v12, v13
    v_cvt_pk_bf16_f32 v99, v14, v15
    v_mfma_f32_16x16x32_bf16 v[36:39], v[156:159], v[188:191], v[36:39]
    s_mov_b32 m0, s39
    s_nop 0
    buffer_load_dwordx4 v251, s[16:19], s25 offen offset:2048 nt lds
    v_mul_f32 v4, s30, v4
    v_mul_f32 v5, s30, v5
    v_mul_f32 v6, s30, v6
    v_mul_f32 v7, s30, v7
    v_mfma_f32_16x16x32_bf16 v[40:43], v[156:159], v[192:195], v[40:43]
    v_cvt_pk_bf16_f32 v100, v4, v5
    v_cvt_pk_bf16_f32 v101, v6, v7
    v_mul_f32 v16, s30, v16
    v_mul_f32 v17, s30, v17
    v_mfma_f32_16x16x32_bf16 v[44:47], v[156:159], v[196:199], v[44:47]
    v_mul_f32 v18, s30, v18
    v_mul_f32 v19, s30, v19
    v_cvt_pk_bf16_f32 v102, v16, v17
    v_cvt_pk_bf16_f32 v103, v18, v19
    v_mfma_f32_16x16x32_bf16 v[48:51], v[160:163], v[188:191], v[48:51]
    v_mul_f32 v8, s30, v8
    v_mul_f32 v9, s30, v9
    v_mul_f32 v10, s30, v10
    v_mul_f32 v11, s30, v11
    v_mfma_f32_16x16x32_bf16 v[52:55], v[160:163], v[192:195], v[52:55]
    v_cvt_pk_bf16_f32 v104, v8, v9
    v_cvt_pk_bf16_f32 v105, v10, v11
    v_mul_f32 v20, s30, v20
    v_mul_f32 v21, s30, v21
    v_mfma_f32_16x16x32_bf16 v[56:59], v[160:163], v[196:199], v[56:59]
    s_add_u32 m0, s39, 4096
    s_add_u32 s25, s25, 4096
    buffer_load_dwordx4 v251, s[16:19], s25 offen nt lds
    v_mul_f32 v22, s30, v22
    v_mul_f32 v23, s30, v23
    v_cvt_pk_bf16_f32 v106, v20, v21
    v_cvt_pk_bf16_f32 v107, v22, v23
    v_mfma_f32_16x16x32_bf16 v[60:63], v[164:167], v[188:191], v[60:63]
    v_permlane16_swap_b32 v96, v98
    v_permlane16_swap_b32 v97, v99
    v_permlane16_swap_b32 v100, v102
    v_permlane16_swap_b32 v101, v103
    v_mfma_f32_16x16x32_bf16 v[64:67], v[164:167], v[192:195], v[64:67]
    v_permlane16_swap_b32 v104, v106
    v_permlane16_swap_b32 v105, v107
    v_mul_f32 v24, s30, v24
    v_mul_f32 v25, s30, v25
    v_mfma_f32_16x16x32_bf16 v[68:71], v[164:167], v[196:199], v[68:71]
    v_mul_f32 v26, s30, v26
    v_mul_f32 v27, s30, v27
    v_cvt_pk_bf16_f32 v108, v24, v25
    v_cvt_pk_bf16_f32 v109, v26, v27
    v_mfma_f32_16x16x32_bf16 v[72:75], v[168:171], v[188:191], v[72:75]
    v_mul_f32 v36, s30, v36
    v_mul_f32 v37, s30, v37
    v_mul_f32 v38, s30, v38
    v_mul_f32 v39, s30, v39
    v_mfma_f32_16x16x32_bf16 v[76:79], v[168:171], v[192:195], v[76:79]
    s_add_u32 m0, s39, 4096
    s_nop 0
    buffer_load_dwordx4 v251, s[16:19], s25 offen offset:2048 nt lds
    s_add_u32 s25, s25, 4096
    s_and_b32 s25, s25, 0x1ffff
    s_add_u32 s39, s39, 16384
    s_cmp_ge_u32 s39, s68
    s_cselect_b32 s39, s74, s39
    v_cvt_pk_bf16_f32 v110, v36, v37
    v_cvt_pk_bf16_f32 v111, v38, v39
    v_mul_f32 v28, s30, v28
    v_mul_f32 v29, s30, v29
    v_mfma_f32_16x16x32_bf16 v[80:83], v[168:171], v[196:199], v[80:83]
    v_mul_f32 v30, s30, v30
    v_mul_f32 v31, s30, v31
    v_cvt_pk_bf16_f32 v112, v28, v29
    v_cvt_pk_bf16_f32 v113, v30, v31
    v_mfma_f32_16x16x32_bf16 v[84:87], v[172:175], v[188:191], v[84:87]
    v_mul_f32 v40, s30, v40
    v_mul_f32 v41, s30, v41
    v_mul_f32 v42, s30, v42
    v_mul_f32 v43, s30, v43
    v_mfma_f32_16x16x32_bf16 v[88:91], v[172:175], v[192:195], v[88:91]
    v_cvt_pk_bf16_f32 v114, v40, v41
    v_cvt_pk_bf16_f32 v115, v42, v43
    v_mul_f32 v32, s30, v32
    v_mul_f32 v33, s30, v33
    v_mfma_f32_16x16x32_bf16 v[92:95], v[172:175], v[196:199], v[92:95]
    ds_read_b128 v[188:191], v252 offset:4352
    ds_read_b128 v[192:195], v252 offset:512
    v_mul_f32 v34, s30, v34
    v_mul_f32 v35, s30, v35
    v_cvt_pk_bf16_f32 v116, v32, v33
    v_cvt_pk_bf16_f32 v117, v34, v35
    s_waitcnt lgkmcnt(4)
    v_mfma_f32_16x16x32_bf16 v[144:147], v[176:179], v[96:99], 0
    s_mov_b32 m0, s26
    s_nop 0
    buffer_load_dwordx4 v255, s[12:15], s24 offen nt lds
    ds_read_b128 v[196:199], v252 offset:4608
    v_mul_f32 v44, s30, v44
    v_mul_f32 v45, s30, v45
    v_mul_f32 v46, s30, v46
    v_mul_f32 v47, s30, v47
    v_mfma_f32_16x16x32_bf16 v[152:155], v[176:179], v[100:103], 0
    v_cvt_pk_bf16_f32 v118, v44, v45
    v_cvt_pk_bf16_f32 v119, v46, v47
    v_permlane16_swap_b32 v108, v110
    v_permlane16_swap_b32 v109, v111
    v_mfma_f32_16x16x32_bf16 v[160:163], v[176:179], v[104:107], 0
    v_permlane16_swap_b32 v112, v114
    v_permlane16_swap_b32 v113, v115
    v_permlane16_swap_b32 v116, v118
    v_permlane16_swap_b32 v117, v119
    s_waitcnt lgkmcnt(4)
    v_mfma_f32_16x16x32_bf16 v[148:151], v[180:183], v[96:99], 0
    ds_read_b128 v[168:171], v252 offset:768
    v_mul_f32 v48, s30, v48
    v_mul_f32 v49, s30, v49
    v_mul_f32 v50, s30, v50
    v_mul_f32 v51, s30, v51
    v_mfma_f32_16x16x32_bf16 v[156:159], v[180:183], v[100:103], 0
    v_cvt_pk_bf16_f32 v120, v48, v49
    v_cvt_pk_bf16_f32 v121, v50, v51
    v_mul_f32 v60, s30, v60
    v_mul_f32 v61, s30, v61
    v_mfma_f32_16x16x32_bf16 v[164:167], v[180:183], v[104:107], 0
    s_mov_b32 m0, s26
    s_nop 0
    buffer_load_dwordx4 v255, s[12:15], s24 offen offset:1024 nt lds
    v_mul_f32 v62, s30, v62
    v_mul_f32 v63, s30, v63
    v_cvt_pk_bf16_f32 v122, v60, v61
    v_cvt_pk_bf16_f32 v123, v62, v63
    s_waitcnt lgkmcnt(4)
    v_mfma_f32_16x16x32_bf16 v[144:147], v[184:187], v[108:111], v[144:147]
    ds_read_b128 v[172:175], v252 offset:4864
    v_add_u32 v252, s28, v252
    v_mul_f32 v52, s30, v52
    v_mul_f32 v53, s30, v53
    v_mul_f32 v54, s30, v54
    v_mul_f32 v55, s30, v55
    v_mfma_f32_16x16x32_bf16 v[152:155], v[184:187], v[112:115], v[152:155]
    v_cvt_pk_bf16_f32 v124, v52, v53
    v_cvt_pk_bf16_f32 v125, v54, v55
    v_mul_f32 v64, s30, v64
    v_mul_f32 v65, s30, v65
    v_mfma_f32_16x16x32_bf16 v[160:163], v[184:187], v[116:119], v[160:163]
    v_mul_f32 v66, s30, v66
    v_mul_f32 v67, s30, v67
    v_cvt_pk_bf16_f32 v126, v64, v65
    v_cvt_pk_bf16_f32 v127, v66, v67
    s_waitcnt lgkmcnt(4)
    v_mfma_f32_16x16x32_bf16 v[148:151], v[188:191], v[108:111], v[148:151]
    v_mul_f32 v56, s30, v56
    v_mul_f32 v57, s30, v57
    v_mul_f32 v58, s30, v58
    v_mul_f32 v59, s30, v59
    v_mfma_f32_16x16x32_bf16 v[156:159], v[188:191], v[112:115], v[156:159]
    s_add_u32 m0, s26, 4096
    s_add_u32 s24, s24, 4096
    buffer_load_dwordx4 v255, s[12:15], s24 offen nt lds
    v_cvt_pk_bf16_f32 v128, v56, v57
    v_cvt_pk_bf16_f32 v129, v58, v59
    v_mul_f32 v68, s30, v68
    v_mul_f32 v69, s30, v69
    v_mfma_f32_16x16x32_bf16 v[164:167], v[188:191], v[116:119], v[164:167]
    v_mul_f32 v70, s30, v70
    v_mul_f32 v71, s30, v71
    v_cvt_pk_bf16_f32 v130, v68, v69
    v_cvt_pk_bf16_f32 v131, v70, v71
    v_permlane16_swap_b32 v120, v122
    v_permlane16_swap_b32 v121, v123
    v_permlane16_swap_b32 v124, v126
    v_permlane16_swap_b32 v125, v127
    v_permlane16_swap_b32 v128, v130
    v_permlane16_swap_b32 v129, v131
    s_waitcnt lgkmcnt(3)
    v_mfma_f32_16x16x32_bf16 v[144:147], v[192:195], v[120:123], v[144:147]
    v_mul_f32 v72, s30, v72
    v_mul_f32 v73, s30, v73
    v_mul_f32 v74, s30, v74
    v_mul_f32 v75, s30, v75
    v_mfma_f32_16x16x32_bf16 v[152:155], v[192:195], v[124:127], v[152:155]
    v_cvt_pk_bf16_f32 v132, v72, v73
    v_cvt_pk_bf16_f32 v133, v74, v75
    v_mul_f32 v84, s30, v84
    v_mul_f32 v85, s30, v85
    v_mfma_f32_16x16x32_bf16 v[160:163], v[192:195], v[128:131], v[160:163]
    v_mul_f32 v86, s30, v86
    v_mul_f32 v87, s30, v87
    v_cvt_pk_bf16_f32 v134, v84, v85
    v_cvt_pk_bf16_f32 v135, v86, v87
    s_waitcnt lgkmcnt(2)
    v_mfma_f32_16x16x32_bf16 v[148:151], v[196:199], v[120:123], v[148:151]
    s_add_u32 m0, s26, 4096
    s_nop 0
    buffer_load_dwordx4 v255, s[12:15], s24 offen offset:1024 nt lds
    s_add_u32 s24, s24, 4096
    s_and_b32 s24, s24, 0x1ffff
    s_add_u32 s26, s26, 16384
    s_cmp_ge_u32 s26, s38
    s_cselect_b32 s26, s73, s26
    v_mul_f32 v76, s30, v76
    v_mul_f32 v77, s30, v77
    v_mul_f32 v78, s30, v78
    v_mul_f32 v79, s30, v79
    v_mfma_f32_16x16x32_bf16 v[156:159], v[196:199], v[124:127], v[156:159]
    v_cvt_pk_bf16_f32 v136, v76, v77
    v_cvt_pk_bf16_f32 v137, v78, v79
    v_mul_f32 v88, s30, v88
    v_mul_f32 v89, s30, v89
    v_mfma_f32_16x16x32_bf16 v[164:167], v[196:199], v[128:131], v[164:167]
    v_mul_f32 v90, s30, v90
    v_mul_f32 v91, s30, v91
    v_cvt_pk_bf16_f32 v138, v88, v89
    v_cvt_pk_bf16_f32 v139, v90, v91
    v_mul_f32 v80, s30, v80
    v_mul_f32 v81, s30, v81
    v_mul_f32 v82, s30, v82
    v_mul_f32 v83, s30, v83
    v_cvt_pk_bf16_f32 v140, v80, v81
    v_cvt_pk_bf16_f32 v141, v82, v83
    v_mul_f32 v92, s30, v92
    v_mul_f32 v93, s30, v93
    v_mul_f32 v94, s30, v94
    v_mul_f32 v95, s30, v95
    v_cvt_pk_bf16_f32 v142, v92, v93
    v_cvt_pk_bf16_f32 v143, v94, v95
    v_permlane16_swap_b32 v132, v134
    v_permlane16_swap_b32 v133, v135
    v_permlane16_swap_b32 v136, v138
    v_permlane16_swap_b32 v137, v139
    v_permlane16_swap_b32 v140, v142
    v_permlane16_swap_b32 v141, v143
    s_waitcnt lgkmcnt(1)
    v_mfma_f32_16x16x32_bf16 v[144:147], v[168:171], v[132:135], v[144:147]
    v_mfma_f32_16x16x32_bf16 v[152:155], v[168:171], v[136:139], v[152:155]
    v_mfma_f32_16x16x32_bf16 v[160:163], v[168:171], v[140:143], v[160:163]
    s_waitcnt lgkmcnt(0)
    v_mfma_f32_16x16x32_bf16 v[148:151], v[172:175], v[132:135], v[148:151]
    v_mfma_f32_16x16x32_bf16 v[156:159], v[172:175], v[136:139], v[156:159]
    v_mfma_f32_16x16x32_bf16 v[164:167], v[172:175], v[140:143], v[164:167]
    s_nop 1
    v_exp_f32 v144, v144
    v_exp_f32 v145, v145
    v_exp_f32 v146, v146
    v_exp_f32 v147, v147
    v_add_f32 v248, v248, v144
    v_add_f32 v248, v248, v145
    v_add_f32 v248, v248, v146
    v_add_f32 v248, v248, v147
    s_mov_b32 m0, s39
    s_nop 0
    buffer_load_dwordx4 v251, s[16:19], s25 offen nt lds
    v_cvt_pk_bf16_f32 v144, v144, v145
    v_cvt_pk_bf16_f32 v145, v146, v147
    v_exp_f32 v152, v152
    v_exp_f32 v153, v153
    v_exp_f32 v154, v154
    v_exp_f32 v155, v155
    v_add_f32 v249, v249, v152
    v_add_f32 v249, v249, v153
    s_mov_b32 m0, s39
    s_nop 0
    buffer_load_dwordx4 v251, s[16:19], s25 offen offset:2048 nt lds
    v_add_f32 v249, v249, v154
    v_add_f32 v249, v249, v155
    v_cvt_pk_bf16_f32 v152, v152, v153
    v_cvt_pk_bf16_f32 v153, v154, v155
    v_exp_f32 v160, v160
    v_exp_f32 v161, v161
    v_exp_f32 v162, v162
    v_exp_f32 v163, v163
    s_add_u32 m0, s39, 4096
    s_add_u32 s25, s25, 4096
    buffer_load_dwordx4 v251, s[16:19], s25 offen nt lds
    v_add_f32 v250, v250, v160
    v_add_f32 v250, v250, v161
    v_add_f32 v250, v250, v162
    v_add_f32 v250, v250, v163
    v_cvt_pk_bf16_f32 v160, v160, v161
    v_cvt_pk_bf16_f32 v161, v162, v163
    v_exp_f32 v148, v148
    v_exp_f32 v149, v149
    v_exp_f32 v150, v150
    s_add_u32 m0, s39, 4096
    s_nop 0
    buffer_load_dwordx4 v251, s[16:19], s25 offen offset:2048 nt lds
    s_add_u32 s25, s25, 4096
    s_and_b32 s25, s25, 0x1ffff
    s_add_u32 s39, s39, 16384
    s_cmp_ge_u32 s39, s68
    s_cselect_b32 s39, s74, s39
    v_exp_f32 v151, v151
    v_add_f32 v248, v248, v148
    v_add_f32 v248, v248, v149
    v_add_f32 v248, v248, v150
    v_add_f32 v248, v248, v151
    v_cvt_pk_bf16_f32 v146, v148, v149
    v_cvt_pk_bf16_f32 v147, v150, v151
    v_exp_f32 v156, v156
    v_exp_f32 v157, v157
    s_mov_b32 m0, s26
    s_nop 0
    buffer_load_dwordx4 v255, s[12:15], s24 offen nt lds
    v_exp_f32 v158, v158
    v_exp_f32 v159, v159
    v_add_f32 v249, v249, v156
    v_add_f32 v249, v249, v157
    v_add_f32 v249, v249, v158
    v_add_f32 v249, v249, v159
    v_cvt_pk_bf16_f32 v154, v156, v157
    v_cvt_pk_bf16_f32 v155, v158, v159
    v_exp_f32 v164, v164
    s_mov_b32 m0, s26
    s_nop 0
    buffer_load_dwordx4 v255, s[12:15], s24 offen offset:1024 nt lds
    v_exp_f32 v165, v165
    v_exp_f32 v166, v166
    v_exp_f32 v167, v167
    v_add_f32 v250, v250, v164
    v_add_f32 v250, v250, v165
    v_add_f32 v250, v250, v166
    v_add_f32 v250, v250, v167
    v_cvt_pk_bf16_f32 v162, v164, v165
    v_cvt_pk_bf16_f32 v163, v166, v167
    s_add_u32 m0, s26, 4096
    s_add_u32 s24, s24, 4096
    buffer_load_dwordx4 v255, s[12:15], s24 offen nt lds
    s_waitcnt vmcnt(23)
    s_barrier
    ds_read_b64_tr_b16 v[168:169], v253 offset:0
    ds_read_b64_tr_b16 v[170:171], v253 offset:4096
    ds_read_b64_tr_b16 v[172:173], v254 offset:0
    ds_read_b64_tr_b16 v[174:175], v254 offset:4096
    ds_read_b64_tr_b16 v[176:177], v253 offset:256
    ds_read_b64_tr_b16 v[178:179], v253 offset:4352
    ds_read_b64_tr_b16 v[180:181], v254 offset:256
    ds_read_b64_tr_b16 v[182:183], v254 offset:4352
    ds_read_b64_tr_b16 v[184:185], v253 offset:512
    ds_read_b64_tr_b16 v[186:187], v253 offset:4608
    s_waitcnt lgkmcnt(8)
    v_mfma_f32_16x16x32_bf16 v[0:3], v[168:171], v[144:147], 0
    ds_read_b64_tr_b16 v[188:189], v254 offset:512
    ds_read_b64_tr_b16 v[190:191], v254 offset:4608
    v_mfma_f32_16x16x32_bf16 v[4:7], v[168:171], v[152:155], 0
    v_mfma_f32_16x16x32_bf16 v[8:11], v[168:171], v[160:163], 0
    s_waitcnt lgkmcnt(8)
    v_mfma_f32_16x16x32_bf16 v[20:23], v[172:175], v[160:163], 0
    ds_read_b64_tr_b16 v[192:193], v253 offset:768
    ds_read_b64_tr_b16 v[194:195], v253 offset:4864
    v_mfma_f32_16x16x32_bf16 v[16:19], v[172:175], v[152:155], 0
    v_mfma_f32_16x16x32_bf16 v[12:15], v[172:175], v[144:147], 0
    s_waitcnt lgkmcnt(8)
    v_mfma_f32_16x16x32_bf16 v[24:27], v[176:179], v[144:147], 0
    ds_read_b64_tr_b16 v[196:197], v254 offset:768
    ds_read_b64_tr_b16 v[198:199], v254 offset:4864
    v_add_u32 v253, s28, v253
    v_add_u32 v254, s28, v254
    v_mfma_f32_16x16x32_bf16 v[28:31], v[176:179], v[152:155], 0
    v_mfma_f32_16x16x32_bf16 v[32:35], v[176:179], v[160:163], 0
    s_waitcnt lgkmcnt(8)
    v_mfma_f32_16x16x32_bf16 v[44:47], v[180:183], v[160:163], 0
    ds_read_b128 v[168:171], v252 offset:0
    v_mfma_f32_16x16x32_bf16 v[40:43], v[180:183], v[152:155], 0
    v_mfma_f32_16x16x32_bf16 v[36:39], v[180:183], v[144:147], 0
    s_waitcnt lgkmcnt(7)
    v_mfma_f32_16x16x32_bf16 v[48:51], v[184:187], v[144:147], 0
    ds_read_b128 v[172:175], v252 offset:256
    v_mfma_f32_16x16x32_bf16 v[52:55], v[184:187], v[152:155], 0
    v_mfma_f32_16x16x32_bf16 v[56:59], v[184:187], v[160:163], 0
    s_waitcnt lgkmcnt(6)
    v_mfma_f32_16x16x32_bf16 v[68:71], v[188:191], v[160:163], 0
    ds_read_b128 v[176:179], v252 offset:512
    v_mfma_f32_16x16x32_bf16 v[64:67], v[188:191], v[152:155], 0
    v_mfma_f32_16x16x32_bf16 v[60:63], v[188:191], v[144:147], 0
    s_waitcnt lgkmcnt(5)
    v_mfma_f32_16x16x32_bf16 v[72:75], v[192:195], v[144:147], 0
    ds_read_b128 v[180:183], v252 offset:768
    v_mfma_f32_16x16x32_bf16 v[76:79], v[192:195], v[152:155], 0
    v_mfma_f32_16x16x32_bf16 v[80:83], v[192:195], v[160:163], 0
    s_waitcnt lgkmcnt(4)
    v_mfma_f32_16x16x32_bf16 v[92:95], v[196:199], v[160:163], 0
    ds_read_b128 v[184:187], v252 offset:4096
    v_mfma_f32_16x16x32_bf16 v[88:91], v[196:199], v[152:155], 0
    v_mfma_f32_16x16x32_bf16 v[84:87], v[196:199], v[144:147], 0
    s_add_u32 s29, s29, 1
    s_cmp_lt_u32 s29, 5
    s_cselect_b32 s28, s37, 4294901760
    s_cselect_b32 s29, s29, 0
    s_waitcnt lgkmcnt(4)
    v_mfma_f32_16x16x32_bf16 v[144:147], v[168:171], v[96:99], 0
    ds_read_b128 v[188:191], v252 offset:4352
    s_waitcnt lgkmcnt(4)
    v_mfma_f32_16x16x32_bf16 v[144:147], v[172:175], v[108:111], v[144:147]
    ds_read_b128 v[192:195], v252 offset:4608
    s_waitcnt lgkmcnt(4)
    v_mfma_f32_16x16x32_bf16 v[144:147], v[176:179], v[120:123], v[144:147]
    ds_read_b128 v[196:199], v252 offset:4864
    v_add_u32 v252, s28, v252
    s_waitcnt lgkmcnt(4)
    v_mfma_f32_16x16x32_bf16 v[144:147], v[180:183], v[132:135], v[144:147]
    v_mfma_f32_16x16x32_bf16 v[152:155], v[180:183], v[136:139], 0
    v_mfma_f32_16x16x32_bf16 v[152:155], v[176:179], v[124:127], v[152:155]
    v_mfma_f32_16x16x32_bf16 v[152:155], v[172:175], v[112:115], v[152:155]
    v_mfma_f32_16x16x32_bf16 v[152:155], v[168:171], v[100:103], v[152:155]
    v_mfma_f32_16x16x32_bf16 v[160:163], v[168:171], v[104:107], 0
    v_mfma_f32_16x16x32_bf16 v[160:163], v[172:175], v[116:119], v[160:163]
    v_mfma_f32_16x16x32_bf16 v[160:163], v[176:179], v[128:131], v[160:163]
    v_mfma_f32_16x16x32_bf16 v[160:163], v[180:183], v[140:143], v[160:163]
    s_waitcnt lgkmcnt(3)
    v_mfma_f32_16x16x32_bf16 v[148:151], v[184:187], v[96:99], 0
    s_waitcnt lgkmcnt(2)
    v_mfma_f32_16x16x32_bf16 v[148:151], v[188:191], v[108:111], v[148:151]
    s_waitcnt lgkmcnt(1)
    v_mfma_f32_16x16x32_bf16 v[148:151], v[192:195], v[120:123], v[148:151]
    v_exp_f32 v144, v144
    s_waitcnt lgkmcnt(0)
    v_mfma_f32_16x16x32_bf16 v[148:151], v[196:199], v[132:135], v[148:151]
    v_exp_f32 v145, v145
    v_mfma_f32_16x16x32_bf16 v[156:159], v[196:199], v[136:139], 0
    v_exp_f32 v146, v146
    v_mfma_f32_16x16x32_bf16 v[156:159], v[192:195], v[124:127], v[156:159]
    v_exp_f32 v147, v147
    v_mfma_f32_16x16x32_bf16 v[156:159], v[188:191], v[112:115], v[156:159]
    v_add_f32 v248, v248, v144
    v_add_f32 v248, v248, v145
    v_mfma_f32_16x16x32_bf16 v[156:159], v[184:187], v[100:103], v[156:159]
    v_add_f32 v248, v248, v146
    v_add_f32 v248, v248, v147
    v_mfma_f32_16x16x32_bf16 v[164:167], v[184:187], v[104:107], 0
    v_cvt_pk_bf16_f32 v144, v144, v145
    v_cvt_pk_bf16_f32 v145, v146, v147
    v_mfma_f32_16x16x32_bf16 v[164:167], v[188:191], v[116:119], v[164:167]
    v_exp_f32 v152, v152
    v_mfma_f32_16x16x32_bf16 v[164:167], v[192:195], v[128:131], v[164:167]
    v_exp_f32 v153, v153
    v_mfma_f32_16x16x32_bf16 v[164:167], v[196:199], v[140:143], v[164:167]
    v_exp_f32 v154, v154
    v_exp_f32 v155, v155
    v_add_f32 v249, v249, v152
    v_add_f32 v249, v249, v153
    v_add_f32 v249, v249, v154
    v_add_f32 v249, v249, v155
    v_cvt_pk_bf16_f32 v152, v152, v153
    v_cvt_pk_bf16_f32 v153, v154, v155
    s_add_u32 m0, s26, 4096
    s_nop 0
    buffer_load_dwordx4 v255, s[12:15], s24 offen offset:1024 nt lds
    s_add_u32 s24, s24, 4096
    s_and_b32 s24, s24, 0x1ffff
    s_add_u32 s26, s26, 16384
    s_cmp_ge_u32 s26, s38
    s_cselect_b32 s26, s73, s26
    v_exp_f32 v160, v160
    v_exp_f32 v161, v161
    v_exp_f32 v162, v162
    v_exp_f32 v163, v163
    s_mov_b32 m0, s39
    s_nop 0
    buffer_load_dwordx4 v251, s[16:19], s25 offen nt lds
    v_add_f32 v250, v250, v160
    v_add_f32 v250, v250, v161
    v_add_f32 v250, v250, v162
    v_add_f32 v250, v250, v163
    v_cvt_pk_bf16_f32 v160, v160, v161
    v_cvt_pk_bf16_f32 v161, v162, v163
    v_exp_f32 v148, v148
    s_mov_b32 m0, s39
    s_nop 0
    buffer_load_dwordx4 v251, s[16:19], s25 offen offset:2048 nt lds
    v_exp_f32 v149, v149
    v_exp_f32 v150, v150
    v_exp_f32 v151, v151
    v_add_f32 v248, v248, v148
    v_add_f32 v248, v248, v149
    s_add_u32 m0, s39, 4096
    s_add_u32 s25, s25, 4096
    buffer_load_dwordx4 v251, s[16:19], s25 offen nt lds
    v_add_f32 v248, v248, v150
    v_add_f32 v248, v248, v151
    v_cvt_pk_bf16_f32 v146, v148, v149
    v_cvt_pk_bf16_f32 v147, v150, v151
    v_exp_f32 v156, v156
    v_exp_f32 v157, v157
    s_add_u32 m0, s39, 4096
    s_nop 0
    buffer_load_dwordx4 v251, s[16:19], s25 offen offset:2048 nt lds
    s_add_u32 s25, s25, 4096
    s_and_b32 s25, s25, 0x1ffff
    s_add_u32 s39, s39, 16384
    s_cmp_ge_u32 s39, s68
    s_cselect_b32 s39, s74, s39
    v_exp_f32 v158, v158
    v_exp_f32 v159, v159
    v_add_f32 v249, v249, v156
    v_add_f32 v249, v249, v157
    v_add_f32 v249, v249, v158
    v_add_f32 v249, v249, v159
    s_mov_b32 m0, s26
    s_nop 0
    buffer_load_dwordx4 v255, s[12:15], s24 offen nt lds
    v_cvt_pk_bf16_f32 v154, v156, v157
    v_cvt_pk_bf16_f32 v155, v158, v159
    v_exp_f32 v164, v164
    v_exp_f32 v165, v165
    v_exp_f32 v166, v166
    s_mov_b32 m0, s26
    s_nop 0
    buffer_load_dwordx4 v255, s[12:15], s24 offen offset:1024 nt lds
    v_exp_f32 v167, v167
    v_add_f32 v250, v250, v164
    v_add_f32 v250, v250, v165
    v_add_f32 v250, v250, v166
    v_add_f32 v250, v250, v167
    v_cvt_pk_bf16_f32 v162, v164, v165
    v_cvt_pk_bf16_f32 v163, v166, v167
    s_waitcnt vmcnt(22)
    s_barrier
    ds_read_b64_tr_b16 v[168:169], v253 offset:0
    ds_read_b64_tr_b16 v[170:171], v253 offset:4096
    ds_read_b64_tr_b16 v[172:173], v254 offset:0
    ds_read_b64_tr_b16 v[174:175], v254 offset:4096
    ds_read_b64_tr_b16 v[176:177], v253 offset:256
    ds_read_b64_tr_b16 v[178:179], v253 offset:4352
    ds_read_b64_tr_b16 v[180:181], v254 offset:256
    ds_read_b64_tr_b16 v[182:183], v254 offset:4352
    ds_read_b64_tr_b16 v[184:185], v253 offset:512
    ds_read_b64_tr_b16 v[186:187], v253 offset:4608
    s_waitcnt lgkmcnt(8)
    v_mfma_f32_16x16x32_bf16 v[0:3], v[168:171], v[144:147], v[0:3]
    ds_read_b64_tr_b16 v[188:189], v254 offset:512
    ds_read_b64_tr_b16 v[190:191], v254 offset:4608
    v_mfma_f32_16x16x32_bf16 v[4:7], v[168:171], v[152:155], v[4:7]
    v_mfma_f32_16x16x32_bf16 v[8:11], v[168:171], v[160:163], v[8:11]
    s_waitcnt lgkmcnt(8)
    v_mfma_f32_16x16x32_bf16 v[20:23], v[172:175], v[160:163], v[20:23]
    ds_read_b64_tr_b16 v[192:193], v253 offset:768
    ds_read_b64_tr_b16 v[194:195], v253 offset:4864
    v_mfma_f32_16x16x32_bf16 v[16:19], v[172:175], v[152:155], v[16:19]
    v_mfma_f32_16x16x32_bf16 v[12:15], v[172:175], v[144:147], v[12:15]
    s_waitcnt lgkmcnt(8)
    v_mfma_f32_16x16x32_bf16 v[24:27], v[176:179], v[144:147], v[24:27]
    ds_read_b64_tr_b16 v[196:197], v254 offset:768
    ds_read_b64_tr_b16 v[198:199], v254 offset:4864
    v_add_u32 v253, s28, v253
    v_add_u32 v254, s28, v254
    v_mfma_f32_16x16x32_bf16 v[28:31], v[176:179], v[152:155], v[28:31]
    v_mfma_f32_16x16x32_bf16 v[32:35], v[176:179], v[160:163], v[32:35]
    s_waitcnt lgkmcnt(8)
    v_mfma_f32_16x16x32_bf16 v[44:47], v[180:183], v[160:163], v[44:47]
    ds_read_b128 v[168:171], v252 offset:0
    v_mfma_f32_16x16x32_bf16 v[40:43], v[180:183], v[152:155], v[40:43]
    v_mfma_f32_16x16x32_bf16 v[36:39], v[180:183], v[144:147], v[36:39]
    s_waitcnt lgkmcnt(7)
    v_mfma_f32_16x16x32_bf16 v[48:51], v[184:187], v[144:147], v[48:51]
    ds_read_b128 v[172:175], v252 offset:256
    v_mfma_f32_16x16x32_bf16 v[52:55], v[184:187], v[152:155], v[52:55]
    v_mfma_f32_16x16x32_bf16 v[56:59], v[184:187], v[160:163], v[56:59]
    s_waitcnt lgkmcnt(6)
    v_mfma_f32_16x16x32_bf16 v[68:71], v[188:191], v[160:163], v[68:71]
    ds_read_b128 v[176:179], v252 offset:512
    v_mfma_f32_16x16x32_bf16 v[64:67], v[188:191], v[152:155], v[64:67]
    v_mfma_f32_16x16x32_bf16 v[60:63], v[188:191], v[144:147], v[60:63]
    s_waitcnt lgkmcnt(5)
    v_mfma_f32_16x16x32_bf16 v[72:75], v[192:195], v[144:147], v[72:75]
    ds_read_b128 v[180:183], v252 offset:768
    v_mfma_f32_16x16x32_bf16 v[76:79], v[192:195], v[152:155], v[76:79]
    v_mfma_f32_16x16x32_bf16 v[80:83], v[192:195], v[160:163], v[80:83]
    s_waitcnt lgkmcnt(4)
    v_mfma_f32_16x16x32_bf16 v[92:95], v[196:199], v[160:163], v[92:95]
    ds_read_b128 v[184:187], v252 offset:4096
    v_mfma_f32_16x16x32_bf16 v[88:91], v[196:199], v[152:155], v[88:91]
    v_mfma_f32_16x16x32_bf16 v[84:87], v[196:199], v[144:147], v[84:87]
    s_add_u32 s29, s29, 1
    s_cmp_lt_u32 s29, 5
    s_cselect_b32 s28, s37, 4294901760
    s_cselect_b32 s29, s29, 0
    s_waitcnt lgkmcnt(4)
    v_mfma_f32_16x16x32_bf16 v[144:147], v[168:171], v[96:99], 0
    ds_read_b128 v[188:191], v252 offset:4352
    s_waitcnt lgkmcnt(4)
    v_mfma_f32_16x16x32_bf16 v[144:147], v[172:175], v[108:111], v[144:147]
    ds_read_b128 v[192:195], v252 offset:4608
    s_waitcnt lgkmcnt(4)
    v_mfma_f32_16x16x32_bf16 v[144:147], v[176:179], v[120:123], v[144:147]
    ds_read_b128 v[196:199], v252 offset:4864
    v_add_u32 v252, s28, v252
    s_waitcnt lgkmcnt(4)
    v_mfma_f32_16x16x32_bf16 v[144:147], v[180:183], v[132:135], v[144:147]
    v_mfma_f32_16x16x32_bf16 v[152:155], v[180:183], v[136:139], 0
    v_mfma_f32_16x16x32_bf16 v[152:155], v[176:179], v[124:127], v[152:155]
    v_mfma_f32_16x16x32_bf16 v[152:155], v[172:175], v[112:115], v[152:155]
    v_mfma_f32_16x16x32_bf16 v[152:155], v[168:171], v[100:103], v[152:155]
    v_mfma_f32_16x16x32_bf16 v[160:163], v[168:171], v[104:107], 0
    v_mfma_f32_16x16x32_bf16 v[160:163], v[172:175], v[116:119], v[160:163]
    v_mfma_f32_16x16x32_bf16 v[160:163], v[176:179], v[128:131], v[160:163]
    v_mfma_f32_16x16x32_bf16 v[160:163], v[180:183], v[140:143], v[160:163]
    s_waitcnt lgkmcnt(3)
    v_mfma_f32_16x16x32_bf16 v[148:151], v[184:187], v[96:99], 0
    s_waitcnt lgkmcnt(2)
    v_mfma_f32_16x16x32_bf16 v[148:151], v[188:191], v[108:111], v[148:151]
    s_waitcnt lgkmcnt(1)
    v_mfma_f32_16x16x32_bf16 v[148:151], v[192:195], v[120:123], v[148:151]
    v_exp_f32 v144, v144
    s_waitcnt lgkmcnt(0)
    v_mfma_f32_16x16x32_bf16 v[148:151], v[196:199], v[132:135], v[148:151]
    v_exp_f32 v145, v145
    v_mfma_f32_16x16x32_bf16 v[156:159], v[196:199], v[136:139], 0
    v_exp_f32 v146, v146
    v_mfma_f32_16x16x32_bf16 v[156:159], v[192:195], v[124:127], v[156:159]
    v_exp_f32 v147, v147
    v_mfma_f32_16x16x32_bf16 v[156:159], v[188:191], v[112:115], v[156:159]
    v_add_f32 v248, v248, v144
    v_add_f32 v248, v248, v145
    v_mfma_f32_16x16x32_bf16 v[156:159], v[184:187], v[100:103], v[156:159]
    v_add_f32 v248, v248, v146
    v_add_f32 v248, v248, v147
    v_mfma_f32_16x16x32_bf16 v[164:167], v[184:187], v[104:107], 0
    v_cvt_pk_bf16_f32 v144, v144, v145
    v_cvt_pk_bf16_f32 v145, v146, v147
    v_mfma_f32_16x16x32_bf16 v[164:167], v[188:191], v[116:119], v[164:167]
    v_exp_f32 v152, v152
    v_mfma_f32_16x16x32_bf16 v[164:167], v[192:195], v[128:131], v[164:167]
    v_exp_f32 v153, v153
    v_mfma_f32_16x16x32_bf16 v[164:167], v[196:199], v[140:143], v[164:167]
    v_exp_f32 v154, v154
    v_exp_f32 v155, v155
    v_add_f32 v249, v249, v152
    v_add_f32 v249, v249, v153
    v_add_f32 v249, v249, v154
    v_add_f32 v249, v249, v155
    v_cvt_pk_bf16_f32 v152, v152, v153
    v_cvt_pk_bf16_f32 v153, v154, v155
    v_exp_f32 v160, v160
    s_add_u32 m0, s26, 4096
    s_add_u32 s24, s24, 4096
    buffer_load_dwordx4 v255, s[12:15], s24 offen nt lds
    v_exp_f32 v161, v161
    v_exp_f32 v162, v162
    v_exp_f32 v163, v163
    v_add_f32 v250, v250, v160
    v_add_f32 v250, v250, v161
    v_add_f32 v250, v250, v162
    v_add_f32 v250, v250, v163
    s_add_u32 m0, s26, 4096
    s_nop 0
    buffer_load_dwordx4 v255, s[12:15], s24 offen offset:1024 nt lds
    s_add_u32 s24, s24, 4096
    s_and_b32 s24, s24, 0x1ffff
    s_add_u32 s26, s26, 16384
    s_cmp_ge_u32 s26, s38
    s_cselect_b32 s26, s73, s26
    v_cvt_pk_bf16_f32 v160, v160, v161
    v_cvt_pk_bf16_f32 v161, v162, v163
    v_exp_f32 v148, v148
    v_exp_f32 v149, v149
    v_exp_f32 v150, v150
    v_exp_f32 v151, v151
    s_mov_b32 m0, s39
    s_nop 0
    buffer_load_dwordx4 v251, s[16:19], s25 offen nt lds
    v_add_f32 v248, v248, v148
    v_add_f32 v248, v248, v149
    v_add_f32 v248, v248, v150
    v_add_f32 v248, v248, v151
    v_cvt_pk_bf16_f32 v146, v148, v149
    v_cvt_pk_bf16_f32 v147, v150, v151
    v_exp_f32 v156, v156
    v_exp_f32 v157, v157
    s_mov_b32 m0, s39
    s_nop 0
    buffer_load_dwordx4 v251, s[16:19], s25 offen offset:2048 nt lds
    v_exp_f32 v158, v158
    v_exp_f32 v159, v159
    v_add_f32 v249, v249, v156
    v_add_f32 v249, v249, v157
    v_add_f32 v249, v249, v158
    v_add_f32 v249, v249, v159
    v_cvt_pk_bf16_f32 v154, v156, v157
    v_cvt_pk_bf16_f32 v155, v158, v159
    s_add_u32 m0, s39, 4096
    s_add_u32 s25, s25, 4096
    buffer_load_dwordx4 v251, s[16:19], s25 offen nt lds
    v_exp_f32 v164, v164
    v_exp_f32 v165, v165
    v_exp_f32 v166, v166
    v_exp_f32 v167, v167
    v_add_f32 v250, v250, v164
    v_add_f32 v250, v250, v165
    s_add_u32 m0, s39, 4096
    s_nop 0
    buffer_load_dwordx4 v251, s[16:19], s25 offen offset:2048 nt lds
    s_add_u32 s25, s25, 4096
    s_and_b32 s25, s25, 0x1ffff
    s_add_u32 s39, s39, 16384
    s_cmp_ge_u32 s39, s68
    s_cselect_b32 s39, s74, s39
    v_add_f32 v250, v250, v166
    v_add_f32 v250, v250, v167
    v_cvt_pk_bf16_f32 v162, v164, v165
    v_cvt_pk_bf16_f32 v163, v166, v167
    s_waitcnt vmcnt(20)
    s_barrier
    ds_read_b64_tr_b16 v[168:169], v253 offset:0
    ds_read_b64_tr_b16 v[170:171], v253 offset:4096
    ds_read_b64_tr_b16 v[172:173], v254 offset:0
    ds_read_b64_tr_b16 v[174:175], v254 offset:4096
    ds_read_b64_tr_b16 v[176:177], v253 offset:256
    ds_read_b64_tr_b16 v[178:179], v253 offset:4352
    ds_read_b64_tr_b16 v[180:181], v254 offset:256
    ds_read_b64_tr_b16 v[182:183], v254 offset:4352
    ds_read_b64_tr_b16 v[184:185], v253 offset:512
    ds_read_b64_tr_b16 v[186:187], v253 offset:4608
    s_waitcnt lgkmcnt(8)
    v_mfma_f32_16x16x32_bf16 v[0:3], v[168:171], v[144:147], v[0:3]
    ds_read_b64_tr_b16 v[188:189], v254 offset:512
    ds_read_b64_tr_b16 v[190:191], v254 offset:4608
    v_mfma_f32_16x16x32_bf16 v[4:7], v[168:171], v[152:155], v[4:7]
    v_mfma_f32_16x16x32_bf16 v[8:11], v[168:171], v[160:163], v[8:11]
    s_waitcnt lgkmcnt(8)
    v_mfma_f32_16x16x32_bf16 v[20:23], v[172:175], v[160:163], v[20:23]
    ds_read_b64_tr_b16 v[192:193], v253 offset:768
    ds_read_b64_tr_b16 v[194:195], v253 offset:4864
    v_mfma_f32_16x16x32_bf16 v[16:19], v[172:175], v[152:155], v[16:19]
    v_mfma_f32_16x16x32_bf16 v[12:15], v[172:175], v[144:147], v[12:15]
    s_waitcnt lgkmcnt(8)
    v_mfma_f32_16x16x32_bf16 v[24:27], v[176:179], v[144:147], v[24:27]
    ds_read_b64_tr_b16 v[196:197], v254 offset:768
    ds_read_b64_tr_b16 v[198:199], v254 offset:4864
    v_add_u32 v253, s28, v253
    v_add_u32 v254, s28, v254
    v_mfma_f32_16x16x32_bf16 v[28:31], v[176:179], v[152:155], v[28:31]
    v_mfma_f32_16x16x32_bf16 v[32:35], v[176:179], v[160:163], v[32:35]
    s_waitcnt lgkmcnt(8)
    v_mfma_f32_16x16x32_bf16 v[44:47], v[180:183], v[160:163], v[44:47]
    ds_read_b128 v[168:171], v252 offset:0
    v_mfma_f32_16x16x32_bf16 v[40:43], v[180:183], v[152:155], v[40:43]
    v_mfma_f32_16x16x32_bf16 v[36:39], v[180:183], v[144:147], v[36:39]
    s_waitcnt lgkmcnt(7)
    v_mfma_f32_16x16x32_bf16 v[48:51], v[184:187], v[144:147], v[48:51]
    ds_read_b128 v[172:175], v252 offset:256
    v_mfma_f32_16x16x32_bf16 v[52:55], v[184:187], v[152:155], v[52:55]
    v_mfma_f32_16x16x32_bf16 v[56:59], v[184:187], v[160:163], v[56:59]
    s_waitcnt lgkmcnt(6)
    v_mfma_f32_16x16x32_bf16 v[68:71], v[188:191], v[160:163], v[68:71]
    ds_read_b128 v[176:179], v252 offset:512
    v_mfma_f32_16x16x32_bf16 v[64:67], v[188:191], v[152:155], v[64:67]
    v_mfma_f32_16x16x32_bf16 v[60:63], v[188:191], v[144:147], v[60:63]
    s_waitcnt lgkmcnt(5)
    v_mfma_f32_16x16x32_bf16 v[72:75], v[192:195], v[144:147], v[72:75]
    ds_read_b128 v[180:183], v252 offset:768
    v_mfma_f32_16x16x32_bf16 v[76:79], v[192:195], v[152:155], v[76:79]
    v_mfma_f32_16x16x32_bf16 v[80:83], v[192:195], v[160:163], v[80:83]
    s_waitcnt lgkmcnt(4)
    v_mfma_f32_16x16x32_bf16 v[92:95], v[196:199], v[160:163], v[92:95]
    ds_read_b128 v[184:187], v252 offset:4096
    v_mfma_f32_16x16x32_bf16 v[88:91], v[196:199], v[152:155], v[88:91]
    v_mfma_f32_16x16x32_bf16 v[84:87], v[196:199], v[144:147], v[84:87]
    s_add_u32 s29, s29, 1
    s_cmp_lt_u32 s29, 5
    s_cselect_b32 s28, s37, 4294901760
    s_cselect_b32 s29, s29, 0
    s_waitcnt lgkmcnt(4)
    v_mfma_f32_16x16x32_bf16 v[144:147], v[168:171], v[96:99], 0
    ds_read_b128 v[188:191], v252 offset:4352
    s_waitcnt lgkmcnt(4)
    v_mfma_f32_16x16x32_bf16 v[144:147], v[172:175], v[108:111], v[144:147]
    ds_read_b128 v[192:195], v252 offset:4608
    s_waitcnt lgkmcnt(4)
    v_mfma_f32_16x16x32_bf16 v[144:147], v[176:179], v[120:123], v[144:147]
    ds_read_b128 v[196:199], v252 offset:4864
    v_add_u32 v252, s28, v252
    s_waitcnt lgkmcnt(4)
    v_mfma_f32_16x16x32_bf16 v[144:147], v[180:183], v[132:135], v[144:147]
    v_mfma_f32_16x16x32_bf16 v[152:155], v[180:183], v[136:139], 0
    v_mfma_f32_16x16x32_bf16 v[152:155], v[176:179], v[124:127], v[152:155]
    v_mfma_f32_16x16x32_bf16 v[152:155], v[172:175], v[112:115], v[152:155]
    v_mfma_f32_16x16x32_bf16 v[152:155], v[168:171], v[100:103], v[152:155]
    v_mfma_f32_16x16x32_bf16 v[160:163], v[168:171], v[104:107], 0
    v_mfma_f32_16x16x32_bf16 v[160:163], v[172:175], v[116:119], v[160:163]
    v_mfma_f32_16x16x32_bf16 v[160:163], v[176:179], v[128:131], v[160:163]
    v_mfma_f32_16x16x32_bf16 v[160:163], v[180:183], v[140:143], v[160:163]
    s_waitcnt lgkmcnt(3)
    v_mfma_f32_16x16x32_bf16 v[148:151], v[184:187], v[96:99], 0
    s_waitcnt lgkmcnt(2)
    v_mfma_f32_16x16x32_bf16 v[148:151], v[188:191], v[108:111], v[148:151]
    s_waitcnt lgkmcnt(1)
    v_mfma_f32_16x16x32_bf16 v[148:151], v[192:195], v[120:123], v[148:151]
    v_exp_f32 v144, v144
    s_waitcnt lgkmcnt(0)
    v_mfma_f32_16x16x32_bf16 v[148:151], v[196:199], v[132:135], v[148:151]
    v_exp_f32 v145, v145
    v_mfma_f32_16x16x32_bf16 v[156:159], v[196:199], v[136:139], 0
    v_exp_f32 v146, v146
    v_mfma_f32_16x16x32_bf16 v[156:159], v[192:195], v[124:127], v[156:159]
    v_exp_f32 v147, v147
    v_mfma_f32_16x16x32_bf16 v[156:159], v[188:191], v[112:115], v[156:159]
    v_add_f32 v248, v248, v144
    v_add_f32 v248, v248, v145
    v_mfma_f32_16x16x32_bf16 v[156:159], v[184:187], v[100:103], v[156:159]
    v_add_f32 v248, v248, v146
    v_add_f32 v248, v248, v147
    v_mfma_f32_16x16x32_bf16 v[164:167], v[184:187], v[104:107], 0
    v_cvt_pk_bf16_f32 v144, v144, v145
    v_cvt_pk_bf16_f32 v145, v146, v147
    v_mfma_f32_16x16x32_bf16 v[164:167], v[188:191], v[116:119], v[164:167]
    v_exp_f32 v152, v152
    v_mfma_f32_16x16x32_bf16 v[164:167], v[192:195], v[128:131], v[164:167]
    v_exp_f32 v153, v153
    v_mfma_f32_16x16x32_bf16 v[164:167], v[196:199], v[140:143], v[164:167]
    v_exp_f32 v154, v154
    v_exp_f32 v155, v155
    v_add_f32 v249, v249, v152
    v_add_f32 v249, v249, v153
    v_add_f32 v249, v249, v154
    v_add_f32 v249, v249, v155
    v_cvt_pk_bf16_f32 v152, v152, v153
    v_cvt_pk_bf16_f32 v153, v154, v155
    s_mov_b32 m0, s26
    s_nop 0
    buffer_load_dwordx4 v255, s[12:15], s24 offen nt lds
    v_exp_f32 v160, v160
    v_exp_f32 v161, v161
    v_exp_f32 v162, v162
    v_exp_f32 v163, v163
    s_mov_b32 m0, s26
    s_nop 0
    buffer_load_dwordx4 v255, s[12:15], s24 offen offset:1024 nt lds
    v_add_f32 v250, v250, v160
    v_add_f32 v250, v250, v161
    v_add_f32 v250, v250, v162
    v_add_f32 v250, v250, v163
    v_cvt_pk_bf16_f32 v160, v160, v161
    v_cvt_pk_bf16_f32 v161, v162, v163
    v_exp_f32 v148, v148
    s_add_u32 m0, s26, 4096
    s_add_u32 s24, s24, 4096
    buffer_load_dwordx4 v255, s[12:15], s24 offen nt lds
    v_exp_f32 v149, v149
    v_exp_f32 v150, v150
    v_exp_f32 v151, v151
    v_add_f32 v248, v248, v148
    v_add_f32 v248, v248, v149
    s_add_u32 m0, s26, 4096
    s_nop 0
    buffer_load_dwordx4 v255, s[12:15], s24 offen offset:1024 nt lds
    s_add_u32 s24, s24, 4096
    s_and_b32 s24, s24, 0x1ffff
    s_add_u32 s26, s26, 16384
    s_cmp_ge_u32 s26, s38
    s_cselect_b32 s26, s73, s26
    v_add_f32 v248, v248, v150
    v_add_f32 v248, v248, v151
    v_cvt_pk_bf16_f32 v146, v148, v149
    v_cvt_pk_bf16_f32 v147, v150, v151
    v_exp_f32 v156, v156
    v_exp_f32 v157, v157
    s_mov_b32 m0, s39
    s_nop 0
    buffer_load_dwordx4 v251, s[16:19], s25 offen nt lds
    v_exp_f32 v158, v158
    v_exp_f32 v159, v159
    v_add_f32 v249, v249, v156
    v_add_f32 v249, v249, v157
    v_add_f32 v249, v249, v158
    v_add_f32 v249, v249, v159
    s_mov_b32 m0, s39
    s_nop 0
    buffer_load_dwordx4 v251, s[16:19], s25 offen offset:2048 nt lds
    v_cvt_pk_bf16_f32 v154, v156, v157
    v_cvt_pk_bf16_f32 v155, v158, v159
    v_exp_f32 v164, v164
    v_exp_f32 v165, v165
    v_exp_f32 v166, v166
    s_add_u32 m0, s39, 4096
    s_add_u32 s25, s25, 4096
    buffer_load_dwordx4 v251, s[16:19], s25 offen nt lds
    v_exp_f32 v167, v167
    v_add_f32 v250, v250, v164
    v_add_f32 v250, v250, v165
    v_add_f32 v250, v250, v166
    v_add_f32 v250, v250, v167
    v_cvt_pk_bf16_f32 v162, v164, v165
    v_cvt_pk_bf16_f32 v163, v166, v167
    s_waitcnt vmcnt(19)
    s_barrier
    ds_read_b64_tr_b16 v[168:169], v253 offset:0
    ds_read_b64_tr_b16 v[170:171], v253 offset:4096
    ds_read_b64_tr_b16 v[172:173], v254 offset:0
    ds_read_b64_tr_b16 v[174:175], v254 offset:4096
    ds_read_b64_tr_b16 v[176:177], v253 offset:256
    ds_read_b64_tr_b16 v[178:179], v253 offset:4352
    ds_read_b64_tr_b16 v[180:181], v254 offset:256
    ds_read_b64_tr_b16 v[182:183], v254 offset:4352
    ds_read_b64_tr_b16 v[184:185], v253 offset:512
    ds_read_b64_tr_b16 v[186:187], v253 offset:4608
    s_waitcnt lgkmcnt(8)
    v_mfma_f32_16x16x32_bf16 v[0:3], v[168:171], v[144:147], v[0:3]
    ds_read_b64_tr_b16 v[188:189], v254 offset:512
    ds_read_b64_tr_b16 v[190:191], v254 offset:4608
    v_mfma_f32_16x16x32_bf16 v[4:7], v[168:171], v[152:155], v[4:7]
    v_mfma_f32_16x16x32_bf16 v[8:11], v[168:171], v[160:163], v[8:11]
    s_waitcnt lgkmcnt(8)
    v_mfma_f32_16x16x32_bf16 v[20:23], v[172:175], v[160:163], v[20:23]
    ds_read_b64_tr_b16 v[192:193], v253 offset:768
    ds_read_b64_tr_b16 v[194:195], v253 offset:4864
    v_mfma_f32_16x16x32_bf16 v[16:19], v[172:175], v[152:155], v[16:19]
    v_mfma_f32_16x16x32_bf16 v[12:15], v[172:175], v[144:147], v[12:15]
    s_waitcnt lgkmcnt(8)
    v_mfma_f32_16x16x32_bf16 v[24:27], v[176:179], v[144:147], v[24:27]
    ds_read_b64_tr_b16 v[196:197], v254 offset:768
    ds_read_b64_tr_b16 v[198:199], v254 offset:4864
    v_add_u32 v253, s28, v253
    v_add_u32 v254, s28, v254
    v_mfma_f32_16x16x32_bf16 v[28:31], v[176:179], v[152:155], v[28:31]
    v_mfma_f32_16x16x32_bf16 v[32:35], v[176:179], v[160:163], v[32:35]
    s_waitcnt lgkmcnt(8)
    v_mfma_f32_16x16x32_bf16 v[44:47], v[180:183], v[160:163], v[44:47]
    ds_read_b128 v[168:171], v252 offset:0
    v_mfma_f32_16x16x32_bf16 v[40:43], v[180:183], v[152:155], v[40:43]
    v_mfma_f32_16x16x32_bf16 v[36:39], v[180:183], v[144:147], v[36:39]
    s_waitcnt lgkmcnt(7)
    v_mfma_f32_16x16x32_bf16 v[48:51], v[184:187], v[144:147], v[48:51]
    ds_read_b128 v[172:175], v252 offset:256
    v_mfma_f32_16x16x32_bf16 v[52:55], v[184:187], v[152:155], v[52:55]
    v_mfma_f32_16x16x32_bf16 v[56:59], v[184:187], v[160:163], v[56:59]
    s_waitcnt lgkmcnt(6)
    v_mfma_f32_16x16x32_bf16 v[68:71], v[188:191], v[160:163], v[68:71]
    ds_read_b128 v[176:179], v252 offset:512
    v_mfma_f32_16x16x32_bf16 v[64:67], v[188:191], v[152:155], v[64:67]
    v_mfma_f32_16x16x32_bf16 v[60:63], v[188:191], v[144:147], v[60:63]
    s_waitcnt lgkmcnt(5)
    v_mfma_f32_16x16x32_bf16 v[72:75], v[192:195], v[144:147], v[72:75]
    ds_read_b128 v[180:183], v252 offset:768
    v_mfma_f32_16x16x32_bf16 v[76:79], v[192:195], v[152:155], v[76:79]
    v_mfma_f32_16x16x32_bf16 v[80:83], v[192:195], v[160:163], v[80:83]
    s_waitcnt lgkmcnt(4)
    v_mfma_f32_16x16x32_bf16 v[92:95], v[196:199], v[160:163], v[92:95]
    ds_read_b128 v[184:187], v252 offset:4096
    v_mfma_f32_16x16x32_bf16 v[88:91], v[196:199], v[152:155], v[88:91]
    v_mfma_f32_16x16x32_bf16 v[84:87], v[196:199], v[144:147], v[84:87]
    s_add_u32 s29, s29, 1
    s_cmp_lt_u32 s29, 5
    s_cselect_b32 s28, s37, 4294901760
    s_cselect_b32 s29, s29, 0
    s_waitcnt lgkmcnt(4)
    v_mfma_f32_16x16x32_bf16 v[144:147], v[168:171], v[96:99], 0
    ds_read_b128 v[188:191], v252 offset:4352
    s_waitcnt lgkmcnt(4)
    v_mfma_f32_16x16x32_bf16 v[144:147], v[172:175], v[108:111], v[144:147]
    ds_read_b128 v[192:195], v252 offset:4608
    s_waitcnt lgkmcnt(4)
    v_mfma_f32_16x16x32_bf16 v[144:147], v[176:179], v[120:123], v[144:147]
    ds_read_b128 v[196:199], v252 offset:4864
    v_add_u32 v252, s28, v252
    s_waitcnt lgkmcnt(4)
    v_mfma_f32_16x16x32_bf16 v[144:147], v[180:183], v[132:135], v[144:147]
    v_mfma_f32_16x16x32_bf16 v[152:155], v[180:183], v[136:139], 0
    v_mfma_f32_16x16x32_bf16 v[152:155], v[176:179], v[124:127], v[152:155]
    v_mfma_f32_16x16x32_bf16 v[152:155], v[172:175], v[112:115], v[152:155]
    v_mfma_f32_16x16x32_bf16 v[152:155], v[168:171], v[100:103], v[152:155]
    v_mfma_f32_16x16x32_bf16 v[160:163], v[168:171], v[104:107], 0
    v_mfma_f32_16x16x32_bf16 v[160:163], v[172:175], v[116:119], v[160:163]
    v_mfma_f32_16x16x32_bf16 v[160:163], v[176:179], v[128:131], v[160:163]
    v_mfma_f32_16x16x32_bf16 v[160:163], v[180:183], v[140:143], v[160:163]
    s_waitcnt lgkmcnt(3)
    v_mfma_f32_16x16x32_bf16 v[148:151], v[184:187], v[96:99], 0
    s_waitcnt lgkmcnt(2)
    v_mfma_f32_16x16x32_bf16 v[148:151], v[188:191], v[108:111], v[148:151]
    s_waitcnt lgkmcnt(1)
    v_mfma_f32_16x16x32_bf16 v[148:151], v[192:195], v[120:123], v[148:151]
    v_exp_f32 v144, v144
    s_waitcnt lgkmcnt(0)
    v_mfma_f32_16x16x32_bf16 v[148:151], v[196:199], v[132:135], v[148:151]
    v_exp_f32 v145, v145
    v_mfma_f32_16x16x32_bf16 v[156:159], v[196:199], v[136:139], 0
    v_exp_f32 v146, v146
    v_mfma_f32_16x16x32_bf16 v[156:159], v[192:195], v[124:127], v[156:159]
    v_exp_f32 v147, v147
    v_mfma_f32_16x16x32_bf16 v[156:159], v[188:191], v[112:115], v[156:159]
    v_add_f32 v248, v248, v144
    v_add_f32 v248, v248, v145
    v_mfma_f32_16x16x32_bf16 v[156:159], v[184:187], v[100:103], v[156:159]
    v_add_f32 v248, v248, v146
    v_add_f32 v248, v248, v147
    v_mfma_f32_16x16x32_bf16 v[164:167], v[184:187], v[104:107], 0
    v_cvt_pk_bf16_f32 v144, v144, v145
    v_cvt_pk_bf16_f32 v145, v146, v147
    v_mfma_f32_16x16x32_bf16 v[164:167], v[188:191], v[116:119], v[164:167]
    v_exp_f32 v152, v152
    v_mfma_f32_16x16x32_bf16 v[164:167], v[192:195], v[128:131], v[164:167]
    v_exp_f32 v153, v153
    v_mfma_f32_16x16x32_bf16 v[164:167], v[196:199], v[140:143], v[164:167]
    v_exp_f32 v154, v154
    v_exp_f32 v155, v155
    v_add_f32 v249, v249, v152
    v_add_f32 v249, v249, v153
    v_add_f32 v249, v249, v154
    v_add_f32 v249, v249, v155
    v_cvt_pk_bf16_f32 v152, v152, v153
    v_cvt_pk_bf16_f32 v153, v154, v155
    v_exp_f32 v160, v160
    s_add_u32 m0, s39, 4096
    s_nop 0
    buffer_load_dwordx4 v251, s[16:19], s25 offen offset:2048 nt lds
    s_add_u32 s25, s25, 4096
    s_and_b32 s25, s25, 0x1ffff
    s_add_u32 s39, s39, 16384
    s_cmp_ge_u32 s39, s68
    s_cselect_b32 s39, s74, s39
    v_exp_f32 v161, v161
    v_exp_f32 v162, v162
    v_exp_f32 v163, v163
    v_add_f32 v250, v250, v160
    v_add_f32 v250, v250, v161
    v_add_f32 v250, v250, v162
    v_add_f32 v250, v250, v163
    s_mov_b32 m0, s26
    s_nop 0
    buffer_load_dwordx4 v255, s[12:15], s24 offen nt lds
    v_cvt_pk_bf16_f32 v160, v160, v161
    v_cvt_pk_bf16_f32 v161, v162, v163
    v_exp_f32 v148, v148
    v_exp_f32 v149, v149
    v_exp_f32 v150, v150
    v_exp_f32 v151, v151
    s_mov_b32 m0, s26
    s_nop 0
    buffer_load_dwordx4 v255, s[12:15], s24 offen offset:1024 nt lds
    v_add_f32 v248, v248, v148
    v_add_f32 v248, v248, v149
    v_add_f32 v248, v248, v150
    v_add_f32 v248, v248, v151
    v_cvt_pk_bf16_f32 v146, v148, v149
    v_cvt_pk_bf16_f32 v147, v150, v151
    v_exp_f32 v156, v156
    v_exp_f32 v157, v157
    s_add_u32 m0, s26, 4096
    s_add_u32 s24, s24, 4096
    buffer_load_dwordx4 v255, s[12:15], s24 offen nt lds
    v_exp_f32 v158, v158
    v_exp_f32 v159, v159
    v_add_f32 v249, v249, v156
    v_add_f32 v249, v249, v157
    v_add_f32 v249, v249, v158
    v_add_f32 v249, v249, v159
    v_cvt_pk_bf16_f32 v154, v156, v157
    v_cvt_pk_bf16_f32 v155, v158, v159
    s_add_u32 m0, s26, 4096
    s_nop 0
    buffer_load_dwordx4 v255, s[12:15], s24 offen offset:1024 nt lds
    s_add_u32 s24, s24, 4096
    s_and_b32 s24, s24, 0x1ffff
    s_add_u32 s26, s26, 16384
    s_cmp_ge_u32 s26, s38
    s_cselect_b32 s26, s73, s26
    v_exp_f32 v164, v164
    v_exp_f32 v165, v165
    v_exp_f32 v166, v166
    v_exp_f32 v167, v167
    v_add_f32 v250, v250, v164
    v_add_f32 v250, v250, v165
    s_mov_b32 m0, s39
    s_nop 0
    buffer_load_dwordx4 v251, s[16:19], s25 offen nt lds
    v_add_f32 v250, v250, v166
    v_add_f32 v250, v250, v167
    v_cvt_pk_bf16_f32 v162, v164, v165
    v_cvt_pk_bf16_f32 v163, v166, v167
    s_waitcnt vmcnt(17)
    s_barrier
    ds_read_b64_tr_b16 v[168:169], v253 offset:0
    ds_read_b64_tr_b16 v[170:171], v253 offset:4096
    ds_read_b64_tr_b16 v[172:173], v254 offset:0
    ds_read_b64_tr_b16 v[174:175], v254 offset:4096
    ds_read_b64_tr_b16 v[176:177], v253 offset:256
    ds_read_b64_tr_b16 v[178:179], v253 offset:4352
    ds_read_b64_tr_b16 v[180:181], v254 offset:256
    ds_read_b64_tr_b16 v[182:183], v254 offset:4352
    ds_read_b64_tr_b16 v[184:185], v253 offset:512
    ds_read_b64_tr_b16 v[186:187], v253 offset:4608
    s_waitcnt lgkmcnt(8)
    v_mfma_f32_16x16x32_bf16 v[0:3], v[168:171], v[144:147], v[0:3]
    ds_read_b64_tr_b16 v[188:189], v254 offset:512
    ds_read_b64_tr_b16 v[190:191], v254 offset:4608
    v_mfma_f32_16x16x32_bf16 v[4:7], v[168:171], v[152:155], v[4:7]
    v_mfma_f32_16x16x32_bf16 v[8:11], v[168:171], v[160:163], v[8:11]
    s_waitcnt lgkmcnt(8)
    v_mfma_f32_16x16x32_bf16 v[20:23], v[172:175], v[160:163], v[20:23]
    ds_read_b64_tr_b16 v[192:193], v253 offset:768
    ds_read_b64_tr_b16 v[194:195], v253 offset:4864
    v_mfma_f32_16x16x32_bf16 v[16:19], v[172:175], v[152:155], v[16:19]
    v_mfma_f32_16x16x32_bf16 v[12:15], v[172:175], v[144:147], v[12:15]
    s_waitcnt lgkmcnt(8)
    v_mfma_f32_16x16x32_bf16 v[24:27], v[176:179], v[144:147], v[24:27]
    ds_read_b64_tr_b16 v[196:197], v254 offset:768
    ds_read_b64_tr_b16 v[198:199], v254 offset:4864
    v_add_u32 v253, s28, v253
    v_add_u32 v254, s28, v254
    v_mfma_f32_16x16x32_bf16 v[28:31], v[176:179], v[152:155], v[28:31]
    v_mfma_f32_16x16x32_bf16 v[32:35], v[176:179], v[160:163], v[32:35]
    s_waitcnt lgkmcnt(8)
    v_mfma_f32_16x16x32_bf16 v[44:47], v[180:183], v[160:163], v[44:47]
    ds_read_b128 v[168:171], v252 offset:0
    v_mfma_f32_16x16x32_bf16 v[40:43], v[180:183], v[152:155], v[40:43]
    v_mfma_f32_16x16x32_bf16 v[36:39], v[180:183], v[144:147], v[36:39]
    s_waitcnt lgkmcnt(7)
    v_mfma_f32_16x16x32_bf16 v[48:51], v[184:187], v[144:147], v[48:51]
    ds_read_b128 v[172:175], v252 offset:256
    v_mfma_f32_16x16x32_bf16 v[52:55], v[184:187], v[152:155], v[52:55]
    v_mfma_f32_16x16x32_bf16 v[56:59], v[184:187], v[160:163], v[56:59]
    s_waitcnt lgkmcnt(6)
    v_mfma_f32_16x16x32_bf16 v[68:71], v[188:191], v[160:163], v[68:71]
    ds_read_b128 v[176:179], v252 offset:512
    v_mfma_f32_16x16x32_bf16 v[64:67], v[188:191], v[152:155], v[64:67]
    v_mfma_f32_16x16x32_bf16 v[60:63], v[188:191], v[144:147], v[60:63]
    s_waitcnt lgkmcnt(5)
    v_mfma_f32_16x16x32_bf16 v[72:75], v[192:195], v[144:147], v[72:75]
    ds_read_b128 v[180:183], v252 offset:768
    v_mfma_f32_16x16x32_bf16 v[76:79], v[192:195], v[152:155], v[76:79]
    v_mfma_f32_16x16x32_bf16 v[80:83], v[192:195], v[160:163], v[80:83]
    s_waitcnt lgkmcnt(4)
    v_mfma_f32_16x16x32_bf16 v[92:95], v[196:199], v[160:163], v[92:95]
    ds_read_b128 v[184:187], v252 offset:4096
    v_mfma_f32_16x16x32_bf16 v[88:91], v[196:199], v[152:155], v[88:91]
    v_mfma_f32_16x16x32_bf16 v[84:87], v[196:199], v[144:147], v[84:87]
    s_add_u32 s29, s29, 1
    s_cmp_lt_u32 s29, 5
    s_cselect_b32 s28, s37, 4294901760
    s_cselect_b32 s29, s29, 0
    s_waitcnt lgkmcnt(4)
    v_mfma_f32_16x16x32_bf16 v[144:147], v[168:171], v[96:99], 0
    ds_read_b128 v[188:191], v252 offset:4352
    s_waitcnt lgkmcnt(4)
    v_mfma_f32_16x16x32_bf16 v[144:147], v[172:175], v[108:111], v[144:147]
    ds_read_b128 v[192:195], v252 offset:4608
    s_waitcnt lgkmcnt(4)
    v_mfma_f32_16x16x32_bf16 v[144:147], v[176:179], v[120:123], v[144:147]
    ds_read_b128 v[196:199], v252 offset:4864
    v_add_u32 v252, s28, v252
    s_waitcnt lgkmcnt(4)
    v_mfma_f32_16x16x32_bf16 v[144:147], v[180:183], v[132:135], v[144:147]
    v_mfma_f32_16x16x32_bf16 v[152:155], v[180:183], v[136:139], 0
    v_mfma_f32_16x16x32_bf16 v[152:155], v[176:179], v[124:127], v[152:155]
    v_mfma_f32_16x16x32_bf16 v[152:155], v[172:175], v[112:115], v[152:155]
    v_mfma_f32_16x16x32_bf16 v[152:155], v[168:171], v[100:103], v[152:155]
    v_mfma_f32_16x16x32_bf16 v[160:163], v[168:171], v[104:107], 0
    v_mfma_f32_16x16x32_bf16 v[160:163], v[172:175], v[116:119], v[160:163]
    v_mfma_f32_16x16x32_bf16 v[160:163], v[176:179], v[128:131], v[160:163]
    v_mfma_f32_16x16x32_bf16 v[160:163], v[180:183], v[140:143], v[160:163]
    s_waitcnt lgkmcnt(3)
    v_mfma_f32_16x16x32_bf16 v[148:151], v[184:187], v[96:99], 0
    s_waitcnt lgkmcnt(2)
    v_mfma_f32_16x16x32_bf16 v[148:151], v[188:191], v[108:111], v[148:151]
    s_waitcnt lgkmcnt(1)
    v_mfma_f32_16x16x32_bf16 v[148:151], v[192:195], v[120:123], v[148:151]
    v_exp_f32 v144, v144
    s_waitcnt lgkmcnt(0)
    v_mfma_f32_16x16x32_bf16 v[148:151], v[196:199], v[132:135], v[148:151]
    v_exp_f32 v145, v145
    v_mfma_f32_16x16x32_bf16 v[156:159], v[196:199], v[136:139], 0
    v_exp_f32 v146, v146
    v_mfma_f32_16x16x32_bf16 v[156:159], v[192:195], v[124:127], v[156:159]
    v_exp_f32 v147, v147
    v_mfma_f32_16x16x32_bf16 v[156:159], v[188:191], v[112:115], v[156:159]
    v_add_f32 v248, v248, v144
    v_add_f32 v248, v248, v145
    v_mfma_f32_16x16x32_bf16 v[156:159], v[184:187], v[100:103], v[156:159]
    v_add_f32 v248, v248, v146
    v_add_f32 v248, v248, v147
    v_mfma_f32_16x16x32_bf16 v[164:167], v[184:187], v[104:107], 0
    v_cvt_pk_bf16_f32 v144, v144, v145
    v_cvt_pk_bf16_f32 v145, v146, v147
    v_mfma_f32_16x16x32_bf16 v[164:167], v[188:191], v[116:119], v[164:167]
    v_exp_f32 v152, v152
    v_mfma_f32_16x16x32_bf16 v[164:167], v[192:195], v[128:131], v[164:167]
    v_exp_f32 v153, v153
    v_mfma_f32_16x16x32_bf16 v[164:167], v[196:199], v[140:143], v[164:167]
    v_exp_f32 v154, v154
    v_exp_f32 v155, v155
    v_add_f32 v249, v249, v152
    v_add_f32 v249, v249, v153
    v_add_f32 v249, v249, v154
    v_add_f32 v249, v249, v155
    v_cvt_pk_bf16_f32 v152, v152, v153
    v_cvt_pk_bf16_f32 v153, v154, v155
    s_mov_b32 m0, s39
    s_nop 0
    buffer_load_dwordx4 v251, s[16:19], s25 offen offset:2048 nt lds
    v_exp_f32 v160, v160
    v_exp_f32 v161, v161
    v_exp_f32 v162, v162
    v_exp_f32 v163, v163
    s_add_u32 m0, s39, 4096
    s_add_u32 s25, s25, 4096
    buffer_load_dwordx4 v251, s[16:19], s25 offen nt lds
    v_add_f32 v250, v250, v160
    v_add_f32 v250, v250, v161
    v_add_f32 v250, v250, v162
    v_add_f32 v250, v250, v163
    v_cvt_pk_bf16_f32 v160, v160, v161
    v_cvt_pk_bf16_f32 v161, v162, v163
    v_exp_f32 v148, v148
    s_add_u32 m0, s39, 4096
    s_nop 0
    buffer_load_dwordx4 v251, s[16:19], s25 offen offset:2048 nt lds
    s_add_u32 s25, s25, 4096
    s_and_b32 s25, s25, 0x1ffff
    s_add_u32 s39, s39, 16384
    s_cmp_ge_u32 s39, s68
    s_cselect_b32 s39, s74, s39
    v_exp_f32 v149, v149
    v_exp_f32 v150, v150
    v_exp_f32 v151, v151
    v_add_f32 v248, v248, v148
    v_add_f32 v248, v248, v149
    s_mov_b32 m0, s26
    s_nop 0
    buffer_load_dwordx4 v255, s[12:15], s24 offen nt lds
    v_add_f32 v248, v248, v150
    v_add_f32 v248, v248, v151
    v_cvt_pk_bf16_f32 v146, v148, v149
    v_cvt_pk_bf16_f32 v147, v150, v151
    v_exp_f32 v156, v156
    v_exp_f32 v157, v157
    s_mov_b32 m0, s26
    s_nop 0
    buffer_load_dwordx4 v255, s[12:15], s24 offen offset:1024 nt lds
    v_exp_f32 v158, v158
    v_exp_f32 v159, v159
    v_add_f32 v249, v249, v156
    v_add_f32 v249, v249, v157
    v_add_f32 v249, v249, v158
    v_add_f32 v249, v249, v159
    s_add_u32 m0, s26, 4096
    s_add_u32 s24, s24, 4096
    buffer_load_dwordx4 v255, s[12:15], s24 offen nt lds
    v_cvt_pk_bf16_f32 v154, v156, v157
    v_cvt_pk_bf16_f32 v155, v158, v159
    v_exp_f32 v164, v164
    v_exp_f32 v165, v165
    v_exp_f32 v166, v166
    s_add_u32 m0, s26, 4096
    s_nop 0
    buffer_load_dwordx4 v255, s[12:15], s24 offen offset:1024 nt lds
    s_add_u32 s24, s24, 4096
    s_and_b32 s24, s24, 0x1ffff
    s_add_u32 s26, s26, 16384
    s_cmp_ge_u32 s26, s38
    s_cselect_b32 s26, s73, s26
    v_exp_f32 v167, v167
    v_add_f32 v250, v250, v164
    v_add_f32 v250, v250, v165
    v_add_f32 v250, v250, v166
    v_add_f32 v250, v250, v167
    v_cvt_pk_bf16_f32 v162, v164, v165
    v_cvt_pk_bf16_f32 v163, v166, v167
    s_waitcnt vmcnt(16)
    s_barrier
    ds_read_b64_tr_b16 v[168:169], v253 offset:0
    ds_read_b64_tr_b16 v[170:171], v253 offset:4096
    ds_read_b64_tr_b16 v[172:173], v254 offset:0
    ds_read_b64_tr_b16 v[174:175], v254 offset:4096
    ds_read_b64_tr_b16 v[176:177], v253 offset:256
    ds_read_b64_tr_b16 v[178:179], v253 offset:4352
    ds_read_b64_tr_b16 v[180:181], v254 offset:256
    ds_read_b64_tr_b16 v[182:183], v254 offset:4352
    ds_read_b64_tr_b16 v[184:185], v253 offset:512
    ds_read_b64_tr_b16 v[186:187], v253 offset:4608
    s_waitcnt lgkmcnt(8)
    v_mfma_f32_16x16x32_bf16 v[0:3], v[168:171], v[144:147], v[0:3]
    ds_read_b64_tr_b16 v[188:189], v254 offset:512
    ds_read_b64_tr_b16 v[190:191], v254 offset:4608
    v_mfma_f32_16x16x32_bf16 v[4:7], v[168:171], v[152:155], v[4:7]
    v_mfma_f32_16x16x32_bf16 v[8:11], v[168:171], v[160:163], v[8:11]
    s_waitcnt lgkmcnt(8)
    v_mfma_f32_16x16x32_bf16 v[20:23], v[172:175], v[160:163], v[20:23]
    ds_read_b64_tr_b16 v[192:193], v253 offset:768
    ds_read_b64_tr_b16 v[194:195], v253 offset:4864
    v_mfma_f32_16x16x32_bf16 v[16:19], v[172:175], v[152:155], v[16:19]
    v_mfma_f32_16x16x32_bf16 v[12:15], v[172:175], v[144:147], v[12:15]
    s_waitcnt lgkmcnt(8)
    v_mfma_f32_16x16x32_bf16 v[24:27], v[176:179], v[144:147], v[24:27]
    ds_read_b64_tr_b16 v[196:197], v254 offset:768
    ds_read_b64_tr_b16 v[198:199], v254 offset:4864
    v_add_u32 v253, s28, v253
    v_add_u32 v254, s28, v254
    v_mfma_f32_16x16x32_bf16 v[28:31], v[176:179], v[152:155], v[28:31]
    v_mfma_f32_16x16x32_bf16 v[32:35], v[176:179], v[160:163], v[32:35]
    s_waitcnt lgkmcnt(8)
    v_mfma_f32_16x16x32_bf16 v[44:47], v[180:183], v[160:163], v[44:47]
    ds_read_b128 v[168:171], v252 offset:0
    v_mfma_f32_16x16x32_bf16 v[40:43], v[180:183], v[152:155], v[40:43]
    v_mfma_f32_16x16x32_bf16 v[36:39], v[180:183], v[144:147], v[36:39]
    s_waitcnt lgkmcnt(7)
    v_mfma_f32_16x16x32_bf16 v[48:51], v[184:187], v[144:147], v[48:51]
    ds_read_b128 v[172:175], v252 offset:256
    v_mfma_f32_16x16x32_bf16 v[52:55], v[184:187], v[152:155], v[52:55]
    v_mfma_f32_16x16x32_bf16 v[56:59], v[184:187], v[160:163], v[56:59]
    s_waitcnt lgkmcnt(6)
    v_mfma_f32_16x16x32_bf16 v[68:71], v[188:191], v[160:163], v[68:71]
    ds_read_b128 v[176:179], v252 offset:512
    v_mfma_f32_16x16x32_bf16 v[64:67], v[188:191], v[152:155], v[64:67]
    v_mfma_f32_16x16x32_bf16 v[60:63], v[188:191], v[144:147], v[60:63]
    s_waitcnt lgkmcnt(5)
    v_mfma_f32_16x16x32_bf16 v[72:75], v[192:195], v[144:147], v[72:75]
    ds_read_b128 v[180:183], v252 offset:768
    v_mfma_f32_16x16x32_bf16 v[76:79], v[192:195], v[152:155], v[76:79]
    v_mfma_f32_16x16x32_bf16 v[80:83], v[192:195], v[160:163], v[80:83]
    s_waitcnt lgkmcnt(4)
    v_mfma_f32_16x16x32_bf16 v[92:95], v[196:199], v[160:163], v[92:95]
    ds_read_b128 v[184:187], v252 offset:4096
    v_mfma_f32_16x16x32_bf16 v[88:91], v[196:199], v[152:155], v[88:91]
    v_mfma_f32_16x16x32_bf16 v[84:87], v[196:199], v[144:147], v[84:87]
    s_add_u32 s29, s29, 1
    s_cmp_lt_u32 s29, 5
    s_cselect_b32 s28, s37, 4294901760
    s_cselect_b32 s29, s29, 0
    s_waitcnt lgkmcnt(4)
    v_mfma_f32_16x16x32_bf16 v[144:147], v[168:171], v[96:99], 0
    ds_read_b128 v[188:191], v252 offset:4352
    s_waitcnt lgkmcnt(4)
    v_mfma_f32_16x16x32_bf16 v[144:147], v[172:175], v[108:111], v[144:147]
    ds_read_b128 v[192:195], v252 offset:4608
    s_waitcnt lgkmcnt(4)
    v_mfma_f32_16x16x32_bf16 v[144:147], v[176:179], v[120:123], v[144:147]
    ds_read_b128 v[196:199], v252 offset:4864
    v_add_u32 v252, s28, v252
    s_waitcnt lgkmcnt(4)
    v_mfma_f32_16x16x32_bf16 v[144:147], v[180:183], v[132:135], v[144:147]
    v_mfma_f32_16x16x32_bf16 v[152:155], v[180:183], v[136:139], 0
    v_mfma_f32_16x16x32_bf16 v[152:155], v[176:179], v[124:127], v[152:155]
    v_mfma_f32_16x16x32_bf16 v[152:155], v[172:175], v[112:115], v[152:155]
    v_mfma_f32_16x16x32_bf16 v[152:155], v[168:171], v[100:103], v[152:155]
    v_mfma_f32_16x16x32_bf16 v[160:163], v[168:171], v[104:107], 0
    v_mfma_f32_16x16x32_bf16 v[160:163], v[172:175], v[116:119], v[160:163]
    v_mfma_f32_16x16x32_bf16 v[160:163], v[176:179], v[128:131], v[160:163]
    v_mfma_f32_16x16x32_bf16 v[160:163], v[180:183], v[140:143], v[160:163]
    s_waitcnt lgkmcnt(3)
    v_mfma_f32_16x16x32_bf16 v[148:151], v[184:187], v[96:99], 0
    s_waitcnt lgkmcnt(2)
    v_mfma_f32_16x16x32_bf16 v[148:151], v[188:191], v[108:111], v[148:151]
    s_waitcnt lgkmcnt(1)
    v_mfma_f32_16x16x32_bf16 v[148:151], v[192:195], v[120:123], v[148:151]
    v_exp_f32 v144, v144
    s_waitcnt lgkmcnt(0)
    v_mfma_f32_16x16x32_bf16 v[148:151], v[196:199], v[132:135], v[148:151]
    v_exp_f32 v145, v145
    v_mfma_f32_16x16x32_bf16 v[156:159], v[196:199], v[136:139], 0
    v_exp_f32 v146, v146
    v_mfma_f32_16x16x32_bf16 v[156:159], v[192:195], v[124:127], v[156:159]
    v_exp_f32 v147, v147
    v_mfma_f32_16x16x32_bf16 v[156:159], v[188:191], v[112:115], v[156:159]
    v_add_f32 v248, v248, v144
    v_add_f32 v248, v248, v145
    v_mfma_f32_16x16x32_bf16 v[156:159], v[184:187], v[100:103], v[156:159]
    v_add_f32 v248, v248, v146
    v_add_f32 v248, v248, v147
    v_mfma_f32_16x16x32_bf16 v[164:167], v[184:187], v[104:107], 0
    v_cvt_pk_bf16_f32 v144, v144, v145
    v_cvt_pk_bf16_f32 v145, v146, v147
    v_mfma_f32_16x16x32_bf16 v[164:167], v[188:191], v[116:119], v[164:167]
    v_exp_f32 v152, v152
    v_mfma_f32_16x16x32_bf16 v[164:167], v[192:195], v[128:131], v[164:167]
    v_exp_f32 v153, v153
    v_mfma_f32_16x16x32_bf16 v[164:167], v[196:199], v[140:143], v[164:167]
    v_exp_f32 v154, v154
    v_exp_f32 v155, v155
    v_add_f32 v249, v249, v152
    v_add_f32 v249, v249, v153
    v_add_f32 v249, v249, v154
    v_add_f32 v249, v249, v155
    v_cvt_pk_bf16_f32 v152, v152, v153
    v_cvt_pk_bf16_f32 v153, v154, v155
    v_exp_f32 v160, v160
    s_mov_b32 m0, s39
    s_nop 0
    buffer_load_dwordx4 v251, s[16:19], s25 offen nt lds
    v_exp_f32 v161, v161
    v_exp_f32 v162, v162
    v_exp_f32 v163, v163
    v_add_f32 v250, v250, v160
    v_add_f32 v250, v250, v161
    v_add_f32 v250, v250, v162
    v_add_f32 v250, v250, v163
    s_mov_b32 m0, s39
    s_nop 0
    buffer_load_dwordx4 v251, s[16:19], s25 offen offset:2048 nt lds
    v_cvt_pk_bf16_f32 v160, v160, v161
    v_cvt_pk_bf16_f32 v161, v162, v163
    v_exp_f32 v148, v148
    v_exp_f32 v149, v149
    v_exp_f32 v150, v150
    v_exp_f32 v151, v151
    s_add_u32 m0, s39, 4096
    s_add_u32 s25, s25, 4096
    buffer_load_dwordx4 v251, s[16:19], s25 offen nt lds
    v_add_f32 v248, v248, v148
    v_add_f32 v248, v248, v149
    v_add_f32 v248, v248, v150
    v_add_f32 v248, v248, v151
    v_cvt_pk_bf16_f32 v146, v148, v149
    v_cvt_pk_bf16_f32 v147, v150, v151
    v_exp_f32 v156, v156
    v_exp_f32 v157, v157
    s_add_u32 m0, s39, 4096
    s_nop 0
    buffer_load_dwordx4 v251, s[16:19], s25 offen offset:2048 nt lds
    s_add_u32 s25, s25, 4096
    s_and_b32 s25, s25, 0x1ffff
    s_add_u32 s39, s39, 16384
    s_cmp_ge_u32 s39, s68
    s_cselect_b32 s39, s74, s39
    v_exp_f32 v158, v158
    v_exp_f32 v159, v159
    v_add_f32 v249, v249, v156
    v_add_f32 v249, v249, v157
    v_add_f32 v249, v249, v158
    v_add_f32 v249, v249, v159
    v_cvt_pk_bf16_f32 v154, v156, v157
    v_cvt_pk_bf16_f32 v155, v158, v159
    s_mov_b32 m0, s26
    s_nop 0
    buffer_load_dwordx4 v255, s[12:15], s24 offen nt lds
    v_exp_f32 v164, v164
    v_exp_f32 v165, v165
    v_exp_f32 v166, v166
    v_exp_f32 v167, v167
    v_add_f32 v250, v250, v164
    v_add_f32 v250, v250, v165
    s_mov_b32 m0, s26
    s_nop 0
    buffer_load_dwordx4 v255, s[12:15], s24 offen offset:1024 nt lds
    v_add_f32 v250, v250, v166
    v_add_f32 v250, v250, v167
    v_cvt_pk_bf16_f32 v162, v164, v165
    v_cvt_pk_bf16_f32 v163, v166, v167
    s_waitcnt vmcnt(14)
    s_barrier
    ds_read_b64_tr_b16 v[168:169], v253 offset:0
    ds_read_b64_tr_b16 v[170:171], v253 offset:4096
    ds_read_b64_tr_b16 v[172:173], v254 offset:0
    ds_read_b64_tr_b16 v[174:175], v254 offset:4096
    ds_read_b64_tr_b16 v[176:177], v253 offset:256
    ds_read_b64_tr_b16 v[178:179], v253 offset:4352
    ds_read_b64_tr_b16 v[180:181], v254 offset:256
    ds_read_b64_tr_b16 v[182:183], v254 offset:4352
    ds_read_b64_tr_b16 v[184:185], v253 offset:512
    ds_read_b64_tr_b16 v[186:187], v253 offset:4608
    s_waitcnt lgkmcnt(8)
    v_mfma_f32_16x16x32_bf16 v[0:3], v[168:171], v[144:147], v[0:3]
    ds_read_b64_tr_b16 v[188:189], v254 offset:512
    ds_read_b64_tr_b16 v[190:191], v254 offset:4608
    v_mfma_f32_16x16x32_bf16 v[4:7], v[168:171], v[152:155], v[4:7]
    v_mfma_f32_16x16x32_bf16 v[8:11], v[168:171], v[160:163], v[8:11]
    s_waitcnt lgkmcnt(8)
    v_mfma_f32_16x16x32_bf16 v[20:23], v[172:175], v[160:163], v[20:23]
    ds_read_b64_tr_b16 v[192:193], v253 offset:768
    ds_read_b64_tr_b16 v[194:195], v253 offset:4864
    v_mfma_f32_16x16x32_bf16 v[16:19], v[172:175], v[152:155], v[16:19]
    v_mfma_f32_16x16x32_bf16 v[12:15], v[172:175], v[144:147], v[12:15]
    s_waitcnt lgkmcnt(8)
    v_mfma_f32_16x16x32_bf16 v[24:27], v[176:179], v[144:147], v[24:27]
    ds_read_b64_tr_b16 v[196:197], v254 offset:768
    ds_read_b64_tr_b16 v[198:199], v254 offset:4864
    v_add_u32 v253, s28, v253
    v_add_u32 v254, s28, v254
    v_mfma_f32_16x16x32_bf16 v[28:31], v[176:179], v[152:155], v[28:31]
    v_mfma_f32_16x16x32_bf16 v[32:35], v[176:179], v[160:163], v[32:35]
    s_waitcnt lgkmcnt(8)
    v_mfma_f32_16x16x32_bf16 v[44:47], v[180:183], v[160:163], v[44:47]
    ds_read_b128 v[168:171], v252 offset:0
    v_mfma_f32_16x16x32_bf16 v[40:43], v[180:183], v[152:155], v[40:43]
    v_mfma_f32_16x16x32_bf16 v[36:39], v[180:183], v[144:147], v[36:39]
    s_waitcnt lgkmcnt(7)
    v_mfma_f32_16x16x32_bf16 v[48:51], v[184:187], v[144:147], v[48:51]
    ds_read_b128 v[172:175], v252 offset:256
    v_mfma_f32_16x16x32_bf16 v[52:55], v[184:187], v[152:155], v[52:55]
    v_mfma_f32_16x16x32_bf16 v[56:59], v[184:187], v[160:163], v[56:59]
    s_waitcnt lgkmcnt(6)
    v_mfma_f32_16x16x32_bf16 v[68:71], v[188:191], v[160:163], v[68:71]
    ds_read_b128 v[176:179], v252 offset:512
    v_mfma_f32_16x16x32_bf16 v[64:67], v[188:191], v[152:155], v[64:67]
    v_mfma_f32_16x16x32_bf16 v[60:63], v[188:191], v[144:147], v[60:63]
    s_waitcnt lgkmcnt(5)
    v_mfma_f32_16x16x32_bf16 v[72:75], v[192:195], v[144:147], v[72:75]
    ds_read_b128 v[180:183], v252 offset:768
    v_mfma_f32_16x16x32_bf16 v[76:79], v[192:195], v[152:155], v[76:79]
    v_mfma_f32_16x16x32_bf16 v[80:83], v[192:195], v[160:163], v[80:83]
    s_waitcnt lgkmcnt(4)
    v_mfma_f32_16x16x32_bf16 v[92:95], v[196:199], v[160:163], v[92:95]
    ds_read_b128 v[184:187], v252 offset:4096
    v_mfma_f32_16x16x32_bf16 v[88:91], v[196:199], v[152:155], v[88:91]
    v_mfma_f32_16x16x32_bf16 v[84:87], v[196:199], v[144:147], v[84:87]
    s_add_u32 s29, s29, 1
    s_cmp_lt_u32 s29, 5
    s_cselect_b32 s28, s37, 4294901760
    s_cselect_b32 s29, s29, 0
    s_waitcnt lgkmcnt(4)
    v_mfma_f32_16x16x32_bf16 v[144:147], v[168:171], v[96:99], 0
    ds_read_b128 v[188:191], v252 offset:4352
    s_waitcnt lgkmcnt(4)
    v_mfma_f32_16x16x32_bf16 v[144:147], v[172:175], v[108:111], v[144:147]
    ds_read_b128 v[192:195], v252 offset:4608
    s_waitcnt lgkmcnt(4)
    v_mfma_f32_16x16x32_bf16 v[144:147], v[176:179], v[120:123], v[144:147]
    ds_read_b128 v[196:199], v252 offset:4864
    v_add_u32 v252, s28, v252
    s_waitcnt lgkmcnt(4)
    v_mfma_f32_16x16x32_bf16 v[144:147], v[180:183], v[132:135], v[144:147]
    v_mfma_f32_16x16x32_bf16 v[152:155], v[180:183], v[136:139], 0
    v_mfma_f32_16x16x32_bf16 v[152:155], v[176:179], v[124:127], v[152:155]
    v_mfma_f32_16x16x32_bf16 v[152:155], v[172:175], v[112:115], v[152:155]
    v_mfma_f32_16x16x32_bf16 v[152:155], v[168:171], v[100:103], v[152:155]
    v_mfma_f32_16x16x32_bf16 v[160:163], v[168:171], v[104:107], 0
    v_mfma_f32_16x16x32_bf16 v[160:163], v[172:175], v[116:119], v[160:163]
    v_mfma_f32_16x16x32_bf16 v[160:163], v[176:179], v[128:131], v[160:163]
    v_mfma_f32_16x16x32_bf16 v[160:163], v[180:183], v[140:143], v[160:163]
    s_waitcnt lgkmcnt(3)
    v_mfma_f32_16x16x32_bf16 v[148:151], v[184:187], v[96:99], 0
    s_waitcnt lgkmcnt(2)
    v_mfma_f32_16x16x32_bf16 v[148:151], v[188:191], v[108:111], v[148:151]
    s_waitcnt lgkmcnt(1)
    v_mfma_f32_16x16x32_bf16 v[148:151], v[192:195], v[120:123], v[148:151]
    v_exp_f32 v144, v144
    s_waitcnt lgkmcnt(0)
    v_mfma_f32_16x16x32_bf16 v[148:151], v[196:199], v[132:135], v[148:151]
    v_exp_f32 v145, v145
    v_mfma_f32_16x16x32_bf16 v[156:159], v[196:199], v[136:139], 0
    v_exp_f32 v146, v146
    v_mfma_f32_16x16x32_bf16 v[156:159], v[192:195], v[124:127], v[156:159]
    v_exp_f32 v147, v147
    v_mfma_f32_16x16x32_bf16 v[156:159], v[188:191], v[112:115], v[156:159]
    v_add_f32 v248, v248, v144
    v_add_f32 v248, v248, v145
    v_mfma_f32_16x16x32_bf16 v[156:159], v[184:187], v[100:103], v[156:159]
    v_add_f32 v248, v248, v146
    v_add_f32 v248, v248, v147
    v_mfma_f32_16x16x32_bf16 v[164:167], v[184:187], v[104:107], 0
    v_cvt_pk_bf16_f32 v144, v144, v145
    v_cvt_pk_bf16_f32 v145, v146, v147
    v_mfma_f32_16x16x32_bf16 v[164:167], v[188:191], v[116:119], v[164:167]
    v_exp_f32 v152, v152
    v_mfma_f32_16x16x32_bf16 v[164:167], v[192:195], v[128:131], v[164:167]
    v_exp_f32 v153, v153
    v_mfma_f32_16x16x32_bf16 v[164:167], v[196:199], v[140:143], v[164:167]
    v_exp_f32 v154, v154
    s_add_u32 s22, s73, 0
    v_lshrrev_b32 v247, 3, v246
    v_add_u32 v247, s22, v247
    ds_write_b128 v247, v[200:203] offset:0
    ds_write_b128 v247, v[204:207] offset:1024
    ds_write_b128 v247, v[208:211] offset:4096
    ds_write_b128 v247, v[212:215] offset:5120
    v_exp_f32 v155, v155
    v_add_f32 v249, v249, v152
    v_add_f32 v249, v249, v153
    v_add_f32 v249, v249, v154
    v_add_f32 v249, v249, v155
    v_cvt_pk_bf16_f32 v152, v152, v153
    v_cvt_pk_bf16_f32 v153, v154, v155
    s_add_u32 m0, s26, 4096
    s_add_u32 s24, s24, 4096
    buffer_load_dwordx4 v255, s[12:15], s24 offen nt lds
    v_exp_f32 v160, v160
    v_exp_f32 v161, v161
    v_exp_f32 v162, v162
    v_exp_f32 v163, v163
    s_add_u32 m0, s26, 4096
    s_nop 0
    buffer_load_dwordx4 v255, s[12:15], s24 offen offset:1024 nt lds
    s_add_u32 s24, s24, 4096
    s_and_b32 s24, s24, 0x1ffff
    s_add_u32 s26, s26, 16384
    s_cmp_ge_u32 s26, s38
    s_cselect_b32 s26, s73, s26
    s_add_u32 s24, s24, 8192
    s_and_b32 s24, s24, 0x1ffff
    s_add_u32 s26, s26, 16384
    s_cmp_ge_u32 s26, s38
    s_cselect_b32 s26, s73, s26
    v_add_f32 v250, v250, v160
    v_add_f32 v250, v250, v161
    v_add_f32 v250, v250, v162
    v_add_f32 v250, v250, v163
    v_cvt_pk_bf16_f32 v160, v160, v161
    v_cvt_pk_bf16_f32 v161, v162, v163
    v_exp_f32 v148, v148
    s_mov_b32 m0, s39
    s_nop 0
    buffer_load_dwordx4 v251, s[16:19], s25 offen nt lds
    v_exp_f32 v149, v149
    v_exp_f32 v150, v150
    v_exp_f32 v151, v151
    v_add_f32 v248, v248, v148
    v_add_f32 v248, v248, v149
    s_mov_b32 m0, s39
    s_nop 0
    buffer_load_dwordx4 v251, s[16:19], s25 offen offset:2048 nt lds
    v_add_f32 v248, v248, v150
    v_add_f32 v248, v248, v151
    v_cvt_pk_bf16_f32 v146, v148, v149
    v_cvt_pk_bf16_f32 v147, v150, v151
    v_exp_f32 v156, v156
    v_exp_f32 v157, v157
    s_add_u32 m0, s39, 4096
    s_add_u32 s25, s25, 4096
    buffer_load_dwordx4 v251, s[16:19], s25 offen nt lds
    v_exp_f32 v158, v158
    v_exp_f32 v159, v159
    v_add_f32 v249, v249, v156
    v_add_f32 v249, v249, v157
    v_add_f32 v249, v249, v158
    v_add_f32 v249, v249, v159
    s_add_u32 m0, s39, 4096
    s_nop 0
    buffer_load_dwordx4 v251, s[16:19], s25 offen offset:2048 nt lds
    s_add_u32 s25, s25, 4096
    s_and_b32 s25, s25, 0x1ffff
    s_add_u32 s39, s39, 16384
    s_cmp_ge_u32 s39, s68
    s_cselect_b32 s39, s74, s39
    v_cvt_pk_bf16_f32 v154, v156, v157
    v_cvt_pk_bf16_f32 v155, v158, v159
    v_exp_f32 v164, v164
    v_exp_f32 v165, v165
    v_exp_f32 v166, v166
    s_mov_b32 m0, s39
    s_nop 0
    buffer_load_dwordx4 v251, s[16:19], s25 offen nt lds
    v_exp_f32 v167, v167
    v_add_f32 v250, v250, v164
    v_add_f32 v250, v250, v165
    v_add_f32 v250, v250, v166
    v_add_f32 v250, v250, v167
    v_cvt_pk_bf16_f32 v162, v164, v165
    v_cvt_pk_bf16_f32 v163, v166, v167
    s_waitcnt lgkmcnt(0)
    s_waitcnt vmcnt(13)
    s_barrier
    ds_read_b64_tr_b16 v[168:169], v253 offset:0
    ds_read_b64_tr_b16 v[170:171], v253 offset:4096
    ds_read_b64_tr_b16 v[172:173], v254 offset:0
    ds_read_b64_tr_b16 v[174:175], v254 offset:4096
    ds_read_b64_tr_b16 v[176:177], v253 offset:256
    ds_read_b64_tr_b16 v[178:179], v253 offset:4352
    ds_read_b64_tr_b16 v[180:181], v254 offset:256
    ds_read_b64_tr_b16 v[182:183], v254 offset:4352
    ds_read_b64_tr_b16 v[184:185], v253 offset:512
    ds_read_b64_tr_b16 v[186:187], v253 offset:4608
    s_waitcnt lgkmcnt(8)
    v_mfma_f32_16x16x32_bf16 v[0:3], v[168:171], v[144:147], v[0:3]
    ds_read_b64_tr_b16 v[188:189], v254 offset:512
    ds_read_b64_tr_b16 v[190:191], v254 offset:4608
    v_mfma_f32_16x16x32_bf16 v[4:7], v[168:171], v[152:155], v[4:7]
    v_mfma_f32_16x16x32_bf16 v[8:11], v[168:171], v[160:163], v[8:11]
    s_waitcnt lgkmcnt(8)
    v_mfma_f32_16x16x32_bf16 v[20:23], v[172:175], v[160:163], v[20:23]
    ds_read_b64_tr_b16 v[192:193], v253 offset:768
    ds_read_b64_tr_b16 v[194:195], v253 offset:4864
    v_mfma_f32_16x16x32_bf16 v[16:19], v[172:175], v[152:155], v[16:19]
    v_mfma_f32_16x16x32_bf16 v[12:15], v[172:175], v[144:147], v[12:15]
    s_waitcnt lgkmcnt(8)
    v_mfma_f32_16x16x32_bf16 v[24:27], v[176:179], v[144:147], v[24:27]
    ds_read_b64_tr_b16 v[196:197], v254 offset:768
    ds_read_b64_tr_b16 v[198:199], v254 offset:4864
    v_add_u32 v253, s28, v253
    v_add_u32 v254, s28, v254
    v_mfma_f32_16x16x32_bf16 v[28:31], v[176:179], v[152:155], v[28:31]
    v_mfma_f32_16x16x32_bf16 v[32:35], v[176:179], v[160:163], v[32:35]
    s_waitcnt lgkmcnt(8)
    v_mfma_f32_16x16x32_bf16 v[44:47], v[180:183], v[160:163], v[44:47]
    ds_read_b128 v[168:171], v252 offset:0
    v_mfma_f32_16x16x32_bf16 v[40:43], v[180:183], v[152:155], v[40:43]
    v_mfma_f32_16x16x32_bf16 v[36:39], v[180:183], v[144:147], v[36:39]
    s_waitcnt lgkmcnt(7)
    v_mfma_f32_16x16x32_bf16 v[48:51], v[184:187], v[144:147], v[48:51]
    ds_read_b128 v[172:175], v252 offset:256
    v_mfma_f32_16x16x32_bf16 v[52:55], v[184:187], v[152:155], v[52:55]
    v_mfma_f32_16x16x32_bf16 v[56:59], v[184:187], v[160:163], v[56:59]
    s_waitcnt lgkmcnt(6)
    v_mfma_f32_16x16x32_bf16 v[68:71], v[188:191], v[160:163], v[68:71]
    ds_read_b128 v[176:179], v252 offset:512
    v_mfma_f32_16x16x32_bf16 v[64:67], v[188:191], v[152:155], v[64:67]
    v_mfma_f32_16x16x32_bf16 v[60:63], v[188:191], v[144:147], v[60:63]
    s_waitcnt lgkmcnt(5)
    v_mfma_f32_16x16x32_bf16 v[72:75], v[192:195], v[144:147], v[72:75]
    ds_read_b128 v[180:183], v252 offset:768
    v_mfma_f32_16x16x32_bf16 v[76:79], v[192:195], v[152:155], v[76:79]
    v_mfma_f32_16x16x32_bf16 v[80:83], v[192:195], v[160:163], v[80:83]
    s_waitcnt lgkmcnt(4)
    v_mfma_f32_16x16x32_bf16 v[92:95], v[196:199], v[160:163], v[92:95]
    ds_read_b128 v[184:187], v252 offset:4096
    v_mfma_f32_16x16x32_bf16 v[88:91], v[196:199], v[152:155], v[88:91]
    v_mfma_f32_16x16x32_bf16 v[84:87], v[196:199], v[144:147], v[84:87]
    s_add_u32 s29, s29, 1
    s_cmp_lt_u32 s29, 5
    s_cselect_b32 s28, s37, 4294901760
    s_cselect_b32 s29, s29, 0
    s_waitcnt lgkmcnt(4)
    v_mfma_f32_16x16x32_bf16 v[144:147], v[168:171], v[96:99], 0
    ds_read_b128 v[188:191], v252 offset:4352
    s_waitcnt lgkmcnt(4)
    v_mfma_f32_16x16x32_bf16 v[144:147], v[172:175], v[108:111], v[144:147]
    ds_read_b128 v[192:195], v252 offset:4608
    s_waitcnt lgkmcnt(4)
    v_mfma_f32_16x16x32_bf16 v[144:147], v[176:179], v[120:123], v[144:147]
    ds_read_b128 v[196:199], v252 offset:4864
    v_add_u32 v252, s28, v252
    s_waitcnt lgkmcnt(4)
    v_mfma_f32_16x16x32_bf16 v[144:147], v[180:183], v[132:135], v[144:147]
    v_mfma_f32_16x16x32_bf16 v[152:155], v[180:183], v[136:139], 0
    v_mfma_f32_16x16x32_bf16 v[152:155], v[176:179], v[124:127], v[152:155]
    v_mfma_f32_16x16x32_bf16 v[152:155], v[172:175], v[112:115], v[152:155]
    v_mfma_f32_16x16x32_bf16 v[152:155], v[168:171], v[100:103], v[152:155]
    v_mfma_f32_16x16x32_bf16 v[160:163], v[168:171], v[104:107], 0
    v_mfma_f32_16x16x32_bf16 v[160:163], v[172:175], v[116:119], v[160:163]
    v_mfma_f32_16x16x32_bf16 v[160:163], v[176:179], v[128:131], v[160:163]
    v_mfma_f32_16x16x32_bf16 v[160:163], v[180:183], v[140:143], v[160:163]
    s_waitcnt lgkmcnt(3)
    v_mfma_f32_16x16x32_bf16 v[148:151], v[184:187], v[96:99], 0
    s_waitcnt lgkmcnt(2)
    v_mfma_f32_16x16x32_bf16 v[148:151], v[188:191], v[108:111], v[148:151]
    s_waitcnt lgkmcnt(1)
    v_mfma_f32_16x16x32_bf16 v[148:151], v[192:195], v[120:123], v[148:151]
    v_exp_f32 v144, v144
    s_waitcnt lgkmcnt(0)
    v_mfma_f32_16x16x32_bf16 v[148:151], v[196:199], v[132:135], v[148:151]
    v_exp_f32 v145, v145
    v_mfma_f32_16x16x32_bf16 v[156:159], v[196:199], v[136:139], 0
    v_exp_f32 v146, v146
    v_mfma_f32_16x16x32_bf16 v[156:159], v[192:195], v[124:127], v[156:159]
    v_exp_f32 v147, v147
    v_mfma_f32_16x16x32_bf16 v[156:159], v[188:191], v[112:115], v[156:159]
    v_add_f32 v248, v248, v144
    v_add_f32 v248, v248, v145
    v_mfma_f32_16x16x32_bf16 v[156:159], v[184:187], v[100:103], v[156:159]
    v_add_f32 v248, v248, v146
    v_add_f32 v248, v248, v147
    v_mfma_f32_16x16x32_bf16 v[164:167], v[184:187], v[104:107], 0
    v_cvt_pk_bf16_f32 v144, v144, v145
    v_cvt_pk_bf16_f32 v145, v146, v147
    v_mfma_f32_16x16x32_bf16 v[164:167], v[188:191], v[116:119], v[164:167]
    v_exp_f32 v152, v152
    v_mfma_f32_16x16x32_bf16 v[164:167], v[192:195], v[128:131], v[164:167]
    v_exp_f32 v153, v153
    v_mfma_f32_16x16x32_bf16 v[164:167], v[196:199], v[140:143], v[164:167]
    v_exp_f32 v154, v154
    v_exp_f32 v155, v155
    v_add_f32 v249, v249, v152
    v_add_f32 v249, v249, v153
    v_add_f32 v249, v249, v154
    v_add_f32 v249, v249, v155
    v_cvt_pk_bf16_f32 v152, v152, v153
    v_cvt_pk_bf16_f32 v153, v154, v155
    s_mov_b32 m0, s39
    s_nop 0
    buffer_load_dwordx4 v251, s[16:19], s25 offen offset:2048 nt lds
    v_exp_f32 v160, v160
    v_exp_f32 v161, v161
    v_exp_f32 v162, v162
    v_exp_f32 v163, v163
    s_add_u32 m0, s39, 4096
    s_add_u32 s25, s25, 4096
    buffer_load_dwordx4 v251, s[16:19], s25 offen nt lds
    v_add_f32 v250, v250, v160
    v_add_f32 v250, v250, v161
    v_add_f32 v250, v250, v162
    v_add_f32 v250, v250, v163
    v_cvt_pk_bf16_f32 v160, v160, v161
    v_cvt_pk_bf16_f32 v161, v162, v163
    v_exp_f32 v148, v148
    s_add_u32 m0, s39, 4096
    s_nop 0
    buffer_load_dwordx4 v251, s[16:19], s25 offen offset:2048 nt lds
    s_add_u32 s25, s25, 4096
    s_and_b32 s25, s25, 0x1ffff
    s_add_u32 s39, s39, 16384
    s_cmp_ge_u32 s39, s68
    s_cselect_b32 s39, s74, s39
    v_exp_f32 v149, v149
    v_exp_f32 v150, v150
    v_exp_f32 v151, v151
    v_add_f32 v248, v248, v148
    v_add_f32 v248, v248, v149
    s_mov_b32 m0, s26
    s_nop 0
    buffer_load_dwordx4 v255, s[12:15], s24 offen nt lds
    v_add_f32 v248, v248, v150
    v_add_f32 v248, v248, v151
    v_cvt_pk_bf16_f32 v146, v148, v149
    v_cvt_pk_bf16_f32 v147, v150, v151
    v_exp_f32 v156, v156
    v_exp_f32 v157, v157
    s_mov_b32 m0, s26
    s_nop 0
    buffer_load_dwordx4 v255, s[12:15], s24 offen offset:1024 nt lds
    v_exp_f32 v158, v158
    v_exp_f32 v159, v159
    v_add_f32 v249, v249, v156
    v_add_f32 v249, v249, v157
    v_add_f32 v249, v249, v158
    v_add_f32 v249, v249, v159
    s_add_u32 m0, s26, 4096
    s_add_u32 s24, s24, 4096
    buffer_load_dwordx4 v255, s[12:15], s24 offen nt lds
    v_cvt_pk_bf16_f32 v154, v156, v157
    v_cvt_pk_bf16_f32 v155, v158, v159
    v_exp_f32 v164, v164
    v_exp_f32 v165, v165
    v_exp_f32 v166, v166
    s_add_u32 m0, s26, 4096
    s_nop 0
    buffer_load_dwordx4 v255, s[12:15], s24 offen offset:1024 nt lds
    s_add_u32 s24, s24, 4096
    s_and_b32 s24, s24, 0x1ffff
    s_add_u32 s26, s26, 16384
    s_cmp_ge_u32 s26, s38
    s_cselect_b32 s26, s73, s26
    v_exp_f32 v167, v167
    v_add_f32 v250, v250, v164
    v_add_f32 v250, v250, v165
    v_add_f32 v250, v250, v166
    v_add_f32 v250, v250, v167
    v_cvt_pk_bf16_f32 v162, v164, v165
    v_cvt_pk_bf16_f32 v163, v166, v167
    s_waitcnt vmcnt(12)
    s_barrier
    ds_read_b64_tr_b16 v[168:169], v253 offset:0
    ds_read_b64_tr_b16 v[170:171], v253 offset:4096
    ds_read_b64_tr_b16 v[172:173], v254 offset:0
    ds_read_b64_tr_b16 v[174:175], v254 offset:4096
    ds_read_b64_tr_b16 v[176:177], v253 offset:256
    ds_read_b64_tr_b16 v[178:179], v253 offset:4352
    ds_read_b64_tr_b16 v[180:181], v254 offset:256
    ds_read_b64_tr_b16 v[182:183], v254 offset:4352
    ds_read_b64_tr_b16 v[184:185], v253 offset:512
    ds_read_b64_tr_b16 v[186:187], v253 offset:4608
    s_waitcnt lgkmcnt(8)
    v_mfma_f32_16x16x32_bf16 v[0:3], v[168:171], v[144:147], v[0:3]
    ds_read_b64_tr_b16 v[188:189], v254 offset:512
    ds_read_b64_tr_b16 v[190:191], v254 offset:4608
    v_mfma_f32_16x16x32_bf16 v[4:7], v[168:171], v[152:155], v[4:7]
    v_mfma_f32_16x16x32_bf16 v[8:11], v[168:171], v[160:163], v[8:11]
    s_waitcnt lgkmcnt(8)
    v_mfma_f32_16x16x32_bf16 v[20:23], v[172:175], v[160:163], v[20:23]
    ds_read_b64_tr_b16 v[192:193], v253 offset:768
    ds_read_b64_tr_b16 v[194:195], v253 offset:4864
    v_mfma_f32_16x16x32_bf16 v[16:19], v[172:175], v[152:155], v[16:19]
    v_mfma_f32_16x16x32_bf16 v[12:15], v[172:175], v[144:147], v[12:15]
    s_waitcnt lgkmcnt(8)
    v_mfma_f32_16x16x32_bf16 v[24:27], v[176:179], v[144:147], v[24:27]
    ds_read_b64_tr_b16 v[196:197], v254 offset:768
    ds_read_b64_tr_b16 v[198:199], v254 offset:4864
    v_add_u32 v253, s28, v253
    v_add_u32 v254, s28, v254
    v_mfma_f32_16x16x32_bf16 v[28:31], v[176:179], v[152:155], v[28:31]
    v_mfma_f32_16x16x32_bf16 v[32:35], v[176:179], v[160:163], v[32:35]
    s_waitcnt lgkmcnt(8)
    v_mfma_f32_16x16x32_bf16 v[44:47], v[180:183], v[160:163], v[44:47]
    ds_read_b128 v[168:171], v252 offset:0
    v_mfma_f32_16x16x32_bf16 v[40:43], v[180:183], v[152:155], v[40:43]
    v_mfma_f32_16x16x32_bf16 v[36:39], v[180:183], v[144:147], v[36:39]
    s_waitcnt lgkmcnt(7)
    v_mfma_f32_16x16x32_bf16 v[48:51], v[184:187], v[144:147], v[48:51]
    ds_read_b128 v[172:175], v252 offset:256
    v_mfma_f32_16x16x32_bf16 v[52:55], v[184:187], v[152:155], v[52:55]
    v_mfma_f32_16x16x32_bf16 v[56:59], v[184:187], v[160:163], v[56:59]
    s_waitcnt lgkmcnt(6)
    v_mfma_f32_16x16x32_bf16 v[68:71], v[188:191], v[160:163], v[68:71]
    ds_read_b128 v[176:179], v252 offset:512
    v_mfma_f32_16x16x32_bf16 v[64:67], v[188:191], v[152:155], v[64:67]
    v_mfma_f32_16x16x32_bf16 v[60:63], v[188:191], v[144:147], v[60:63]
    s_waitcnt lgkmcnt(5)
    v_mfma_f32_16x16x32_bf16 v[72:75], v[192:195], v[144:147], v[72:75]
    ds_read_b128 v[180:183], v252 offset:768
    v_mfma_f32_16x16x32_bf16 v[76:79], v[192:195], v[152:155], v[76:79]
    v_mfma_f32_16x16x32_bf16 v[80:83], v[192:195], v[160:163], v[80:83]
    s_waitcnt lgkmcnt(4)
    v_mfma_f32_16x16x32_bf16 v[92:95], v[196:199], v[160:163], v[92:95]
    ds_read_b128 v[184:187], v252 offset:4096
    v_mfma_f32_16x16x32_bf16 v[88:91], v[196:199], v[152:155], v[88:91]
    v_mfma_f32_16x16x32_bf16 v[84:87], v[196:199], v[144:147], v[84:87]
    s_add_u32 s29, s29, 1
    s_cmp_lt_u32 s29, 5
    s_cselect_b32 s28, s37, 4294901760
    s_cselect_b32 s29, s29, 0
    s_waitcnt lgkmcnt(4)
    v_mfma_f32_16x16x32_bf16 v[144:147], v[168:171], v[96:99], 0
    ds_read_b128 v[188:191], v252 offset:4352
    s_waitcnt lgkmcnt(4)
    v_mfma_f32_16x16x32_bf16 v[144:147], v[172:175], v[108:111], v[144:147]
    ds_read_b128 v[192:195], v252 offset:4608
    s_waitcnt lgkmcnt(4)
    v_mfma_f32_16x16x32_bf16 v[144:147], v[176:179], v[120:123], v[144:147]
    ds_read_b128 v[196:199], v252 offset:4864
    v_add_u32 v252, s28, v252
    s_waitcnt lgkmcnt(4)
    v_mfma_f32_16x16x32_bf16 v[144:147], v[180:183], v[132:135], v[144:147]
    v_mfma_f32_16x16x32_bf16 v[152:155], v[180:183], v[136:139], 0
    v_mfma_f32_16x16x32_bf16 v[152:155], v[176:179], v[124:127], v[152:155]
    v_mfma_f32_16x16x32_bf16 v[152:155], v[172:175], v[112:115], v[152:155]
    v_mfma_f32_16x16x32_bf16 v[152:155], v[168:171], v[100:103], v[152:155]
    v_mfma_f32_16x16x32_bf16 v[160:163], v[168:171], v[104:107], 0
    v_mfma_f32_16x16x32_bf16 v[160:163], v[172:175], v[116:119], v[160:163]
    v_mfma_f32_16x16x32_bf16 v[160:163], v[176:179], v[128:131], v[160:163]
    v_mfma_f32_16x16x32_bf16 v[160:163], v[180:183], v[140:143], v[160:163]
    s_waitcnt lgkmcnt(3)
    v_mfma_f32_16x16x32_bf16 v[148:151], v[184:187], v[96:99], 0
    s_waitcnt lgkmcnt(2)
    v_mfma_f32_16x16x32_bf16 v[148:151], v[188:191], v[108:111], v[148:151]
    s_waitcnt lgkmcnt(1)
    v_mfma_f32_16x16x32_bf16 v[148:151], v[192:195], v[120:123], v[148:151]
    v_exp_f32 v144, v144
    s_waitcnt lgkmcnt(0)
    v_mfma_f32_16x16x32_bf16 v[148:151], v[196:199], v[132:135], v[148:151]
    v_exp_f32 v145, v145
    v_mfma_f32_16x16x32_bf16 v[156:159], v[196:199], v[136:139], 0
    v_exp_f32 v146, v146
    v_mfma_f32_16x16x32_bf16 v[156:159], v[192:195], v[124:127], v[156:159]
    v_exp_f32 v147, v147
    v_mfma_f32_16x16x32_bf16 v[156:159], v[188:191], v[112:115], v[156:159]
    v_add_f32 v248, v248, v144
    v_add_f32 v248, v248, v145
    v_mfma_f32_16x16x32_bf16 v[156:159], v[184:187], v[100:103], v[156:159]
    v_add_f32 v248, v248, v146
    v_add_f32 v248, v248, v147
    v_mfma_f32_16x16x32_bf16 v[164:167], v[184:187], v[104:107], 0
    v_cvt_pk_bf16_f32 v144, v144, v145
    v_cvt_pk_bf16_f32 v145, v146, v147
    v_mfma_f32_16x16x32_bf16 v[164:167], v[188:191], v[116:119], v[164:167]
    v_exp_f32 v152, v152
    v_mfma_f32_16x16x32_bf16 v[164:167], v[192:195], v[128:131], v[164:167]
    v_exp_f32 v153, v153
    v_mfma_f32_16x16x32_bf16 v[164:167], v[196:199], v[140:143], v[164:167]
    v_exp_f32 v154, v154
    v_exp_f32 v155, v155
    v_add_f32 v249, v249, v152
    v_add_f32 v249, v249, v153
    v_add_f32 v249, v249, v154
    v_add_f32 v249, v249, v155
    v_cvt_pk_bf16_f32 v152, v152, v153
    v_cvt_pk_bf16_f32 v153, v154, v155
    v_exp_f32 v160, v160
    s_mov_b32 m0, s39
    s_nop 0
    buffer_load_dwordx4 v251, s[16:19], s25 offen nt lds
    v_exp_f32 v161, v161
    v_exp_f32 v162, v162
    v_exp_f32 v163, v163
    v_add_f32 v250, v250, v160
    v_add_f32 v250, v250, v161
    v_add_f32 v250, v250, v162
    v_add_f32 v250, v250, v163
    s_mov_b32 m0, s39
    s_nop 0
    buffer_load_dwordx4 v251, s[16:19], s25 offen offset:2048 nt lds
    v_cvt_pk_bf16_f32 v160, v160, v161
    v_cvt_pk_bf16_f32 v161, v162, v163
    v_exp_f32 v148, v148
    v_exp_f32 v149, v149
    v_exp_f32 v150, v150
    v_exp_f32 v151, v151
    s_add_u32 m0, s39, 4096
    s_add_u32 s25, s25, 4096
    buffer_load_dwordx4 v251, s[16:19], s25 offen nt lds
    v_add_f32 v248, v248, v148
    v_add_f32 v248, v248, v149
    v_add_f32 v248, v248, v150
    v_add_f32 v248, v248, v151
    v_cvt_pk_bf16_f32 v146, v148, v149
    v_cvt_pk_bf16_f32 v147, v150, v151
    v_exp_f32 v156, v156
    v_exp_f32 v157, v157
    s_add_u32 m0, s39, 4096
    s_nop 0
    buffer_load_dwordx4 v251, s[16:19], s25 offen offset:2048 nt lds
    s_add_u32 s25, s25, 4096
    s_and_b32 s25, s25, 0x1ffff
    s_add_u32 s39, s39, 16384
    s_cmp_ge_u32 s39, s68
    s_cselect_b32 s39, s74, s39
    v_exp_f32 v158, v158
    v_exp_f32 v159, v159
    v_add_f32 v249, v249, v156
    v_add_f32 v249, v249, v157
    v_add_f32 v249, v249, v158
    v_add_f32 v249, v249, v159
    v_cvt_pk_bf16_f32 v154, v156, v157
    v_cvt_pk_bf16_f32 v155, v158, v159
    s_mov_b32 m0, s26
    s_nop 0
    buffer_load_dwordx4 v255, s[12:15], s24 offen nt lds
    v_exp_f32 v164, v164
    v_exp_f32 v165, v165
    v_exp_f32 v166, v166
    v_exp_f32 v167, v167
    v_add_f32 v250, v250, v164
    v_add_f32 v250, v250, v165
    s_mov_b32 m0, s26
    s_nop 0
    buffer_load_dwordx4 v255, s[12:15], s24 offen offset:1024 nt lds
    v_add_f32 v250, v250, v166
    v_add_f32 v250, v250, v167
    v_cvt_pk_bf16_f32 v162, v164, v165
    v_cvt_pk_bf16_f32 v163, v166, v167
    s_waitcnt vmcnt(14)
    s_barrier
    ds_read_b64_tr_b16 v[168:169], v253 offset:0
    ds_read_b64_tr_b16 v[170:171], v253 offset:4096
    ds_read_b64_tr_b16 v[172:173], v254 offset:0
    ds_read_b64_tr_b16 v[174:175], v254 offset:4096
    ds_read_b64_tr_b16 v[176:177], v253 offset:256
    ds_read_b64_tr_b16 v[178:179], v253 offset:4352
    ds_read_b64_tr_b16 v[180:181], v254 offset:256
    ds_read_b64_tr_b16 v[182:183], v254 offset:4352
    ds_read_b64_tr_b16 v[184:185], v253 offset:512
    ds_read_b64_tr_b16 v[186:187], v253 offset:4608
    s_waitcnt lgkmcnt(8)
    v_mfma_f32_16x16x32_bf16 v[0:3], v[168:171], v[144:147], v[0:3]
    ds_read_b64_tr_b16 v[188:189], v254 offset:512
    ds_read_b64_tr_b16 v[190:191], v254 offset:4608
    v_mfma_f32_16x16x32_bf16 v[4:7], v[168:171], v[152:155], v[4:7]
    v_mfma_f32_16x16x32_bf16 v[8:11], v[168:171], v[160:163], v[8:11]
    s_waitcnt lgkmcnt(8)
    v_mfma_f32_16x16x32_bf16 v[20:23], v[172:175], v[160:163], v[20:23]
    ds_read_b64_tr_b16 v[192:193], v253 offset:768
    ds_read_b64_tr_b16 v[194:195], v253 offset:4864
    v_mfma_f32_16x16x32_bf16 v[16:19], v[172:175], v[152:155], v[16:19]
    v_mfma_f32_16x16x32_bf16 v[12:15], v[172:175], v[144:147], v[12:15]
    s_waitcnt lgkmcnt(8)
    v_mfma_f32_16x16x32_bf16 v[24:27], v[176:179], v[144:147], v[24:27]
    ds_read_b64_tr_b16 v[196:197], v254 offset:768
    ds_read_b64_tr_b16 v[198:199], v254 offset:4864
    v_add_u32 v253, s28, v253
    v_add_u32 v254, s28, v254
    v_mfma_f32_16x16x32_bf16 v[28:31], v[176:179], v[152:155], v[28:31]
    v_mfma_f32_16x16x32_bf16 v[32:35], v[176:179], v[160:163], v[32:35]
    s_waitcnt lgkmcnt(8)
    v_mfma_f32_16x16x32_bf16 v[44:47], v[180:183], v[160:163], v[44:47]
    ds_read_b128 v[168:171], v252 offset:0
    v_mfma_f32_16x16x32_bf16 v[40:43], v[180:183], v[152:155], v[40:43]
    v_mfma_f32_16x16x32_bf16 v[36:39], v[180:183], v[144:147], v[36:39]
    s_waitcnt lgkmcnt(7)
    v_mfma_f32_16x16x32_bf16 v[48:51], v[184:187], v[144:147], v[48:51]
    ds_read_b128 v[172:175], v252 offset:256
    v_mfma_f32_16x16x32_bf16 v[52:55], v[184:187], v[152:155], v[52:55]
    v_mfma_f32_16x16x32_bf16 v[56:59], v[184:187], v[160:163], v[56:59]
    s_waitcnt lgkmcnt(6)
    v_mfma_f32_16x16x32_bf16 v[68:71], v[188:191], v[160:163], v[68:71]
    ds_read_b128 v[176:179], v252 offset:512
    v_mfma_f32_16x16x32_bf16 v[64:67], v[188:191], v[152:155], v[64:67]
    v_mfma_f32_16x16x32_bf16 v[60:63], v[188:191], v[144:147], v[60:63]
    s_waitcnt lgkmcnt(5)
    v_mfma_f32_16x16x32_bf16 v[72:75], v[192:195], v[144:147], v[72:75]
    ds_read_b128 v[180:183], v252 offset:768
    v_mfma_f32_16x16x32_bf16 v[76:79], v[192:195], v[152:155], v[76:79]
    v_mfma_f32_16x16x32_bf16 v[80:83], v[192:195], v[160:163], v[80:83]
    s_waitcnt lgkmcnt(4)
    v_mfma_f32_16x16x32_bf16 v[92:95], v[196:199], v[160:163], v[92:95]
    ds_read_b128 v[184:187], v252 offset:4096
    v_mfma_f32_16x16x32_bf16 v[88:91], v[196:199], v[152:155], v[88:91]
    v_mfma_f32_16x16x32_bf16 v[84:87], v[196:199], v[144:147], v[84:87]
    s_add_u32 s29, s29, 1
    s_cmp_lt_u32 s29, 5
    s_cselect_b32 s28, s37, 4294901760
    s_cselect_b32 s29, s29, 0
    s_waitcnt lgkmcnt(4)
    v_mfma_f32_16x16x32_bf16 v[144:147], v[168:171], v[96:99], 0
    ds_read_b128 v[188:191], v252 offset:4352
    s_waitcnt lgkmcnt(4)
    v_mfma_f32_16x16x32_bf16 v[144:147], v[172:175], v[108:111], v[144:147]
    ds_read_b128 v[192:195], v252 offset:4608
    s_waitcnt lgkmcnt(4)
    v_mfma_f32_16x16x32_bf16 v[144:147], v[176:179], v[120:123], v[144:147]
    ds_read_b128 v[196:199], v252 offset:4864
    v_add_u32 v252, s28, v252
    s_waitcnt lgkmcnt(4)
    v_mfma_f32_16x16x32_bf16 v[144:147], v[180:183], v[132:135], v[144:147]
    v_mfma_f32_16x16x32_bf16 v[152:155], v[180:183], v[136:139], 0
    v_mfma_f32_16x16x32_bf16 v[152:155], v[176:179], v[124:127], v[152:155]
    v_mfma_f32_16x16x32_bf16 v[152:155], v[172:175], v[112:115], v[152:155]
    v_mfma_f32_16x16x32_bf16 v[152:155], v[168:171], v[100:103], v[152:155]
    v_mfma_f32_16x16x32_bf16 v[160:163], v[168:171], v[104:107], 0
    v_mfma_f32_16x16x32_bf16 v[160:163], v[172:175], v[116:119], v[160:163]
    v_mfma_f32_16x16x32_bf16 v[160:163], v[176:179], v[128:131], v[160:163]
    v_mfma_f32_16x16x32_bf16 v[160:163], v[180:183], v[140:143], v[160:163]
    s_waitcnt lgkmcnt(3)
    v_mfma_f32_16x16x32_bf16 v[148:151], v[184:187], v[96:99], 0
    s_waitcnt lgkmcnt(2)
    v_mfma_f32_16x16x32_bf16 v[148:151], v[188:191], v[108:111], v[148:151]
    s_waitcnt lgkmcnt(1)
    v_mfma_f32_16x16x32_bf16 v[148:151], v[192:195], v[120:123], v[148:151]
    v_exp_f32 v144, v144
    s_waitcnt lgkmcnt(0)
    v_mfma_f32_16x16x32_bf16 v[148:151], v[196:199], v[132:135], v[148:151]
    v_exp_f32 v145, v145
    v_mfma_f32_16x16x32_bf16 v[156:159], v[196:199], v[136:139], 0
    v_exp_f32 v146, v146
    v_mfma_f32_16x16x32_bf16 v[156:159], v[192:195], v[124:127], v[156:159]
    v_exp_f32 v147, v147
    v_mfma_f32_16x16x32_bf16 v[156:159], v[188:191], v[112:115], v[156:159]
    v_add_f32 v248, v248, v144
    v_add_f32 v248, v248, v145
    v_mfma_f32_16x16x32_bf16 v[156:159], v[184:187], v[100:103], v[156:159]
    v_add_f32 v248, v248, v146
    v_add_f32 v248, v248, v147
    v_mfma_f32_16x16x32_bf16 v[164:167], v[184:187], v[104:107], 0
    v_cvt_pk_bf16_f32 v144, v144, v145
    v_cvt_pk_bf16_f32 v145, v146, v147
    v_mfma_f32_16x16x32_bf16 v[164:167], v[188:191], v[116:119], v[164:167]
    v_exp_f32 v152, v152
    v_mfma_f32_16x16x32_bf16 v[164:167], v[192:195], v[128:131], v[164:167]
    v_exp_f32 v153, v153
    v_mfma_f32_16x16x32_bf16 v[164:167], v[196:199], v[140:143], v[164:167]
    v_exp_f32 v154, v154
    v_exp_f32 v155, v155
    v_add_f32 v249, v249, v152
    v_add_f32 v249, v249, v153
    v_add_f32 v249, v249, v154
    v_add_f32 v249, v249, v155
    v_cvt_pk_bf16_f32 v152, v152, v153
    v_cvt_pk_bf16_f32 v153, v154, v155
    s_add_u32 m0, s26, 4096
    s_add_u32 s24, s24, 4096
    buffer_load_dwordx4 v255, s[12:15], s24 offen nt lds
    v_exp_f32 v160, v160
    v_exp_f32 v161, v161
    v_exp_f32 v162, v162
    v_exp_f32 v163, v163
    s_add_u32 m0, s26, 4096
    s_nop 0
    buffer_load_dwordx4 v255, s[12:15], s24 offen offset:1024 nt lds
    s_add_u32 s24, s24, 4096
    s_and_b32 s24, s24, 0x1ffff
    s_add_u32 s26, s26, 16384
    s_cmp_ge_u32 s26, s38
    s_cselect_b32 s26, s73, s26
    v_add_f32 v250, v250, v160
    v_add_f32 v250, v250, v161
    v_add_f32 v250, v250, v162
    v_add_f32 v250, v250, v163
    v_cvt_pk_bf16_f32 v160, v160, v161
    v_cvt_pk_bf16_f32 v161, v162, v163
    v_exp_f32 v148, v148
    s_mov_b32 m0, s39
    s_nop 0
    buffer_load_dwordx4 v251, s[16:19], s25 offen nt lds
    v_exp_f32 v149, v149
    v_exp_f32 v150, v150
    v_exp_f32 v151, v151
    v_add_f32 v248, v248, v148
    v_add_f32 v248, v248, v149
    s_mov_b32 m0, s39
    s_nop 0
    buffer_load_dwordx4 v251, s[16:19], s25 offen offset:2048 nt lds
    v_add_f32 v248, v248, v150
    v_add_f32 v248, v248, v151
    v_cvt_pk_bf16_f32 v146, v148, v149
    v_cvt_pk_bf16_f32 v147, v150, v151
    v_exp_f32 v156, v156
    v_exp_f32 v157, v157
    s_add_u32 m0, s39, 4096
    s_add_u32 s25, s25, 4096
    buffer_load_dwordx4 v251, s[16:19], s25 offen nt lds
    v_exp_f32 v158, v158
    v_exp_f32 v159, v159
    v_add_f32 v249, v249, v156
    v_add_f32 v249, v249, v157
    v_add_f32 v249, v249, v158
    v_add_f32 v249, v249, v159
    s_add_u32 m0, s39, 4096
    s_nop 0
    buffer_load_dwordx4 v251, s[16:19], s25 offen offset:2048 nt lds
    s_add_u32 s25, s25, 4096
    s_and_b32 s25, s25, 0x1ffff
    s_add_u32 s39, s39, 16384
    s_cmp_ge_u32 s39, s68
    s_cselect_b32 s39, s74, s39
    v_cvt_pk_bf16_f32 v154, v156, v157
    v_cvt_pk_bf16_f32 v155, v158, v159
    v_exp_f32 v164, v164
    v_exp_f32 v165, v165
    v_exp_f32 v166, v166
    s_mov_b32 m0, s26
    s_nop 0
    buffer_load_dwordx4 v255, s[12:15], s24 offen nt lds
    v_exp_f32 v167, v167
    v_add_f32 v250, v250, v164
    v_add_f32 v250, v250, v165
    v_add_f32 v250, v250, v166
    v_add_f32 v250, v250, v167
    v_cvt_pk_bf16_f32 v162, v164, v165
    v_cvt_pk_bf16_f32 v163, v166, v167
    s_waitcnt vmcnt(13)
    s_barrier
    ds_read_b64_tr_b16 v[168:169], v253 offset:0
    ds_read_b64_tr_b16 v[170:171], v253 offset:4096
    ds_read_b64_tr_b16 v[172:173], v254 offset:0
    ds_read_b64_tr_b16 v[174:175], v254 offset:4096
    ds_read_b64_tr_b16 v[176:177], v253 offset:256
    ds_read_b64_tr_b16 v[178:179], v253 offset:4352
    ds_read_b64_tr_b16 v[180:181], v254 offset:256
    ds_read_b64_tr_b16 v[182:183], v254 offset:4352
    ds_read_b64_tr_b16 v[184:185], v253 offset:512
    ds_read_b64_tr_b16 v[186:187], v253 offset:4608
    s_waitcnt lgkmcnt(8)
    v_mfma_f32_16x16x32_bf16 v[0:3], v[168:171], v[144:147], v[0:3]
    ds_read_b64_tr_b16 v[188:189], v254 offset:512
    ds_read_b64_tr_b16 v[190:191], v254 offset:4608
    v_mfma_f32_16x16x32_bf16 v[4:7], v[168:171], v[152:155], v[4:7]
    v_mfma_f32_16x16x32_bf16 v[8:11], v[168:171], v[160:163], v[8:11]
    s_waitcnt lgkmcnt(8)
    v_mfma_f32_16x16x32_bf16 v[20:23], v[172:175], v[160:163], v[20:23]
    ds_read_b64_tr_b16 v[192:193], v253 offset:768
    ds_read_b64_tr_b16 v[194:195], v253 offset:4864
    v_mfma_f32_16x16x32_bf16 v[16:19], v[172:175], v[152:155], v[16:19]
    v_mfma_f32_16x16x32_bf16 v[12:15], v[172:175], v[144:147], v[12:15]
    s_waitcnt lgkmcnt(8)
    v_mfma_f32_16x16x32_bf16 v[24:27], v[176:179], v[144:147], v[24:27]
    ds_read_b64_tr_b16 v[196:197], v254 offset:768
    ds_read_b64_tr_b16 v[198:199], v254 offset:4864
    v_add_u32 v253, s28, v253
    v_add_u32 v254, s28, v254
    v_mfma_f32_16x16x32_bf16 v[28:31], v[176:179], v[152:155], v[28:31]
    v_mfma_f32_16x16x32_bf16 v[32:35], v[176:179], v[160:163], v[32:35]
    s_waitcnt lgkmcnt(8)
    v_mfma_f32_16x16x32_bf16 v[44:47], v[180:183], v[160:163], v[44:47]
    ds_read_b128 v[168:171], v252 offset:0
    v_mfma_f32_16x16x32_bf16 v[40:43], v[180:183], v[152:155], v[40:43]
    v_mfma_f32_16x16x32_bf16 v[36:39], v[180:183], v[144:147], v[36:39]
    s_waitcnt lgkmcnt(7)
    v_mfma_f32_16x16x32_bf16 v[48:51], v[184:187], v[144:147], v[48:51]
    ds_read_b128 v[172:175], v252 offset:256
    v_mfma_f32_16x16x32_bf16 v[52:55], v[184:187], v[152:155], v[52:55]
    v_mfma_f32_16x16x32_bf16 v[56:59], v[184:187], v[160:163], v[56:59]
    s_waitcnt lgkmcnt(6)
    v_mfma_f32_16x16x32_bf16 v[68:71], v[188:191], v[160:163], v[68:71]
    ds_read_b128 v[176:179], v252 offset:512
    v_mfma_f32_16x16x32_bf16 v[64:67], v[188:191], v[152:155], v[64:67]
    v_mfma_f32_16x16x32_bf16 v[60:63], v[188:191], v[144:147], v[60:63]
    s_waitcnt lgkmcnt(5)
    v_mfma_f32_16x16x32_bf16 v[72:75], v[192:195], v[144:147], v[72:75]
    ds_read_b128 v[180:183], v252 offset:768
    v_mfma_f32_16x16x32_bf16 v[76:79], v[192:195], v[152:155], v[76:79]
    v_mfma_f32_16x16x32_bf16 v[80:83], v[192:195], v[160:163], v[80:83]
    s_waitcnt lgkmcnt(4)
    v_mfma_f32_16x16x32_bf16 v[92:95], v[196:199], v[160:163], v[92:95]
    ds_read_b128 v[184:187], v252 offset:4096
    v_mfma_f32_16x16x32_bf16 v[88:91], v[196:199], v[152:155], v[88:91]
    v_mfma_f32_16x16x32_bf16 v[84:87], v[196:199], v[144:147], v[84:87]
    s_add_u32 s29, s29, 1
    s_cmp_lt_u32 s29, 5
    s_cselect_b32 s28, s37, 4294901760
    s_cselect_b32 s29, s29, 0
    s_waitcnt lgkmcnt(4)
    v_mfma_f32_16x16x32_bf16 v[144:147], v[168:171], v[96:99], 0
    ds_read_b128 v[188:191], v252 offset:4352
    s_waitcnt lgkmcnt(4)
    v_mfma_f32_16x16x32_bf16 v[144:147], v[172:175], v[108:111], v[144:147]
    ds_read_b128 v[192:195], v252 offset:4608
    s_waitcnt lgkmcnt(4)
    v_mfma_f32_16x16x32_bf16 v[144:147], v[176:179], v[120:123], v[144:147]
    ds_read_b128 v[196:199], v252 offset:4864
    v_add_u32 v252, s28, v252
    s_waitcnt lgkmcnt(4)
    v_mfma_f32_16x16x32_bf16 v[144:147], v[180:183], v[132:135], v[144:147]
    v_mfma_f32_16x16x32_bf16 v[152:155], v[180:183], v[136:139], 0
    v_mfma_f32_16x16x32_bf16 v[152:155], v[176:179], v[124:127], v[152:155]
    v_mfma_f32_16x16x32_bf16 v[152:155], v[172:175], v[112:115], v[152:155]
    v_mfma_f32_16x16x32_bf16 v[152:155], v[168:171], v[100:103], v[152:155]
    v_mfma_f32_16x16x32_bf16 v[160:163], v[168:171], v[104:107], 0
    v_mfma_f32_16x16x32_bf16 v[160:163], v[172:175], v[116:119], v[160:163]
    v_mfma_f32_16x16x32_bf16 v[160:163], v[176:179], v[128:131], v[160:163]
    v_mfma_f32_16x16x32_bf16 v[160:163], v[180:183], v[140:143], v[160:163]
    s_waitcnt lgkmcnt(3)
    v_mfma_f32_16x16x32_bf16 v[148:151], v[184:187], v[96:99], 0
    s_waitcnt lgkmcnt(2)
    v_mfma_f32_16x16x32_bf16 v[148:151], v[188:191], v[108:111], v[148:151]
    s_waitcnt lgkmcnt(1)
    v_mfma_f32_16x16x32_bf16 v[148:151], v[192:195], v[120:123], v[148:151]
    v_exp_f32 v144, v144
    s_waitcnt lgkmcnt(0)
    v_mfma_f32_16x16x32_bf16 v[148:151], v[196:199], v[132:135], v[148:151]
    v_exp_f32 v145, v145
    v_mfma_f32_16x16x32_bf16 v[156:159], v[196:199], v[136:139], 0
    v_exp_f32 v146, v146
    v_mfma_f32_16x16x32_bf16 v[156:159], v[192:195], v[124:127], v[156:159]
    v_exp_f32 v147, v147
    v_mfma_f32_16x16x32_bf16 v[156:159], v[188:191], v[112:115], v[156:159]
    v_add_f32 v248, v248, v144
    v_add_f32 v248, v248, v145
    v_mfma_f32_16x16x32_bf16 v[156:159], v[184:187], v[100:103], v[156:159]
    v_add_f32 v248, v248, v146
    v_add_f32 v248, v248, v147
    v_mfma_f32_16x16x32_bf16 v[164:167], v[184:187], v[104:107], 0
    v_cvt_pk_bf16_f32 v144, v144, v145
    v_cvt_pk_bf16_f32 v145, v146, v147
    v_mfma_f32_16x16x32_bf16 v[164:167], v[188:191], v[116:119], v[164:167]
    v_exp_f32 v152, v152
    v_mfma_f32_16x16x32_bf16 v[164:167], v[192:195], v[128:131], v[164:167]
    v_exp_f32 v153, v153
    v_mfma_f32_16x16x32_bf16 v[164:167], v[196:199], v[140:143], v[164:167]
    v_exp_f32 v154, v154
    v_exp_f32 v155, v155
    v_add_f32 v249, v249, v152
    v_add_f32 v249, v249, v153
    v_add_f32 v249, v249, v154
    v_add_f32 v249, v249, v155
    v_cvt_pk_bf16_f32 v152, v152, v153
    v_cvt_pk_bf16_f32 v153, v154, v155
    v_exp_f32 v160, v160
    s_mov_b32 m0, s26
    s_nop 0
    buffer_load_dwordx4 v255, s[12:15], s24 offen offset:1024 nt lds
    v_exp_f32 v161, v161
    v_exp_f32 v162, v162
    v_exp_f32 v163, v163
    v_add_f32 v250, v250, v160
    v_add_f32 v250, v250, v161
    v_add_f32 v250, v250, v162
    v_add_f32 v250, v250, v163
    s_add_u32 m0, s26, 4096
    s_add_u32 s24, s24, 4096
    buffer_load_dwordx4 v255, s[12:15], s24 offen nt lds
    v_cvt_pk_bf16_f32 v160, v160, v161
    v_cvt_pk_bf16_f32 v161, v162, v163
    v_exp_f32 v148, v148
    v_exp_f32 v149, v149
    v_exp_f32 v150, v150
    v_exp_f32 v151, v151
    s_add_u32 m0, s26, 4096
    s_nop 0
    buffer_load_dwordx4 v255, s[12:15], s24 offen offset:1024 nt lds
    s_add_u32 s24, s24, 4096
    s_and_b32 s24, s24, 0x1ffff
    s_add_u32 s26, s26, 16384
    s_cmp_ge_u32 s26, s38
    s_cselect_b32 s26, s73, s26
    v_add_f32 v248, v248, v148
    v_add_f32 v248, v248, v149
    v_add_f32 v248, v248, v150
    v_add_f32 v248, v248, v151
    v_cvt_pk_bf16_f32 v146, v148, v149
    v_cvt_pk_bf16_f32 v147, v150, v151
    v_exp_f32 v156, v156
    v_exp_f32 v157, v157
    s_mov_b32 m0, s39
    s_nop 0
    buffer_load_dwordx4 v251, s[16:19], s25 offen nt lds
    v_exp_f32 v158, v158
    v_exp_f32 v159, v159
    v_add_f32 v249, v249, v156
    v_add_f32 v249, v249, v157
    v_add_f32 v249, v249, v158
    v_add_f32 v249, v249, v159
    v_cvt_pk_bf16_f32 v154, v156, v157
    v_cvt_pk_bf16_f32 v155, v158, v159
    s_mov_b32 m0, s39
    s_nop 0
    buffer_load_dwordx4 v251, s[16:19], s25 offen offset:2048 nt lds
    v_exp_f32 v164, v164
    v_exp_f32 v165, v165
    v_exp_f32 v166, v166
    v_exp_f32 v167, v167
    v_add_f32 v250, v250, v164
    v_add_f32 v250, v250, v165
    s_add_u32 m0, s39, 4096
    s_add_u32 s25, s25, 4096
    buffer_load_dwordx4 v251, s[16:19], s25 offen nt lds
    v_add_f32 v250, v250, v166
    v_add_f32 v250, v250, v167
    v_cvt_pk_bf16_f32 v162, v164, v165
    v_cvt_pk_bf16_f32 v163, v166, v167
    s_waitcnt vmcnt(11)
    s_barrier
    ds_read_b64_tr_b16 v[168:169], v253 offset:0
    ds_read_b64_tr_b16 v[170:171], v253 offset:4096
    ds_read_b64_tr_b16 v[172:173], v254 offset:0
    ds_read_b64_tr_b16 v[174:175], v254 offset:4096
    ds_read_b64_tr_b16 v[176:177], v253 offset:256
    ds_read_b64_tr_b16 v[178:179], v253 offset:4352
    ds_read_b64_tr_b16 v[180:181], v254 offset:256
    ds_read_b64_tr_b16 v[182:183], v254 offset:4352
    ds_read_b64_tr_b16 v[184:185], v253 offset:512
    ds_read_b64_tr_b16 v[186:187], v253 offset:4608
    s_waitcnt lgkmcnt(8)
    v_mfma_f32_16x16x32_bf16 v[0:3], v[168:171], v[144:147], v[0:3]
    ds_read_b64_tr_b16 v[188:189], v254 offset:512
    ds_read_b64_tr_b16 v[190:191], v254 offset:4608
    v_mfma_f32_16x16x32_bf16 v[4:7], v[168:171], v[152:155], v[4:7]
    v_mfma_f32_16x16x32_bf16 v[8:11], v[168:171], v[160:163], v[8:11]
    s_waitcnt lgkmcnt(8)
    v_mfma_f32_16x16x32_bf16 v[20:23], v[172:175], v[160:163], v[20:23]
    ds_read_b64_tr_b16 v[192:193], v253 offset:768
    ds_read_b64_tr_b16 v[194:195], v253 offset:4864
    v_mfma_f32_16x16x32_bf16 v[16:19], v[172:175], v[152:155], v[16:19]
    v_mfma_f32_16x16x32_bf16 v[12:15], v[172:175], v[144:147], v[12:15]
    s_waitcnt lgkmcnt(8)
    v_mfma_f32_16x16x32_bf16 v[24:27], v[176:179], v[144:147], v[24:27]
    ds_read_b64_tr_b16 v[196:197], v254 offset:768
    ds_read_b64_tr_b16 v[198:199], v254 offset:4864
    v_add_u32 v253, s28, v253
    v_add_u32 v254, s28, v254
    v_mfma_f32_16x16x32_bf16 v[28:31], v[176:179], v[152:155], v[28:31]
    v_mfma_f32_16x16x32_bf16 v[32:35], v[176:179], v[160:163], v[32:35]
    s_waitcnt lgkmcnt(8)
    v_mfma_f32_16x16x32_bf16 v[44:47], v[180:183], v[160:163], v[44:47]
    ds_read_b128 v[168:171], v252 offset:0
    v_mfma_f32_16x16x32_bf16 v[40:43], v[180:183], v[152:155], v[40:43]
    v_mfma_f32_16x16x32_bf16 v[36:39], v[180:183], v[144:147], v[36:39]
    s_waitcnt lgkmcnt(7)
    v_mfma_f32_16x16x32_bf16 v[48:51], v[184:187], v[144:147], v[48:51]
    ds_read_b128 v[172:175], v252 offset:256
    v_mfma_f32_16x16x32_bf16 v[52:55], v[184:187], v[152:155], v[52:55]
    v_mfma_f32_16x16x32_bf16 v[56:59], v[184:187], v[160:163], v[56:59]
    s_waitcnt lgkmcnt(6)
    v_mfma_f32_16x16x32_bf16 v[68:71], v[188:191], v[160:163], v[68:71]
    ds_read_b128 v[176:179], v252 offset:512
    v_mfma_f32_16x16x32_bf16 v[64:67], v[188:191], v[152:155], v[64:67]
    v_mfma_f32_16x16x32_bf16 v[60:63], v[188:191], v[144:147], v[60:63]
    s_waitcnt lgkmcnt(5)
    v_mfma_f32_16x16x32_bf16 v[72:75], v[192:195], v[144:147], v[72:75]
    ds_read_b128 v[180:183], v252 offset:768
    v_mfma_f32_16x16x32_bf16 v[76:79], v[192:195], v[152:155], v[76:79]
    v_mfma_f32_16x16x32_bf16 v[80:83], v[192:195], v[160:163], v[80:83]
    s_waitcnt lgkmcnt(4)
    v_mfma_f32_16x16x32_bf16 v[92:95], v[196:199], v[160:163], v[92:95]
    ds_read_b128 v[184:187], v252 offset:4096
    v_mfma_f32_16x16x32_bf16 v[88:91], v[196:199], v[152:155], v[88:91]
    v_mfma_f32_16x16x32_bf16 v[84:87], v[196:199], v[144:147], v[84:87]
    s_add_u32 s29, s29, 1
    s_cmp_lt_u32 s29, 5
    s_cselect_b32 s28, s37, 4294901760
    s_cselect_b32 s29, s29, 0
    s_waitcnt lgkmcnt(4)
    v_mfma_f32_16x16x32_bf16 v[144:147], v[168:171], v[96:99], 0
    ds_read_b128 v[188:191], v252 offset:4352
    s_waitcnt lgkmcnt(4)
    v_mfma_f32_16x16x32_bf16 v[144:147], v[172:175], v[108:111], v[144:147]
    ds_read_b128 v[192:195], v252 offset:4608
    s_waitcnt lgkmcnt(4)
    v_mfma_f32_16x16x32_bf16 v[144:147], v[176:179], v[120:123], v[144:147]
    ds_read_b128 v[196:199], v252 offset:4864
    v_add_u32 v252, s28, v252
    s_waitcnt lgkmcnt(4)
    v_mfma_f32_16x16x32_bf16 v[144:147], v[180:183], v[132:135], v[144:147]
    v_mfma_f32_16x16x32_bf16 v[152:155], v[180:183], v[136:139], 0
    v_mfma_f32_16x16x32_bf16 v[152:155], v[176:179], v[124:127], v[152:155]
    v_mfma_f32_16x16x32_bf16 v[152:155], v[172:175], v[112:115], v[152:155]
    v_mfma_f32_16x16x32_bf16 v[152:155], v[168:171], v[100:103], v[152:155]
    v_mfma_f32_16x16x32_bf16 v[160:163], v[168:171], v[104:107], 0
    v_mfma_f32_16x16x32_bf16 v[160:163], v[172:175], v[116:119], v[160:163]
    v_mfma_f32_16x16x32_bf16 v[160:163], v[176:179], v[128:131], v[160:163]
    v_mfma_f32_16x16x32_bf16 v[160:163], v[180:183], v[140:143], v[160:163]
    s_waitcnt lgkmcnt(3)
    v_mfma_f32_16x16x32_bf16 v[148:151], v[184:187], v[96:99], 0
    s_waitcnt lgkmcnt(2)
    v_mfma_f32_16x16x32_bf16 v[148:151], v[188:191], v[108:111], v[148:151]
    s_waitcnt lgkmcnt(1)
    v_mfma_f32_16x16x32_bf16 v[148:151], v[192:195], v[120:123], v[148:151]
    v_exp_f32 v144, v144
    s_waitcnt lgkmcnt(0)
    v_mfma_f32_16x16x32_bf16 v[148:151], v[196:199], v[132:135], v[148:151]
    v_exp_f32 v145, v145
    v_mfma_f32_16x16x32_bf16 v[156:159], v[196:199], v[136:139], 0
    v_exp_f32 v146, v146
    v_mfma_f32_16x16x32_bf16 v[156:159], v[192:195], v[124:127], v[156:159]
    v_exp_f32 v147, v147
    v_mfma_f32_16x16x32_bf16 v[156:159], v[188:191], v[112:115], v[156:159]
    v_add_f32 v248, v248, v144
    v_add_f32 v248, v248, v145
    v_mfma_f32_16x16x32_bf16 v[156:159], v[184:187], v[100:103], v[156:159]
    v_add_f32 v248, v248, v146
    v_add_f32 v248, v248, v147
    v_mfma_f32_16x16x32_bf16 v[164:167], v[184:187], v[104:107], 0
    v_cvt_pk_bf16_f32 v144, v144, v145
    v_cvt_pk_bf16_f32 v145, v146, v147
    v_mfma_f32_16x16x32_bf16 v[164:167], v[188:191], v[116:119], v[164:167]
    v_exp_f32 v152, v152
    v_mfma_f32_16x16x32_bf16 v[164:167], v[192:195], v[128:131], v[164:167]
    v_exp_f32 v153, v153
    v_mfma_f32_16x16x32_bf16 v[164:167], v[196:199], v[140:143], v[164:167]
    v_exp_f32 v154, v154
    v_exp_f32 v155, v155
    v_add_f32 v249, v249, v152
    v_add_f32 v249, v249, v153
    v_add_f32 v249, v249, v154
    v_add_f32 v249, v249, v155
    v_cvt_pk_bf16_f32 v152, v152, v153
    v_cvt_pk_bf16_f32 v153, v154, v155
    s_add_u32 m0, s39, 4096
    s_nop 0
    buffer_load_dwordx4 v251, s[16:19], s25 offen offset:2048 nt lds
    s_add_u32 s25, s25, 4096
    s_and_b32 s25, s25, 0x1ffff
    s_add_u32 s39, s39, 16384
    s_cmp_ge_u32 s39, s68
    s_cselect_b32 s39, s74, s39
    v_exp_f32 v160, v160
    v_exp_f32 v161, v161
    v_exp_f32 v162, v162
    v_exp_f32 v163, v163
    s_mov_b32 m0, s26
    s_nop 0
    buffer_load_dwordx4 v255, s[12:15], s24 offen nt lds
    v_add_f32 v250, v250, v160
    v_add_f32 v250, v250, v161
    v_add_f32 v250, v250, v162
    v_add_f32 v250, v250, v163
    v_cvt_pk_bf16_f32 v160, v160, v161
    v_cvt_pk_bf16_f32 v161, v162, v163
    v_exp_f32 v148, v148
    s_mov_b32 m0, s26
    s_nop 0
    buffer_load_dwordx4 v255, s[12:15], s24 offen offset:1024 nt lds
    v_exp_f32 v149, v149
    v_exp_f32 v150, v150
    v_exp_f32 v151, v151
    v_add_f32 v248, v248, v148
    v_add_f32 v248, v248, v149
    s_add_u32 m0, s26, 4096
    s_add_u32 s24, s24, 4096
    buffer_load_dwordx4 v255, s[12:15], s24 offen nt lds
    v_add_f32 v248, v248, v150
    v_add_f32 v248, v248, v151
    v_cvt_pk_bf16_f32 v146, v148, v149
    v_cvt_pk_bf16_f32 v147, v150, v151
    v_exp_f32 v156, v156
    v_exp_f32 v157, v157
    s_add_u32 m0, s26, 4096
    s_nop 0
    buffer_load_dwordx4 v255, s[12:15], s24 offen offset:1024 nt lds
    s_add_u32 s24, s24, 4096
    s_and_b32 s24, s24, 0x1ffff
    s_add_u32 s26, s26, 16384
    s_cmp_ge_u32 s26, s38
    s_cselect_b32 s26, s73, s26
    v_exp_f32 v158, v158
    v_exp_f32 v159, v159
    v_add_f32 v249, v249, v156
    v_add_f32 v249, v249, v157
    v_add_f32 v249, v249, v158
    v_add_f32 v249, v249, v159
    s_mov_b32 m0, s39
    s_nop 0
    buffer_load_dwordx4 v251, s[16:19], s25 offen nt lds
    v_cvt_pk_bf16_f32 v154, v156, v157
    v_cvt_pk_bf16_f32 v155, v158, v159
    v_exp_f32 v164, v164
    v_exp_f32 v165, v165
    v_exp_f32 v166, v166
    s_mov_b32 m0, s39
    s_nop 0
    buffer_load_dwordx4 v251, s[16:19], s25 offen offset:2048 nt lds
    v_exp_f32 v167, v167
    v_add_f32 v250, v250, v164
    v_add_f32 v250, v250, v165
    v_add_f32 v250, v250, v166
    v_add_f32 v250, v250, v167
    v_cvt_pk_bf16_f32 v162, v164, v165
    v_cvt_pk_bf16_f32 v163, v166, v167
    s_waitcnt vmcnt(10)
    s_barrier
    ds_read_b64_tr_b16 v[168:169], v253 offset:0
    ds_read_b64_tr_b16 v[170:171], v253 offset:4096
    ds_read_b64_tr_b16 v[172:173], v254 offset:0
    ds_read_b64_tr_b16 v[174:175], v254 offset:4096
    ds_read_b64_tr_b16 v[176:177], v253 offset:256
    ds_read_b64_tr_b16 v[178:179], v253 offset:4352
    ds_read_b64_tr_b16 v[180:181], v254 offset:256
    ds_read_b64_tr_b16 v[182:183], v254 offset:4352
    ds_read_b64_tr_b16 v[184:185], v253 offset:512
    ds_read_b64_tr_b16 v[186:187], v253 offset:4608
    s_waitcnt lgkmcnt(8)
    v_mfma_f32_16x16x32_bf16 v[0:3], v[168:171], v[144:147], v[0:3]
    ds_read_b64_tr_b16 v[188:189], v254 offset:512
    ds_read_b64_tr_b16 v[190:191], v254 offset:4608
    v_mfma_f32_16x16x32_bf16 v[4:7], v[168:171], v[152:155], v[4:7]
    v_mfma_f32_16x16x32_bf16 v[8:11], v[168:171], v[160:163], v[8:11]
    s_waitcnt lgkmcnt(8)
    v_mfma_f32_16x16x32_bf16 v[20:23], v[172:175], v[160:163], v[20:23]
    ds_read_b64_tr_b16 v[192:193], v253 offset:768
    ds_read_b64_tr_b16 v[194:195], v253 offset:4864
    v_mfma_f32_16x16x32_bf16 v[16:19], v[172:175], v[152:155], v[16:19]
    v_mfma_f32_16x16x32_bf16 v[12:15], v[172:175], v[144:147], v[12:15]
    s_waitcnt lgkmcnt(8)
    v_mfma_f32_16x16x32_bf16 v[24:27], v[176:179], v[144:147], v[24:27]
    ds_read_b64_tr_b16 v[196:197], v254 offset:768
    ds_read_b64_tr_b16 v[198:199], v254 offset:4864
    v_add_u32 v253, s28, v253
    v_add_u32 v254, s28, v254
    v_mfma_f32_16x16x32_bf16 v[28:31], v[176:179], v[152:155], v[28:31]
    v_mfma_f32_16x16x32_bf16 v[32:35], v[176:179], v[160:163], v[32:35]
    s_waitcnt lgkmcnt(8)
    v_mfma_f32_16x16x32_bf16 v[44:47], v[180:183], v[160:163], v[44:47]
    ds_read_b128 v[168:171], v252 offset:0
    v_mfma_f32_16x16x32_bf16 v[40:43], v[180:183], v[152:155], v[40:43]
    v_mfma_f32_16x16x32_bf16 v[36:39], v[180:183], v[144:147], v[36:39]
    s_waitcnt lgkmcnt(7)
    v_mfma_f32_16x16x32_bf16 v[48:51], v[184:187], v[144:147], v[48:51]
    ds_read_b128 v[172:175], v252 offset:256
    v_mfma_f32_16x16x32_bf16 v[52:55], v[184:187], v[152:155], v[52:55]
    v_mfma_f32_16x16x32_bf16 v[56:59], v[184:187], v[160:163], v[56:59]
    s_waitcnt lgkmcnt(6)
    v_mfma_f32_16x16x32_bf16 v[68:71], v[188:191], v[160:163], v[68:71]
    ds_read_b128 v[176:179], v252 offset:512
    v_mfma_f32_16x16x32_bf16 v[64:67], v[188:191], v[152:155], v[64:67]
    v_mfma_f32_16x16x32_bf16 v[60:63], v[188:191], v[144:147], v[60:63]
    s_waitcnt lgkmcnt(5)
    v_mfma_f32_16x16x32_bf16 v[72:75], v[192:195], v[144:147], v[72:75]
    ds_read_b128 v[180:183], v252 offset:768
    v_mfma_f32_16x16x32_bf16 v[76:79], v[192:195], v[152:155], v[76:79]
    v_mfma_f32_16x16x32_bf16 v[80:83], v[192:195], v[160:163], v[80:83]
    s_waitcnt lgkmcnt(4)
    v_mfma_f32_16x16x32_bf16 v[92:95], v[196:199], v[160:163], v[92:95]
    ds_read_b128 v[184:187], v252 offset:4096
    v_mfma_f32_16x16x32_bf16 v[88:91], v[196:199], v[152:155], v[88:91]
    v_mfma_f32_16x16x32_bf16 v[84:87], v[196:199], v[144:147], v[84:87]
    s_add_u32 s29, s29, 1
    s_cmp_lt_u32 s29, 5
    s_cselect_b32 s28, s37, 4294901760
    s_cselect_b32 s29, s29, 0
    s_waitcnt lgkmcnt(4)
    v_mfma_f32_16x16x32_bf16 v[144:147], v[168:171], v[96:99], 0
    ds_read_b128 v[188:191], v252 offset:4352
    s_waitcnt lgkmcnt(4)
    v_mfma_f32_16x16x32_bf16 v[144:147], v[172:175], v[108:111], v[144:147]
    ds_read_b128 v[192:195], v252 offset:4608
    s_waitcnt lgkmcnt(4)
    v_mfma_f32_16x16x32_bf16 v[144:147], v[176:179], v[120:123], v[144:147]
    ds_read_b128 v[196:199], v252 offset:4864
    v_add_u32 v252, s28, v252
    s_waitcnt lgkmcnt(4)
    v_mfma_f32_16x16x32_bf16 v[144:147], v[180:183], v[132:135], v[144:147]
    v_mfma_f32_16x16x32_bf16 v[152:155], v[180:183], v[136:139], 0
    v_mfma_f32_16x16x32_bf16 v[152:155], v[176:179], v[124:127], v[152:155]
    v_mfma_f32_16x16x32_bf16 v[152:155], v[172:175], v[112:115], v[152:155]
    v_mfma_f32_16x16x32_bf16 v[152:155], v[168:171], v[100:103], v[152:155]
    v_mfma_f32_16x16x32_bf16 v[160:163], v[168:171], v[104:107], 0
    v_mfma_f32_16x16x32_bf16 v[160:163], v[172:175], v[116:119], v[160:163]
    v_mfma_f32_16x16x32_bf16 v[160:163], v[176:179], v[128:131], v[160:163]
    v_mfma_f32_16x16x32_bf16 v[160:163], v[180:183], v[140:143], v[160:163]
    s_waitcnt lgkmcnt(3)
    v_mfma_f32_16x16x32_bf16 v[148:151], v[184:187], v[96:99], 0
    s_waitcnt lgkmcnt(2)
    v_mfma_f32_16x16x32_bf16 v[148:151], v[188:191], v[108:111], v[148:151]
    s_waitcnt lgkmcnt(1)
    v_mfma_f32_16x16x32_bf16 v[148:151], v[192:195], v[120:123], v[148:151]
    v_exp_f32 v144, v144
    s_waitcnt lgkmcnt(0)
    v_mfma_f32_16x16x32_bf16 v[148:151], v[196:199], v[132:135], v[148:151]
    v_exp_f32 v145, v145
    v_mfma_f32_16x16x32_bf16 v[156:159], v[196:199], v[136:139], 0
    v_exp_f32 v146, v146
    v_mfma_f32_16x16x32_bf16 v[156:159], v[192:195], v[124:127], v[156:159]
    v_exp_f32 v147, v147
    v_mfma_f32_16x16x32_bf16 v[156:159], v[188:191], v[112:115], v[156:159]
    v_add_f32 v248, v248, v144
    v_add_f32 v248, v248, v145
    v_mfma_f32_16x16x32_bf16 v[156:159], v[184:187], v[100:103], v[156:159]
    v_add_f32 v248, v248, v146
    v_add_f32 v248, v248, v147
    v_mfma_f32_16x16x32_bf16 v[164:167], v[184:187], v[104:107], 0
    v_cvt_pk_bf16_f32 v144, v144, v145
    v_cvt_pk_bf16_f32 v145, v146, v147
    v_mfma_f32_16x16x32_bf16 v[164:167], v[188:191], v[116:119], v[164:167]
    v_exp_f32 v152, v152
    v_mfma_f32_16x16x32_bf16 v[164:167], v[192:195], v[128:131], v[164:167]
    v_exp_f32 v153, v153
    v_mfma_f32_16x16x32_bf16 v[164:167], v[196:199], v[140:143], v[164:167]
    v_exp_f32 v154, v154
    v_exp_f32 v155, v155
    v_add_f32 v249, v249, v152
    v_add_f32 v249, v249, v153
    v_add_f32 v249, v249, v154
    v_add_f32 v249, v249, v155
    v_cvt_pk_bf16_f32 v152, v152, v153
    v_cvt_pk_bf16_f32 v153, v154, v155
    v_exp_f32 v160, v160
    s_add_u32 m0, s39, 4096
    s_add_u32 s25, s25, 4096
    buffer_load_dwordx4 v251, s[16:19], s25 offen nt lds
    v_exp_f32 v161, v161
    v_exp_f32 v162, v162
    v_exp_f32 v163, v163
    v_add_f32 v250, v250, v160
    v_add_f32 v250, v250, v161
    v_add_f32 v250, v250, v162
    v_add_f32 v250, v250, v163
    s_add_u32 m0, s39, 4096
    s_nop 0
    buffer_load_dwordx4 v251, s[16:19], s25 offen offset:2048 nt lds
    s_add_u32 s25, s25, 4096
    s_and_b32 s25, s25, 0x1ffff
    s_add_u32 s39, s39, 16384
    s_cmp_ge_u32 s39, s68
    s_cselect_b32 s39, s74, s39
    v_cvt_pk_bf16_f32 v160, v160, v161
    v_cvt_pk_bf16_f32 v161, v162, v163
    v_exp_f32 v148, v148
    v_exp_f32 v149, v149
    v_exp_f32 v150, v150
    v_exp_f32 v151, v151
    s_mov_b32 m0, s26
    s_nop 0
    buffer_load_dwordx4 v255, s[12:15], s24 offen nt lds
    v_add_f32 v248, v248, v148
    v_add_f32 v248, v248, v149
    v_add_f32 v248, v248, v150
    v_add_f32 v248, v248, v151
    v_cvt_pk_bf16_f32 v146, v148, v149
    v_cvt_pk_bf16_f32 v147, v150, v151
    v_exp_f32 v156, v156
    v_exp_f32 v157, v157
    s_mov_b32 m0, s26
    s_nop 0
    buffer_load_dwordx4 v255, s[12:15], s24 offen offset:1024 nt lds
    v_exp_f32 v158, v158
    v_exp_f32 v159, v159
    v_add_f32 v249, v249, v156
    v_add_f32 v249, v249, v157
    v_add_f32 v249, v249, v158
    v_add_f32 v249, v249, v159
    v_cvt_pk_bf16_f32 v154, v156, v157
    v_cvt_pk_bf16_f32 v155, v158, v159
    s_add_u32 m0, s26, 4096
    s_add_u32 s24, s24, 4096
    buffer_load_dwordx4 v255, s[12:15], s24 offen nt lds
    v_exp_f32 v164, v164
    v_exp_f32 v165, v165
    v_exp_f32 v166, v166
    v_exp_f32 v167, v167
    v_add_f32 v250, v250, v164
    v_add_f32 v250, v250, v165
    s_add_u32 m0, s26, 4096
    s_nop 0
    buffer_load_dwordx4 v255, s[12:15], s24 offen offset:1024 nt lds
    s_add_u32 s24, s24, 4096
    s_and_b32 s24, s24, 0x1ffff
    s_add_u32 s26, s26, 16384
    s_cmp_ge_u32 s26, s38
    s_cselect_b32 s26, s73, s26
    v_add_f32 v250, v250, v166
    v_add_f32 v250, v250, v167
    v_cvt_pk_bf16_f32 v162, v164, v165
    v_cvt_pk_bf16_f32 v163, v166, v167
    s_waitcnt vmcnt(8)
    s_barrier
    ds_read_b64_tr_b16 v[168:169], v253 offset:0
    ds_read_b64_tr_b16 v[170:171], v253 offset:4096
    ds_read_b64_tr_b16 v[172:173], v254 offset:0
    ds_read_b64_tr_b16 v[174:175], v254 offset:4096
    ds_read_b64_tr_b16 v[176:177], v253 offset:256
    ds_read_b64_tr_b16 v[178:179], v253 offset:4352
    ds_read_b64_tr_b16 v[180:181], v254 offset:256
    ds_read_b64_tr_b16 v[182:183], v254 offset:4352
    ds_read_b64_tr_b16 v[184:185], v253 offset:512
    ds_read_b64_tr_b16 v[186:187], v253 offset:4608
    s_waitcnt lgkmcnt(8)
    v_mfma_f32_16x16x32_bf16 v[0:3], v[168:171], v[144:147], v[0:3]
    ds_read_b64_tr_b16 v[188:189], v254 offset:512
    ds_read_b64_tr_b16 v[190:191], v254 offset:4608
    v_mfma_f32_16x16x32_bf16 v[4:7], v[168:171], v[152:155], v[4:7]
    v_mfma_f32_16x16x32_bf16 v[8:11], v[168:171], v[160:163], v[8:11]
    s_waitcnt lgkmcnt(8)
    v_mfma_f32_16x16x32_bf16 v[20:23], v[172:175], v[160:163], v[20:23]
    ds_read_b64_tr_b16 v[192:193], v253 offset:768
    ds_read_b64_tr_b16 v[194:195], v253 offset:4864
    v_mfma_f32_16x16x32_bf16 v[16:19], v[172:175], v[152:155], v[16:19]
    v_mfma_f32_16x16x32_bf16 v[12:15], v[172:175], v[144:147], v[12:15]
    s_waitcnt lgkmcnt(8)
    v_mfma_f32_16x16x32_bf16 v[24:27], v[176:179], v[144:147], v[24:27]
    ds_read_b64_tr_b16 v[196:197], v254 offset:768
    ds_read_b64_tr_b16 v[198:199], v254 offset:4864
    v_add_u32 v253, s28, v253
    v_add_u32 v254, s28, v254
    v_mfma_f32_16x16x32_bf16 v[28:31], v[176:179], v[152:155], v[28:31]
    v_mfma_f32_16x16x32_bf16 v[32:35], v[176:179], v[160:163], v[32:35]
    s_waitcnt lgkmcnt(8)
    v_mfma_f32_16x16x32_bf16 v[44:47], v[180:183], v[160:163], v[44:47]
    ds_read_b128 v[168:171], v252 offset:0
    v_mfma_f32_16x16x32_bf16 v[40:43], v[180:183], v[152:155], v[40:43]
    v_mfma_f32_16x16x32_bf16 v[36:39], v[180:183], v[144:147], v[36:39]
    s_waitcnt lgkmcnt(7)
    v_mfma_f32_16x16x32_bf16 v[48:51], v[184:187], v[144:147], v[48:51]
    ds_read_b128 v[172:175], v252 offset:256
    v_mfma_f32_16x16x32_bf16 v[52:55], v[184:187], v[152:155], v[52:55]
    v_mfma_f32_16x16x32_bf16 v[56:59], v[184:187], v[160:163], v[56:59]
    s_waitcnt lgkmcnt(6)
    v_mfma_f32_16x16x32_bf16 v[68:71], v[188:191], v[160:163], v[68:71]
    ds_read_b128 v[176:179], v252 offset:512
    v_mfma_f32_16x16x32_bf16 v[64:67], v[188:191], v[152:155], v[64:67]
    v_mfma_f32_16x16x32_bf16 v[60:63], v[188:191], v[144:147], v[60:63]
    s_waitcnt lgkmcnt(5)
    v_mfma_f32_16x16x32_bf16 v[72:75], v[192:195], v[144:147], v[72:75]
    ds_read_b128 v[180:183], v252 offset:768
    v_mfma_f32_16x16x32_bf16 v[76:79], v[192:195], v[152:155], v[76:79]
    v_mfma_f32_16x16x32_bf16 v[80:83], v[192:195], v[160:163], v[80:83]
    s_waitcnt lgkmcnt(4)
    v_mfma_f32_16x16x32_bf16 v[92:95], v[196:199], v[160:163], v[92:95]
    ds_read_b128 v[184:187], v252 offset:4096
    v_mfma_f32_16x16x32_bf16 v[88:91], v[196:199], v[152:155], v[88:91]
    v_mfma_f32_16x16x32_bf16 v[84:87], v[196:199], v[144:147], v[84:87]
    s_add_u32 s29, s29, 1
    s_cmp_lt_u32 s29, 5
    s_cselect_b32 s28, s37, 4294901760
    s_cselect_b32 s29, s29, 0
    s_waitcnt lgkmcnt(4)
    v_mfma_f32_16x16x32_bf16 v[144:147], v[168:171], v[96:99], 0
    ds_read_b128 v[188:191], v252 offset:4352
    s_waitcnt lgkmcnt(4)
    v_mfma_f32_16x16x32_bf16 v[144:147], v[172:175], v[108:111], v[144:147]
    ds_read_b128 v[192:195], v252 offset:4608
    s_waitcnt lgkmcnt(4)
    v_mfma_f32_16x16x32_bf16 v[144:147], v[176:179], v[120:123], v[144:147]
    ds_read_b128 v[196:199], v252 offset:4864
    v_add_u32 v252, s28, v252
    s_waitcnt lgkmcnt(4)
    v_mfma_f32_16x16x32_bf16 v[144:147], v[180:183], v[132:135], v[144:147]
    v_mfma_f32_16x16x32_bf16 v[152:155], v[180:183], v[136:139], 0
    v_mfma_f32_16x16x32_bf16 v[152:155], v[176:179], v[124:127], v[152:155]
    v_mfma_f32_16x16x32_bf16 v[152:155], v[172:175], v[112:115], v[152:155]
    v_mfma_f32_16x16x32_bf16 v[152:155], v[168:171], v[100:103], v[152:155]
    v_mfma_f32_16x16x32_bf16 v[160:163], v[168:171], v[104:107], 0
    v_mfma_f32_16x16x32_bf16 v[160:163], v[172:175], v[116:119], v[160:163]
    v_mfma_f32_16x16x32_bf16 v[160:163], v[176:179], v[128:131], v[160:163]
    v_mfma_f32_16x16x32_bf16 v[160:163], v[180:183], v[140:143], v[160:163]
    s_waitcnt lgkmcnt(3)
    v_mfma_f32_16x16x32_bf16 v[148:151], v[184:187], v[96:99], 0
    s_waitcnt lgkmcnt(2)
    v_mfma_f32_16x16x32_bf16 v[148:151], v[188:191], v[108:111], v[148:151]
    s_waitcnt lgkmcnt(1)
    v_mfma_f32_16x16x32_bf16 v[148:151], v[192:195], v[120:123], v[148:151]
    v_exp_f32 v144, v144
    s_waitcnt lgkmcnt(0)
    v_mfma_f32_16x16x32_bf16 v[148:151], v[196:199], v[132:135], v[148:151]
    v_exp_f32 v145, v145
    v_mfma_f32_16x16x32_bf16 v[156:159], v[196:199], v[136:139], 0
    v_exp_f32 v146, v146
    v_mfma_f32_16x16x32_bf16 v[156:159], v[192:195], v[124:127], v[156:159]
    v_exp_f32 v147, v147
    v_mfma_f32_16x16x32_bf16 v[156:159], v[188:191], v[112:115], v[156:159]
    v_add_f32 v248, v248, v144
    v_add_f32 v248, v248, v145
    v_mfma_f32_16x16x32_bf16 v[156:159], v[184:187], v[100:103], v[156:159]
    v_add_f32 v248, v248, v146
    v_add_f32 v248, v248, v147
    v_mfma_f32_16x16x32_bf16 v[164:167], v[184:187], v[104:107], 0
    v_cvt_pk_bf16_f32 v144, v144, v145
    v_cvt_pk_bf16_f32 v145, v146, v147
    v_mfma_f32_16x16x32_bf16 v[164:167], v[188:191], v[116:119], v[164:167]
    v_exp_f32 v152, v152
    v_mfma_f32_16x16x32_bf16 v[164:167], v[192:195], v[128:131], v[164:167]
    v_exp_f32 v153, v153
    v_mfma_f32_16x16x32_bf16 v[164:167], v[196:199], v[140:143], v[164:167]
    v_exp_f32 v154, v154
    v_exp_f32 v155, v155
    v_add_f32 v249, v249, v152
    v_add_f32 v249, v249, v153
    v_add_f32 v249, v249, v154
    v_add_f32 v249, v249, v155
    v_cvt_pk_bf16_f32 v152, v152, v153
    v_cvt_pk_bf16_f32 v153, v154, v155
    v_exp_f32 v160, v160
    v_exp_f32 v161, v161
    s_mov_b32 m0, s39
    s_nop 0
    buffer_load_dwordx4 v251, s[16:19], s25 offen nt lds
    v_exp_f32 v162, v162
    v_exp_f32 v163, v163
    v_add_f32 v250, v250, v160
    v_add_f32 v250, v250, v161
    v_add_f32 v250, v250, v162
    v_add_f32 v250, v250, v163
    v_cvt_pk_bf16_f32 v160, v160, v161
    v_cvt_pk_bf16_f32 v161, v162, v163
    v_exp_f32 v148, v148
    s_mov_b32 m0, s39
    s_nop 0
    buffer_load_dwordx4 v251, s[16:19], s25 offen offset:2048 nt lds
    v_exp_f32 v149, v149
    v_exp_f32 v150, v150
    v_exp_f32 v151, v151
    v_add_f32 v248, v248, v148
    v_add_f32 v248, v248, v149
    v_add_f32 v248, v248, v150
    v_add_f32 v248, v248, v151
    v_cvt_pk_bf16_f32 v146, v148, v149
    v_cvt_pk_bf16_f32 v147, v150, v151
    s_add_u32 m0, s39, 4096
    s_add_u32 s25, s25, 4096
    buffer_load_dwordx4 v251, s[16:19], s25 offen nt lds
    v_exp_f32 v156, v156
    v_exp_f32 v157, v157
    v_exp_f32 v158, v158
    v_exp_f32 v159, v159
    v_add_f32 v249, v249, v156
    v_add_f32 v249, v249, v157
    v_add_f32 v249, v249, v158
    v_add_f32 v249, v249, v159
    s_add_u32 m0, s39, 4096
    s_nop 0
    buffer_load_dwordx4 v251, s[16:19], s25 offen offset:2048 nt lds
    s_add_u32 s25, s25, 4096
    s_and_b32 s25, s25, 0x1ffff
    s_add_u32 s39, s39, 16384
    s_cmp_ge_u32 s39, s68
    s_cselect_b32 s39, s74, s39
    v_cvt_pk_bf16_f32 v154, v156, v157
    v_cvt_pk_bf16_f32 v155, v158, v159
    v_exp_f32 v164, v164
    v_exp_f32 v165, v165
    v_exp_f32 v166, v166
    v_exp_f32 v167, v167
    v_add_f32 v250, v250, v164
    v_add_f32 v250, v250, v165
    s_sub_u32 s22, s52, 8192
    buffer_load_dword v247, v246, s[40:43], s22 offen
    v_add_f32 v250, v250, v166
    v_add_f32 v250, v250, v167
    v_cvt_pk_bf16_f32 v162, v164, v165
    v_cvt_pk_bf16_f32 v163, v166, v167
    s_waitcnt vmcnt(5)
    s_barrier
    ds_read_b64_tr_b16 v[168:169], v253 offset:0
    ds_read_b64_tr_b16 v[170:171], v253 offset:4096
    ds_read_b64_tr_b16 v[172:173], v254 offset:0
    ds_read_b64_tr_b16 v[174:175], v254 offset:4096
    ds_read_b64_tr_b16 v[176:177], v253 offset:256
    ds_read_b64_tr_b16 v[178:179], v253 offset:4352
    ds_read_b64_tr_b16 v[180:181], v254 offset:256
    ds_read_b64_tr_b16 v[182:183], v254 offset:4352
    ds_read_b64_tr_b16 v[184:185], v253 offset:512
    ds_read_b64_tr_b16 v[186:187], v253 offset:4608
    s_waitcnt lgkmcnt(8)
    v_mfma_f32_16x16x32_bf16 v[0:3], v[168:171], v[144:147], v[0:3]
    ds_read_b64_tr_b16 v[188:189], v254 offset:512
    ds_read_b64_tr_b16 v[190:191], v254 offset:4608
    v_mfma_f32_16x16x32_bf16 v[4:7], v[168:171], v[152:155], v[4:7]
    v_mfma_f32_16x16x32_bf16 v[8:11], v[168:171], v[160:163], v[8:11]
    s_waitcnt lgkmcnt(8)
    v_mfma_f32_16x16x32_bf16 v[20:23], v[172:175], v[160:163], v[20:23]
    ds_read_b64_tr_b16 v[192:193], v253 offset:768
    ds_read_b64_tr_b16 v[194:195], v253 offset:4864
    v_mfma_f32_16x16x32_bf16 v[16:19], v[172:175], v[152:155], v[16:19]
    v_mfma_f32_16x16x32_bf16 v[12:15], v[172:175], v[144:147], v[12:15]
    s_waitcnt lgkmcnt(8)
    v_mfma_f32_16x16x32_bf16 v[24:27], v[176:179], v[144:147], v[24:27]
    ds_read_b64_tr_b16 v[196:197], v254 offset:768
    ds_read_b64_tr_b16 v[198:199], v254 offset:4864
    v_add_u32 v253, s28, v253
    v_add_u32 v254, s28, v254
    v_mfma_f32_16x16x32_bf16 v[28:31], v[176:179], v[152:155], v[28:31]
    v_mfma_f32_16x16x32_bf16 v[32:35], v[176:179], v[160:163], v[32:35]
    s_waitcnt lgkmcnt(8)
    v_mfma_f32_16x16x32_bf16 v[44:47], v[180:183], v[160:163], v[44:47]
    ds_read_b128 v[168:171], v252 offset:0
    v_mfma_f32_16x16x32_bf16 v[40:43], v[180:183], v[152:155], v[40:43]
    v_mfma_f32_16x16x32_bf16 v[36:39], v[180:183], v[144:147], v[36:39]
    s_waitcnt lgkmcnt(7)
    v_mfma_f32_16x16x32_bf16 v[48:51], v[184:187], v[144:147], v[48:51]
    ds_read_b128 v[172:175], v252 offset:256
    v_mfma_f32_16x16x32_bf16 v[52:55], v[184:187], v[152:155], v[52:55]
    v_mfma_f32_16x16x32_bf16 v[56:59], v[184:187], v[160:163], v[56:59]
    s_waitcnt lgkmcnt(6)
    v_mfma_f32_16x16x32_bf16 v[68:71], v[188:191], v[160:163], v[68:71]
    ds_read_b128 v[176:179], v252 offset:512
    v_mfma_f32_16x16x32_bf16 v[64:67], v[188:191], v[152:155], v[64:67]
    v_mfma_f32_16x16x32_bf16 v[60:63], v[188:191], v[144:147], v[60:63]
    s_waitcnt lgkmcnt(5)
    v_mfma_f32_16x16x32_bf16 v[72:75], v[192:195], v[144:147], v[72:75]
    ds_read_b128 v[180:183], v252 offset:768
    v_mfma_f32_16x16x32_bf16 v[76:79], v[192:195], v[152:155], v[76:79]
    v_mfma_f32_16x16x32_bf16 v[80:83], v[192:195], v[160:163], v[80:83]
    s_waitcnt lgkmcnt(4)
    v_mfma_f32_16x16x32_bf16 v[92:95], v[196:199], v[160:163], v[92:95]
    ds_read_b128 v[184:187], v252 offset:4096
    v_mfma_f32_16x16x32_bf16 v[88:91], v[196:199], v[152:155], v[88:91]
    v_mfma_f32_16x16x32_bf16 v[84:87], v[196:199], v[144:147], v[84:87]
    s_add_u32 s29, s29, 1
    s_cmp_lt_u32 s29, 5
    s_cselect_b32 s28, s37, 4294901760
    s_cselect_b32 s29, s29, 0
    s_waitcnt lgkmcnt(4)
    v_mfma_f32_16x16x32_bf16 v[144:147], v[168:171], v[96:99], 0
    ds_read_b128 v[188:191], v252 offset:4352
    s_waitcnt lgkmcnt(4)
    v_mfma_f32_16x16x32_bf16 v[144:147], v[172:175], v[108:111], v[144:147]
    ds_read_b128 v[192:195], v252 offset:4608
    s_waitcnt lgkmcnt(4)
    v_mfma_f32_16x16x32_bf16 v[144:147], v[176:179], v[120:123], v[144:147]
    ds_read_b128 v[196:199], v252 offset:4864
    v_add_u32 v252, s28, v252
    s_waitcnt lgkmcnt(4)
    v_mfma_f32_16x16x32_bf16 v[144:147], v[180:183], v[132:135], v[144:147]
    v_mfma_f32_16x16x32_bf16 v[152:155], v[180:183], v[136:139], 0
    v_mfma_f32_16x16x32_bf16 v[152:155], v[176:179], v[124:127], v[152:155]
    v_mfma_f32_16x16x32_bf16 v[152:155], v[172:175], v[112:115], v[152:155]
    v_mfma_f32_16x16x32_bf16 v[152:155], v[168:171], v[100:103], v[152:155]
    v_mfma_f32_16x16x32_bf16 v[160:163], v[168:171], v[104:107], 0
    v_mfma_f32_16x16x32_bf16 v[160:163], v[172:175], v[116:119], v[160:163]
    v_mfma_f32_16x16x32_bf16 v[160:163], v[176:179], v[128:131], v[160:163]
    v_mfma_f32_16x16x32_bf16 v[160:163], v[180:183], v[140:143], v[160:163]
    s_waitcnt lgkmcnt(3)
    v_mfma_f32_16x16x32_bf16 v[148:151], v[184:187], v[96:99], 0
    s_waitcnt lgkmcnt(2)
    v_mfma_f32_16x16x32_bf16 v[148:151], v[188:191], v[108:111], v[148:151]
    s_waitcnt lgkmcnt(1)
    v_mfma_f32_16x16x32_bf16 v[148:151], v[192:195], v[120:123], v[148:151]
    v_exp_f32 v144, v144
    s_waitcnt lgkmcnt(0)
    v_mfma_f32_16x16x32_bf16 v[148:151], v[196:199], v[132:135], v[148:151]
    v_exp_f32 v145, v145
    v_mfma_f32_16x16x32_bf16 v[156:159], v[196:199], v[136:139], 0
    v_exp_f32 v146, v146
    v_mfma_f32_16x16x32_bf16 v[156:159], v[192:195], v[124:127], v[156:159]
    v_exp_f32 v147, v147
    v_mfma_f32_16x16x32_bf16 v[156:159], v[188:191], v[112:115], v[156:159]
    v_add_f32 v248, v248, v144
    v_add_f32 v248, v248, v145
    v_mfma_f32_16x16x32_bf16 v[156:159], v[184:187], v[100:103], v[156:159]
    v_add_f32 v248, v248, v146
    v_add_f32 v248, v248, v147
    v_mfma_f32_16x16x32_bf16 v[164:167], v[184:187], v[104:107], 0
    v_cvt_pk_bf16_f32 v144, v144, v145
    v_cvt_pk_bf16_f32 v145, v146, v147
    v_mfma_f32_16x16x32_bf16 v[164:167], v[188:191], v[116:119], v[164:167]
    v_exp_f32 v152, v152
    v_mfma_f32_16x16x32_bf16 v[164:167], v[192:195], v[128:131], v[164:167]
    v_exp_f32 v153, v153
    v_mfma_f32_16x16x32_bf16 v[164:167], v[196:199], v[140:143], v[164:167]
    v_exp_f32 v154, v154
    v_exp_f32 v155, v155
    s_add_u32 m0, s74, 4294901760
    s_add_u32 s22, s56, 0
    buffer_load_dwordx4 v245, s[4:7], s22 offen lds
    v_add_f32 v249, v249, v152
    v_add_f32 v249, v249, v153
    s_add_u32 m0, s74, 4294903808
    s_add_u32 s22, s56, 8192
    buffer_load_dwordx4 v245, s[4:7], s22 offen lds
    v_add_f32 v249, v249, v154
    v_add_f32 v249, v249, v155
    s_add_u32 m0, s74, 4294905856
    s_add_u32 s22, s56, 16384
    buffer_load_dwordx4 v245, s[4:7], s22 offen lds
    v_cvt_pk_bf16_f32 v152, v152, v153
    v_cvt_pk_bf16_f32 v153, v154, v155
    s_add_u32 m0, s74, 4294907904
    s_add_u32 s22, s56, 24576
    buffer_load_dwordx4 v245, s[4:7], s22 offen lds
    v_exp_f32 v160, v160
    s_add_u32 m0, s74, 4294918144
    s_add_u32 s22, s56, 32768
    buffer_load_dwordx4 v245, s[4:7], s22 offen lds
    v_exp_f32 v161, v161
    s_add_u32 m0, s74, 4294920192
    s_add_u32 s22, s56, 40960
    buffer_load_dwordx4 v245, s[4:7], s22 offen lds
    v_exp_f32 v162, v162
    s_add_u32 m0, s74, 4294922240
    s_add_u32 s22, s56, 49152
    buffer_load_dwordx4 v245, s[4:7], s22 offen lds
    v_exp_f32 v163, v163
    s_add_u32 m0, s74, 4294924288
    s_add_u32 s22, s56, 57344
    buffer_load_dwordx4 v245, s[4:7], s22 offen lds
    v_add_f32 v250, v250, v160
    v_add_f32 v250, v250, v161
    s_add_u32 m0, s74, 16384
    s_add_u32 s22, s56, 65536
    buffer_load_dwordx4 v245, s[4:7], s22 offen lds
    v_add_f32 v250, v250, v162
    v_add_f32 v250, v250, v163
    s_add_u32 m0, s74, 18432
    s_add_u32 s22, s56, 73728
    buffer_load_dwordx4 v245, s[4:7], s22 offen lds
    v_cvt_pk_bf16_f32 v160, v160, v161
    v_cvt_pk_bf16_f32 v161, v162, v163
    s_add_u32 m0, s74, 20480
    s_add_u32 s22, s56, 81920
    buffer_load_dwordx4 v245, s[4:7], s22 offen lds
    v_exp_f32 v148, v148
    s_add_u32 m0, s74, 22528
    s_add_u32 s22, s56, 90112
    buffer_load_dwordx4 v245, s[4:7], s22 offen lds
    v_exp_f32 v149, v149
    s_add_u32 m0, s74, 4294934528
    s_add_u32 s22, s56, 98304
    buffer_load_dwordx4 v245, s[4:7], s22 offen lds
    v_exp_f32 v150, v150
    s_add_u32 m0, s74, 4294936576
    s_add_u32 s22, s56, 106496
    buffer_load_dwordx4 v245, s[4:7], s22 offen lds
    v_exp_f32 v151, v151
    s_add_u32 m0, s74, 4294938624
    s_add_u32 s22, s56, 114688
    buffer_load_dwordx4 v245, s[4:7], s22 offen lds
    v_add_f32 v248, v248, v148
    v_add_f32 v248, v248, v149
    s_add_u32 m0, s74, 4294940672
    s_add_u32 s22, s56, 122880
    buffer_load_dwordx4 v245, s[4:7], s22 offen lds
    v_add_f32 v248, v248, v150
    v_add_f32 v248, v248, v151
    s_sub_u32 s22, s52, 2048
    buffer_load_dword v247, v246, s[40:43], s22 offen
    v_cvt_pk_bf16_f32 v146, v148, v149
    v_cvt_pk_bf16_f32 v147, v150, v151
    v_exp_f32 v156, v156
    v_exp_f32 v157, v157
    v_exp_f32 v158, v158
    v_exp_f32 v159, v159
    v_add_f32 v249, v249, v156
    v_add_f32 v249, v249, v157
    v_add_f32 v249, v249, v158
    v_add_f32 v249, v249, v159
    v_cvt_pk_bf16_f32 v154, v156, v157
    v_cvt_pk_bf16_f32 v155, v158, v159
    v_exp_f32 v164, v164
    v_exp_f32 v165, v165
    v_exp_f32 v166, v166
    v_exp_f32 v167, v167
    v_add_f32 v250, v250, v164
    v_add_f32 v250, v250, v165
    v_add_f32 v250, v250, v166
    v_add_f32 v250, v250, v167
    v_cvt_pk_bf16_f32 v162, v164, v165
    v_cvt_pk_bf16_f32 v163, v166, v167
    s_waitcnt vmcnt(18)
    s_barrier
    ds_read_b64_tr_b16 v[168:169], v253 offset:0
    ds_read_b64_tr_b16 v[170:171], v253 offset:4096
    ds_read_b64_tr_b16 v[172:173], v254 offset:0
    ds_read_b64_tr_b16 v[174:175], v254 offset:4096
    ds_read_b64_tr_b16 v[176:177], v253 offset:256
    ds_read_b64_tr_b16 v[178:179], v253 offset:4352
    ds_read_b64_tr_b16 v[180:181], v254 offset:256
    ds_read_b64_tr_b16 v[182:183], v254 offset:4352
    ds_read_b64_tr_b16 v[184:185], v253 offset:512
    ds_read_b64_tr_b16 v[186:187], v253 offset:4608
    s_waitcnt lgkmcnt(8)
    v_mfma_f32_16x16x32_bf16 v[0:3], v[168:171], v[144:147], v[0:3]
    ds_read_b64_tr_b16 v[188:189], v254 offset:512
    ds_read_b64_tr_b16 v[190:191], v254 offset:4608
    v_mfma_f32_16x16x32_bf16 v[4:7], v[168:171], v[152:155], v[4:7]
    v_mfma_f32_16x16x32_bf16 v[8:11], v[168:171], v[160:163], v[8:11]
    s_waitcnt lgkmcnt(8)
    v_mfma_f32_16x16x32_bf16 v[20:23], v[172:175], v[160:163], v[20:23]
    ds_read_b64_tr_b16 v[192:193], v253 offset:768
    ds_read_b64_tr_b16 v[194:195], v253 offset:4864
    v_mfma_f32_16x16x32_bf16 v[16:19], v[172:175], v[152:155], v[16:19]
    v_mfma_f32_16x16x32_bf16 v[12:15], v[172:175], v[144:147], v[12:15]
    s_waitcnt lgkmcnt(8)
    v_mfma_f32_16x16x32_bf16 v[24:27], v[176:179], v[144:147], v[24:27]
    ds_read_b64_tr_b16 v[196:197], v254 offset:768
    ds_read_b64_tr_b16 v[198:199], v254 offset:4864
    v_add_u32 v253, s28, v253
    v_add_u32 v254, s28, v254
    v_mfma_f32_16x16x32_bf16 v[28:31], v[176:179], v[152:155], v[28:31]
    v_mfma_f32_16x16x32_bf16 v[32:35], v[176:179], v[160:163], v[32:35]
    s_waitcnt lgkmcnt(8)
    v_mfma_f32_16x16x32_bf16 v[44:47], v[180:183], v[160:163], v[44:47]
    ds_read_b128 v[168:171], v252 offset:0
    v_mfma_f32_16x16x32_bf16 v[40:43], v[180:183], v[152:155], v[40:43]
    v_mfma_f32_16x16x32_bf16 v[36:39], v[180:183], v[144:147], v[36:39]
    s_waitcnt lgkmcnt(7)
    v_mfma_f32_16x16x32_bf16 v[48:51], v[184:187], v[144:147], v[48:51]
    ds_read_b128 v[172:175], v252 offset:256
    v_mfma_f32_16x16x32_bf16 v[52:55], v[184:187], v[152:155], v[52:55]
    v_mfma_f32_16x16x32_bf16 v[56:59], v[184:187], v[160:163], v[56:59]
    s_waitcnt lgkmcnt(6)
    v_mfma_f32_16x16x32_bf16 v[68:71], v[188:191], v[160:163], v[68:71]
    ds_read_b128 v[176:179], v252 offset:512
    v_mfma_f32_16x16x32_bf16 v[64:67], v[188:191], v[152:155], v[64:67]
    v_mfma_f32_16x16x32_bf16 v[60:63], v[188:191], v[144:147], v[60:63]
    s_waitcnt lgkmcnt(5)
    v_mfma_f32_16x16x32_bf16 v[72:75], v[192:195], v[144:147], v[72:75]
    ds_read_b128 v[180:183], v252 offset:768
    v_mfma_f32_16x16x32_bf16 v[76:79], v[192:195], v[152:155], v[76:79]
    v_mfma_f32_16x16x32_bf16 v[80:83], v[192:195], v[160:163], v[80:83]
    s_waitcnt lgkmcnt(4)
    v_mfma_f32_16x16x32_bf16 v[92:95], v[196:199], v[160:163], v[92:95]
    ds_read_b128 v[184:187], v252 offset:4096
    v_mfma_f32_16x16x32_bf16 v[88:91], v[196:199], v[152:155], v[88:91]
    v_mfma_f32_16x16x32_bf16 v[84:87], v[196:199], v[144:147], v[84:87]
    v_subrev_u32 v253, 98304, v253
    v_subrev_u32 v254, 98304, v254
    v_subrev_u32 v252, 16384, v252
    s_mov_b32 s27, 0
L_post_Y:
    s_waitcnt lgkmcnt(0)
    v_mov_b32 v144, v248
    v_mov_b32 v145, v249
    v_mov_b32 v146, v250
    v_permlane16_swap_b32 v144, v248
    v_permlane16_swap_b32 v145, v249
    v_permlane16_swap_b32 v146, v250
    v_add_f32 v248, v248, v144
    v_add_f32 v249, v249, v145
    v_add_f32 v250, v250, v146
    v_mov_b32 v144, v248
    v_mov_b32 v145, v249
    v_mov_b32 v146, v250
    v_permlane32_swap_b32 v144, v248
    v_permlane32_swap_b32 v145, v249
    v_permlane32_swap_b32 v146, v250
    v_add_f32 v248, v248, v144
    v_add_f32 v249, v249, v145
    v_add_f32 v250, v250, v146
    s_mov_b32 s20, 0x30800000
    s_mov_b32 s21, 0x4e800000
    v_mov_b32 v152, s21
    s_mov_b64 s[22:23], 0
    v_med3_f32 v153, v248, s20, v152
    v_cmp_neq_f32 vcc, v153, v248
    v_rcp_f32 v144, v248
    s_or_b64 s[22:23], s[22:23], vcc
    v_med3_f32 v153, v249, s20, v152
    v_cmp_neq_f32 vcc, v153, v249
    v_rcp_f32 v146, v249
    s_or_b64 s[22:23], s[22:23], vcc
    v_med3_f32 v153, v250, s20, v152
    v_cmp_neq_f32 vcc, v153, v250
    v_rcp_f32 v148, v250
    s_or_b64 s[22:23], s[22:23], vcc
    s_cselect_b32 s62, 1, 0
    s_cmp_eq_u32 s27, 0
    s_cselect_b32 s62, s62, 0
    s_lshl_b32 s20, s3, 2
    s_add_u32 s20, s20, 163776
    v_mov_b32 v152, s20
    v_mov_b32 v153, s62
    ds_write_b32 v152, v153
    v_mbcnt_lo_u32_b32 v249, -1, 0
    v_mbcnt_hi_u32_b32 v249, -1, v249
    v_lshlrev_b32 v248, 4, v249
    v_mov_b32 v250, 0
    s_or_b32 s20, s62, s63
    s_cbranch_scc0 L_pack_Y
    s_waitcnt vmcnt(0)
    s_branch L_nopack_Y
L_pack_Y:
    v_mul_f32 v0, v0, v144
    v_mul_f32 v1, v1, v144
    v_mul_f32 v2, v2, v144
    v_mul_f32 v3, v3, v144
    v_cvt_pk_bf16_f32 v96, v0, v1
    v_cvt_pk_bf16_f32 v97, v2, v3
    v_mul_f32 v12, v12, v144
    v_mul_f32 v13, v13, v144
    v_mul_f32 v14, v14, v144
    v_mul_f32 v15, v15, v144
    v_cvt_pk_bf16_f32 v98, v12, v13
    v_cvt_pk_bf16_f32 v99, v14, v15
    v_mul_f32 v4, v4, v146
    v_mul_f32 v5, v5, v146
    v_mul_f32 v6, v6, v146
    v_mul_f32 v7, v7, v146
    v_cvt_pk_bf16_f32 v100, v4, v5
    v_cvt_pk_bf16_f32 v101, v6, v7
    v_mul_f32 v16, v16, v146
    v_mul_f32 v17, v17, v146
    v_mul_f32 v18, v18, v146
    v_mul_f32 v19, v19, v146
    v_cvt_pk_bf16_f32 v102, v16, v17
    v_cvt_pk_bf16_f32 v103, v18, v19
    v_mul_f32 v8, v8, v148
    v_mul_f32 v9, v9, v148
    v_mul_f32 v10, v10, v148
    v_mul_f32 v11, v11, v148
    v_cvt_pk_bf16_f32 v104, v8, v9
    v_cvt_pk_bf16_f32 v105, v10, v11
    v_mul_f32 v20, v20, v148
    v_mul_f32 v21, v21, v148
    v_mul_f32 v22, v22, v148
    v_mul_f32 v23, v23, v148
    v_cvt_pk_bf16_f32 v106, v20, v21
    v_cvt_pk_bf16_f32 v107, v22, v23
    s_add_u32 s20, s52, 0
    s_cmp_eq_u32 s61, 0
    s_cbranch_scc1 L_st0_Y_s
    buffer_store_dwordx4 v[96:99], v248, s[40:43], s20 offen offset:0
    buffer_store_dwordx4 v[100:103], v248, s[40:43], s20 offen offset:1024
    buffer_store_dwordx4 v[104:107], v248, s[40:43], s20 offen offset:2048
    s_branch L_st0_Y_e
L_st0_Y_s:
    buffer_store_dwordx4 v[96:99], v248, s[40:43], s20 offen offset:0 sc1
    buffer_store_dwordx4 v[100:103], v248, s[40:43], s20 offen offset:1024 sc1
    buffer_store_dwordx4 v[104:107], v248, s[40:43], s20 offen offset:2048 sc1
L_st0_Y_e:
    v_mul_f32 v24, v24, v144
    v_mul_f32 v25, v25, v144
    v_mul_f32 v26, v26, v144
    v_mul_f32 v27, v27, v144
    v_cvt_pk_bf16_f32 v108, v24, v25
    v_cvt_pk_bf16_f32 v109, v26, v27
    v_mul_f32 v36, v36, v144
    v_mul_f32 v37, v37, v144
    v_mul_f32 v38, v38, v144
    v_mul_f32 v39, v39, v144
    v_cvt_pk_bf16_f32 v110, v36, v37
    v_cvt_pk_bf16_f32 v111, v38, v39
    v_mul_f32 v28, v28, v146
    v_mul_f32 v29, v29, v146
    v_mul_f32 v30, v30, v146
    v_mul_f32 v31, v31, v146
    v_cvt_pk_bf16_f32 v112, v28, v29
    v_cvt_pk_bf16_f32 v113, v30, v31
    v_mul_f32 v40, v40, v146
    v_mul_f32 v41, v41, v146
    v_mul_f32 v42, v42, v146
    v_mul_f32 v43, v43, v146
    v_cvt_pk_bf16_f32 v114, v40, v41
    v_cvt_pk_bf16_f32 v115, v42, v43
    v_mul_f32 v32, v32, v148
    v_mul_f32 v33, v33, v148
    v_mul_f32 v34, v34, v148
    v_mul_f32 v35, v35, v148
    v_cvt_pk_bf16_f32 v116, v32, v33
    v_cvt_pk_bf16_f32 v117, v34, v35
    v_mul_f32 v44, v44, v148
    v_mul_f32 v45, v45, v148
    v_mul_f32 v46, v46, v148
    v_mul_f32 v47, v47, v148
    v_cvt_pk_bf16_f32 v118, v44, v45
    v_cvt_pk_bf16_f32 v119, v46, v47
    s_add_u32 s20, s52, 3072
    s_cmp_eq_u32 s61, 0
    s_cbranch_scc1 L_st1_Y_s
    buffer_store_dwordx4 v[108:111], v248, s[40:43], s20 offen offset:0
    buffer_store_dwordx4 v[112:115], v248, s[40:43], s20 offen offset:1024
    buffer_store_dwordx4 v[116:119], v248, s[40:43], s20 offen offset:2048
    s_branch L_st1_Y_e
L_st1_Y_s:
    buffer_store_dwordx4 v[108:111], v248, s[40:43], s20 offen offset:0 sc1
    buffer_store_dwordx4 v[112:115], v248, s[40:43], s20 offen offset:1024 sc1
    buffer_store_dwordx4 v[116:119], v248, s[40:43], s20 offen offset:2048 sc1
L_st1_Y_e:
    v_mul_f32 v48, v48, v144
    v_mul_f32 v49, v49, v144
    v_mul_f32 v50, v50, v144
    v_mul_f32 v51, v51, v144
    v_cvt_pk_bf16_f32 v120, v48, v49
    v_cvt_pk_bf16_f32 v121, v50, v51
    v_mul_f32 v60, v60, v144
    v_mul_f32 v61, v61, v144
    v_mul_f32 v62, v62, v144
    v_mul_f32 v63, v63, v144
    v_cvt_pk_bf16_f32 v122, v60, v61
    v_cvt_pk_bf16_f32 v123, v62, v63
    v_mul_f32 v52, v52, v146
    v_mul_f32 v53, v53, v146
    v_mul_f32 v54, v54, v146
    v_mul_f32 v55, v55, v146
    v_cvt_pk_bf16_f32 v124, v52, v53
    v_cvt_pk_bf16_f32 v125, v54, v55
    v_mul_f32 v64, v64, v146
    v_mul_f32 v65, v65, v146
    v_mul_f32 v66, v66, v146
    v_mul_f32 v67, v67, v146
    v_cvt_pk_bf16_f32 v126, v64, v65
    v_cvt_pk_bf16_f32 v127, v66, v67
    v_mul_f32 v56, v56, v148
    v_mul_f32 v57, v57, v148
    v_mul_f32 v58, v58, v148
    v_mul_f32 v59, v59, v148
    v_cvt_pk_bf16_f32 v128, v56, v57
    v_cvt_pk_bf16_f32 v129, v58, v59
    v_mul_f32 v68, v68, v148
    v_mul_f32 v69, v69, v148
    v_mul_f32 v70, v70, v148
    v_mul_f32 v71, v71, v148
    v_cvt_pk_bf16_f32 v130, v68, v69
    v_cvt_pk_bf16_f32 v131, v70, v71
    v_mul_f32 v72, v72, v144
    v_mul_f32 v73, v73, v144
    v_mul_f32 v74, v74, v144
    v_mul_f32 v75, v75, v144
    v_cvt_pk_bf16_f32 v132, v72, v73
    v_cvt_pk_bf16_f32 v133, v74, v75
    v_mul_f32 v84, v84, v144
    v_mul_f32 v85, v85, v144
    v_mul_f32 v86, v86, v144
    v_mul_f32 v87, v87, v144
    v_cvt_pk_bf16_f32 v134, v84, v85
    v_cvt_pk_bf16_f32 v135, v86, v87
    v_mul_f32 v76, v76, v146
    v_mul_f32 v77, v77, v146
    v_mul_f32 v78, v78, v146
    v_mul_f32 v79, v79, v146
    v_cvt_pk_bf16_f32 v136, v76, v77
    v_cvt_pk_bf16_f32 v137, v78, v79
    v_mul_f32 v88, v88, v146
    v_mul_f32 v89, v89, v146
    v_mul_f32 v90, v90, v146
    v_mul_f32 v91, v91, v146
    v_cvt_pk_bf16_f32 v138, v88, v89
    v_cvt_pk_bf16_f32 v139, v90, v91
    v_mul_f32 v80, v80, v148
    v_mul_f32 v81, v81, v148
    v_mul_f32 v82, v82, v148
    v_mul_f32 v83, v83, v148
    v_cvt_pk_bf16_f32 v140, v80, v81
    v_cvt_pk_bf16_f32 v141, v82, v83
    v_mul_f32 v92, v92, v148
    v_mul_f32 v93, v93, v148
    v_mul_f32 v94, v94, v148
    v_mul_f32 v95, v95, v148
    v_cvt_pk_bf16_f32 v142, v92, v93
    v_cvt_pk_bf16_f32 v143, v94, v95
L_nopack_Y:
    v_and_b32 v152, 7, v249
    v_lshlrev_b32 v152, 2, v152
    v_add_u32 v152, 163776, v152
    s_waitcnt vmcnt(7) lgkmcnt(0)
    s_barrier
    ds_read_b32 v153, v152
    ds_read_b64_tr_b16 v[180:181], v253 offset:16384
    ds_read_b64_tr_b16 v[182:183], v253 offset:20480
    ds_read_b64_tr_b16 v[184:185], v254 offset:16384
    ds_read_b64_tr_b16 v[186:187], v254 offset:20480
    ds_read_b64_tr_b16 v[188:189], v253 offset:16640
    ds_read_b64_tr_b16 v[190:191], v253 offset:20736
    ds_read_b64_tr_b16 v[192:193], v254 offset:16640
    ds_read_b64_tr_b16 v[194:195], v254 offset:20736
    ds_read_b64_tr_b16 v[196:197], v253 offset:16896
    ds_read_b64_tr_b16 v[198:199], v253 offset:20992
    ds_read_b64_tr_b16 v[200:201], v254 offset:16896
    ds_read_b64_tr_b16 v[202:203], v254 offset:20992
    ds_read_b64_tr_b16 v[204:205], v253 offset:17152
    ds_read_b64_tr_b16 v[206:207], v253 offset:21248
    s_waitcnt lgkmcnt(14)
    v_cmp_ne_u32 vcc, 0, v153
    s_cbranch_vccnz L_slow_Y
    v_and_b32 v149, 3, v249
    v_lshlrev_b32 v149, 3, v149
    s_and_b32 s20, s2, 3
    s_lshl_b32 s20, s20, 5
    v_add_u32 v149, s20, v149
    s_waitcnt lgkmcnt(12)
    v_mfma_f32_16x16x32_bf16 v[0:3], v[180:183], v[96:99], 0
    ds_read_b64_tr_b16 v[208:209], v254 offset:17152
    ds_read_b64_tr_b16 v[210:211], v254 offset:21248
    v_mfma_f32_16x16x32_bf16 v[4:7], v[180:183], v[100:103], 0
    s_add_u32 m0, s74, 32768
    s_add_u32 s22, s57, 0
    buffer_load_dwordx4 v245, s[4:7], s22 offen lds
    v_mfma_f32_16x16x32_bf16 v[8:11], v[180:183], v[104:107], 0
    s_add_u32 m0, s74, 34816
    s_add_u32 s22, s57, 8192
    buffer_load_dwordx4 v245, s[4:7], s22 offen lds
    s_waitcnt lgkmcnt(12)
    v_mfma_f32_16x16x32_bf16 v[20:23], v[184:187], v[104:107], 0
    ds_read_b64_tr_b16 v[180:181], v253 offset:32768
    ds_read_b64_tr_b16 v[182:183], v253 offset:36864
    v_mfma_f32_16x16x32_bf16 v[16:19], v[184:187], v[100:103], 0
    s_add_u32 m0, s74, 36864
    s_add_u32 s22, s57, 16384
    buffer_load_dwordx4 v245, s[4:7], s22 offen lds
    v_mfma_f32_16x16x32_bf16 v[12:15], v[184:187], v[96:99], 0
    s_add_u32 m0, s74, 38912
    s_add_u32 s22, s57, 24576
    buffer_load_dwordx4 v245, s[4:7], s22 offen lds
    s_waitcnt vmcnt(4)
    v_mov_b32 v146, 1
    s_mov_b64 exec, 1
    s_cmp_eq_u32 s61, 0
    s_cbranch_scc1 L_fl0_Y_s
    buffer_store_dword v146, v250, s[40:43], s72 offen
    s_branch L_fl0_Y_e
L_fl0_Y_s:
    buffer_store_dword v146, v250, s[40:43], s72 offen sc1
L_fl0_Y_e:
    s_mov_b64 exec, -1
    s_waitcnt lgkmcnt(12)
    v_mfma_f32_16x16x32_bf16 v[24:27], v[188:191], v[96:99], 0
    ds_read_b64_tr_b16 v[184:185], v254 offset:32768
    ds_read_b64_tr_b16 v[186:187], v254 offset:36864
    v_mfma_f32_16x16x32_bf16 v[28:31], v[188:191], v[100:103], 0
    s_add_u32 m0, s74, 4294950912
    s_add_u32 s22, s58, 0
    buffer_load_dwordx4 v245, s[4:7], s22 offen lds
    v_mfma_f32_16x16x32_bf16 v[32:35], v[188:191], v[104:107], 0
    s_add_u32 m0, s74, 4294952960
    s_add_u32 s22, s58, 8192
    buffer_load_dwordx4 v245, s[4:7], s22 offen lds
    s_waitcnt lgkmcnt(12)
    v_mfma_f32_16x16x32_bf16 v[44:47], v[192:195], v[104:107], 0
    ds_read_b64_tr_b16 v[188:189], v253 offset:33024
    ds_read_b64_tr_b16 v[190:191], v253 offset:37120
    v_mfma_f32_16x16x32_bf16 v[40:43], v[192:195], v[100:103], 0
    s_add_u32 m0, s74, 4294955008
    s_add_u32 s22, s58, 16384
    buffer_load_dwordx4 v245, s[4:7], s22 offen lds
    v_mfma_f32_16x16x32_bf16 v[36:39], v[192:195], v[96:99], 0
    s_add_u32 m0, s74, 4294957056
    s_add_u32 s22, s58, 24576
    buffer_load_dwordx4 v245, s[4:7], s22 offen lds
    s_waitcnt lgkmcnt(12)
    v_mfma_f32_16x16x32_bf16 v[48:51], v[196:199], v[96:99], 0
    ds_read_b64_tr_b16 v[192:193], v254 offset:33024
    ds_read_b64_tr_b16 v[194:195], v254 offset:37120
    v_mfma_f32_16x16x32_bf16 v[52:55], v[196:199], v[100:103], 0
    v_mfma_f32_16x16x32_bf16 v[56:59], v[196:199], v[104:107], 0
    s_waitcnt lgkmcnt(12)
    v_mfma_f32_16x16x32_bf16 v[68:71], v[200:203], v[104:107], 0
    ds_read_b64_tr_b16 v[196:197], v253 offset:33280
    ds_read_b64_tr_b16 v[198:199], v253 offset:37376
    v_mfma_f32_16x16x32_bf16 v[64:67], v[200:203], v[100:103], 0
    v_mfma_f32_16x16x32_bf16 v[60:63], v[200:203], v[96:99], 0
    s_waitcnt lgkmcnt(12)
    v_mfma_f32_16x16x32_bf16 v[72:75], v[204:207], v[96:99], 0
    ds_read_b64_tr_b16 v[200:201], v254 offset:33280
    ds_read_b64_tr_b16 v[202:203], v254 offset:37376
    v_mfma_f32_16x16x32_bf16 v[76:79], v[204:207], v[100:103], 0
    v_mfma_f32_16x16x32_bf16 v[80:83], v[204:207], v[104:107], 0
    s_waitcnt lgkmcnt(12)
    v_mfma_f32_16x16x32_bf16 v[92:95], v[208:211], v[104:107], 0
    ds_read_b64_tr_b16 v[204:205], v253 offset:33536
    ds_read_b64_tr_b16 v[206:207], v253 offset:37632
    v_mfma_f32_16x16x32_bf16 v[88:91], v[208:211], v[100:103], 0
    v_mfma_f32_16x16x32_bf16 v[84:87], v[208:211], v[96:99], 0
    s_waitcnt lgkmcnt(12)
    v_mfma_f32_16x16x32_bf16 v[0:3], v[180:183], v[108:111], v[0:3]
    ds_read_b64_tr_b16 v[208:209], v254 offset:33536
    ds_read_b64_tr_b16 v[210:211], v254 offset:37632
    v_mfma_f32_16x16x32_bf16 v[4:7], v[180:183], v[112:115], v[4:7]
    s_add_u32 m0, s74, 49152
    s_add_u32 s22, s59, 0
    buffer_load_dwordx4 v245, s[4:7], s22 offen lds
    v_mfma_f32_16x16x32_bf16 v[8:11], v[180:183], v[116:119], v[8:11]
    s_add_u32 m0, s74, 51200
    s_add_u32 s22, s59, 8192
    buffer_load_dwordx4 v245, s[4:7], s22 offen lds
    s_waitcnt lgkmcnt(12)
    v_mfma_f32_16x16x32_bf16 v[20:23], v[184:187], v[116:119], v[20:23]
    v_add_u32 v253, 98304, v253
    v_add_u32 v254, 98304, v254
    ds_read_b64_tr_b16 v[180:181], v253 offset:0
    ds_read_b64_tr_b16 v[182:183], v253 offset:4096
    v_mfma_f32_16x16x32_bf16 v[16:19], v[184:187], v[112:115], v[16:19]
    s_add_u32 m0, s74, 53248
    s_add_u32 s22, s59, 16384
    buffer_load_dwordx4 v245, s[4:7], s22 offen lds
    v_mfma_f32_16x16x32_bf16 v[12:15], v[184:187], v[108:111], v[12:15]
    s_add_u32 m0, s74, 55296
    s_add_u32 s22, s59, 24576
    buffer_load_dwordx4 v245, s[4:7], s22 offen lds
    buffer_load_dword v148, v149, s[40:43], s60 offen sc1
    s_waitcnt lgkmcnt(12)
    v_mfma_f32_16x16x32_bf16 v[24:27], v[188:191], v[108:111], v[24:27]
    ds_read_b64_tr_b16 v[184:185], v254 offset:0
    ds_read_b64_tr_b16 v[186:187], v254 offset:4096
    v_mfma_f32_16x16x32_bf16 v[28:31], v[188:191], v[112:115], v[28:31]
    v_mfma_f32_16x16x32_bf16 v[32:35], v[188:191], v[116:119], v[32:35]
    s_waitcnt lgkmcnt(12)
    v_mfma_f32_16x16x32_bf16 v[44:47], v[192:195], v[116:119], v[44:47]
    ds_read_b64_tr_b16 v[188:189], v253 offset:256
    ds_read_b64_tr_b16 v[190:191], v253 offset:4352
    v_mfma_f32_16x16x32_bf16 v[40:43], v[192:195], v[112:115], v[40:43]
    v_mfma_f32_16x16x32_bf16 v[36:39], v[192:195], v[108:111], v[36:39]
    s_waitcnt lgkmcnt(12)
    v_mfma_f32_16x16x32_bf16 v[48:51], v[196:199], v[108:111], v[48:51]
    ds_read_b64_tr_b16 v[192:193], v254 offset:256
    ds_read_b64_tr_b16 v[194:195], v254 offset:4352
    v_mfma_f32_16x16x32_bf16 v[52:55], v[196:199], v[112:115], v[52:55]
    v_mfma_f32_16x16x32_bf16 v[56:59], v[196:199], v[116:119], v[56:59]
    s_waitcnt lgkmcnt(12)
    v_mfma_f32_16x16x32_bf16 v[68:71], v[200:203], v[116:119], v[68:71]
    ds_read_b64_tr_b16 v[196:197], v253 offset:512
    ds_read_b64_tr_b16 v[198:199], v253 offset:4608
    v_mfma_f32_16x16x32_bf16 v[64:67], v[200:203], v[112:115], v[64:67]
    v_mfma_f32_16x16x32_bf16 v[60:63], v[200:203], v[108:111], v[60:63]
    s_waitcnt lgkmcnt(12)
    v_mfma_f32_16x16x32_bf16 v[72:75], v[204:207], v[108:111], v[72:75]
    ds_read_b64_tr_b16 v[200:201], v254 offset:512
    ds_read_b64_tr_b16 v[202:203], v254 offset:4608
    v_mfma_f32_16x16x32_bf16 v[76:79], v[204:207], v[112:115], v[76:79]
    v_mfma_f32_16x16x32_bf16 v[80:83], v[204:207], v[116:119], v[80:83]
    s_waitcnt lgkmcnt(12)
    v_mfma_f32_16x16x32_bf16 v[92:95], v[208:211], v[116:119], v[92:95]
    ds_read_b64_tr_b16 v[204:205], v253 offset:768
    ds_read_b64_tr_b16 v[206:207], v253 offset:4864
    v_mfma_f32_16x16x32_bf16 v[88:91], v[208:211], v[112:115], v[88:91]
    v_mfma_f32_16x16x32_bf16 v[84:87], v[208:211], v[108:111], v[84:87]
    s_waitcnt vmcnt(0)
    v_cmp_gt_u32 vcc, 1, v148
    s_cbranch_vccz L_polled0_Y
L_poll0_Y:
    buffer_load_dword v148, v149, s[40:43], s60 offen sc1
    s_add_u32 s79, s79, 1
    s_cmp_ge_u32 s79, 0x40000
    s_waitcnt vmcnt(0)
    s_cbranch_scc1 L_polled0_Y
    v_cmp_gt_u32 vcc, 1, v148
    s_cbranch_vccnz L_poll0_Y
L_polled0_Y:
    s_waitcnt lgkmcnt(12)
    v_mfma_f32_16x16x32_bf16 v[0:3], v[180:183], v[120:123], v[0:3]
    ds_read_b64_tr_b16 v[208:209], v254 offset:768
    ds_read_b64_tr_b16 v[210:211], v254 offset:4864
    v_mfma_f32_16x16x32_bf16 v[4:7], v[180:183], v[124:127], v[4:7]
    s_add_u32 s20, s53, 0
    buffer_load_dwordx4 v[156:159], v248, s[40:43], s20 offen offset:0 sc1
    v_mfma_f32_16x16x32_bf16 v[8:11], v[180:183], v[128:131], v[8:11]
    s_add_u32 s20, s53, 0
    buffer_load_dwordx4 v[160:163], v248, s[40:43], s20 offen offset:1024 sc1
    s_waitcnt lgkmcnt(12)
    v_mfma_f32_16x16x32_bf16 v[20:23], v[184:187], v[128:131], v[20:23]
    v_add_u32 v253, 4294918144, v253
    v_add_u32 v254, 4294918144, v254
    ds_read_b64_tr_b16 v[180:181], v253 offset:0
    ds_read_b64_tr_b16 v[182:183], v253 offset:4096
    v_mfma_f32_16x16x32_bf16 v[16:19], v[184:187], v[124:127], v[16:19]
    s_add_u32 s20, s53, 0
    buffer_load_dwordx4 v[164:167], v248, s[40:43], s20 offen offset:2048 sc1
    v_mfma_f32_16x16x32_bf16 v[12:15], v[184:187], v[120:123], v[12:15]
    s_add_u32 s20, s54, 0
    buffer_load_dwordx4 v[168:171], v248, s[40:43], s20 offen offset:0 sc1
    s_waitcnt lgkmcnt(12)
    v_mfma_f32_16x16x32_bf16 v[24:27], v[188:191], v[120:123], v[24:27]
    ds_read_b64_tr_b16 v[184:185], v254 offset:0
    ds_read_b64_tr_b16 v[186:187], v254 offset:4096
    v_mfma_f32_16x16x32_bf16 v[28:31], v[188:191], v[124:127], v[28:31]
    s_add_u32 s20, s54, 0
    buffer_load_dwordx4 v[172:175], v248, s[40:43], s20 offen offset:1024 sc1
    v_mfma_f32_16x16x32_bf16 v[32:35], v[188:191], v[128:131], v[32:35]
    s_add_u32 s20, s54, 0
    buffer_load_dwordx4 v[176:179], v248, s[40:43], s20 offen offset:2048 sc1
    s_waitcnt lgkmcnt(12)
    v_mfma_f32_16x16x32_bf16 v[44:47], v[192:195], v[128:131], v[44:47]
    ds_read_b64_tr_b16 v[188:189], v253 offset:256
    ds_read_b64_tr_b16 v[190:191], v253 offset:4352
    v_mfma_f32_16x16x32_bf16 v[40:43], v[192:195], v[124:127], v[40:43]
    s_add_u32 m0, s74, 4294885376
    s_add_u32 s22, s57, 32768
    buffer_load_dwordx4 v245, s[4:7], s22 offen lds
    v_mfma_f32_16x16x32_bf16 v[36:39], v[192:195], v[120:123], v[36:39]
    s_add_u32 m0, s74, 4294887424
    s_add_u32 s22, s57, 40960
    buffer_load_dwordx4 v245, s[4:7], s22 offen lds
    s_waitcnt lgkmcnt(12)
    v_mfma_f32_16x16x32_bf16 v[48:51], v[196:199], v[120:123], v[48:51]
    ds_read_b64_tr_b16 v[192:193], v254 offset:256
    ds_read_b64_tr_b16 v[194:195], v254 offset:4352
    v_mfma_f32_16x16x32_bf16 v[52:55], v[196:199], v[124:127], v[52:55]
    s_add_u32 m0, s74, 4294889472
    s_add_u32 s22, s57, 49152
    buffer_load_dwordx4 v245, s[4:7], s22 offen lds
    v_mfma_f32_16x16x32_bf16 v[56:59], v[196:199], v[128:131], v[56:59]
    s_add_u32 m0, s74, 4294891520
    s_add_u32 s22, s57, 57344
    buffer_load_dwordx4 v245, s[4:7], s22 offen lds
    s_waitcnt lgkmcnt(12)
    v_mfma_f32_16x16x32_bf16 v[68:71], v[200:203], v[128:131], v[68:71]
    ds_read_b64_tr_b16 v[196:197], v253 offset:512
    ds_read_b64_tr_b16 v[198:199], v253 offset:4608
    v_mfma_f32_16x16x32_bf16 v[64:67], v[200:203], v[124:127], v[64:67]
    v_mfma_f32_16x16x32_bf16 v[60:63], v[200:203], v[120:123], v[60:63]
    s_waitcnt lgkmcnt(12)
    v_mfma_f32_16x16x32_bf16 v[72:75], v[204:207], v[120:123], v[72:75]
    ds_read_b64_tr_b16 v[200:201], v254 offset:512
    ds_read_b64_tr_b16 v[202:203], v254 offset:4608
    v_mfma_f32_16x16x32_bf16 v[76:79], v[204:207], v[124:127], v[76:79]
    v_mfma_f32_16x16x32_bf16 v[80:83], v[204:207], v[128:131], v[80:83]
    s_waitcnt lgkmcnt(12)
    v_mfma_f32_16x16x32_bf16 v[92:95], v[208:211], v[128:131], v[92:95]
    ds_read_b64_tr_b16 v[204:205], v253 offset:768
    ds_read_b64_tr_b16 v[206:207], v253 offset:4864
    v_mfma_f32_16x16x32_bf16 v[88:91], v[208:211], v[124:127], v[88:91]
    v_mfma_f32_16x16x32_bf16 v[84:87], v[208:211], v[120:123], v[84:87]
    s_waitcnt lgkmcnt(12)
    v_mfma_f32_16x16x32_bf16 v[0:3], v[180:183], v[132:135], v[0:3]
    ds_read_b64_tr_b16 v[208:209], v254 offset:768
    ds_read_b64_tr_b16 v[210:211], v254 offset:4864
    v_mfma_f32_16x16x32_bf16 v[4:7], v[180:183], v[136:139], v[4:7]
    s_add_u32 s20, s55, 0
    buffer_load_dwordx4 v[96:99], v248, s[40:43], s20 offen offset:0 sc1
    v_mfma_f32_16x16x32_bf16 v[8:11], v[180:183], v[140:143], v[8:11]
    s_add_u32 s20, s55, 0
    buffer_load_dwordx4 v[100:103], v248, s[40:43], s20 offen offset:1024 sc1
    s_barrier
    s_waitcnt lgkmcnt(12)
    v_mfma_f32_16x16x32_bf16 v[20:23], v[184:187], v[140:143], v[20:23]
    v_add_u32 v253, 49152, v253
    v_add_u32 v254, 49152, v254
    ds_read_b64_tr_b16 v[180:181], v253 offset:16384
    ds_read_b64_tr_b16 v[182:183], v253 offset:20480
    v_mfma_f32_16x16x32_bf16 v[16:19], v[184:187], v[136:139], v[16:19]
    s_add_u32 s20, s55, 0
    buffer_load_dwordx4 v[104:107], v248, s[40:43], s20 offen offset:2048 sc1
    v_mfma_f32_16x16x32_bf16 v[12:15], v[184:187], v[132:135], v[12:15]
    s_add_u32 s20, s53, 3072
    buffer_load_dwordx4 v[108:111], v248, s[40:43], s20 offen offset:0 sc1
    s_waitcnt lgkmcnt(12)
    v_mfma_f32_16x16x32_bf16 v[24:27], v[188:191], v[132:135], v[24:27]
    ds_read_b64_tr_b16 v[184:185], v254 offset:16384
    ds_read_b64_tr_b16 v[186:187], v254 offset:20480
    v_mfma_f32_16x16x32_bf16 v[28:31], v[188:191], v[136:139], v[28:31]
    s_add_u32 s20, s53, 3072
    buffer_load_dwordx4 v[112:115], v248, s[40:43], s20 offen offset:1024 sc1
    v_mfma_f32_16x16x32_bf16 v[32:35], v[188:191], v[140:143], v[32:35]
    s_add_u32 s20, s53, 3072
    buffer_load_dwordx4 v[116:119], v248, s[40:43], s20 offen offset:2048 sc1
    s_waitcnt lgkmcnt(12)
    v_mfma_f32_16x16x32_bf16 v[44:47], v[192:195], v[140:143], v[44:47]
    ds_read_b64_tr_b16 v[188:189], v253 offset:16640
    ds_read_b64_tr_b16 v[190:191], v253 offset:20736
    v_mfma_f32_16x16x32_bf16 v[40:43], v[192:195], v[136:139], v[40:43]
    s_add_u32 m0, s74, 0
    s_add_u32 s22, s58, 32768
    buffer_load_dwordx4 v245, s[4:7], s22 offen lds
    v_mfma_f32_16x16x32_bf16 v[36:39], v[192:195], v[132:135], v[36:39]
    s_add_u32 m0, s74, 2048
    s_add_u32 s22, s58, 40960
    buffer_load_dwordx4 v245, s[4:7], s22 offen lds
    s_waitcnt lgkmcnt(12)
    v_mfma_f32_16x16x32_bf16 v[48:51], v[196:199], v[132:135], v[48:51]
    ds_read_b64_tr_b16 v[192:193], v254 offset:16640
    ds_read_b64_tr_b16 v[194:195], v254 offset:20736
    v_mfma_f32_16x16x32_bf16 v[52:55], v[196:199], v[136:139], v[52:55]
    s_add_u32 m0, s74, 4096
    s_add_u32 s22, s58, 49152
    buffer_load_dwordx4 v245, s[4:7], s22 offen lds
    v_mfma_f32_16x16x32_bf16 v[56:59], v[196:199], v[140:143], v[56:59]
    s_add_u32 m0, s74, 6144
    s_add_u32 s22, s58, 57344
    buffer_load_dwordx4 v245, s[4:7], s22 offen lds
    s_waitcnt lgkmcnt(12)
    v_mfma_f32_16x16x32_bf16 v[68:71], v[200:203], v[140:143], v[68:71]
    ds_read_b64_tr_b16 v[196:197], v253 offset:16896
    ds_read_b64_tr_b16 v[198:199], v253 offset:20992
    v_mfma_f32_16x16x32_bf16 v[64:67], v[200:203], v[136:139], v[64:67]
    v_mfma_f32_16x16x32_bf16 v[60:63], v[200:203], v[132:135], v[60:63]
    s_waitcnt vmcnt(7)
    v_mov_b32 v146, 2
    s_mov_b64 exec, 1
    s_cmp_eq_u32 s61, 0
    s_cbranch_scc1 L_fl1_Y_s
    buffer_store_dword v146, v250, s[40:43], s72 offen
    s_branch L_fl1_Y_e
L_fl1_Y_s:
    buffer_store_dword v146, v250, s[40:43], s72 offen sc1
L_fl1_Y_e:
    s_mov_b64 exec, -1
    s_waitcnt lgkmcnt(12)
    v_mfma_f32_16x16x32_bf16 v[72:75], v[204:207], v[132:135], v[72:75]
    ds_read_b64_tr_b16 v[200:201], v254 offset:16896
    ds_read_b64_tr_b16 v[202:203], v254 offset:20992
    v_mfma_f32_16x16x32_bf16 v[76:79], v[204:207], v[136:139], v[76:79]
    v_mfma_f32_16x16x32_bf16 v[80:83], v[204:207], v[140:143], v[80:83]
    s_waitcnt lgkmcnt(12)
    v_mfma_f32_16x16x32_bf16 v[92:95], v[208:211], v[140:143], v[92:95]
    ds_read_b64_tr_b16 v[204:205], v253 offset:17152
    ds_read_b64_tr_b16 v[206:207], v253 offset:21248
    v_mfma_f32_16x16x32_bf16 v[88:91], v[208:211], v[136:139], v[88:91]
    v_mfma_f32_16x16x32_bf16 v[84:87], v[208:211], v[132:135], v[84:87]
    s_waitcnt lgkmcnt(12)
    v_mfma_f32_16x16x32_bf16 v[0:3], v[180:183], v[156:159], v[0:3]
    ds_read_b64_tr_b16 v[208:209], v254 offset:17152
    ds_read_b64_tr_b16 v[210:211], v254 offset:21248
    v_mfma_f32_16x16x32_bf16 v[4:7], v[180:183], v[160:163], v[4:7]
    s_add_u32 m0, s74, 65536
    s_add_u32 s22, s59, 32768
    buffer_load_dwordx4 v245, s[4:7], s22 offen lds
    v_mfma_f32_16x16x32_bf16 v[8:11], v[180:183], v[164:167], v[8:11]
    s_add_u32 m0, s74, 67584
    s_add_u32 s22, s59, 40960
    buffer_load_dwordx4 v245, s[4:7], s22 offen lds
    s_waitcnt lgkmcnt(12)
    v_mfma_f32_16x16x32_bf16 v[20:23], v[184:187], v[164:167], v[20:23]
    v_add_u32 v253, 4294918144, v253
    v_add_u32 v254, 4294918144, v254
    ds_read_b64_tr_b16 v[180:181], v253 offset:16384
    ds_read_b64_tr_b16 v[182:183], v253 offset:20480
    v_mfma_f32_16x16x32_bf16 v[16:19], v[184:187], v[160:163], v[16:19]
    s_add_u32 m0, s74, 69632
    s_add_u32 s22, s59, 49152
    buffer_load_dwordx4 v245, s[4:7], s22 offen lds
    v_mfma_f32_16x16x32_bf16 v[12:15], v[184:187], v[156:159], v[12:15]
    s_add_u32 m0, s74, 71680
    s_add_u32 s22, s59, 57344
    buffer_load_dwordx4 v245, s[4:7], s22 offen lds
    buffer_load_dword v148, v149, s[40:43], s60 offen sc1
    s_waitcnt lgkmcnt(12)
    v_mfma_f32_16x16x32_bf16 v[24:27], v[188:191], v[156:159], v[24:27]
    ds_read_b64_tr_b16 v[184:185], v254 offset:16384
    ds_read_b64_tr_b16 v[186:187], v254 offset:20480
    v_mfma_f32_16x16x32_bf16 v[28:31], v[188:191], v[160:163], v[28:31]
    s_add_u32 m0, s74, 4294901760
    s_add_u32 s22, s57, 65536
    buffer_load_dwordx4 v245, s[4:7], s22 offen lds
    v_mfma_f32_16x16x32_bf16 v[32:35], v[188:191], v[164:167], v[32:35]
    s_add_u32 m0, s74, 4294903808
    s_add_u32 s22, s57, 73728
    buffer_load_dwordx4 v245, s[4:7], s22 offen lds
    s_waitcnt lgkmcnt(12)
    v_mfma_f32_16x16x32_bf16 v[44:47], v[192:195], v[164:167], v[44:47]
    ds_read_b64_tr_b16 v[188:189], v253 offset:16640
    ds_read_b64_tr_b16 v[190:191], v253 offset:20736
    v_mfma_f32_16x16x32_bf16 v[40:43], v[192:195], v[160:163], v[40:43]
    s_add_u32 m0, s74, 4294905856
    s_add_u32 s22, s57, 81920
    buffer_load_dwordx4 v245, s[4:7], s22 offen lds
    v_mfma_f32_16x16x32_bf16 v[36:39], v[192:195], v[156:159], v[36:39]
    s_add_u32 m0, s74, 4294907904
    s_add_u32 s22, s57, 90112
    buffer_load_dwordx4 v245, s[4:7], s22 offen lds
    s_waitcnt lgkmcnt(12)
    v_mfma_f32_16x16x32_bf16 v[48:51], v[196:199], v[156:159], v[48:51]
    ds_read_b64_tr_b16 v[192:193], v254 offset:16640
    ds_read_b64_tr_b16 v[194:195], v254 offset:20736
    v_mfma_f32_16x16x32_bf16 v[52:55], v[196:199], v[160:163], v[52:55]
    v_mfma_f32_16x16x32_bf16 v[56:59], v[196:199], v[164:167], v[56:59]
    s_waitcnt lgkmcnt(12)
    v_mfma_f32_16x16x32_bf16 v[68:71], v[200:203], v[164:167], v[68:71]
    ds_read_b64_tr_b16 v[196:197], v253 offset:16896
    ds_read_b64_tr_b16 v[198:199], v253 offset:20992
    v_mfma_f32_16x16x32_bf16 v[64:67], v[200:203], v[160:163], v[64:67]
    v_mfma_f32_16x16x32_bf16 v[60:63], v[200:203], v[156:159], v[60:63]
    s_waitcnt lgkmcnt(12)
    v_mfma_f32_16x16x32_bf16 v[72:75], v[204:207], v[156:159], v[72:75]
    ds_read_b64_tr_b16 v[200:201], v254 offset:16896
    ds_read_b64_tr_b16 v[202:203], v254 offset:20992
    v_mfma_f32_16x16x32_bf16 v[76:79], v[204:207], v[160:163], v[76:79]
    v_mfma_f32_16x16x32_bf16 v[80:83], v[204:207], v[164:167], v[80:83]
    s_waitcnt lgkmcnt(12)
    v_mfma_f32_16x16x32_bf16 v[92:95], v[208:211], v[164:167], v[92:95]
    ds_read_b64_tr_b16 v[204:205], v253 offset:17152
    ds_read_b64_tr_b16 v[206:207], v253 offset:21248
    v_mfma_f32_16x16x32_bf16 v[88:91], v[208:211], v[160:163], v[88:91]
    v_mfma_f32_16x16x32_bf16 v[84:87], v[208:211], v[156:159], v[84:87]
    s_waitcnt vmcnt(4)
    v_cmp_gt_u32 vcc, 2, v148
    s_cbranch_vccz L_polled1_Y
L_poll1_Y:
    buffer_load_dword v148, v149, s[40:43], s60 offen sc1
    s_add_u32 s79, s79, 1
    s_cmp_ge_u32 s79, 0x40000
    s_waitcnt vmcnt(0)
    s_cbranch_scc1 L_polled1_Y
    v_cmp_gt_u32 vcc, 2, v148
    s_cbranch_vccnz L_poll1_Y
L_polled1_Y:
    s_add_u32 s20, s52, 0
    s_add_u32 s20, s20, s78
    s_cmp_eq_u32 s61, 0
    s_cbranch_scc1 L_st2_Y_s
    buffer_store_dwordx4 v[120:123], v248, s[40:43], s20 offen offset:0
    buffer_store_dwordx4 v[124:127], v248, s[40:43], s20 offen offset:1024
    buffer_store_dwordx4 v[128:131], v248, s[40:43], s20 offen offset:2048
    s_branch L_st2_Y_e
L_st2_Y_s:
    buffer_store_dwordx4 v[120:123], v248, s[40:43], s20 offen offset:0 sc1
    buffer_store_dwordx4 v[124:127], v248, s[40:43], s20 offen offset:1024 sc1
    buffer_store_dwordx4 v[128:131], v248, s[40:43], s20 offen offset:2048 sc1
L_st2_Y_e:
    s_waitcnt lgkmcnt(12)
    v_mfma_f32_16x16x32_bf16 v[0:3], v[180:183], v[168:171], v[0:3]
    ds_read_b64_tr_b16 v[208:209], v254 offset:17152
    ds_read_b64_tr_b16 v[210:211], v254 offset:21248
    v_mfma_f32_16x16x32_bf16 v[4:7], v[180:183], v[172:175], v[4:7]
    s_add_u32 s20, s54, 3072
    buffer_load_dwordx4 v[156:159], v248, s[40:43], s20 offen offset:0 sc1
    v_mfma_f32_16x16x32_bf16 v[8:11], v[180:183], v[176:179], v[8:11]
    s_add_u32 s20, s54, 3072
    buffer_load_dwordx4 v[160:163], v248, s[40:43], s20 offen offset:1024 sc1
    s_waitcnt lgkmcnt(12)
    v_mfma_f32_16x16x32_bf16 v[20:23], v[184:187], v[176:179], v[20:23]
    v_add_u32 v253, 49152, v253
    v_add_u32 v254, 49152, v254
    ds_read_b64_tr_b16 v[180:181], v253 offset:32768
    ds_read_b64_tr_b16 v[182:183], v253 offset:36864
    v_mfma_f32_16x16x32_bf16 v[16:19], v[184:187], v[172:175], v[16:19]
    s_add_u32 s20, s54, 3072
    buffer_load_dwordx4 v[164:167], v248, s[40:43], s20 offen offset:2048 sc1
    v_mfma_f32_16x16x32_bf16 v[12:15], v[184:187], v[168:171], v[12:15]
    s_add_u32 m0, s74, 4294918144
    s_add_u32 s22, s58, 65536
    buffer_load_dwordx4 v245, s[4:7], s22 offen lds
    s_waitcnt lgkmcnt(12)
    v_mfma_f32_16x16x32_bf16 v[24:27], v[188:191], v[168:171], v[24:27]
    ds_read_b64_tr_b16 v[184:185], v254 offset:32768
    ds_read_b64_tr_b16 v[186:187], v254 offset:36864
    v_mfma_f32_16x16x32_bf16 v[28:31], v[188:191], v[172:175], v[28:31]
    s_add_u32 m0, s74, 4294920192
    s_add_u32 s22, s58, 73728
    buffer_load_dwordx4 v245, s[4:7], s22 offen lds
    v_mfma_f32_16x16x32_bf16 v[32:35], v[188:191], v[176:179], v[32:35]
    s_add_u32 m0, s74, 4294922240
    s_add_u32 s22, s58, 81920
    buffer_load_dwordx4 v245, s[4:7], s22 offen lds
    s_waitcnt lgkmcnt(12)
    v_mfma_f32_16x16x32_bf16 v[44:47], v[192:195], v[176:179], v[44:47]
    ds_read_b64_tr_b16 v[188:189], v253 offset:33024
    ds_read_b64_tr_b16 v[190:191], v253 offset:37120
    v_mfma_f32_16x16x32_bf16 v[40:43], v[192:195], v[172:175], v[40:43]
    s_add_u32 m0, s74, 4294924288
    s_add_u32 s22, s58, 90112
    buffer_load_dwordx4 v245, s[4:7], s22 offen lds
    v_mfma_f32_16x16x32_bf16 v[36:39], v[192:195], v[168:171], v[36:39]
    s_waitcnt lgkmcnt(12)
    v_mfma_f32_16x16x32_bf16 v[48:51], v[196:199], v[168:171], v[48:51]
    ds_read_b64_tr_b16 v[192:193], v254 offset:33024
    ds_read_b64_tr_b16 v[194:195], v254 offset:37120
    v_mfma_f32_16x16x32_bf16 v[52:55], v[196:199], v[172:175], v[52:55]
    v_mfma_f32_16x16x32_bf16 v[56:59], v[196:199], v[176:179], v[56:59]
    s_waitcnt lgkmcnt(12)
    v_mfma_f32_16x16x32_bf16 v[68:71], v[200:203], v[176:179], v[68:71]
    ds_read_b64_tr_b16 v[196:197], v253 offset:33280
    ds_read_b64_tr_b16 v[198:199], v253 offset:37376
    v_mfma_f32_16x16x32_bf16 v[64:67], v[200:203], v[172:175], v[64:67]
    v_mfma_f32_16x16x32_bf16 v[60:63], v[200:203], v[168:171], v[60:63]
    s_waitcnt lgkmcnt(12)
    v_mfma_f32_16x16x32_bf16 v[72:75], v[204:207], v[168:171], v[72:75]
    ds_read_b64_tr_b16 v[200:201], v254 offset:33280
    ds_read_b64_tr_b16 v[202:203], v254 offset:37376
    v_mfma_f32_16x16x32_bf16 v[76:79], v[204:207], v[172:175], v[76:79]
    v_mfma_f32_16x16x32_bf16 v[80:83], v[204:207], v[176:179], v[80:83]
    s_waitcnt lgkmcnt(12)
    v_mfma_f32_16x16x32_bf16 v[92:95], v[208:211], v[176:179], v[92:95]
    ds_read_b64_tr_b16 v[204:205], v253 offset:33536
    ds_read_b64_tr_b16 v[206:207], v253 offset:37632
    v_mfma_f32_16x16x32_bf16 v[88:91], v[208:211], v[172:175], v[88:91]
    v_mfma_f32_16x16x32_bf16 v[84:87], v[208:211], v[168:171], v[84:87]
    s_waitcnt lgkmcnt(12)
    v_mfma_f32_16x16x32_bf16 v[0:3], v[180:183], v[96:99], v[0:3]
    ds_read_b64_tr_b16 v[208:209], v254 offset:33536
    ds_read_b64_tr_b16 v[210:211], v254 offset:37632
    v_mfma_f32_16x16x32_bf16 v[4:7], v[180:183], v[100:103], v[4:7]
    s_add_u32 s20, s55, 3072
    buffer_load_dwordx4 v[120:123], v248, s[40:43], s20 offen offset:0 sc1
    v_mfma_f32_16x16x32_bf16 v[8:11], v[180:183], v[104:107], v[8:11]
    s_add_u32 s20, s55, 3072
    buffer_load_dwordx4 v[124:127], v248, s[40:43], s20 offen offset:1024 sc1
    s_barrier
    s_waitcnt lgkmcnt(12)
    v_mfma_f32_16x16x32_bf16 v[20:23], v[184:187], v[104:107], v[20:23]
    v_add_u32 v253, 4294868992, v253
    v_add_u32 v254, 4294868992, v254
    ds_read_b64_tr_b16 v[180:181], v253 offset:0
    ds_read_b64_tr_b16 v[182:183], v253 offset:4096
    v_mfma_f32_16x16x32_bf16 v[16:19], v[184:187], v[100:103], v[16:19]
    s_add_u32 s20, s55, 3072
    buffer_load_dwordx4 v[128:131], v248, s[40:43], s20 offen offset:2048 sc1
    v_mfma_f32_16x16x32_bf16 v[12:15], v[184:187], v[96:99], v[12:15]
    s_add_u32 m0, s74, 16384
    s_add_u32 s22, s57, 98304
    buffer_load_dwordx4 v245, s[4:7], s22 offen lds
    s_waitcnt lgkmcnt(12)
    v_mfma_f32_16x16x32_bf16 v[24:27], v[188:191], v[96:99], v[24:27]
    ds_read_b64_tr_b16 v[184:185], v254 offset:0
    ds_read_b64_tr_b16 v[186:187], v254 offset:4096
    v_mfma_f32_16x16x32_bf16 v[28:31], v[188:191], v[100:103], v[28:31]
    s_add_u32 m0, s74, 18432
    s_add_u32 s22, s57, 106496
    buffer_load_dwordx4 v245, s[4:7], s22 offen lds
    v_mfma_f32_16x16x32_bf16 v[32:35], v[188:191], v[104:107], v[32:35]
    s_add_u32 m0, s74, 20480
    s_add_u32 s22, s57, 114688
    buffer_load_dwordx4 v245, s[4:7], s22 offen lds
    s_waitcnt lgkmcnt(12)
    v_mfma_f32_16x16x32_bf16 v[44:47], v[192:195], v[104:107], v[44:47]
    ds_read_b64_tr_b16 v[188:189], v253 offset:256
    ds_read_b64_tr_b16 v[190:191], v253 offset:4352
    v_mfma_f32_16x16x32_bf16 v[40:43], v[192:195], v[100:103], v[40:43]
    s_add_u32 m0, s74, 22528
    s_add_u32 s22, s57, 122880
    buffer_load_dwordx4 v245, s[4:7], s22 offen lds
    v_mfma_f32_16x16x32_bf16 v[36:39], v[192:195], v[96:99], v[36:39]
    s_waitcnt lgkmcnt(12)
    v_mfma_f32_16x16x32_bf16 v[48:51], v[196:199], v[96:99], v[48:51]
    ds_read_b64_tr_b16 v[192:193], v254 offset:256
    ds_read_b64_tr_b16 v[194:195], v254 offset:4352
    v_mfma_f32_16x16x32_bf16 v[52:55], v[196:199], v[100:103], v[52:55]
    v_mfma_f32_16x16x32_bf16 v[56:59], v[196:199], v[104:107], v[56:59]
    s_waitcnt lgkmcnt(12)
    v_mfma_f32_16x16x32_bf16 v[68:71], v[200:203], v[104:107], v[68:71]
    ds_read_b64_tr_b16 v[196:197], v253 offset:512
    ds_read_b64_tr_b16 v[198:199], v253 offset:4608
    v_mfma_f32_16x16x32_bf16 v[64:67], v[200:203], v[100:103], v[64:67]
    v_mfma_f32_16x16x32_bf16 v[60:63], v[200:203], v[96:99], v[60:63]
    s_waitcnt lgkmcnt(12)
    v_mfma_f32_16x16x32_bf16 v[72:75], v[204:207], v[96:99], v[72:75]
    ds_read_b64_tr_b16 v[200:201], v254 offset:512
    ds_read_b64_tr_b16 v[202:203], v254 offset:4608
    v_mfma_f32_16x16x32_bf16 v[76:79], v[204:207], v[100:103], v[76:79]
    v_mfma_f32_16x16x32_bf16 v[80:83], v[204:207], v[104:107], v[80:83]
    s_waitcnt lgkmcnt(12)
    v_mfma_f32_16x16x32_bf16 v[92:95], v[208:211], v[104:107], v[92:95]
    ds_read_b64_tr_b16 v[204:205], v253 offset:768
    ds_read_b64_tr_b16 v[206:207], v253 offset:4864
    v_mfma_f32_16x16x32_bf16 v[88:91], v[208:211], v[100:103], v[88:91]
    v_mfma_f32_16x16x32_bf16 v[84:87], v[208:211], v[96:99], v[84:87]
    s_waitcnt vmcnt(4)
    v_mov_b32 v146, 3
    s_mov_b64 exec, 1
    s_cmp_eq_u32 s61, 0
    s_cbranch_scc1 L_fl2_Y_s
    buffer_store_dword v146, v250, s[40:43], s72 offen
    s_branch L_fl2_Y_e
L_fl2_Y_s:
    buffer_store_dword v146, v250, s[40:43], s72 offen sc1
L_fl2_Y_e:
    s_mov_b64 exec, -1
    s_waitcnt lgkmcnt(12)
    v_mfma_f32_16x16x32_bf16 v[0:3], v[180:183], v[108:111], v[0:3]
    ds_read_b64_tr_b16 v[208:209], v254 offset:768
    ds_read_b64_tr_b16 v[210:211], v254 offset:4864
    v_mfma_f32_16x16x32_bf16 v[4:7], v[180:183], v[112:115], v[4:7]
    s_add_u32 m0, s74, 4294934528
    s_add_u32 s22, s59, 65536
    buffer_load_dwordx4 v245, s[4:7], s22 offen lds
    v_mfma_f32_16x16x32_bf16 v[8:11], v[180:183], v[116:119], v[8:11]
    s_add_u32 m0, s74, 4294936576
    s_add_u32 s22, s59, 73728
    buffer_load_dwordx4 v245, s[4:7], s22 offen lds
    s_waitcnt lgkmcnt(12)
    v_mfma_f32_16x16x32_bf16 v[20:23], v[184:187], v[116:119], v[20:23]
    v_add_u32 v253, 49152, v253
    v_add_u32 v254, 49152, v254
    ds_read_b64_tr_b16 v[180:181], v253 offset:32768
    ds_read_b64_tr_b16 v[182:183], v253 offset:36864
    v_mfma_f32_16x16x32_bf16 v[16:19], v[184:187], v[112:115], v[16:19]
    s_add_u32 m0, s74, 4294938624
    s_add_u32 s22, s59, 81920
    buffer_load_dwordx4 v245, s[4:7], s22 offen lds
    v_mfma_f32_16x16x32_bf16 v[12:15], v[184:187], v[108:111], v[12:15]
    s_add_u32 m0, s74, 4294940672
    s_add_u32 s22, s59, 90112
    buffer_load_dwordx4 v245, s[4:7], s22 offen lds
    buffer_load_dword v148, v149, s[40:43], s60 offen sc1
    s_waitcnt lgkmcnt(12)
    v_mfma_f32_16x16x32_bf16 v[24:27], v[188:191], v[108:111], v[24:27]
    ds_read_b64_tr_b16 v[184:185], v254 offset:32768
    ds_read_b64_tr_b16 v[186:187], v254 offset:36864
    v_mfma_f32_16x16x32_bf16 v[28:31], v[188:191], v[112:115], v[28:31]
    v_mfma_f32_16x16x32_bf16 v[32:35], v[188:191], v[116:119], v[32:35]
    s_waitcnt lgkmcnt(12)
    v_mfma_f32_16x16x32_bf16 v[44:47], v[192:195], v[116:119], v[44:47]
    ds_read_b64_tr_b16 v[188:189], v253 offset:33024
    ds_read_b64_tr_b16 v[190:191], v253 offset:37120
    v_mfma_f32_16x16x32_bf16 v[40:43], v[192:195], v[112:115], v[40:43]
    v_mfma_f32_16x16x32_bf16 v[36:39], v[192:195], v[108:111], v[36:39]
    s_waitcnt lgkmcnt(12)
    v_mfma_f32_16x16x32_bf16 v[48:51], v[196:199], v[108:111], v[48:51]
    ds_read_b64_tr_b16 v[192:193], v254 offset:33024
    ds_read_b64_tr_b16 v[194:195], v254 offset:37120
    v_mfma_f32_16x16x32_bf16 v[52:55], v[196:199], v[112:115], v[52:55]
    v_mfma_f32_16x16x32_bf16 v[56:59], v[196:199], v[116:119], v[56:59]
    s_waitcnt lgkmcnt(12)
    v_mfma_f32_16x16x32_bf16 v[68:71], v[200:203], v[116:119], v[68:71]
    ds_read_b64_tr_b16 v[196:197], v253 offset:33280
    ds_read_b64_tr_b16 v[198:199], v253 offset:37376
    v_mfma_f32_16x16x32_bf16 v[64:67], v[200:203], v[112:115], v[64:67]
    v_mfma_f32_16x16x32_bf16 v[60:63], v[200:203], v[108:111], v[60:63]
    s_waitcnt lgkmcnt(12)
    v_mfma_f32_16x16x32_bf16 v[72:75], v[204:207], v[108:111], v[72:75]
    ds_read_b64_tr_b16 v[200:201], v254 offset:33280
    ds_read_b64_tr_b16 v[202:203], v254 offset:37376
    v_mfma_f32_16x16x32_bf16 v[76:79], v[204:207], v[112:115], v[76:79]
    v_mfma_f32_16x16x32_bf16 v[80:83], v[204:207], v[116:119], v[80:83]
    s_waitcnt lgkmcnt(12)
    v_mfma_f32_16x16x32_bf16 v[92:95], v[208:211], v[116:119], v[92:95]
    ds_read_b64_tr_b16 v[204:205], v253 offset:33536
    ds_read_b64_tr_b16 v[206:207], v253 offset:37632
    v_mfma_f32_16x16x32_bf16 v[88:91], v[208:211], v[112:115], v[88:91]
    v_mfma_f32_16x16x32_bf16 v[84:87], v[208:211], v[108:111], v[84:87]
    s_waitcnt vmcnt(0)
    v_cmp_gt_u32 vcc, 3, v148
    s_cbranch_vccz L_polled2_Y
L_poll2_Y:
    buffer_load_dword v148, v149, s[40:43], s60 offen sc1
    s_add_u32 s79, s79, 1
    s_cmp_ge_u32 s79, 0x40000
    s_waitcnt vmcnt(0)
    s_cbranch_scc1 L_polled2_Y
    v_cmp_gt_u32 vcc, 3, v148
    s_cbranch_vccnz L_poll2_Y
L_polled2_Y:
    s_add_u32 s20, s52, 3072
    s_add_u32 s20, s20, s78
    s_cmp_eq_u32 s61, 0
    s_cbranch_scc1 L_st3_Y_s
    buffer_store_dwordx4 v[132:135], v248, s[40:43], s20 offen offset:0
    buffer_store_dwordx4 v[136:139], v248, s[40:43], s20 offen offset:1024
    buffer_store_dwordx4 v[140:143], v248, s[40:43], s20 offen offset:2048
    s_branch L_st3_Y_e
L_st3_Y_s:
    buffer_store_dwordx4 v[132:135], v248, s[40:43], s20 offen offset:0 sc1
    buffer_store_dwordx4 v[136:139], v248, s[40:43], s20 offen offset:1024 sc1
    buffer_store_dwordx4 v[140:143], v248, s[40:43], s20 offen offset:2048 sc1
L_st3_Y_e:
    s_waitcnt lgkmcnt(12)
    v_mfma_f32_16x16x32_bf16 v[0:3], v[180:183], v[156:159], v[0:3]
    ds_read_b64_tr_b16 v[208:209], v254 offset:33536
    ds_read_b64_tr_b16 v[210:211], v254 offset:37632
    v_mfma_f32_16x16x32_bf16 v[4:7], v[180:183], v[160:163], v[4:7]
    s_add_u32 s20, s53, 0
    s_add_u32 s20, s20, s78
    buffer_load_dwordx4 v[168:171], v248, s[40:43], s20 offen offset:0 sc1
    v_mfma_f32_16x16x32_bf16 v[8:11], v[180:183], v[164:167], v[8:11]
    s_add_u32 s20, s53, 0
    s_add_u32 s20, s20, s78
    buffer_load_dwordx4 v[172:175], v248, s[40:43], s20 offen offset:1024 sc1
    s_waitcnt lgkmcnt(12)
    v_mfma_f32_16x16x32_bf16 v[20:23], v[184:187], v[164:167], v[20:23]
    v_add_u32 v253, 98304, v253
    v_add_u32 v254, 98304, v254
    ds_read_b64_tr_b16 v[180:181], v253 offset:0
    ds_read_b64_tr_b16 v[182:183], v253 offset:4096
    v_mfma_f32_16x16x32_bf16 v[16:19], v[184:187], v[160:163], v[16:19]
    s_add_u32 s20, s53, 0
    s_add_u32 s20, s20, s78
    buffer_load_dwordx4 v[176:179], v248, s[40:43], s20 offen offset:2048 sc1
    v_mfma_f32_16x16x32_bf16 v[12:15], v[184:187], v[156:159], v[12:15]
    s_add_u32 s20, s54, 0
    s_add_u32 s20, s20, s78
    buffer_load_dwordx4 v[96:99], v248, s[40:43], s20 offen offset:0 sc1
    s_waitcnt lgkmcnt(12)
    v_mfma_f32_16x16x32_bf16 v[24:27], v[188:191], v[156:159], v[24:27]
    ds_read_b64_tr_b16 v[184:185], v254 offset:0
    ds_read_b64_tr_b16 v[186:187], v254 offset:4096
    v_mfma_f32_16x16x32_bf16 v[28:31], v[188:191], v[160:163], v[28:31]
    s_add_u32 s20, s54, 0
    s_add_u32 s20, s20, s78
    buffer_load_dwordx4 v[100:103], v248, s[40:43], s20 offen offset:1024 sc1
    v_mfma_f32_16x16x32_bf16 v[32:35], v[188:191], v[164:167], v[32:35]
    s_add_u32 s20, s54, 0
    s_add_u32 s20, s20, s78
    buffer_load_dwordx4 v[104:107], v248, s[40:43], s20 offen offset:2048 sc1
    s_waitcnt lgkmcnt(12)
    v_mfma_f32_16x16x32_bf16 v[44:47], v[192:195], v[164:167], v[44:47]
    ds_read_b64_tr_b16 v[188:189], v253 offset:256
    ds_read_b64_tr_b16 v[190:191], v253 offset:4352
    v_mfma_f32_16x16x32_bf16 v[40:43], v[192:195], v[160:163], v[40:43]
    v_mfma_f32_16x16x32_bf16 v[36:39], v[192:195], v[156:159], v[36:39]
    s_waitcnt lgkmcnt(12)
    v_mfma_f32_16x16x32_bf16 v[48:51], v[196:199], v[156:159], v[48:51]
    ds_read_b64_tr_b16 v[192:193], v254 offset:256
    ds_read_b64_tr_b16 v[194:195], v254 offset:4352
    v_mfma_f32_16x16x32_bf16 v[52:55], v[196:199], v[160:163], v[52:55]
    v_mfma_f32_16x16x32_bf16 v[56:59], v[196:199], v[164:167], v[56:59]
    s_waitcnt lgkmcnt(12)
    v_mfma_f32_16x16x32_bf16 v[68:71], v[200:203], v[164:167], v[68:71]
    ds_read_b64_tr_b16 v[196:197], v253 offset:512
    ds_read_b64_tr_b16 v[198:199], v253 offset:4608
    v_mfma_f32_16x16x32_bf16 v[64:67], v[200:203], v[160:163], v[64:67]
    v_mfma_f32_16x16x32_bf16 v[60:63], v[200:203], v[156:159], v[60:63]
    s_waitcnt vmcnt(6)
    v_mov_b32 v146, 4
    s_mov_b64 exec, 1
    s_cmp_eq_u32 s61, 0
    s_cbranch_scc1 L_fl3_Y_s
    buffer_store_dword v146, v250, s[40:43], s72 offen
    s_branch L_fl3_Y_e
L_fl3_Y_s:
    buffer_store_dword v146, v250, s[40:43], s72 offen sc1
L_fl3_Y_e:
    s_mov_b64 exec, -1
    s_waitcnt lgkmcnt(12)
    v_mfma_f32_16x16x32_bf16 v[72:75], v[204:207], v[156:159], v[72:75]
    ds_read_b64_tr_b16 v[200:201], v254 offset:512
    ds_read_b64_tr_b16 v[202:203], v254 offset:4608
    v_mfma_f32_16x16x32_bf16 v[76:79], v[204:207], v[160:163], v[76:79]
    v_mfma_f32_16x16x32_bf16 v[80:83], v[204:207], v[164:167], v[80:83]
    s_waitcnt lgkmcnt(12)
    v_mfma_f32_16x16x32_bf16 v[92:95], v[208:211], v[164:167], v[92:95]
    ds_read_b64_tr_b16 v[204:205], v253 offset:768
    ds_read_b64_tr_b16 v[206:207], v253 offset:4864
    v_mfma_f32_16x16x32_bf16 v[88:91], v[208:211], v[160:163], v[88:91]
    v_mfma_f32_16x16x32_bf16 v[84:87], v[208:211], v[156:159], v[84:87]
    s_waitcnt lgkmcnt(12)
    v_mfma_f32_16x16x32_bf16 v[0:3], v[180:183], v[120:123], v[0:3]
    ds_read_b64_tr_b16 v[208:209], v254 offset:768
    ds_read_b64_tr_b16 v[210:211], v254 offset:4864
    v_mfma_f32_16x16x32_bf16 v[4:7], v[180:183], v[124:127], v[4:7]
    s_add_u32 s20, s55, 0
    s_add_u32 s20, s20, s78
    buffer_load_dwordx4 v[108:111], v248, s[40:43], s20 offen offset:0 sc1
    v_mfma_f32_16x16x32_bf16 v[8:11], v[180:183], v[128:131], v[8:11]
    s_add_u32 s20, s55, 0
    s_add_u32 s20, s20, s78
    buffer_load_dwordx4 v[112:115], v248, s[40:43], s20 offen offset:1024 sc1
    s_barrier
    s_waitcnt lgkmcnt(12)
    v_mfma_f32_16x16x32_bf16 v[20:23], v[184:187], v[128:131], v[20:23]
    v_add_u32 v253, 4294819840, v253
    v_add_u32 v254, 4294819840, v254
    ds_read_b64_tr_b16 v[180:181], v253 offset:16384
    ds_read_b64_tr_b16 v[182:183], v253 offset:20480
    v_mfma_f32_16x16x32_bf16 v[16:19], v[184:187], v[124:127], v[16:19]
    s_add_u32 s20, s55, 0
    s_add_u32 s20, s20, s78
    buffer_load_dwordx4 v[116:119], v248, s[40:43], s20 offen offset:2048 sc1
    v_mfma_f32_16x16x32_bf16 v[12:15], v[184:187], v[120:123], v[12:15]
    s_add_u32 m0, s74, 4294950912
    s_add_u32 s22, s58, 98304
    buffer_load_dwordx4 v245, s[4:7], s22 offen lds
    s_waitcnt lgkmcnt(12)
    v_mfma_f32_16x16x32_bf16 v[24:27], v[188:191], v[120:123], v[24:27]
    ds_read_b64_tr_b16 v[184:185], v254 offset:16384
    ds_read_b64_tr_b16 v[186:187], v254 offset:20480
    v_mfma_f32_16x16x32_bf16 v[28:31], v[188:191], v[124:127], v[28:31]
    s_add_u32 m0, s74, 4294952960
    s_add_u32 s22, s58, 106496
    buffer_load_dwordx4 v245, s[4:7], s22 offen lds
    v_mfma_f32_16x16x32_bf16 v[32:35], v[188:191], v[128:131], v[32:35]
    s_add_u32 m0, s74, 4294955008
    s_add_u32 s22, s58, 114688
    buffer_load_dwordx4 v245, s[4:7], s22 offen lds
    s_waitcnt lgkmcnt(12)
    v_mfma_f32_16x16x32_bf16 v[44:47], v[192:195], v[128:131], v[44:47]
    ds_read_b64_tr_b16 v[188:189], v253 offset:16640
    ds_read_b64_tr_b16 v[190:191], v253 offset:20736
    v_mfma_f32_16x16x32_bf16 v[40:43], v[192:195], v[124:127], v[40:43]
    s_add_u32 m0, s74, 4294957056
    s_add_u32 s22, s58, 122880
    buffer_load_dwordx4 v245, s[4:7], s22 offen lds
    v_mfma_f32_16x16x32_bf16 v[36:39], v[192:195], v[120:123], v[36:39]
    s_waitcnt lgkmcnt(12)
    v_mfma_f32_16x16x32_bf16 v[48:51], v[196:199], v[120:123], v[48:51]
    ds_read_b64_tr_b16 v[192:193], v254 offset:16640
    ds_read_b64_tr_b16 v[194:195], v254 offset:20736
    v_mfma_f32_16x16x32_bf16 v[52:55], v[196:199], v[124:127], v[52:55]
    v_mfma_f32_16x16x32_bf16 v[56:59], v[196:199], v[128:131], v[56:59]
    s_waitcnt lgkmcnt(12)
    v_mfma_f32_16x16x32_bf16 v[68:71], v[200:203], v[128:131], v[68:71]
    ds_read_b64_tr_b16 v[196:197], v253 offset:16896
    ds_read_b64_tr_b16 v[198:199], v253 offset:20992
    v_mfma_f32_16x16x32_bf16 v[64:67], v[200:203], v[124:127], v[64:67]
    v_mfma_f32_16x16x32_bf16 v[60:63], v[200:203], v[120:123], v[60:63]
    s_waitcnt lgkmcnt(12)
    v_mfma_f32_16x16x32_bf16 v[72:75], v[204:207], v[120:123], v[72:75]
    ds_read_b64_tr_b16 v[200:201], v254 offset:16896
    ds_read_b64_tr_b16 v[202:203], v254 offset:20992
    v_mfma_f32_16x16x32_bf16 v[76:79], v[204:207], v[124:127], v[76:79]
    v_mfma_f32_16x16x32_bf16 v[80:83], v[204:207], v[128:131], v[80:83]
    s_waitcnt lgkmcnt(12)
    v_mfma_f32_16x16x32_bf16 v[92:95], v[208:211], v[128:131], v[92:95]
    ds_read_b64_tr_b16 v[204:205], v253 offset:17152
    ds_read_b64_tr_b16 v[206:207], v253 offset:21248
    v_mfma_f32_16x16x32_bf16 v[88:91], v[208:211], v[124:127], v[88:91]
    v_mfma_f32_16x16x32_bf16 v[84:87], v[208:211], v[120:123], v[84:87]
    s_waitcnt vmcnt(11)
    s_waitcnt lgkmcnt(12)
    v_mfma_f32_16x16x32_bf16 v[0:3], v[180:183], v[168:171], v[0:3]
    ds_read_b64_tr_b16 v[208:209], v254 offset:17152
    ds_read_b64_tr_b16 v[210:211], v254 offset:21248
    v_mfma_f32_16x16x32_bf16 v[4:7], v[180:183], v[172:175], v[4:7]
    s_add_u32 m0, s74, 0
    s_add_u32 s22, s59, 98304
    buffer_load_dwordx4 v245, s[4:7], s22 offen lds
    v_mfma_f32_16x16x32_bf16 v[8:11], v[180:183], v[176:179], v[8:11]
    s_add_u32 m0, s74, 2048
    s_add_u32 s22, s59, 106496
    buffer_load_dwordx4 v245, s[4:7], s22 offen lds
    s_waitcnt lgkmcnt(12)
    v_mfma_f32_16x16x32_bf16 v[20:23], v[184:187], v[176:179], v[20:23]
    ds_read_b64_tr_b16 v[180:181], v253 offset:32768
    ds_read_b64_tr_b16 v[182:183], v253 offset:36864
    v_mfma_f32_16x16x32_bf16 v[16:19], v[184:187], v[172:175], v[16:19]
    s_add_u32 m0, s74, 4096
    s_add_u32 s22, s59, 114688
    buffer_load_dwordx4 v245, s[4:7], s22 offen lds
    v_mfma_f32_16x16x32_bf16 v[12:15], v[184:187], v[168:171], v[12:15]
    s_add_u32 m0, s74, 6144
    s_add_u32 s22, s59, 122880
    buffer_load_dwordx4 v245, s[4:7], s22 offen lds
    buffer_load_dword v148, v149, s[40:43], s60 offen sc1
    s_waitcnt lgkmcnt(12)
    v_mfma_f32_16x16x32_bf16 v[24:27], v[188:191], v[168:171], v[24:27]
    ds_read_b64_tr_b16 v[184:185], v254 offset:32768
    ds_read_b64_tr_b16 v[186:187], v254 offset:36864
    v_mfma_f32_16x16x32_bf16 v[28:31], v[188:191], v[172:175], v[28:31]
    v_mfma_f32_16x16x32_bf16 v[32:35], v[188:191], v[176:179], v[32:35]
    s_waitcnt lgkmcnt(12)
    v_mfma_f32_16x16x32_bf16 v[44:47], v[192:195], v[176:179], v[44:47]
    ds_read_b64_tr_b16 v[188:189], v253 offset:33024
    ds_read_b64_tr_b16 v[190:191], v253 offset:37120
    v_mfma_f32_16x16x32_bf16 v[40:43], v[192:195], v[172:175], v[40:43]
    v_mfma_f32_16x16x32_bf16 v[36:39], v[192:195], v[168:171], v[36:39]
    s_waitcnt lgkmcnt(12)
    v_mfma_f32_16x16x32_bf16 v[48:51], v[196:199], v[168:171], v[48:51]
    ds_read_b64_tr_b16 v[192:193], v254 offset:33024
    ds_read_b64_tr_b16 v[194:195], v254 offset:37120
    v_mfma_f32_16x16x32_bf16 v[52:55], v[196:199], v[172:175], v[52:55]
    v_mfma_f32_16x16x32_bf16 v[56:59], v[196:199], v[176:179], v[56:59]
    s_waitcnt lgkmcnt(12)
    v_mfma_f32_16x16x32_bf16 v[68:71], v[200:203], v[176:179], v[68:71]
    ds_read_b64_tr_b16 v[196:197], v253 offset:33280
    ds_read_b64_tr_b16 v[198:199], v253 offset:37376
    v_mfma_f32_16x16x32_bf16 v[64:67], v[200:203], v[172:175], v[64:67]
    v_mfma_f32_16x16x32_bf16 v[60:63], v[200:203], v[168:171], v[60:63]
    s_waitcnt lgkmcnt(12)
    v_mfma_f32_16x16x32_bf16 v[72:75], v[204:207], v[168:171], v[72:75]
    ds_read_b64_tr_b16 v[200:201], v254 offset:33280
    ds_read_b64_tr_b16 v[202:203], v254 offset:37376
    v_mfma_f32_16x16x32_bf16 v[76:79], v[204:207], v[172:175], v[76:79]
    v_mfma_f32_16x16x32_bf16 v[80:83], v[204:207], v[176:179], v[80:83]
    s_waitcnt lgkmcnt(12)
    v_mfma_f32_16x16x32_bf16 v[92:95], v[208:211], v[176:179], v[92:95]
    ds_read_b64_tr_b16 v[204:205], v253 offset:33536
    ds_read_b64_tr_b16 v[206:207], v253 offset:37632
    v_mfma_f32_16x16x32_bf16 v[88:91], v[208:211], v[172:175], v[88:91]
    v_mfma_f32_16x16x32_bf16 v[84:87], v[208:211], v[168:171], v[84:87]
    s_waitcnt vmcnt(0)
    v_cmp_gt_u32 vcc, 4, v148
    s_cbranch_vccz L_polled3_Y
L_poll3_Y:
    buffer_load_dword v148, v149, s[40:43], s60 offen sc1
    s_add_u32 s79, s79, 1
    s_cmp_ge_u32 s79, 0x40000
    s_waitcnt vmcnt(0)
    s_cbranch_scc1 L_polled3_Y
    v_cmp_gt_u32 vcc, 4, v148
    s_cbranch_vccnz L_poll3_Y
L_polled3_Y:
    s_waitcnt lgkmcnt(12)
    v_mfma_f32_16x16x32_bf16 v[0:3], v[180:183], v[96:99], v[0:3]
    ds_read_b64_tr_b16 v[208:209], v254 offset:33536
    ds_read_b64_tr_b16 v[210:211], v254 offset:37632
    v_mfma_f32_16x16x32_bf16 v[4:7], v[180:183], v[100:103], v[4:7]
    s_add_u32 s20, s53, 3072
    s_add_u32 s20, s20, s78
    buffer_load_dwordx4 v[132:135], v248, s[40:43], s20 offen offset:0 sc1
    v_mfma_f32_16x16x32_bf16 v[8:11], v[180:183], v[104:107], v[8:11]
    s_add_u32 s20, s53, 3072
    s_add_u32 s20, s20, s78
    buffer_load_dwordx4 v[136:139], v248, s[40:43], s20 offen offset:1024 sc1
    s_waitcnt lgkmcnt(12)
    v_mfma_f32_16x16x32_bf16 v[20:23], v[184:187], v[104:107], v[20:23]
    v_add_u32 v253, 49152, v253
    v_add_u32 v254, 49152, v254
    ds_read_b64_tr_b16 v[180:181], v253 offset:0
    ds_read_b64_tr_b16 v[182:183], v253 offset:4096
    v_mfma_f32_16x16x32_bf16 v[16:19], v[184:187], v[100:103], v[16:19]
    s_add_u32 s20, s53, 3072
    s_add_u32 s20, s20, s78
    buffer_load_dwordx4 v[140:143], v248, s[40:43], s20 offen offset:2048 sc1
    v_mfma_f32_16x16x32_bf16 v[12:15], v[184:187], v[96:99], v[12:15]
    s_add_u32 s20, s54, 3072
    s_add_u32 s20, s20, s78
    buffer_load_dwordx4 v[156:159], v248, s[40:43], s20 offen offset:0 sc1
    s_waitcnt lgkmcnt(12)
    v_mfma_f32_16x16x32_bf16 v[24:27], v[188:191], v[96:99], v[24:27]
    ds_read_b64_tr_b16 v[184:185], v254 offset:0
    ds_read_b64_tr_b16 v[186:187], v254 offset:4096
    v_mfma_f32_16x16x32_bf16 v[28:31], v[188:191], v[100:103], v[28:31]
    s_add_u32 s20, s54, 3072
    s_add_u32 s20, s20, s78
    buffer_load_dwordx4 v[160:163], v248, s[40:43], s20 offen offset:1024 sc1
    v_mfma_f32_16x16x32_bf16 v[32:35], v[188:191], v[104:107], v[32:35]
    s_add_u32 s20, s54, 3072
    s_add_u32 s20, s20, s78
    buffer_load_dwordx4 v[164:167], v248, s[40:43], s20 offen offset:2048 sc1
    s_waitcnt lgkmcnt(12)
    v_mfma_f32_16x16x32_bf16 v[44:47], v[192:195], v[104:107], v[44:47]
    ds_read_b64_tr_b16 v[188:189], v253 offset:256
    ds_read_b64_tr_b16 v[190:191], v253 offset:4352
    v_mfma_f32_16x16x32_bf16 v[40:43], v[192:195], v[100:103], v[40:43]
    v_mfma_f32_16x16x32_bf16 v[36:39], v[192:195], v[96:99], v[36:39]
    s_waitcnt lgkmcnt(12)
    v_mfma_f32_16x16x32_bf16 v[48:51], v[196:199], v[96:99], v[48:51]
    ds_read_b64_tr_b16 v[192:193], v254 offset:256
    ds_read_b64_tr_b16 v[194:195], v254 offset:4352
    v_mfma_f32_16x16x32_bf16 v[52:55], v[196:199], v[100:103], v[52:55]
    v_mfma_f32_16x16x32_bf16 v[56:59], v[196:199], v[104:107], v[56:59]
    s_waitcnt lgkmcnt(12)
    v_mfma_f32_16x16x32_bf16 v[68:71], v[200:203], v[104:107], v[68:71]
    ds_read_b64_tr_b16 v[196:197], v253 offset:512
    ds_read_b64_tr_b16 v[198:199], v253 offset:4608
    v_mfma_f32_16x16x32_bf16 v[64:67], v[200:203], v[100:103], v[64:67]
    v_mfma_f32_16x16x32_bf16 v[60:63], v[200:203], v[96:99], v[60:63]
    s_waitcnt lgkmcnt(12)
    v_mfma_f32_16x16x32_bf16 v[72:75], v[204:207], v[96:99], v[72:75]
    ds_read_b64_tr_b16 v[200:201], v254 offset:512
    ds_read_b64_tr_b16 v[202:203], v254 offset:4608
    v_mfma_f32_16x16x32_bf16 v[76:79], v[204:207], v[100:103], v[76:79]
    v_mfma_f32_16x16x32_bf16 v[80:83], v[204:207], v[104:107], v[80:83]
    s_waitcnt lgkmcnt(12)
    v_mfma_f32_16x16x32_bf16 v[92:95], v[208:211], v[104:107], v[92:95]
    ds_read_b64_tr_b16 v[204:205], v253 offset:768
    ds_read_b64_tr_b16 v[206:207], v253 offset:4864
    v_mfma_f32_16x16x32_bf16 v[88:91], v[208:211], v[100:103], v[88:91]
    v_mfma_f32_16x16x32_bf16 v[84:87], v[208:211], v[96:99], v[84:87]
    s_waitcnt lgkmcnt(12)
    v_mfma_f32_16x16x32_bf16 v[0:3], v[180:183], v[108:111], v[0:3]
    ds_read_b64_tr_b16 v[208:209], v254 offset:768
    ds_read_b64_tr_b16 v[210:211], v254 offset:4864
    v_mfma_f32_16x16x32_bf16 v[4:7], v[180:183], v[112:115], v[4:7]
    s_add_u32 s20, s55, 3072
    s_add_u32 s20, s20, s78
    buffer_load_dwordx4 v[120:123], v248, s[40:43], s20 offen offset:0 sc1
    v_mfma_f32_16x16x32_bf16 v[8:11], v[180:183], v[116:119], v[8:11]
    s_add_u32 s20, s55, 3072
    s_add_u32 s20, s20, s78
    buffer_load_dwordx4 v[124:127], v248, s[40:43], s20 offen offset:1024 sc1
    s_waitcnt lgkmcnt(12)
    v_mfma_f32_16x16x32_bf16 v[20:23], v[184:187], v[116:119], v[20:23]
    v_add_u32 v253, 49152, v253
    v_add_u32 v254, 49152, v254
    ds_read_b64_tr_b16 v[180:181], v253 offset:0
    ds_read_b64_tr_b16 v[182:183], v253 offset:4096
    v_mfma_f32_16x16x32_bf16 v[16:19], v[184:187], v[112:115], v[16:19]
    s_add_u32 s20, s55, 3072
    s_add_u32 s20, s20, s78
    buffer_load_dwordx4 v[128:131], v248, s[40:43], s20 offen offset:2048 sc1
    v_mfma_f32_16x16x32_bf16 v[12:15], v[184:187], v[108:111], v[12:15]
    s_waitcnt lgkmcnt(12)
    v_mfma_f32_16x16x32_bf16 v[24:27], v[188:191], v[108:111], v[24:27]
    ds_read_b64_tr_b16 v[184:185], v254 offset:0
    ds_read_b64_tr_b16 v[186:187], v254 offset:4096
    v_mfma_f32_16x16x32_bf16 v[28:31], v[188:191], v[112:115], v[28:31]
    v_mfma_f32_16x16x32_bf16 v[32:35], v[188:191], v[116:119], v[32:35]
    s_waitcnt lgkmcnt(12)
    v_mfma_f32_16x16x32_bf16 v[44:47], v[192:195], v[116:119], v[44:47]
    ds_read_b64_tr_b16 v[188:189], v253 offset:256
    ds_read_b64_tr_b16 v[190:191], v253 offset:4352
    v_mfma_f32_16x16x32_bf16 v[40:43], v[192:195], v[112:115], v[40:43]
    v_mfma_f32_16x16x32_bf16 v[36:39], v[192:195], v[108:111], v[36:39]
    s_waitcnt lgkmcnt(12)
    v_mfma_f32_16x16x32_bf16 v[48:51], v[196:199], v[108:111], v[48:51]
    ds_read_b64_tr_b16 v[192:193], v254 offset:256
    ds_read_b64_tr_b16 v[194:195], v254 offset:4352
    v_mfma_f32_16x16x32_bf16 v[52:55], v[196:199], v[112:115], v[52:55]
    v_mfma_f32_16x16x32_bf16 v[56:59], v[196:199], v[116:119], v[56:59]
    s_waitcnt lgkmcnt(12)
    v_mfma_f32_16x16x32_bf16 v[68:71], v[200:203], v[116:119], v[68:71]
    ds_read_b64_tr_b16 v[196:197], v253 offset:512
    ds_read_b64_tr_b16 v[198:199], v253 offset:4608
    v_mfma_f32_16x16x32_bf16 v[64:67], v[200:203], v[112:115], v[64:67]
    v_mfma_f32_16x16x32_bf16 v[60:63], v[200:203], v[108:111], v[60:63]
    s_waitcnt lgkmcnt(12)
    v_mfma_f32_16x16x32_bf16 v[72:75], v[204:207], v[108:111], v[72:75]
    ds_read_b64_tr_b16 v[200:201], v254 offset:512
    ds_read_b64_tr_b16 v[202:203], v254 offset:4608
    v_mfma_f32_16x16x32_bf16 v[76:79], v[204:207], v[112:115], v[76:79]
    v_mfma_f32_16x16x32_bf16 v[80:83], v[204:207], v[116:119], v[80:83]
    s_waitcnt lgkmcnt(12)
    v_mfma_f32_16x16x32_bf16 v[92:95], v[208:211], v[116:119], v[92:95]
    ds_read_b64_tr_b16 v[204:205], v253 offset:768
    ds_read_b64_tr_b16 v[206:207], v253 offset:4864
    v_mfma_f32_16x16x32_bf16 v[88:91], v[208:211], v[112:115], v[88:91]
    v_mfma_f32_16x16x32_bf16 v[84:87], v[208:211], v[108:111], v[84:87]
    s_waitcnt vmcnt(6)
    s_waitcnt lgkmcnt(12)
    v_mfma_f32_16x16x32_bf16 v[0:3], v[180:183], v[132:135], v[0:3]
    ds_read_b64_tr_b16 v[208:209], v254 offset:768
    ds_read_b64_tr_b16 v[210:211], v254 offset:4864
    v_mfma_f32_16x16x32_bf16 v[4:7], v[180:183], v[136:139], v[4:7]
    v_mfma_f32_16x16x32_bf16 v[8:11], v[180:183], v[140:143], v[8:11]
    s_barrier
    s_waitcnt lgkmcnt(12)
    v_mfma_f32_16x16x32_bf16 v[20:23], v[184:187], v[140:143], v[20:23]
    v_add_u32 v253, 4294918144, v253
    v_add_u32 v254, 4294918144, v254
    ds_read_b64_tr_b16 v[180:181], v253 offset:16896
    ds_read_b64_tr_b16 v[182:183], v253 offset:20992
    v_mfma_f32_16x16x32_bf16 v[16:19], v[184:187], v[136:139], v[16:19]
    v_mfma_f32_16x16x32_bf16 v[12:15], v[184:187], v[132:135], v[12:15]
    s_waitcnt lgkmcnt(12)
    v_mfma_f32_16x16x32_bf16 v[24:27], v[188:191], v[132:135], v[24:27]
    ds_read_b64_tr_b16 v[184:185], v253 offset:33280
    ds_read_b64_tr_b16 v[186:187], v253 offset:37376
    v_mfma_f32_16x16x32_bf16 v[28:31], v[188:191], v[136:139], v[28:31]
    v_mfma_f32_16x16x32_bf16 v[32:35], v[188:191], v[140:143], v[32:35]
    s_waitcnt lgkmcnt(12)
    v_mfma_f32_16x16x32_bf16 v[44:47], v[192:195], v[140:143], v[44:47]
    ds_read_b64_tr_b16 v[188:189], v254 offset:16896
    ds_read_b64_tr_b16 v[190:191], v254 offset:20992
    v_mfma_f32_16x16x32_bf16 v[40:43], v[192:195], v[136:139], v[40:43]
    v_mfma_f32_16x16x32_bf16 v[36:39], v[192:195], v[132:135], v[36:39]
    s_waitcnt lgkmcnt(12)
    v_mfma_f32_16x16x32_bf16 v[48:51], v[196:199], v[132:135], v[48:51]
    ds_read_b64_tr_b16 v[192:193], v254 offset:33280
    ds_read_b64_tr_b16 v[194:195], v254 offset:37376
    v_mfma_f32_16x16x32_bf16 v[52:55], v[196:199], v[136:139], v[52:55]
    v_mfma_f32_16x16x32_bf16 v[56:59], v[196:199], v[140:143], v[56:59]
    s_waitcnt lgkmcnt(12)
    v_mfma_f32_16x16x32_bf16 v[68:71], v[200:203], v[140:143], v[68:71]
    ds_read_b64_tr_b16 v[196:197], v253 offset:17152
    ds_read_b64_tr_b16 v[198:199], v253 offset:21248
    v_mfma_f32_16x16x32_bf16 v[64:67], v[200:203], v[136:139], v[64:67]
    v_mfma_f32_16x16x32_bf16 v[60:63], v[200:203], v[132:135], v[60:63]
    s_waitcnt lgkmcnt(12)
    v_mfma_f32_16x16x32_bf16 v[72:75], v[204:207], v[132:135], v[72:75]
    ds_read_b64_tr_b16 v[200:201], v253 offset:33536
    ds_read_b64_tr_b16 v[202:203], v253 offset:37632
    v_mfma_f32_16x16x32_bf16 v[76:79], v[204:207], v[136:139], v[76:79]
    v_mfma_f32_16x16x32_bf16 v[80:83], v[204:207], v[140:143], v[80:83]
    s_waitcnt lgkmcnt(12)
    v_mfma_f32_16x16x32_bf16 v[92:95], v[208:211], v[140:143], v[92:95]
    ds_read_b64_tr_b16 v[204:205], v254 offset:17152
    ds_read_b64_tr_b16 v[206:207], v254 offset:21248
    v_mfma_f32_16x16x32_bf16 v[88:91], v[208:211], v[136:139], v[88:91]
    v_mfma_f32_16x16x32_bf16 v[84:87], v[208:211], v[132:135], v[84:87]
    s_waitcnt vmcnt(3)
    s_waitcnt vmcnt(0)
    v_add_u32 v144, s75, v248
    v_add_u32 v145, s76, v248
    s_mov_b32 s12, s66
    s_mov_b32 s13, s67
    s_and_b32 s20, s2, 3
    s_add_u32 s21, s20, s3
    s_and_b32 s21, s21, 3
    s_mul_i32 s22, s20, 229376
    s_sub_u32 s56, s52, s22
    s_lshl_b32 s22, s21, 11
    s_add_u32 s56, s56, s22
    s_cmp_eq_u32 s61, 0
    s_cselect_b32 s57, 41943040, 0
    s_add_u32 s56, s56, s57
    s_add_u32 s57, s57, s52
    s_bfe_u32 s22, s2, 0x10002
    s_lshr_b32 s23, s2, 3
    s_lshl_b32 s59, s22, 10
    s_and_b32 s22, s23, 3
    s_lshl_b32 s22, s22, 8
    s_add_u32 s59, s59, s22
    s_lshl_b32 s22, s34, 7
    s_add_u32 s59, s59, s22
    s_lshr_b32 s23, s23, 2
    s_mul_i32 s23, s23, 224
    s_add_u32 s23, s23, s35
    s_lshl_b32 s22, s21, 4
    s_add_u32 s23, s23, s22
    s_lshl_b32 s23, s23, 11
    s_add_u32 s59, s59, s23
    s_mov_b32 s63, s21
    s_mov_b32 s14, 3670016
    s_waitcnt lgkmcnt(12)
    v_mfma_f32_16x16x32_bf16 v[48:51], v[180:183], v[156:159], v[48:51]
    ds_read_b64_tr_b16 v[208:209], v254 offset:33536
    ds_read_b64_tr_b16 v[210:211], v254 offset:37632
    v_mfma_f32_16x16x32_bf16 v[52:55], v[180:183], v[160:163], v[52:55]
    v_mfma_f32_16x16x32_bf16 v[56:59], v[180:183], v[164:167], v[56:59]
    s_waitcnt lgkmcnt(12)
    v_mfma_f32_16x16x32_bf16 v[56:59], v[184:187], v[128:131], v[56:59]
    ds_read_b64_tr_b16 v[180:181], v253 offset:16384
    ds_read_b64_tr_b16 v[182:183], v253 offset:20480
    v_mfma_f32_16x16x32_bf16 v[52:55], v[184:187], v[124:127], v[52:55]
    v_mfma_f32_16x16x32_bf16 v[48:51], v[184:187], v[120:123], v[48:51]
    s_waitcnt lgkmcnt(12)
    v_mfma_f32_16x16x32_bf16 v[60:63], v[188:191], v[156:159], v[60:63]
    ds_read_b64_tr_b16 v[184:185], v253 offset:32768
    ds_read_b64_tr_b16 v[186:187], v253 offset:36864
    v_mfma_f32_16x16x32_bf16 v[64:67], v[188:191], v[160:163], v[64:67]
    v_mfma_f32_16x16x32_bf16 v[68:71], v[188:191], v[164:167], v[68:71]
    s_waitcnt lgkmcnt(12)
    v_mfma_f32_16x16x32_bf16 v[68:71], v[192:195], v[128:131], v[68:71]
    ds_read_b64_tr_b16 v[188:189], v254 offset:16384
    ds_read_b64_tr_b16 v[190:191], v254 offset:20480
    v_mfma_f32_16x16x32_bf16 v[64:67], v[192:195], v[124:127], v[64:67]
    ds_write_b128 v144, v[48:51] offset:0
    v_mfma_f32_16x16x32_bf16 v[60:63], v[192:195], v[120:123], v[60:63]
    v_mov_b32 v146, 5
    s_mov_b64 exec, 1
    s_cmp_eq_u32 s61, 0
    s_cbranch_scc1 L_fl4_Y_s
    buffer_store_dword v146, v250, s[40:43], s72 offen
    s_branch L_fl4_Y_e
L_fl4_Y_s:
    buffer_store_dword v146, v250, s[40:43], s72 offen sc1
L_fl4_Y_e:
    s_mov_b64 exec, -1
    s_waitcnt lgkmcnt(13)
    v_mfma_f32_16x16x32_bf16 v[72:75], v[196:199], v[156:159], v[72:75]
    ds_read_b64_tr_b16 v[192:193], v254 offset:32768
    ds_read_b64_tr_b16 v[194:195], v254 offset:36864
    v_mfma_f32_16x16x32_bf16 v[76:79], v[196:199], v[160:163], v[76:79]
    ds_write_b128 v144, v[52:55] offset:1024
    v_mfma_f32_16x16x32_bf16 v[80:83], v[196:199], v[164:167], v[80:83]
    s_waitcnt lgkmcnt(14)
    v_mfma_f32_16x16x32_bf16 v[80:83], v[200:203], v[128:131], v[80:83]
    ds_read_b64_tr_b16 v[196:197], v253 offset:16640
    ds_read_b64_tr_b16 v[198:199], v253 offset:20736
    v_mfma_f32_16x16x32_bf16 v[76:79], v[200:203], v[124:127], v[76:79]
    ds_write_b128 v144, v[56:59] offset:2048
    v_mfma_f32_16x16x32_bf16 v[72:75], v[200:203], v[120:123], v[72:75]
    s_waitcnt lgkmcnt(15)
    v_mfma_f32_16x16x32_bf16 v[84:87], v[204:207], v[156:159], v[84:87]
    ds_read_b64_tr_b16 v[200:201], v253 offset:33024
    ds_read_b64_tr_b16 v[202:203], v253 offset:37120
    v_mfma_f32_16x16x32_bf16 v[88:91], v[204:207], v[160:163], v[88:91]
    ds_write_b128 v144, v[60:63] offset:3072
    v_mfma_f32_16x16x32_bf16 v[92:95], v[204:207], v[164:167], v[92:95]
    s_waitcnt lgkmcnt(15)
    v_mfma_f32_16x16x32_bf16 v[92:95], v[208:211], v[128:131], v[92:95]
    ds_read_b64_tr_b16 v[204:205], v254 offset:16640
    ds_read_b64_tr_b16 v[206:207], v254 offset:20736
    v_mfma_f32_16x16x32_bf16 v[88:91], v[208:211], v[124:127], v[88:91]
    ds_write_b128 v144, v[64:67] offset:4096
    v_mfma_f32_16x16x32_bf16 v[84:87], v[208:211], v[120:123], v[84:87]
    s_waitcnt lgkmcnt(15)
    v_mfma_f32_16x16x32_bf16 v[0:3], v[180:183], v[156:159], v[0:3]
    ds_read_b64_tr_b16 v[208:209], v254 offset:33024
    ds_read_b64_tr_b16 v[210:211], v254 offset:37120
    v_mfma_f32_16x16x32_bf16 v[4:7], v[180:183], v[160:163], v[4:7]
    ds_write_b128 v144, v[68:71] offset:5120
    v_mfma_f32_16x16x32_bf16 v[8:11], v[180:183], v[164:167], v[8:11]
    v_mfma_f32_16x16x32_bf16 v[8:11], v[184:187], v[128:131], v[8:11]
    v_mfma_f32_16x16x32_bf16 v[4:7], v[184:187], v[124:127], v[4:7]
    ds_write_b128 v144, v[72:75] offset:6144
    v_mfma_f32_16x16x32_bf16 v[0:3], v[184:187], v[120:123], v[0:3]
    buffer_load_dword v148, v149, s[40:43], s60 offen sc1
    s_waitcnt lgkmcnt(15)
    v_mfma_f32_16x16x32_bf16 v[12:15], v[188:191], v[156:159], v[12:15]
    v_mfma_f32_16x16x32_bf16 v[16:19], v[188:191], v[160:163], v[16:19]
    ds_write_b128 v144, v[76:79] offset:7168
    v_mfma_f32_16x16x32_bf16 v[20:23], v[188:191], v[164:167], v[20:23]
    s_waitcnt lgkmcnt(15)
    v_mfma_f32_16x16x32_bf16 v[20:23], v[192:195], v[128:131], v[20:23]
    v_mfma_f32_16x16x32_bf16 v[16:19], v[192:195], v[124:127], v[16:19]
    ds_write_b128 v144, v[80:83] offset:8192
    v_mfma_f32_16x16x32_bf16 v[12:15], v[192:195], v[120:123], v[12:15]
    ds_write_b128 v144, v[84:87] offset:9216
    ds_write_b128 v144, v[88:91] offset:10240
    ds_write_b128 v144, v[92:95] offset:11264
    s_waitcnt lgkmcnt(0)
    s_barrier
    v_mfma_f32_16x16x32_bf16 v[24:27], v[196:199], v[156:159], v[24:27]
    v_mfma_f32_16x16x32_bf16 v[28:31], v[196:199], v[160:163], v[28:31]
    ds_read_b128 v[48:51], v145 offset:0
    ds_read_b128 v[60:63], v145 offset:3072
    v_mfma_f32_16x16x32_bf16 v[32:35], v[196:199], v[164:167], v[32:35]
    ds_read_b128 v[52:55], v145 offset:1024
    ds_read_b128 v[64:67], v145 offset:4096
    v_mfma_f32_16x16x32_bf16 v[32:35], v[200:203], v[128:131], v[32:35]
    v_mfma_f32_16x16x32_bf16 v[28:31], v[200:203], v[124:127], v[28:31]
    ds_read_b128 v[56:59], v145 offset:2048
    ds_read_b128 v[68:71], v145 offset:5120
    v_mfma_f32_16x16x32_bf16 v[24:27], v[200:203], v[120:123], v[24:27]
    ds_read_b128 v[72:75], v145 offset:6144
    ds_read_b128 v[84:87], v145 offset:9216
    v_mfma_f32_16x16x32_bf16 v[36:39], v[204:207], v[156:159], v[36:39]
    v_mfma_f32_16x16x32_bf16 v[40:43], v[204:207], v[160:163], v[40:43]
    ds_read_b128 v[76:79], v145 offset:7168
    ds_read_b128 v[88:91], v145 offset:10240
    v_mfma_f32_16x16x32_bf16 v[44:47], v[204:207], v[164:167], v[44:47]
    ds_read_b128 v[80:83], v145 offset:8192
    ds_read_b128 v[92:95], v145 offset:11264
    v_mfma_f32_16x16x32_bf16 v[44:47], v[208:211], v[128:131], v[44:47]
    v_mfma_f32_16x16x32_bf16 v[40:43], v[208:211], v[124:127], v[40:43]
    v_mfma_f32_16x16x32_bf16 v[36:39], v[208:211], v[120:123], v[36:39]
    s_waitcnt vmcnt(0)
    v_cmp_gt_u32 vcc, 5, v148
    s_cbranch_vccz L_polled4_Y
L_poll4_Y:
    buffer_load_dword v148, v149, s[40:43], s60 offen sc1
    s_add_u32 s79, s79, 1
    s_cmp_ge_u32 s79, 0x40000
    s_waitcnt vmcnt(0)
    s_cbranch_scc1 L_polled4_Y
    v_cmp_gt_u32 vcc, 5, v148
    s_cbranch_vccnz L_poll4_Y
L_polled4_Y:
    s_waitcnt lgkmcnt(10)
    v_add_f32 v0, v0, v48
    v_add_f32 v1, v1, v49
    v_add_f32 v2, v2, v50
    v_add_f32 v3, v3, v51
    v_add_f32 v12, v12, v60
    v_add_f32 v13, v13, v61
    v_add_f32 v14, v14, v62
    v_add_f32 v15, v15, v63
    v_cvt_pk_bf16_f32 v48, v0, v1
    v_cvt_pk_bf16_f32 v49, v2, v3
    v_cvt_pk_bf16_f32 v50, v12, v13
    v_cvt_pk_bf16_f32 v51, v14, v15
    s_add_u32 s20, s57, 0
    v_permlane16_swap_b32 v48, v50
    v_permlane16_swap_b32 v49, v51
    s_cmp_eq_u32 s61, 0
    s_cbranch_scc1 L_ps0_Y_s
    buffer_store_dwordx4 v[48:51], v248, s[40:43], s20 offen offset:0
    s_branch L_ps0_Y_e
L_ps0_Y_s:
    buffer_store_dwordx4 v[48:51], v248, s[40:43], s20 offen offset:0 sc1
L_ps0_Y_e:
    s_waitcnt lgkmcnt(8)
    v_add_f32 v4, v4, v52
    v_add_f32 v5, v5, v53
    v_add_f32 v6, v6, v54
    v_add_f32 v7, v7, v55
    v_add_f32 v16, v16, v64
    v_add_f32 v17, v17, v65
    v_add_f32 v18, v18, v66
    v_add_f32 v19, v19, v67
    v_cvt_pk_bf16_f32 v52, v4, v5
    v_cvt_pk_bf16_f32 v53, v6, v7
    v_cvt_pk_bf16_f32 v54, v16, v17
    v_cvt_pk_bf16_f32 v55, v18, v19
    s_add_u32 s20, s57, 2048
    v_permlane16_swap_b32 v52, v54
    v_permlane16_swap_b32 v53, v55
    s_cmp_eq_u32 s61, 0
    s_cbranch_scc1 L_ps1_Y_s
    buffer_store_dwordx4 v[52:55], v248, s[40:43], s20 offen offset:0
    s_branch L_ps1_Y_e
L_ps1_Y_s:
    buffer_store_dwordx4 v[52:55], v248, s[40:43], s20 offen offset:0 sc1
L_ps1_Y_e:
    s_waitcnt lgkmcnt(6)
    v_add_f32 v8, v8, v56
    v_add_f32 v9, v9, v57
    v_add_f32 v10, v10, v58
    v_add_f32 v11, v11, v59
    v_add_f32 v20, v20, v68
    v_add_f32 v21, v21, v69
    v_add_f32 v22, v22, v70
    v_add_f32 v23, v23, v71
    v_cvt_pk_bf16_f32 v56, v8, v9
    v_cvt_pk_bf16_f32 v57, v10, v11
    v_cvt_pk_bf16_f32 v58, v20, v21
    v_cvt_pk_bf16_f32 v59, v22, v23
    s_add_u32 s20, s57, 4096
    v_permlane16_swap_b32 v56, v58
    v_permlane16_swap_b32 v57, v59
    s_cmp_eq_u32 s61, 0
    s_cbranch_scc1 L_ps2_Y_s
    buffer_store_dwordx4 v[56:59], v248, s[40:43], s20 offen offset:0
    s_branch L_ps2_Y_e
L_ps2_Y_s:
    buffer_store_dwordx4 v[56:59], v248, s[40:43], s20 offen offset:0 sc1
L_ps2_Y_e:
    s_waitcnt lgkmcnt(4)
    v_add_f32 v24, v24, v72
    v_add_f32 v25, v25, v73
    v_add_f32 v26, v26, v74
    v_add_f32 v27, v27, v75
    v_add_f32 v36, v36, v84
    v_add_f32 v37, v37, v85
    v_add_f32 v38, v38, v86
    v_add_f32 v39, v39, v87
    v_cvt_pk_bf16_f32 v72, v24, v25
    v_cvt_pk_bf16_f32 v73, v26, v27
    v_cvt_pk_bf16_f32 v74, v36, v37
    v_cvt_pk_bf16_f32 v75, v38, v39
    s_add_u32 s20, s57, 0
    v_permlane16_swap_b32 v72, v74
    v_permlane16_swap_b32 v73, v75
    s_cmp_eq_u32 s61, 0
    s_cbranch_scc1 L_ps3_Y_s
    buffer_store_dwordx4 v[72:75], v248, s[40:43], s20 offen offset:1024
    s_branch L_ps3_Y_e
L_ps3_Y_s:
    buffer_store_dwordx4 v[72:75], v248, s[40:43], s20 offen offset:1024 sc1
L_ps3_Y_e:
    s_waitcnt lgkmcnt(2)
    v_add_f32 v28, v28, v76
    v_add_f32 v29, v29, v77
    v_add_f32 v30, v30, v78
    v_add_f32 v31, v31, v79
    v_add_f32 v40, v40, v88
    v_add_f32 v41, v41, v89
    v_add_f32 v42, v42, v90
    v_add_f32 v43, v43, v91
    v_cvt_pk_bf16_f32 v76, v28, v29
    v_cvt_pk_bf16_f32 v77, v30, v31
    v_cvt_pk_bf16_f32 v78, v40, v41
    v_cvt_pk_bf16_f32 v79, v42, v43
    s_add_u32 s20, s57, 2048
    v_permlane16_swap_b32 v76, v78
    v_permlane16_swap_b32 v77, v79
    s_cmp_eq_u32 s61, 0
    s_cbranch_scc1 L_ps4_Y_s
    buffer_store_dwordx4 v[76:79], v248, s[40:43], s20 offen offset:1024
    s_branch L_ps4_Y_e
L_ps4_Y_s:
    buffer_store_dwordx4 v[76:79], v248, s[40:43], s20 offen offset:1024 sc1
L_ps4_Y_e:
    s_waitcnt lgkmcnt(0)
    v_add_f32 v32, v32, v80
    v_add_f32 v33, v33, v81
    v_add_f32 v34, v34, v82
    v_add_f32 v35, v35, v83
    v_add_f32 v44, v44, v92
    v_add_f32 v45, v45, v93
    v_add_f32 v46, v46, v94
    v_add_f32 v47, v47, v95
    v_cvt_pk_bf16_f32 v80, v32, v33
    v_cvt_pk_bf16_f32 v81, v34, v35
    v_cvt_pk_bf16_f32 v82, v44, v45
    v_cvt_pk_bf16_f32 v83, v46, v47
    s_add_u32 s20, s57, 4096
    v_permlane16_swap_b32 v80, v82
    v_permlane16_swap_b32 v81, v83
    s_cmp_eq_u32 s61, 0
    s_cbranch_scc1 L_ps5_Y_s
    buffer_store_dwordx4 v[80:83], v248, s[40:43], s20 offen offset:1024
    s_branch L_ps5_Y_e
L_ps5_Y_s:
    buffer_store_dwordx4 v[80:83], v248, s[40:43], s20 offen offset:1024 sc1
L_ps5_Y_e:
    v_and_b32 v149, 3, v249
    v_lshlrev_b32 v149, 5, v149
    s_and_b32 s20, s2, 0x18
    v_add_u32 v149, s20, v149
    v_and_b32 v144, 15, v249
    v_lshlrev_b32 v144, 11, v144
    v_bfe_u32 v145, v249, 4, 1
    v_lshl_add_u32 v144, v145, 5, v144
    v_lshrrev_b32 v145, 5, v249
    v_lshl_add_u32 v144, v145, 4, v144
    s_mov_b32 s23, 0xffff0000
    s_waitcnt vmcnt(0)
    v_mov_b32 v146, 6
    s_mov_b64 exec, 1
    s_cmp_eq_u32 s61, 0
    s_cbranch_scc1 L_fl5_Y_s
    buffer_store_dword v146, v250, s[40:43], s72 offen
    s_branch L_fl5_Y_e
L_fl5_Y_s:
    buffer_store_dword v146, v250, s[40:43], s72 offen sc1
L_fl5_Y_e:
    s_mov_b64 exec, -1
    s_cmp_lg_u32 s63, 3
    s_cbranch_scc1 L_own_Y
    s_branch L_done_Y
L_own_Y:
L_poll5_Y:
    buffer_load_dword v148, v149, s[40:43], s60 offen sc1
    s_add_u32 s79, s79, 1
    s_cmp_ge_u32 s79, 0x40000
    s_waitcnt vmcnt(0)
    s_cbranch_scc1 L_polled5_Y
    v_cmp_gt_u32 vcc, 6, v148
    s_cbranch_vccnz L_poll5_Y
L_polled5_Y:
    buffer_load_dwordx4 v[0:3], v248, s[40:43], s56 offen offset:0 sc1
    buffer_load_dwordx4 v[4:7], v248, s[40:43], s56 offen offset:1024 sc1
    s_add_u32 s56, s56, 229376
    buffer_load_dwordx4 v[8:11], v248, s[40:43], s56 offen offset:0 sc1
    buffer_load_dwordx4 v[12:15], v248, s[40:43], s56 offen offset:1024 sc1
    s_add_u32 s56, s56, 229376
    buffer_load_dwordx4 v[16:19], v248, s[40:43], s56 offen offset:0 sc1
    buffer_load_dwordx4 v[20:23], v248, s[40:43], s56 offen offset:1024 sc1
    s_add_u32 s56, s56, 229376
    buffer_load_dwordx4 v[24:27], v248, s[40:43], s56 offen offset:0 sc1
    buffer_load_dwordx4 v[28:31], v248, s[40:43], s56 offen offset:1024 sc1
    s_waitcnt vmcnt(6)
    v_lshlrev_b32 v32, 16, v0
    v_and_b32 v33, s23, v0
    v_lshlrev_b32 v34, 16, v1
    v_and_b32 v35, s23, v1
    v_lshlrev_b32 v36, 16, v2
    v_and_b32 v37, s23, v2
    v_lshlrev_b32 v38, 16, v3
    v_and_b32 v39, s23, v3
    v_lshlrev_b32 v40, 16, v4
    v_and_b32 v41, s23, v4
    v_lshlrev_b32 v42, 16, v5
    v_and_b32 v43, s23, v5
    v_lshlrev_b32 v44, 16, v6
    v_and_b32 v45, s23, v6
    v_lshlrev_b32 v46, 16, v7
    v_and_b32 v47, s23, v7
    s_waitcnt vmcnt(4)
    v_lshlrev_b32 v48, 16, v8
    v_and_b32 v49, s23, v8
    v_pk_add_f32 v[32:33], v[32:33], v[48:49]
    v_lshlrev_b32 v48, 16, v9
    v_and_b32 v49, s23, v9
    v_pk_add_f32 v[34:35], v[34:35], v[48:49]
    v_lshlrev_b32 v48, 16, v10
    v_and_b32 v49, s23, v10
    v_pk_add_f32 v[36:37], v[36:37], v[48:49]
    v_lshlrev_b32 v48, 16, v11
    v_and_b32 v49, s23, v11
    v_pk_add_f32 v[38:39], v[38:39], v[48:49]
    v_lshlrev_b32 v48, 16, v12
    v_and_b32 v49, s23, v12
    v_pk_add_f32 v[40:41], v[40:41], v[48:49]
    v_lshlrev_b32 v48, 16, v13
    v_and_b32 v49, s23, v13
    v_pk_add_f32 v[42:43], v[42:43], v[48:49]
    v_lshlrev_b32 v48, 16, v14
    v_and_b32 v49, s23, v14
    v_pk_add_f32 v[44:45], v[44:45], v[48:49]
    v_lshlrev_b32 v48, 16, v15
    v_and_b32 v49, s23, v15
    v_pk_add_f32 v[46:47], v[46:47], v[48:49]
    s_waitcnt vmcnt(2)
    v_lshlrev_b32 v48, 16, v16
    v_and_b32 v49, s23, v16
    v_pk_add_f32 v[32:33], v[32:33], v[48:49]
    v_lshlrev_b32 v48, 16, v17
    v_and_b32 v49, s23, v17
    v_pk_add_f32 v[34:35], v[34:35], v[48:49]
    v_lshlrev_b32 v48, 16, v18
    v_and_b32 v49, s23, v18
    v_pk_add_f32 v[36:37], v[36:37], v[48:49]
    v_lshlrev_b32 v48, 16, v19
    v_and_b32 v49, s23, v19
    v_pk_add_f32 v[38:39], v[38:39], v[48:49]
    v_lshlrev_b32 v48, 16, v20
    v_and_b32 v49, s23, v20
    v_pk_add_f32 v[40:41], v[40:41], v[48:49]
    v_lshlrev_b32 v48, 16, v21
    v_and_b32 v49, s23, v21
    v_pk_add_f32 v[42:43], v[42:43], v[48:49]
    v_lshlrev_b32 v48, 16, v22
    v_and_b32 v49, s23, v22
    v_pk_add_f32 v[44:45], v[44:45], v[48:49]
    v_lshlrev_b32 v48, 16, v23
    v_and_b32 v49, s23, v23
    v_pk_add_f32 v[46:47], v[46:47], v[48:49]
    s_waitcnt vmcnt(0)
    v_lshlrev_b32 v48, 16, v24
    v_and_b32 v49, s23, v24
    v_pk_add_f32 v[32:33], v[32:33], v[48:49]
    v_lshlrev_b32 v48, 16, v25
    v_and_b32 v49, s23, v25
    v_pk_add_f32 v[34:35], v[34:35], v[48:49]
    v_lshlrev_b32 v48, 16, v26
    v_and_b32 v49, s23, v26
    v_pk_add_f32 v[36:37], v[36:37], v[48:49]
    v_lshlrev_b32 v48, 16, v27
    v_and_b32 v49, s23, v27
    v_pk_add_f32 v[38:39], v[38:39], v[48:49]
    v_lshlrev_b32 v48, 16, v28
    v_and_b32 v49, s23, v28
    v_pk_add_f32 v[40:41], v[40:41], v[48:49]
    v_lshlrev_b32 v48, 16, v29
    v_and_b32 v49, s23, v29
    v_pk_add_f32 v[42:43], v[42:43], v[48:49]
    v_lshlrev_b32 v48, 16, v30
    v_and_b32 v49, s23, v30
    v_pk_add_f32 v[44:45], v[44:45], v[48:49]
    v_lshlrev_b32 v48, 16, v31
    v_and_b32 v49, s23, v31
    v_pk_add_f32 v[46:47], v[46:47], v[48:49]
    v_cvt_pk_bf16_f32 v52, v32, v33
    v_cvt_pk_bf16_f32 v53, v34, v35
    v_cvt_pk_bf16_f32 v54, v36, v37
    v_cvt_pk_bf16_f32 v55, v38, v39
    v_cvt_pk_bf16_f32 v56, v40, v41
    v_cvt_pk_bf16_f32 v57, v42, v43
    v_cvt_pk_bf16_f32 v58, v44, v45
    v_cvt_pk_bf16_f32 v59, v46, v47
    buffer_store_dwordx4 v[52:55], v144, s[12:15], s59 offen offset:0
    buffer_store_dwordx4 v[56:59], v144, s[12:15], s59 offen offset:64
L_done_Y:
    s_endpgm
L_k1_end:
    s_endpgm
CODE_END:
L_slow_X:
    s_waitcnt vmcnt(0) lgkmcnt(0)
    s_mov_b32 s63, 0
    v_add_u32 v253, 81920, v253
    v_add_u32 v254, 81920, v254
    v_mov_b64 v[0:1], 0
    v_mov_b64 v[2:3], 0
    v_mov_b64 v[4:5], 0
    v_mov_b64 v[6:7], 0
    v_mov_b64 v[8:9], 0
    v_mov_b64 v[10:11], 0
    v_mov_b64 v[12:13], 0
    v_mov_b64 v[14:15], 0
    v_mov_b64 v[16:17], 0
    v_mov_b64 v[18:19], 0
    v_mov_b64 v[20:21], 0
    v_mov_b64 v[22:23], 0
    v_mov_b64 v[24:25], 0
    v_mov_b64 v[26:27], 0
    v_mov_b64 v[28:29], 0
    v_mov_b64 v[30:31], 0
    v_mov_b64 v[32:33], 0
    v_mov_b64 v[34:35], 0
    v_mov_b64 v[36:37], 0
    v_mov_b64 v[38:39], 0
    v_mov_b64 v[40:41], 0
    v_mov_b64 v[42:43], 0
    v_mov_b64 v[44:45], 0
    v_mov_b64 v[46:47], 0
    v_mov_b64 v[48:49], 0
    v_mov_b64 v[50:51], 0
    v_mov_b64 v[52:53], 0
    v_mov_b64 v[54:55], 0
    v_mov_b64 v[56:57], 0
    v_mov_b64 v[58:59], 0
    v_mov_b64 v[60:61], 0
    v_mov_b64 v[62:63], 0
    v_mov_b64 v[64:65], 0
    v_mov_b64 v[66:67], 0
    v_mov_b64 v[68:69], 0
    v_mov_b64 v[70:71], 0
    v_mov_b64 v[72:73], 0
    v_mov_b64 v[74:75], 0
    v_mov_b64 v[76:77], 0
    v_mov_b64 v[78:79], 0
    v_mov_b64 v[80:81], 0
    v_mov_b64 v[82:83], 0
    v_mov_b64 v[84:85], 0
    v_mov_b64 v[86:87], 0
    v_mov_b64 v[88:89], 0
    v_mov_b64 v[90:91], 0
    v_mov_b64 v[92:93], 0
    v_mov_b64 v[94:95], 0
    v_mov_b64 v[96:97], 0
    v_mov_b64 v[98:99], 0
    v_mov_b64 v[100:101], 0
    v_mov_b64 v[102:103], 0
    v_mov_b64 v[104:105], 0
    v_mov_b64 v[106:107], 0
    v_mov_b64 v[108:109], 0
    v_mov_b64 v[110:111], 0
    v_mov_b64 v[112:113], 0
    v_mov_b64 v[114:115], 0
    v_mov_b64 v[116:117], 0
    v_mov_b64 v[118:119], 0
    v_mov_b64 v[120:121], 0
    v_mov_b64 v[122:123], 0
    v_mov_b64 v[124:125], 0
    v_mov_b64 v[126:127], 0
    v_mov_b32 v248, 0
    v_mov_b32 v232, 0xff61b1e6
    v_mov_b32 v249, 0
    v_mov_b32 v233, 0xff61b1e6
    v_mov_b32 v250, 0
    v_mov_b32 v234, 0xff61b1e6
    v_mov_b32 v251, 0
    v_mov_b32 v235, 0xff61b1e6
    s_mov_b32 s27, 16
L_slowloop_X:
    s_barrier
    s_waitcnt vmcnt(0)
    s_barrier
    ds_read_b128 v[224:227], v252 offset:0
    s_waitcnt lgkmcnt(0)
    v_mfma_f32_16x16x32_bf16 v[192:195], v[224:227], v[128:131], 0
    v_mfma_f32_16x16x32_bf16 v[200:203], v[224:227], v[132:135], 0
    v_mfma_f32_16x16x32_bf16 v[208:211], v[224:227], v[136:139], 0
    v_mfma_f32_16x16x32_bf16 v[216:219], v[224:227], v[140:143], 0
    ds_read_b128 v[228:231], v252 offset:256
    s_waitcnt lgkmcnt(0)
    v_mfma_f32_16x16x32_bf16 v[192:195], v[228:231], v[144:147], v[192:195]
    v_mfma_f32_16x16x32_bf16 v[200:203], v[228:231], v[148:151], v[200:203]
    v_mfma_f32_16x16x32_bf16 v[208:211], v[228:231], v[152:155], v[208:211]
    v_mfma_f32_16x16x32_bf16 v[216:219], v[228:231], v[156:159], v[216:219]
    ds_read_b128 v[224:227], v252 offset:512
    s_waitcnt lgkmcnt(0)
    v_mfma_f32_16x16x32_bf16 v[192:195], v[224:227], v[160:163], v[192:195]
    v_mfma_f32_16x16x32_bf16 v[200:203], v[224:227], v[164:167], v[200:203]
    v_mfma_f32_16x16x32_bf16 v[208:211], v[224:227], v[168:171], v[208:211]
    v_mfma_f32_16x16x32_bf16 v[216:219], v[224:227], v[172:175], v[216:219]
    ds_read_b128 v[228:231], v252 offset:768
    s_waitcnt lgkmcnt(0)
    v_mfma_f32_16x16x32_bf16 v[192:195], v[228:231], v[176:179], v[192:195]
    v_mfma_f32_16x16x32_bf16 v[200:203], v[228:231], v[180:183], v[200:203]
    v_mfma_f32_16x16x32_bf16 v[208:211], v[228:231], v[184:187], v[208:211]
    v_mfma_f32_16x16x32_bf16 v[216:219], v[228:231], v[188:191], v[216:219]
    ds_read_b128 v[224:227], v252 offset:4096
    s_waitcnt lgkmcnt(0)
    v_mfma_f32_16x16x32_bf16 v[196:199], v[224:227], v[128:131], 0
    v_mfma_f32_16x16x32_bf16 v[204:207], v[224:227], v[132:135], 0
    v_mfma_f32_16x16x32_bf16 v[212:215], v[224:227], v[136:139], 0
    v_mfma_f32_16x16x32_bf16 v[220:223], v[224:227], v[140:143], 0
    ds_read_b128 v[228:231], v252 offset:4352
    s_waitcnt lgkmcnt(0)
    v_mfma_f32_16x16x32_bf16 v[196:199], v[228:231], v[144:147], v[196:199]
    v_mfma_f32_16x16x32_bf16 v[204:207], v[228:231], v[148:151], v[204:207]
    v_mfma_f32_16x16x32_bf16 v[212:215], v[228:231], v[152:155], v[212:215]
    v_mfma_f32_16x16x32_bf16 v[220:223], v[228:231], v[156:159], v[220:223]
    ds_read_b128 v[224:227], v252 offset:4608
    s_waitcnt lgkmcnt(0)
    v_mfma_f32_16x16x32_bf16 v[196:199], v[224:227], v[160:163], v[196:199]
    v_mfma_f32_16x16x32_bf16 v[204:207], v[224:227], v[164:167], v[204:207]
    v_mfma_f32_16x16x32_bf16 v[212:215], v[224:227], v[168:171], v[212:215]
    v_mfma_f32_16x16x32_bf16 v[220:223], v[224:227], v[172:175], v[220:223]
    ds_read_b128 v[228:231], v252 offset:4864
    s_waitcnt lgkmcnt(0)
    v_mfma_f32_16x16x32_bf16 v[196:199], v[228:231], v[176:179], v[196:199]
    v_mfma_f32_16x16x32_bf16 v[204:207], v[228:231], v[180:183], v[204:207]
    v_mfma_f32_16x16x32_bf16 v[212:215], v[228:231], v[184:187], v[212:215]
    v_mfma_f32_16x16x32_bf16 v[220:223], v[228:231], v[188:191], v[220:223]
    v_max3_f32 v236, v192, v193, v194
    s_nop 3
    v_max3_f32 v236, v236, v195, v196
    v_max3_f32 v236, v236, v197, v198
    v_max3_f32 v236, v236, v199, v232
    v_max3_f32 v237, v200, v201, v202
    v_max3_f32 v237, v237, v203, v204
    v_max3_f32 v237, v237, v205, v206
    v_max3_f32 v237, v237, v207, v233
    v_max3_f32 v238, v208, v209, v210
    v_max3_f32 v238, v238, v211, v212
    v_max3_f32 v238, v238, v213, v214
    v_max3_f32 v238, v238, v215, v234
    v_max3_f32 v239, v216, v217, v218
    v_max3_f32 v239, v239, v219, v220
    v_max3_f32 v239, v239, v221, v222
    v_max3_f32 v239, v239, v223, v235
    v_mov_b32 v240, v236
    v_mov_b32 v241, v237
    v_mov_b32 v242, v238
    v_mov_b32 v243, v239
    v_permlane16_swap_b32 v240, v236
    v_permlane16_swap_b32 v241, v237
    v_permlane16_swap_b32 v242, v238
    v_permlane16_swap_b32 v243, v239
    v_max_f32 v236, v236, v240
    v_max_f32 v237, v237, v241
    v_max_f32 v238, v238, v242
    v_max_f32 v239, v239, v243
    v_mov_b32 v240, v236
    v_mov_b32 v241, v237
    v_mov_b32 v242, v238
    v_mov_b32 v243, v239
    v_permlane32_swap_b32 v240, v236
    v_permlane32_swap_b32 v241, v237
    v_permlane32_swap_b32 v242, v238
    v_permlane32_swap_b32 v243, v239
    v_max_f32 v236, v236, v240
    v_max_f32 v237, v237, v241
    v_max_f32 v238, v238, v242
    v_max_f32 v239, v239, v243
    v_sub_f32 v240, v232, v236
    v_exp_f32 v240, v240
    v_mov_b32 v232, v236
    v_sub_f32 v241, v233, v237
    v_exp_f32 v241, v241
    v_mov_b32 v233, v237
    v_sub_f32 v242, v234, v238
    v_exp_f32 v242, v242
    v_mov_b32 v234, v238
    v_sub_f32 v243, v235, v239
    v_exp_f32 v243, v243
    v_mov_b32 v235, v239
    v_mul_f32 v248, v248, v240
    v_mul_f32 v0, v0, v240
    v_mul_f32 v1, v1, v240
    v_mul_f32 v2, v2, v240
    v_mul_f32 v3, v3, v240
    v_mul_f32 v16, v16, v240
    v_mul_f32 v17, v17, v240
    v_mul_f32 v18, v18, v240
    v_mul_f32 v19, v19, v240
    v_mul_f32 v32, v32, v240
    v_mul_f32 v33, v33, v240
    v_mul_f32 v34, v34, v240
    v_mul_f32 v35, v35, v240
    v_mul_f32 v48, v48, v240
    v_mul_f32 v49, v49, v240
    v_mul_f32 v50, v50, v240
    v_mul_f32 v51, v51, v240
    v_mul_f32 v64, v64, v240
    v_mul_f32 v65, v65, v240
    v_mul_f32 v66, v66, v240
    v_mul_f32 v67, v67, v240
    v_mul_f32 v80, v80, v240
    v_mul_f32 v81, v81, v240
    v_mul_f32 v82, v82, v240
    v_mul_f32 v83, v83, v240
    v_mul_f32 v96, v96, v240
    v_mul_f32 v97, v97, v240
    v_mul_f32 v98, v98, v240
    v_mul_f32 v99, v99, v240
    v_mul_f32 v112, v112, v240
    v_mul_f32 v113, v113, v240
    v_mul_f32 v114, v114, v240
    v_mul_f32 v115, v115, v240
    v_sub_f32 v192, v192, v232
    v_sub_f32 v193, v193, v232
    v_sub_f32 v194, v194, v232
    v_sub_f32 v195, v195, v232
    v_sub_f32 v196, v196, v232
    v_sub_f32 v197, v197, v232
    v_sub_f32 v198, v198, v232
    v_sub_f32 v199, v199, v232
    v_mul_f32 v249, v249, v241
    v_mul_f32 v4, v4, v241
    v_mul_f32 v5, v5, v241
    v_mul_f32 v6, v6, v241
    v_mul_f32 v7, v7, v241
    v_mul_f32 v20, v20, v241
    v_mul_f32 v21, v21, v241
    v_mul_f32 v22, v22, v241
    v_mul_f32 v23, v23, v241
    v_mul_f32 v36, v36, v241
    v_mul_f32 v37, v37, v241
    v_mul_f32 v38, v38, v241
    v_mul_f32 v39, v39, v241
    v_mul_f32 v52, v52, v241
    v_mul_f32 v53, v53, v241
    v_mul_f32 v54, v54, v241
    v_mul_f32 v55, v55, v241
    v_mul_f32 v68, v68, v241
    v_mul_f32 v69, v69, v241
    v_mul_f32 v70, v70, v241
    v_mul_f32 v71, v71, v241
    v_mul_f32 v84, v84, v241
    v_mul_f32 v85, v85, v241
    v_mul_f32 v86, v86, v241
    v_mul_f32 v87, v87, v241
    v_mul_f32 v100, v100, v241
    v_mul_f32 v101, v101, v241
    v_mul_f32 v102, v102, v241
    v_mul_f32 v103, v103, v241
    v_mul_f32 v116, v116, v241
    v_mul_f32 v117, v117, v241
    v_mul_f32 v118, v118, v241
    v_mul_f32 v119, v119, v241
    v_sub_f32 v200, v200, v233
    v_sub_f32 v201, v201, v233
    v_sub_f32 v202, v202, v233
    v_sub_f32 v203, v203, v233
    v_sub_f32 v204, v204, v233
    v_sub_f32 v205, v205, v233
    v_sub_f32 v206, v206, v233
    v_sub_f32 v207, v207, v233
    v_mul_f32 v250, v250, v242
    v_mul_f32 v8, v8, v242
    v_mul_f32 v9, v9, v242
    v_mul_f32 v10, v10, v242
    v_mul_f32 v11, v11, v242
    v_mul_f32 v24, v24, v242
    v_mul_f32 v25, v25, v242
    v_mul_f32 v26, v26, v242
    v_mul_f32 v27, v27, v242
    v_mul_f32 v40, v40, v242
    v_mul_f32 v41, v41, v242
    v_mul_f32 v42, v42, v242
    v_mul_f32 v43, v43, v242
    v_mul_f32 v56, v56, v242
    v_mul_f32 v57, v57, v242
    v_mul_f32 v58, v58, v242
    v_mul_f32 v59, v59, v242
    v_mul_f32 v72, v72, v242
    v_mul_f32 v73, v73, v242
    v_mul_f32 v74, v74, v242
    v_mul_f32 v75, v75, v242
    v_mul_f32 v88, v88, v242
    v_mul_f32 v89, v89, v242
    v_mul_f32 v90, v90, v242
    v_mul_f32 v91, v91, v242
    v_mul_f32 v104, v104, v242
    v_mul_f32 v105, v105, v242
    v_mul_f32 v106, v106, v242
    v_mul_f32 v107, v107, v242
    v_mul_f32 v120, v120, v242
    v_mul_f32 v121, v121, v242
    v_mul_f32 v122, v122, v242
    v_mul_f32 v123, v123, v242
    v_sub_f32 v208, v208, v234
    v_sub_f32 v209, v209, v234
    v_sub_f32 v210, v210, v234
    v_sub_f32 v211, v211, v234
    v_sub_f32 v212, v212, v234
    v_sub_f32 v213, v213, v234
    v_sub_f32 v214, v214, v234
    v_sub_f32 v215, v215, v234
    v_mul_f32 v251, v251, v243
    v_mul_f32 v12, v12, v243
    v_mul_f32 v13, v13, v243
    v_mul_f32 v14, v14, v243
    v_mul_f32 v15, v15, v243
    v_mul_f32 v28, v28, v243
    v_mul_f32 v29, v29, v243
    v_mul_f32 v30, v30, v243
    v_mul_f32 v31, v31, v243
    v_mul_f32 v44, v44, v243
    v_mul_f32 v45, v45, v243
    v_mul_f32 v46, v46, v243
    v_mul_f32 v47, v47, v243
    v_mul_f32 v60, v60, v243
    v_mul_f32 v61, v61, v243
    v_mul_f32 v62, v62, v243
    v_mul_f32 v63, v63, v243
    v_mul_f32 v76, v76, v243
    v_mul_f32 v77, v77, v243
    v_mul_f32 v78, v78, v243
    v_mul_f32 v79, v79, v243
    v_mul_f32 v92, v92, v243
    v_mul_f32 v93, v93, v243
    v_mul_f32 v94, v94, v243
    v_mul_f32 v95, v95, v243
    v_mul_f32 v108, v108, v243
    v_mul_f32 v109, v109, v243
    v_mul_f32 v110, v110, v243
    v_mul_f32 v111, v111, v243
    v_mul_f32 v124, v124, v243
    v_mul_f32 v125, v125, v243
    v_mul_f32 v126, v126, v243
    v_mul_f32 v127, v127, v243
    v_sub_f32 v216, v216, v235
    v_sub_f32 v217, v217, v235
    v_sub_f32 v218, v218, v235
    v_sub_f32 v219, v219, v235
    v_sub_f32 v220, v220, v235
    v_sub_f32 v221, v221, v235
    v_sub_f32 v222, v222, v235
    v_sub_f32 v223, v223, v235
    v_exp_f32 v192, v192
    v_exp_f32 v193, v193
    v_exp_f32 v194, v194
    v_exp_f32 v195, v195
    v_add_f32 v248, v248, v192
    v_add_f32 v248, v248, v193
    v_add_f32 v248, v248, v194
    v_add_f32 v248, v248, v195
    v_cvt_pk_bf16_f32 v192, v192, v193
    v_cvt_pk_bf16_f32 v193, v194, v195
    v_exp_f32 v200, v200
    v_exp_f32 v201, v201
    v_exp_f32 v202, v202
    v_exp_f32 v203, v203
    v_add_f32 v249, v249, v200
    v_add_f32 v249, v249, v201
    v_add_f32 v249, v249, v202
    v_add_f32 v249, v249, v203
    v_cvt_pk_bf16_f32 v200, v200, v201
    v_cvt_pk_bf16_f32 v201, v202, v203
    v_exp_f32 v208, v208
    v_exp_f32 v209, v209
    v_exp_f32 v210, v210
    v_exp_f32 v211, v211
    v_add_f32 v250, v250, v208
    v_add_f32 v250, v250, v209
    v_add_f32 v250, v250, v210
    v_add_f32 v250, v250, v211
    v_cvt_pk_bf16_f32 v208, v208, v209
    v_cvt_pk_bf16_f32 v209, v210, v211
    v_exp_f32 v216, v216
    v_exp_f32 v217, v217
    v_exp_f32 v218, v218
    v_exp_f32 v219, v219
    v_add_f32 v251, v251, v216
    v_add_f32 v251, v251, v217
    v_add_f32 v251, v251, v218
    v_add_f32 v251, v251, v219
    v_cvt_pk_bf16_f32 v216, v216, v217
    v_cvt_pk_bf16_f32 v217, v218, v219
    v_exp_f32 v196, v196
    v_exp_f32 v197, v197
    v_exp_f32 v198, v198
    v_exp_f32 v199, v199
    v_add_f32 v248, v248, v196
    v_add_f32 v248, v248, v197
    v_add_f32 v248, v248, v198
    v_add_f32 v248, v248, v199
    v_cvt_pk_bf16_f32 v194, v196, v197
    v_cvt_pk_bf16_f32 v195, v198, v199
    v_exp_f32 v204, v204
    v_exp_f32 v205, v205
    v_exp_f32 v206, v206
    v_exp_f32 v207, v207
    v_add_f32 v249, v249, v204
    v_add_f32 v249, v249, v205
    v_add_f32 v249, v249, v206
    v_add_f32 v249, v249, v207
    v_cvt_pk_bf16_f32 v202, v204, v205
    v_cvt_pk_bf16_f32 v203, v206, v207
    v_exp_f32 v212, v212
    v_exp_f32 v213, v213
    v_exp_f32 v214, v214
    v_exp_f32 v215, v215
    v_add_f32 v250, v250, v212
    v_add_f32 v250, v250, v213
    v_add_f32 v250, v250, v214
    v_add_f32 v250, v250, v215
    v_cvt_pk_bf16_f32 v210, v212, v213
    v_cvt_pk_bf16_f32 v211, v214, v215
    v_exp_f32 v220, v220
    v_exp_f32 v221, v221
    v_exp_f32 v222, v222
    v_exp_f32 v223, v223
    v_add_f32 v251, v251, v220
    v_add_f32 v251, v251, v221
    v_add_f32 v251, v251, v222
    v_add_f32 v251, v251, v223
    v_cvt_pk_bf16_f32 v218, v220, v221
    v_cvt_pk_bf16_f32 v219, v222, v223
    ds_read_b64_tr_b16 v[224:225], v253 offset:0
    ds_read_b64_tr_b16 v[226:227], v253 offset:4096
    s_waitcnt lgkmcnt(0)
    v_mfma_f32_16x16x32_bf16 v[0:3], v[224:227], v[192:195], v[0:3]
    v_mfma_f32_16x16x32_bf16 v[4:7], v[224:227], v[200:203], v[4:7]
    v_mfma_f32_16x16x32_bf16 v[8:11], v[224:227], v[208:211], v[8:11]
    v_mfma_f32_16x16x32_bf16 v[12:15], v[224:227], v[216:219], v[12:15]
    ds_read_b64_tr_b16 v[228:229], v254 offset:0
    ds_read_b64_tr_b16 v[230:231], v254 offset:4096
    s_waitcnt lgkmcnt(0)
    v_mfma_f32_16x16x32_bf16 v[16:19], v[228:231], v[192:195], v[16:19]
    v_mfma_f32_16x16x32_bf16 v[20:23], v[228:231], v[200:203], v[20:23]
    v_mfma_f32_16x16x32_bf16 v[24:27], v[228:231], v[208:211], v[24:27]
    v_mfma_f32_16x16x32_bf16 v[28:31], v[228:231], v[216:219], v[28:31]
    ds_read_b64_tr_b16 v[224:225], v253 offset:256
    ds_read_b64_tr_b16 v[226:227], v253 offset:4352
    s_waitcnt lgkmcnt(0)
    v_mfma_f32_16x16x32_bf16 v[32:35], v[224:227], v[192:195], v[32:35]
    v_mfma_f32_16x16x32_bf16 v[36:39], v[224:227], v[200:203], v[36:39]
    v_mfma_f32_16x16x32_bf16 v[40:43], v[224:227], v[208:211], v[40:43]
    v_mfma_f32_16x16x32_bf16 v[44:47], v[224:227], v[216:219], v[44:47]
    ds_read_b64_tr_b16 v[228:229], v254 offset:256
    ds_read_b64_tr_b16 v[230:231], v254 offset:4352
    s_waitcnt lgkmcnt(0)
    v_mfma_f32_16x16x32_bf16 v[48:51], v[228:231], v[192:195], v[48:51]
    v_mfma_f32_16x16x32_bf16 v[52:55], v[228:231], v[200:203], v[52:55]
    v_mfma_f32_16x16x32_bf16 v[56:59], v[228:231], v[208:211], v[56:59]
    v_mfma_f32_16x16x32_bf16 v[60:63], v[228:231], v[216:219], v[60:63]
    ds_read_b64_tr_b16 v[224:225], v253 offset:512
    ds_read_b64_tr_b16 v[226:227], v253 offset:4608
    s_waitcnt lgkmcnt(0)
    v_mfma_f32_16x16x32_bf16 v[64:67], v[224:227], v[192:195], v[64:67]
    v_mfma_f32_16x16x32_bf16 v[68:71], v[224:227], v[200:203], v[68:71]
    v_mfma_f32_16x16x32_bf16 v[72:75], v[224:227], v[208:211], v[72:75]
    v_mfma_f32_16x16x32_bf16 v[76:79], v[224:227], v[216:219], v[76:79]
    ds_read_b64_tr_b16 v[228:229], v254 offset:512
    ds_read_b64_tr_b16 v[230:231], v254 offset:4608
    s_waitcnt lgkmcnt(0)
    v_mfma_f32_16x16x32_bf16 v[80:83], v[228:231], v[192:195], v[80:83]
    v_mfma_f32_16x16x32_bf16 v[84:87], v[228:231], v[200:203], v[84:87]
    v_mfma_f32_16x16x32_bf16 v[88:91], v[228:231], v[208:211], v[88:91]
    v_mfma_f32_16x16x32_bf16 v[92:95], v[228:231], v[216:219], v[92:95]
    ds_read_b64_tr_b16 v[224:225], v253 offset:768
    ds_read_b64_tr_b16 v[226:227], v253 offset:4864
    s_waitcnt lgkmcnt(0)
    v_mfma_f32_16x16x32_bf16 v[96:99], v[224:227], v[192:195], v[96:99]
    v_mfma_f32_16x16x32_bf16 v[100:103], v[224:227], v[200:203], v[100:103]
    v_mfma_f32_16x16x32_bf16 v[104:107], v[224:227], v[208:211], v[104:107]
    v_mfma_f32_16x16x32_bf16 v[108:111], v[224:227], v[216:219], v[108:111]
    ds_read_b64_tr_b16 v[228:229], v254 offset:768
    ds_read_b64_tr_b16 v[230:231], v254 offset:4864
    s_waitcnt lgkmcnt(0)
    v_mfma_f32_16x16x32_bf16 v[112:115], v[228:231], v[192:195], v[112:115]
    v_mfma_f32_16x16x32_bf16 v[116:119], v[228:231], v[200:203], v[116:119]
    v_mfma_f32_16x16x32_bf16 v[120:123], v[228:231], v[208:211], v[120:123]
    v_mfma_f32_16x16x32_bf16 v[124:127], v[228:231], v[216:219], v[124:127]
    s_sub_u32 s27, s27, 1
    s_cmp_lg_u32 s27, 0
    s_cbranch_scc1 L_slowloop_X
    s_nop 7
    s_barrier
    v_subrev_u32 v253, 81920, v253
    v_subrev_u32 v254, 81920, v254
    s_mov_b32 s27, 1
    s_waitcnt vmcnt(0)
    s_branch L_post_X
L_slow_Y:
    s_waitcnt vmcnt(0) lgkmcnt(0)
    s_xor_b32 s63, s62, 1
    v_add_u32 v253, 81920, v253
    v_add_u32 v254, 81920, v254
    v_mov_b64 v[0:1], 0
    v_mov_b64 v[2:3], 0
    v_mov_b64 v[4:5], 0
    v_mov_b64 v[6:7], 0
    v_mov_b64 v[8:9], 0
    v_mov_b64 v[10:11], 0
    v_mov_b64 v[12:13], 0
    v_mov_b64 v[14:15], 0
    v_mov_b64 v[16:17], 0
    v_mov_b64 v[18:19], 0
    v_mov_b64 v[20:21], 0
    v_mov_b64 v[22:23], 0
    v_mov_b64 v[24:25], 0
    v_mov_b64 v[26:27], 0
    v_mov_b64 v[28:29], 0
    v_mov_b64 v[30:31], 0
    v_mov_b64 v[32:33], 0
    v_mov_b64 v[34:35], 0
    v_mov_b64 v[36:37], 0
    v_mov_b64 v[38:39], 0
    v_mov_b64 v[40:41], 0
    v_mov_b64 v[42:43], 0
    v_mov_b64 v[44:45], 0
    v_mov_b64 v[46:47], 0
    v_mov_b64 v[48:49], 0
    v_mov_b64 v[50:51], 0
    v_mov_b64 v[52:53], 0
    v_mov_b64 v[54:55], 0
    v_mov_b64 v[56:57], 0
    v_mov_b64 v[58:59], 0
    v_mov_b64 v[60:61], 0
    v_mov_b64 v[62:63], 0
    v_mov_b64 v[64:65], 0
    v_mov_b64 v[66:67], 0
    v_mov_b64 v[68:69], 0
    v_mov_b64 v[70:71], 0
    v_mov_b64 v[72:73], 0
    v_mov_b64 v[74:75], 0
    v_mov_b64 v[76:77], 0
    v_mov_b64 v[78:79], 0
    v_mov_b64 v[80:81], 0
    v_mov_b64 v[82:83], 0
    v_mov_b64 v[84:85], 0
    v_mov_b64 v[86:87], 0
    v_mov_b64 v[88:89], 0
    v_mov_b64 v[90:91], 0
    v_mov_b64 v[92:93], 0
    v_mov_b64 v[94:95], 0
    v_mov_b32 v248, 0
    v_mov_b32 v176, 0xff61b1e6
    v_mov_b32 v249, 0
    v_mov_b32 v177, 0xff61b1e6
    v_mov_b32 v250, 0
    v_mov_b32 v178, 0xff61b1e6
    s_mov_b32 s26, s73
    s_mov_b32 s39, s74
    s_mov_b32 s24, 0
    s_mov_b32 s25, 0
    s_mov_b32 s27, 16
L_slowloop_Y:
    s_barrier
    s_mov_b32 m0, s26
    s_nop 0
    buffer_load_dwordx4 v255, s[12:15], s24 offen nt lds
    s_mov_b32 m0, s26
    s_nop 0
    buffer_load_dwordx4 v255, s[12:15], s24 offen offset:1024 nt lds
    s_add_u32 m0, s26, 4096
    s_add_u32 s24, s24, 4096
    buffer_load_dwordx4 v255, s[12:15], s24 offen nt lds
    s_add_u32 m0, s26, 4096
    s_nop 0
    buffer_load_dwordx4 v255, s[12:15], s24 offen offset:1024 nt lds
    s_add_u32 s24, s24, 4096
    s_and_b32 s24, s24, 0x1ffff
    s_mov_b32 m0, s39
    s_nop 0
    buffer_load_dwordx4 v251, s[16:19], s25 offen nt lds
    s_mov_b32 m0, s39
    s_nop 0
    buffer_load_dwordx4 v251, s[16:19], s25 offen offset:2048 nt lds
    s_add_u32 m0, s39, 4096
    s_add_u32 s25, s25, 4096
    buffer_load_dwordx4 v251, s[16:19], s25 offen nt lds
    s_add_u32 m0, s39, 4096
    s_nop 0
    buffer_load_dwordx4 v251, s[16:19], s25 offen offset:2048 nt lds
    s_add_u32 s25, s25, 4096
    s_and_b32 s25, s25, 0x1ffff
    s_waitcnt vmcnt(0)
    s_barrier
    ds_read_b128 v[168:171], v252 offset:0
    s_waitcnt lgkmcnt(0)
    v_mfma_f32_16x16x32_bf16 v[144:147], v[168:171], v[96:99], 0
    v_mfma_f32_16x16x32_bf16 v[152:155], v[168:171], v[100:103], 0
    v_mfma_f32_16x16x32_bf16 v[160:163], v[168:171], v[104:107], 0
    ds_read_b128 v[172:175], v252 offset:256
    s_waitcnt lgkmcnt(0)
    v_mfma_f32_16x16x32_bf16 v[144:147], v[172:175], v[108:111], v[144:147]
    v_mfma_f32_16x16x32_bf16 v[152:155], v[172:175], v[112:115], v[152:155]
    v_mfma_f32_16x16x32_bf16 v[160:163], v[172:175], v[116:119], v[160:163]
    ds_read_b128 v[168:171], v252 offset:512
    s_waitcnt lgkmcnt(0)
    v_mfma_f32_16x16x32_bf16 v[144:147], v[168:171], v[120:123], v[144:147]
    v_mfma_f32_16x16x32_bf16 v[152:155], v[168:171], v[124:127], v[152:155]
    v_mfma_f32_16x16x32_bf16 v[160:163], v[168:171], v[128:131], v[160:163]
    ds_read_b128 v[172:175], v252 offset:768
    s_waitcnt lgkmcnt(0)
    v_mfma_f32_16x16x32_bf16 v[144:147], v[172:175], v[132:135], v[144:147]
    v_mfma_f32_16x16x32_bf16 v[152:155], v[172:175], v[136:139], v[152:155]
    v_mfma_f32_16x16x32_bf16 v[160:163], v[172:175], v[140:143], v[160:163]
    ds_read_b128 v[168:171], v252 offset:4096
    s_waitcnt lgkmcnt(0)
    v_mfma_f32_16x16x32_bf16 v[148:151], v[168:171], v[96:99], 0
    v_mfma_f32_16x16x32_bf16 v[156:159], v[168:171], v[100:103], 0
    v_mfma_f32_16x16x32_bf16 v[164:167], v[168:171], v[104:107], 0
    ds_read_b128 v[172:175], v252 offset:4352
    s_waitcnt lgkmcnt(0)
    v_mfma_f32_16x16x32_bf16 v[148:151], v[172:175], v[108:111], v[148:151]
    v_mfma_f32_16x16x32_bf16 v[156:159], v[172:175], v[112:115], v[156:159]
    v_mfma_f32_16x16x32_bf16 v[164:167], v[172:175], v[116:119], v[164:167]
    ds_read_b128 v[168:171], v252 offset:4608
    s_waitcnt lgkmcnt(0)
    v_mfma_f32_16x16x32_bf16 v[148:151], v[168:171], v[120:123], v[148:151]
    v_mfma_f32_16x16x32_bf16 v[156:159], v[168:171], v[124:127], v[156:159]
    v_mfma_f32_16x16x32_bf16 v[164:167], v[168:171], v[128:131], v[164:167]
    ds_read_b128 v[172:175], v252 offset:4864
    s_waitcnt lgkmcnt(0)
    v_mfma_f32_16x16x32_bf16 v[148:151], v[172:175], v[132:135], v[148:151]
    v_mfma_f32_16x16x32_bf16 v[156:159], v[172:175], v[136:139], v[156:159]
    v_mfma_f32_16x16x32_bf16 v[164:167], v[172:175], v[140:143], v[164:167]
    v_max3_f32 v180, v144, v145, v146
    s_nop 4
    v_max3_f32 v180, v180, v147, v148
    v_max3_f32 v180, v180, v149, v150
    v_max3_f32 v180, v180, v151, v176
    v_max3_f32 v181, v152, v153, v154
    v_max3_f32 v181, v181, v155, v156
    v_max3_f32 v181, v181, v157, v158
    v_max3_f32 v181, v181, v159, v177
    v_max3_f32 v182, v160, v161, v162
    v_max3_f32 v182, v182, v163, v164
    v_max3_f32 v182, v182, v165, v166
    v_max3_f32 v182, v182, v167, v178
    v_mov_b32 v184, v180
    v_mov_b32 v185, v181
    v_mov_b32 v186, v182
    v_permlane16_swap_b32 v184, v180
    v_permlane16_swap_b32 v185, v181
    v_permlane16_swap_b32 v186, v182
    v_max_f32 v180, v180, v184
    v_max_f32 v181, v181, v185
    v_max_f32 v182, v182, v186
    v_mov_b32 v184, v180
    v_mov_b32 v185, v181
    v_mov_b32 v186, v182
    v_permlane32_swap_b32 v184, v180
    v_permlane32_swap_b32 v185, v181
    v_permlane32_swap_b32 v186, v182
    v_max_f32 v180, v180, v184
    v_max_f32 v181, v181, v185
    v_max_f32 v182, v182, v186
    v_sub_f32 v184, v176, v180
    v_exp_f32 v184, v184
    v_mov_b32 v176, v180
    v_sub_f32 v185, v177, v181
    v_exp_f32 v185, v185
    v_mov_b32 v177, v181
    v_sub_f32 v186, v178, v182
    v_exp_f32 v186, v186
    v_mov_b32 v178, v182
    v_mul_f32 v248, v248, v184
    v_mul_f32 v0, v0, v184
    v_mul_f32 v1, v1, v184
    v_mul_f32 v2, v2, v184
    v_mul_f32 v3, v3, v184
    v_mul_f32 v12, v12, v184
    v_mul_f32 v13, v13, v184
    v_mul_f32 v14, v14, v184
    v_mul_f32 v15, v15, v184
    v_mul_f32 v24, v24, v184
    v_mul_f32 v25, v25, v184
    v_mul_f32 v26, v26, v184
    v_mul_f32 v27, v27, v184
    v_mul_f32 v36, v36, v184
    v_mul_f32 v37, v37, v184
    v_mul_f32 v38, v38, v184
    v_mul_f32 v39, v39, v184
    v_mul_f32 v48, v48, v184
    v_mul_f32 v49, v49, v184
    v_mul_f32 v50, v50, v184
    v_mul_f32 v51, v51, v184
    v_mul_f32 v60, v60, v184
    v_mul_f32 v61, v61, v184
    v_mul_f32 v62, v62, v184
    v_mul_f32 v63, v63, v184
    v_mul_f32 v72, v72, v184
    v_mul_f32 v73, v73, v184
    v_mul_f32 v74, v74, v184
    v_mul_f32 v75, v75, v184
    v_mul_f32 v84, v84, v184
    v_mul_f32 v85, v85, v184
    v_mul_f32 v86, v86, v184
    v_mul_f32 v87, v87, v184
    v_sub_f32 v144, v144, v176
    v_sub_f32 v145, v145, v176
    v_sub_f32 v146, v146, v176
    v_sub_f32 v147, v147, v176
    v_sub_f32 v148, v148, v176
    v_sub_f32 v149, v149, v176
    v_sub_f32 v150, v150, v176
    v_sub_f32 v151, v151, v176
    v_mul_f32 v249, v249, v185
    v_mul_f32 v4, v4, v185
    v_mul_f32 v5, v5, v185
    v_mul_f32 v6, v6, v185
    v_mul_f32 v7, v7, v185
    v_mul_f32 v16, v16, v185
    v_mul_f32 v17, v17, v185
    v_mul_f32 v18, v18, v185
    v_mul_f32 v19, v19, v185
    v_mul_f32 v28, v28, v185
    v_mul_f32 v29, v29, v185
    v_mul_f32 v30, v30, v185
    v_mul_f32 v31, v31, v185
    v_mul_f32 v40, v40, v185
    v_mul_f32 v41, v41, v185
    v_mul_f32 v42, v42, v185
    v_mul_f32 v43, v43, v185
    v_mul_f32 v52, v52, v185
    v_mul_f32 v53, v53, v185
    v_mul_f32 v54, v54, v185
    v_mul_f32 v55, v55, v185
    v_mul_f32 v64, v64, v185
    v_mul_f32 v65, v65, v185
    v_mul_f32 v66, v66, v185
    v_mul_f32 v67, v67, v185
    v_mul_f32 v76, v76, v185
    v_mul_f32 v77, v77, v185
    v_mul_f32 v78, v78, v185
    v_mul_f32 v79, v79, v185
    v_mul_f32 v88, v88, v185
    v_mul_f32 v89, v89, v185
    v_mul_f32 v90, v90, v185
    v_mul_f32 v91, v91, v185
    v_sub_f32 v152, v152, v177
    v_sub_f32 v153, v153, v177
    v_sub_f32 v154, v154, v177
    v_sub_f32 v155, v155, v177
    v_sub_f32 v156, v156, v177
    v_sub_f32 v157, v157, v177
    v_sub_f32 v158, v158, v177
    v_sub_f32 v159, v159, v177
    v_mul_f32 v250, v250, v186
    v_mul_f32 v8, v8, v186
    v_mul_f32 v9, v9, v186
    v_mul_f32 v10, v10, v186
    v_mul_f32 v11, v11, v186
    v_mul_f32 v20, v20, v186
    v_mul_f32 v21, v21, v186
    v_mul_f32 v22, v22, v186
    v_mul_f32 v23, v23, v186
    v_mul_f32 v32, v32, v186
    v_mul_f32 v33, v33, v186
    v_mul_f32 v34, v34, v186
    v_mul_f32 v35, v35, v186
    v_mul_f32 v44, v44, v186
    v_mul_f32 v45, v45, v186
    v_mul_f32 v46, v46, v186
    v_mul_f32 v47, v47, v186
    v_mul_f32 v56, v56, v186
    v_mul_f32 v57, v57, v186
    v_mul_f32 v58, v58, v186
    v_mul_f32 v59, v59, v186
    v_mul_f32 v68, v68, v186
    v_mul_f32 v69, v69, v186
    v_mul_f32 v70, v70, v186
    v_mul_f32 v71, v71, v186
    v_mul_f32 v80, v80, v186
    v_mul_f32 v81, v81, v186
    v_mul_f32 v82, v82, v186
    v_mul_f32 v83, v83, v186
    v_mul_f32 v92, v92, v186
    v_mul_f32 v93, v93, v186
    v_mul_f32 v94, v94, v186
    v_mul_f32 v95, v95, v186
    v_sub_f32 v160, v160, v178
    v_sub_f32 v161, v161, v178
    v_sub_f32 v162, v162, v178
    v_sub_f32 v163, v163, v178
    v_sub_f32 v164, v164, v178
    v_sub_f32 v165, v165, v178
    v_sub_f32 v166, v166, v178
    v_sub_f32 v167, v167, v178
    v_exp_f32 v144, v144
    v_exp_f32 v145, v145
    v_exp_f32 v146, v146
    v_exp_f32 v147, v147
    v_add_f32 v248, v248, v144
    v_add_f32 v248, v248, v145
    v_add_f32 v248, v248, v146
    v_add_f32 v248, v248, v147
    v_cvt_pk_bf16_f32 v144, v144, v145
    v_cvt_pk_bf16_f32 v145, v146, v147
    v_exp_f32 v152, v152
    v_exp_f32 v153, v153
    v_exp_f32 v154, v154
    v_exp_f32 v155, v155
    v_add_f32 v249, v249, v152
    v_add_f32 v249, v249, v153
    v_add_f32 v249, v249, v154
    v_add_f32 v249, v249, v155
    v_cvt_pk_bf16_f32 v152, v152, v153
    v_cvt_pk_bf16_f32 v153, v154, v155
    v_exp_f32 v160, v160
    v_exp_f32 v161, v161
    v_exp_f32 v162, v162
    v_exp_f32 v163, v163
    v_add_f32 v250, v250, v160
    v_add_f32 v250, v250, v161
    v_add_f32 v250, v250, v162
    v_add_f32 v250, v250, v163
    v_cvt_pk_bf16_f32 v160, v160, v161
    v_cvt_pk_bf16_f32 v161, v162, v163
    v_exp_f32 v148, v148
    v_exp_f32 v149, v149
    v_exp_f32 v150, v150
    v_exp_f32 v151, v151
    v_add_f32 v248, v248, v148
    v_add_f32 v248, v248, v149
    v_add_f32 v248, v248, v150
    v_add_f32 v248, v248, v151
    v_cvt_pk_bf16_f32 v146, v148, v149
    v_cvt_pk_bf16_f32 v147, v150, v151
    v_exp_f32 v156, v156
    v_exp_f32 v157, v157
    v_exp_f32 v158, v158
    v_exp_f32 v159, v159
    v_add_f32 v249, v249, v156
    v_add_f32 v249, v249, v157
    v_add_f32 v249, v249, v158
    v_add_f32 v249, v249, v159
    v_cvt_pk_bf16_f32 v154, v156, v157
    v_cvt_pk_bf16_f32 v155, v158, v159
    v_exp_f32 v164, v164
    v_exp_f32 v165, v165
    v_exp_f32 v166, v166
    v_exp_f32 v167, v167
    v_add_f32 v250, v250, v164
    v_add_f32 v250, v250, v165
    v_add_f32 v250, v250, v166
    v_add_f32 v250, v250, v167
    v_cvt_pk_bf16_f32 v162, v164, v165
    v_cvt_pk_bf16_f32 v163, v166, v167
    ds_read_b64_tr_b16 v[168:169], v253 offset:0
    ds_read_b64_tr_b16 v[170:171], v253 offset:4096
    s_waitcnt lgkmcnt(0)
    v_mfma_f32_16x16x32_bf16 v[0:3], v[168:171], v[144:147], v[0:3]
    v_mfma_f32_16x16x32_bf16 v[4:7], v[168:171], v[152:155], v[4:7]
    v_mfma_f32_16x16x32_bf16 v[8:11], v[168:171], v[160:163], v[8:11]
    ds_read_b64_tr_b16 v[172:173], v254 offset:0
    ds_read_b64_tr_b16 v[174:175], v254 offset:4096
    s_waitcnt lgkmcnt(0)
    v_mfma_f32_16x16x32_bf16 v[12:15], v[172:175], v[144:147], v[12:15]
    v_mfma_f32_16x16x32_bf16 v[16:19], v[172:175], v[152:155], v[16:19]
    v_mfma_f32_16x16x32_bf16 v[20:23], v[172:175], v[160:163], v[20:23]
    ds_read_b64_tr_b16 v[168:169], v253 offset:256
    ds_read_b64_tr_b16 v[170:171], v253 offset:4352
    s_waitcnt lgkmcnt(0)
    v_mfma_f32_16x16x32_bf16 v[24:27], v[168:171], v[144:147], v[24:27]
    v_mfma_f32_16x16x32_bf16 v[28:31], v[168:171], v[152:155], v[28:31]
    v_mfma_f32_16x16x32_bf16 v[32:35], v[168:171], v[160:163], v[32:35]
    ds_read_b64_tr_b16 v[172:173], v254 offset:256
    ds_read_b64_tr_b16 v[174:175], v254 offset:4352
    s_waitcnt lgkmcnt(0)
    v_mfma_f32_16x16x32_bf16 v[36:39], v[172:175], v[144:147], v[36:39]
    v_mfma_f32_16x16x32_bf16 v[40:43], v[172:175], v[152:155], v[40:43]
    v_mfma_f32_16x16x32_bf16 v[44:47], v[172:175], v[160:163], v[44:47]
    ds_read_b64_tr_b16 v[168:169], v253 offset:512
    ds_read_b64_tr_b16 v[170:171], v253 offset:4608
    s_waitcnt lgkmcnt(0)
    v_mfma_f32_16x16x32_bf16 v[48:51], v[168:171], v[144:147], v[48:51]
    v_mfma_f32_16x16x32_bf16 v[52:55], v[168:171], v[152:155], v[52:55]
    v_mfma_f32_16x16x32_bf16 v[56:59], v[168:171], v[160:163], v[56:59]
    ds_read_b64_tr_b16 v[172:173], v254 offset:512
    ds_read_b64_tr_b16 v[174:175], v254 offset:4608
    s_waitcnt lgkmcnt(0)
    v_mfma_f32_16x16x32_bf16 v[60:63], v[172:175], v[144:147], v[60:63]
    v_mfma_f32_16x16x32_bf16 v[64:67], v[172:175], v[152:155], v[64:67]
    v_mfma_f32_16x16x32_bf16 v[68:71], v[172:175], v[160:163], v[68:71]
    ds_read_b64_tr_b16 v[168:169], v253 offset:768
    ds_read_b64_tr_b16 v[170:171], v253 offset:4864
    s_waitcnt lgkmcnt(0)
    v_mfma_f32_16x16x32_bf16 v[72:75], v[168:171], v[144:147], v[72:75]
    v_mfma_f32_16x16x32_bf16 v[76:79], v[168:171], v[152:155], v[76:79]
    v_mfma_f32_16x16x32_bf16 v[80:83], v[168:171], v[160:163], v[80:83]
    ds_read_b64_tr_b16 v[172:173], v254 offset:768
    ds_read_b64_tr_b16 v[174:175], v254 offset:4864
    s_waitcnt lgkmcnt(0)
    v_mfma_f32_16x16x32_bf16 v[84:87], v[172:175], v[144:147], v[84:87]
    v_mfma_f32_16x16x32_bf16 v[88:91], v[172:175], v[152:155], v[88:91]
    v_mfma_f32_16x16x32_bf16 v[92:95], v[172:175], v[160:163], v[92:95]
    s_sub_u32 s27, s27, 1
    s_cmp_lg_u32 s27, 0
    s_cbranch_scc1 L_slowloop_Y
    s_nop 7
    s_barrier
    v_subrev_u32 v253, 81920, v253
    v_subrev_u32 v254, 81920, v254
    s_mov_b32 s27, 1
    s_add_u32 m0, s74, 4294901760
    s_add_u32 s22, s56, 0
    buffer_load_dwordx4 v245, s[4:7], s22 offen lds
    s_add_u32 m0, s74, 4294903808
    s_add_u32 s22, s56, 8192
    buffer_load_dwordx4 v245, s[4:7], s22 offen lds
    s_add_u32 m0, s74, 4294905856
    s_add_u32 s22, s56, 16384
    buffer_load_dwordx4 v245, s[4:7], s22 offen lds
    s_add_u32 m0, s74, 4294907904
    s_add_u32 s22, s56, 24576
    buffer_load_dwordx4 v245, s[4:7], s22 offen lds
    s_add_u32 m0, s74, 4294918144
    s_add_u32 s22, s56, 32768
    buffer_load_dwordx4 v245, s[4:7], s22 offen lds
    s_add_u32 m0, s74, 4294920192
    s_add_u32 s22, s56, 40960
    buffer_load_dwordx4 v245, s[4:7], s22 offen lds
    s_add_u32 m0, s74, 4294922240
    s_add_u32 s22, s56, 49152
    buffer_load_dwordx4 v245, s[4:7], s22 offen lds
    s_add_u32 m0, s74, 4294924288
    s_add_u32 s22, s56, 57344
    buffer_load_dwordx4 v245, s[4:7], s22 offen lds
    s_add_u32 m0, s74, 16384
    s_add_u32 s22, s56, 65536
    buffer_load_dwordx4 v245, s[4:7], s22 offen lds
    s_add_u32 m0, s74, 18432
    s_add_u32 s22, s56, 73728
    buffer_load_dwordx4 v245, s[4:7], s22 offen lds
    s_add_u32 m0, s74, 20480
    s_add_u32 s22, s56, 81920
    buffer_load_dwordx4 v245, s[4:7], s22 offen lds
    s_add_u32 m0, s74, 22528
    s_add_u32 s22, s56, 90112
    buffer_load_dwordx4 v245, s[4:7], s22 offen lds
    s_add_u32 m0, s74, 4294934528
    s_add_u32 s22, s56, 98304
    buffer_load_dwordx4 v245, s[4:7], s22 offen lds
    s_add_u32 m0, s74, 4294936576
    s_add_u32 s22, s56, 106496
    buffer_load_dwordx4 v245, s[4:7], s22 offen lds
    s_add_u32 m0, s74, 4294938624
    s_add_u32 s22, s56, 114688
    buffer_load_dwordx4 v245, s[4:7], s22 offen lds
    s_add_u32 m0, s74, 4294940672
    s_add_u32 s22, s56, 122880
    buffer_load_dwordx4 v245, s[4:7], s22 offen lds
    s_waitcnt vmcnt(0)
    s_branch L_post_Y
.section .rodata,"a"
.p2align 6
.amdhsa_kernel concat_heads__mha_block_cached__gqa_block_cached__near_ridge_kernel
  .amdhsa_next_free_vgpr 256
  .amdhsa_next_free_sgpr 102
  .amdhsa_accum_offset 256
  .amdhsa_group_segment_fixed_size 0
  .amdhsa_kernarg_size 104
  .amdhsa_user_sgpr_count 2
  .amdhsa_user_sgpr_kernarg_segment_ptr 1
  .amdhsa_system_sgpr_workgroup_id_x 1
.end_amdhsa_kernel
```
